```python
import torch

def _softmax(x, axis=-1):
    return torch.softmax(x, dim=axis)
def _gelu(x):
    return torch.nn.functional.gelu(x, approximate="tanh")
def _silu(x):
    return torch.nn.functional.silu(x)
def _sigmoid(x):
    return torch.sigmoid(x)
def _layernorm(x, axis=-1, eps=1e-5):
    m = x.mean(dim=axis, keepdim=True)
    v = x.var(dim=axis, keepdim=True, unbiased=False)
    return (x - m) / torch.sqrt(v + eps)
def _scatter_add(tgt, idx, src, axis=0):
    return tgt.clone().index_add_(axis, idx, src)
def _segment_sum(src, seg, n):
    out = torch.zeros((n,) + src.shape[1:], dtype=src.dtype)
    return out.index_add_(0, seg, src)
def _pad(x, pw):
    flat = tuple(v for pair in reversed(pw) for v in pair)
    return torch.nn.functional.pad(x, flat)

kernel_name = 'concat_heads__gqa_block_cached__gqa_block_cached__near_ridge'

def setup_inputs():

    _w = (lambda a: (lambda t: t.to(torch.bfloat16) if t.is_floating_point() else t)(torch.as_tensor(a)))
    def _A_setup():
        B, Sq, D = 8, 256, 640
        Hq, Hkv, Sk, Dh = 32, 32, 1024, 192
        assert Hq % Hkv == 0, (Hq, Hkv)
        return {
            "x": _w((lambda *s: torch.randn(*s, dtype=torch.bfloat16) * 0.8)(B, Sq, D)),
            "k_cache": _w((lambda *s: torch.randn(*s, dtype=torch.bfloat16) * 0.8)(B, Hkv, Sk, Dh)),
            "v_cache": _w((lambda *s: torch.randn(*s, dtype=torch.bfloat16) * 0.05)(B, Hkv, Sk, Dh)),
            "wq": _w((lambda *s: torch.randn(*s, dtype=torch.bfloat16) * 0.8)(D, Hq * Dh) * (D ** -0.5)),
            "wo": _w((lambda *s: torch.randn(*s, dtype=torch.bfloat16) * 0.05)(Hq * Dh, D) * ((Hq * Dh) ** -0.5)),
        }
    _A_in = _A_setup()

    def _B_setup():
        B, Sq, D = 8, 256, 640
        Hq, Hkv, Sk, Dh = 32, 32, 1024, 192
        assert Hq % Hkv == 0, (Hq, Hkv)
        return {
            "x": _w((lambda *s: torch.randn(*s, dtype=torch.bfloat16) * 0.8)(B, Sq, D)),
            "k_cache": _w((lambda *s: torch.randn(*s, dtype=torch.bfloat16) * 0.8)(B, Hkv, Sk, Dh)),
            "v_cache": _w((lambda *s: torch.randn(*s, dtype=torch.bfloat16) * 0.05)(B, Hkv, Sk, Dh)),
            "wq": _w((lambda *s: torch.randn(*s, dtype=torch.bfloat16) * 0.8)(D, Hq * Dh) * (D ** -0.5)),
            "wo": _w((lambda *s: torch.randn(*s, dtype=torch.bfloat16) * 0.05)(Hq * Dh, D) * ((Hq * Dh) ** -0.5)),
        }
    _B_in = _B_setup()

    return {
        "A_x": _A_in["x"],
        "A_k_cache": _A_in["k_cache"],
        "A_v_cache": _A_in["v_cache"],
        "A_wq": _A_in["wq"],
        "A_wo": _A_in["wo"],
        "B_x": _B_in["x"],
        "B_k_cache": _B_in["k_cache"],
        "B_v_cache": _B_in["v_cache"],
        "B_wq": _B_in["wq"],
        "B_wo": _B_in["wo"],
    }

def reference(A_x, A_k_cache, A_v_cache, A_wq, A_wo, B_x, B_k_cache, B_v_cache, B_wq, B_wo):
    def _A_ref(x, k_cache, v_cache, wq, wo):
        B, Sq, D = x.shape
        Hq, Dh = 32, 192
        Hkv = k_cache.shape[1]
        rep = Hq // Hkv
        q = (lambda x, *d: x.permute(*d))((x @ wq).reshape(B, Sq, Hq, Dh), 0, 2, 1, 3)
        k = (lambda x, n, axis: torch.repeat_interleave(x, n, dim=axis))(k_cache, rep, axis=1)
        v = (lambda x, n, axis: torch.repeat_interleave(x, n, dim=axis))(v_cache, rep, axis=1)
        scores = torch.einsum("bhqd,bhkd->bhqk", q, k) * (Dh ** -0.5)
        p = _softmax(scores, axis=-1)
        o = torch.einsum("bhqk,bhkd->bhqd", p, v)
        return (lambda x, *d: x.permute(*d))(o, 0, 2, 1, 3).reshape(B, Sq, Hq * Dh) @ wo

    def _B_ref(x, k_cache, v_cache, wq, wo):
        B, Sq, D = x.shape
        Hq, Dh = 32, 192
        Hkv = k_cache.shape[1]
        rep = Hq // Hkv
        q = (lambda x, *d: x.permute(*d))((x @ wq).reshape(B, Sq, Hq, Dh), 0, 2, 1, 3)
        k = (lambda x, n, axis: torch.repeat_interleave(x, n, dim=axis))(k_cache, rep, axis=1)
        v = (lambda x, n, axis: torch.repeat_interleave(x, n, dim=axis))(v_cache, rep, axis=1)
        scores = torch.einsum("bhqd,bhkd->bhqk", q, k) * (Dh ** -0.5)
        p = _softmax(scores, axis=-1)
        o = torch.einsum("bhqk,bhkd->bhqd", p, v)
        return (lambda x, *d: x.permute(*d))(o, 0, 2, 1, 3).reshape(B, Sq, Hq * Dh) @ wo

    a = _A_ref(A_x, A_k_cache, A_v_cache, A_wq, A_wo)
    b = _B_ref(B_x, B_k_cache, B_v_cache, B_wq, B_wo)
    return torch.concatenate([a, b], axis=-1)
```

```asm
; @launch kernel=concat_heads__gqa_block_cached__gqa_block_cached__near_ridge_kernel grid=(256,1,1) block=(256,1,1) lds=163840
.amdgcn_target "amdgcn-amd-amdhsa--gfx950"
.text
.globl concat_heads__gqa_block_cached__gqa_block_cached__near_ridge_kernel
.p2align 8
.type concat_heads__gqa_block_cached__gqa_block_cached__near_ridge_kernel,@function
concat_heads__gqa_block_cached__gqa_block_cached__near_ridge_kernel:
  s_cmp_ge_u32 s2, 256
  s_cbranch_scc1 K2_END
  s_load_dwordx16 s[28:43], s[0:1], 0
  s_load_dwordx8 s[44:51], s[0:1], 64
  s_load_dwordx2 s[52:53], s[0:1], 96
  v_and_b32 v101, 63, v0
  v_lshrrev_b32 v102, 6, v0
  s_nop 1
  v_readfirstlane_b32 s54, v102
  s_waitcnt lgkmcnt(0)
  s_mov_b32 s8, s50
  s_mov_b32 s9, s51
  s_mov_b32 s10, 256
  s_mov_b32 s11, 0x00020000
  s_getreg_b32 s60, hwreg(HW_REG_XCC_ID)
  s_and_b32 s60, s60, 7
  s_lshl_b32 s61, s60, 5
  v_mov_b32 v1, 0
  v_mov_b32 v2, 1
  s_cmp_eq_u32 s54, 0
  s_cbranch_scc0 CLI_8_1
  s_mov_b64 exec, 1
  buffer_atomic_add v2, v1, s[8:11], s61 offen sc0 sc1
  s_mov_b64 exec, -1
CLI_8_1:
  v_lshrrev_b32 v104, 4, v101
  v_and_b32 v103, 15, v101
  v_and_b32 v105, 6, v101
  s_mul_i32 s55, s54, 3072
  s_mov_b32 s59, 0x3dd53b95
  v_lshlrev_b32 v28, 4, v101
  v_lshlrev_b32 v45, 7, v101
  v_min_u32 v107, 47, v101
  v_mul_u32_u24 v108, 2731, v107
  v_lshrrev_b32 v108, 16, v108
  v_mul_u32_u24 v108, 9216, v108
  v_lshl_add_u32 v46, v107, 7, v108
  v_mov_b32 v107, 0x7fffff00
  v_cmp_gt_u32 vcc, 16, v101
  s_nop 1
  v_cndmask_b32 v20, v107, v45, vcc
  v_cmp_gt_u32 vcc, 24, v101
  s_nop 1
  v_cndmask_b32 v36, v107, v45, vcc
  v_lshlrev_b32 v44, 2, v102
  v_add_u32 v44, 12288, v44
  s_lshl_b32 s68, s54, 13
  s_add_u32 s75, s68, 98304
  v_mul_u32_u24 v107, 384, v103
  v_lshlrev_b32 v109, 7, v103
  v_add_u32 v109, s75, v109
  v_add_u32 v108, 0, v104
  v_xor_b32 v108, v108, v105
  v_lshl_add_u32 v17, v108, 4, v107
  v_lshl_add_u32 v29, v108, 4, v109
  v_add_u32 v108, 4, v104
  v_xor_b32 v108, v108, v105
  v_lshl_add_u32 v18, v108, 4, v107
  v_lshl_add_u32 v30, v108, 4, v109
  v_bfe_u32 v109, v101, 2, 2
  v_bfe_u32 v110, v101, 1, 1
  v_and_b32 v111, 1, v101
  v_lshlrev_b32 v111, 3, v111
  v_and_b32 v112, 1, v104
  v_lshlrev_b32 v112, 2, v112
  v_and_b32 v113, 2, v109
  v_or_b32 v112, v112, v113
  v_lshl_add_u32 v113, v104, 2, v109
  v_mul_u32_u24 v113, 384, v113
  v_add_u32 v113, v113, v111
  v_lshl_add_u32 v114, v104, 3, v109
  v_mul_u32_u24 v114, 384, v114
  v_add_u32 v114, v114, v111
  v_add_u32 v114, 36864, v114
  v_add_u32 v115, 0, v110
  v_xor_b32 v115, v115, v112
  v_lshl_add_u32 v21, v115, 4, v113
  v_lshl_add_u32 v31, v115, 4, v114
  v_add_u32 v115, 2, v110
  v_xor_b32 v115, v115, v112
  v_lshl_add_u32 v22, v115, 4, v113
  v_lshl_add_u32 v32, v115, 4, v114
  v_add_u32 v115, 4, v110
  v_xor_b32 v115, v115, v112
  v_lshl_add_u32 v23, v115, 4, v113
  v_lshl_add_u32 v33, v115, 4, v114
  v_add_u32 v115, 6, v110
  v_xor_b32 v115, v115, v112
  v_lshl_add_u32 v24, v115, 4, v113
  v_lshl_add_u32 v34, v115, 4, v114
  s_mul_i32 s68, s54, 192
  v_add_u32 v107, s68, v101
  v_mul_u32_u24 v108, 2731, v107
  v_lshrrev_b32 v108, 16, v108
  v_and_b32 v113, 6, v108
  v_lshlrev_b32 v113, 4, v113
  v_lshlrev_b32 v114, 4, v107
  v_xor_b32 v113, v114, v113
  v_subrev_u32 v25, 0, v113
  v_bfe_u32 v113, v108, 3, 1
  v_lshlrev_b32 v113, 2, v113
  v_and_b32 v115, 2, v108
  v_or_b32 v113, v113, v115
  v_lshlrev_b32 v113, 4, v113
  v_xor_b32 v113, v114, v113
  v_mul_u32_u24 v115, 11904, v108
  v_add_u32 v113, v115, v113
  v_subrev_u32 v41, 0, v113
  v_add_u32 v107, s68, v101
  v_add_u32 v107, 64, v107
  v_mul_u32_u24 v108, 2731, v107
  v_lshrrev_b32 v108, 16, v108
  v_and_b32 v113, 6, v108
  v_lshlrev_b32 v113, 4, v113
  v_lshlrev_b32 v114, 4, v107
  v_xor_b32 v113, v114, v113
  v_subrev_u32 v26, 1024, v113
  v_bfe_u32 v113, v108, 3, 1
  v_lshlrev_b32 v113, 2, v113
  v_and_b32 v115, 2, v108
  v_or_b32 v113, v113, v115
  v_lshlrev_b32 v113, 4, v113
  v_xor_b32 v113, v114, v113
  v_mul_u32_u24 v115, 11904, v108
  v_add_u32 v113, v115, v113
  v_subrev_u32 v42, 1024, v113
  v_add_u32 v107, s68, v101
  v_add_u32 v107, 128, v107
  v_mul_u32_u24 v108, 2731, v107
  v_lshrrev_b32 v108, 16, v108
  v_and_b32 v113, 6, v108
  v_lshlrev_b32 v113, 4, v113
  v_lshlrev_b32 v114, 4, v107
  v_xor_b32 v113, v114, v113
  v_subrev_u32 v27, 2048, v113
  v_bfe_u32 v113, v108, 3, 1
  v_lshlrev_b32 v113, 2, v113
  v_and_b32 v115, 2, v108
  v_or_b32 v113, v113, v115
  v_lshlrev_b32 v113, 4, v113
  v_xor_b32 v113, v114, v113
  v_mul_u32_u24 v115, 11904, v108
  v_add_u32 v113, v115, v113
  v_subrev_u32 v43, 2048, v113
  s_mul_i32 s68, s54, 81920
  v_lshrrev_b32 v107, 3, v101
  v_and_b32 v113, 6, v107
  v_add_u32 v107, 0, v107
  v_and_b32 v114, 7, v101
  v_xor_b32 v113, v113, v114
  v_mul_u32_u24 v107, 1280, v107
  v_lshl_add_u32 v107, v113, 4, v107
  v_add_u32 v107, s68, v107
  v_subrev_u32 v9, 0, v107
  v_lshrrev_b32 v107, 3, v101
  v_and_b32 v113, 6, v107
  v_add_u32 v107, 8, v107
  v_and_b32 v114, 7, v101
  v_xor_b32 v113, v113, v114
  v_mul_u32_u24 v107, 1280, v107
  v_lshl_add_u32 v107, v113, 4, v107
  v_add_u32 v107, s68, v107
  v_subrev_u32 v10, 1024, v107
  v_lshrrev_b32 v107, 3, v101
  v_and_b32 v113, 6, v107
  v_add_u32 v107, 16, v107
  v_and_b32 v114, 7, v101
  v_xor_b32 v113, v113, v114
  v_mul_u32_u24 v107, 1280, v107
  v_lshl_add_u32 v107, v113, 4, v107
  v_add_u32 v107, s68, v107
  v_subrev_u32 v11, 2048, v107
  v_lshrrev_b32 v107, 3, v101
  v_and_b32 v113, 6, v107
  v_add_u32 v107, 24, v107
  v_and_b32 v114, 7, v101
  v_xor_b32 v113, v113, v114
  v_mul_u32_u24 v107, 1280, v107
  v_lshl_add_u32 v107, v113, 4, v107
  v_add_u32 v107, s68, v107
  v_subrev_u32 v12, 3072, v107
  v_lshrrev_b32 v107, 3, v101
  v_and_b32 v113, 6, v107
  v_add_u32 v107, 32, v107
  v_and_b32 v114, 7, v101
  v_xor_b32 v113, v113, v114
  v_mul_u32_u24 v107, 1280, v107
  v_lshl_add_u32 v107, v113, 4, v107
  v_add_u32 v107, s68, v107
  v_subrev_u32 v13, 0, v107
  v_lshrrev_b32 v107, 3, v101
  v_and_b32 v113, 6, v107
  v_add_u32 v107, 40, v107
  v_and_b32 v114, 7, v101
  v_xor_b32 v113, v113, v114
  v_mul_u32_u24 v107, 1280, v107
  v_lshl_add_u32 v107, v113, 4, v107
  v_add_u32 v107, s68, v107
  v_subrev_u32 v14, 1024, v107
  v_lshrrev_b32 v107, 3, v101
  v_and_b32 v113, 6, v107
  v_add_u32 v107, 48, v107
  v_and_b32 v114, 7, v101
  v_xor_b32 v113, v113, v114
  v_mul_u32_u24 v107, 1280, v107
  v_lshl_add_u32 v107, v113, 4, v107
  v_add_u32 v107, s68, v107
  v_subrev_u32 v15, 2048, v107
  v_lshrrev_b32 v107, 3, v101
  v_and_b32 v113, 6, v107
  v_add_u32 v107, 56, v107
  v_and_b32 v114, 7, v101
  v_xor_b32 v113, v113, v114
  v_mul_u32_u24 v107, 1280, v107
  v_lshl_add_u32 v107, v113, 4, v107
  v_add_u32 v107, s68, v107
  v_subrev_u32 v16, 3072, v107
  v_accvgpr_write_b32 a240, v29
  v_accvgpr_write_b32 a241, v30
  v_accvgpr_write_b32 a242, v31
  v_accvgpr_write_b32 a243, v32
  v_accvgpr_write_b32 a244, v33
  v_accvgpr_write_b32 a245, v34
  s_waitcnt lgkmcnt(0)
  v_mov_b32 v3, 12288
  s_cmp_lg_u32 s54, 0
  s_cbranch_scc1 K1_CLAIMED
  s_mov_b64 exec, 1
  s_mov_b32 s2, 0
  s_waitcnt vmcnt(0)
  s_branch K1_CHK2
K1_TRY:
  v_mov_b32 v2, 1
  s_lshl_b32 s61, s60, 5
  buffer_atomic_add v2, v1, s[8:11], s61 offen sc0 sc1
  s_waitcnt vmcnt(0)
K1_CHK2:
  v_readfirstlane_b32 s61, v2
  s_nop 3
  s_cmp_lt_u32 s61, 32
  s_cbranch_scc1 K1_GOT
  s_add_u32 s60, s60, 1
  s_and_b32 s60, s60, 7
  s_add_u32 s2, s2, 1
  s_cmp_lt_u32 s2, 8
  s_cbranch_scc1 K1_TRY
K1_GOT:
  s_and_b32 s61, s61, 31
  s_lshl_b32 s61, s61, 3
  s_or_b32 s61, s61, s60
  v_mov_b32 v2, s61
  ds_write_b32 v3, v2
  s_waitcnt lgkmcnt(0)
  s_mov_b64 exec, -1
K1_CLAIMED:
  s_barrier
  ds_read_b32 v2, v3
  s_waitcnt lgkmcnt(0)
  v_readfirstlane_b32 s2, v2
  s_nop 3
  s_and_b32 s2, s2, 255
  s_mov_b32 s24, s52
  s_mov_b32 s25, s53
  s_mov_b32 s26, 439353344
  s_mov_b32 s27, 0x00020000
  s_mov_b32 s4, s52
  s_mov_b32 s5, s53
  s_mov_b32 s6, 0
  s_mov_b32 s7, 0x00020000
  v_min_u32 v107, 15, v101
  v_lshlrev_b32 v107, 2, v107
  v_mov_b32 v108, 0
  s_lshl_b32 s68, s2, 6
  s_add_u32 s68, s68, 54525952
  buffer_store_dword v108, v107, s[24:27], s68 offen sc0 sc1
  s_and_b32 s68, s2, 1
  s_lshl_b32 s68, s68, 2
  s_bfe_u32 s69, s2, 0x20003
  s_or_b32 s57, s68, s69
  s_bfe_u32 s68, s2, 0x20001
  s_lshl_b32 s68, s68, 3
  s_lshr_b32 s69, s2, 5
  s_or_b32 s58, s68, s69
  s_mov_b32 s56, 0
  s_lshl_b32 s68, s57, 5
  s_add_u32 s68, s68, s58
  s_mul_i32 s78, s68, 393216
  s_lshl_b32 s52, s68, 6
  s_add_u32 s52, s52, 55574528
  v_mov_b32 v107, 0
  v_mov_b32 v109, 0
  v_mov_b32 v110, 0
  v_mov_b32 v111, 0
  buffer_store_dwordx4 v[108:111], v107, s[24:27], s52 offen sc0 sc1
  s_add_u32 s69, s52, 16384
  buffer_store_dword v108, v107, s[24:27], s69 offen sc0 sc1
  s_mov_b32 s48, s50
  s_mov_b32 s49, s51
  s_mov_b32 s50, 256
  s_mov_b32 s51, 0x00020000
  s_mul_i32 s70, s57, 327680
  s_mul_i32 s71, s58, 384
  s_mov_b32 s11, 0x00020000
  s_mov_b32 s15, 0x00020000
  s_mov_b32 s19, 0x00020000
  s_mov_b32 s23, 0x00020000
  s_lshl_b32 s68, s57, 4
  s_lshl_b32 s69, s54, 2
  s_add_u32 s68, s68, s69
  s_mul_i32 s72, s68, 196608
  s_mul_i32 s68, s58, 6144
  s_add_u32 s72, s72, s68
  s_mov_b32 s80, s24
  s_mov_b32 s81, s25
  s_mov_b32 s83, 0x00020000
K1_COLD:
  s_cmp_eq_u32 s56, 0
  s_cselect_b32 s8, s28, s38
  s_cselect_b32 s9, s29, s39
  s_mov_b32 s10, 2621440
  s_cselect_b32 s12, s34, s44
  s_cselect_b32 s13, s35, s45
  s_mov_b32 s14, 7864320
  s_cmp_eq_u32 s56, 0
  s_cselect_b32 s16, s30, s40
  s_cselect_b32 s17, s31, s41
  s_mov_b32 s18, 393216
  s_add_u32 s16, s16, s78
  s_addc_u32 s17, s17, 0
  s_add_u32 m0, s55, 49152
  s_add_u32 s73, s71, 0
  buffer_load_dwordx4 v41, s[12:15], s73 offen offset:0 lds
  buffer_load_dwordx4 v42, s[12:15], s73 offen offset:1024 lds
  buffer_load_dwordx4 v43, s[12:15], s73 offen offset:2048 lds
  s_add_u32 m0, s55, 73728
  s_add_u32 s73, s71, 393216
  buffer_load_dwordx4 v41, s[12:15], s73 offen offset:0 lds
  buffer_load_dwordx4 v42, s[12:15], s73 offen offset:1024 lds
  buffer_load_dwordx4 v43, s[12:15], s73 offen offset:2048 lds
  s_add_u32 m0, s55, 61440
  s_add_u32 s73, s71, 786432
  buffer_load_dwordx4 v41, s[12:15], s73 offen offset:0 lds
  buffer_load_dwordx4 v42, s[12:15], s73 offen offset:1024 lds
  buffer_load_dwordx4 v43, s[12:15], s73 offen offset:2048 lds
  s_mov_b32 s6, 0
  s_lshr_b32 s68, s2, 3
  s_lshl_b32 s68, s68, 2
  s_add_u32 s68, s68, s54
  s_and_b32 s69, s2, 1
  s_mul_i32 s69, s69, 1310720
  s_mul_i32 s68, s68, 10240
  s_add_u32 s69, s69, s68
  buffer_load_dword v47, v45, s[8:11], s69 offen
  v_min_u32 v4, 1920, v45
  s_add_u32 s69, s69, 8192
  buffer_load_dword v47, v4, s[8:11], s69 offen
  s_add_u32 m0, s55, 86016
  s_add_u32 s73, s71, 1179648
  buffer_load_dwordx4 v41, s[12:15], s73 offen offset:0 lds
  buffer_load_dwordx4 v42, s[12:15], s73 offen offset:1024 lds
  buffer_load_dwordx4 v43, s[12:15], s73 offen offset:2048 lds
  s_lshr_b32 s68, s2, 3
  s_lshl_b32 s68, s68, 2
  s_add_u32 s68, s68, s54
  s_bfe_u32 s69, s2, 0x20001
  s_mul_i32 s69, s69, 3072
  s_mul_i32 s68, s68, 61440
  s_add_u32 s69, s69, s68
  buffer_load_dword v47, v46, s[12:15], s69 offen
  s_add_u32 s69, s69, 24576
  buffer_load_dword v47, v46, s[12:15], s69 offen
  v_min_u32 v4, 2944, v45
  s_add_u32 s69, s69, 24576
  buffer_load_dword v47, v4, s[12:15], s69 offen
  s_mov_b32 s6, 0
  s_mov_b32 s69, 0
  buffer_load_dword v47, v45, s[4:7], s69 offen
  v_min_u32 v4, 7040, v45
  s_add_u32 s69, s69, 8192
  buffer_load_dword v47, v4, s[4:7], s69 offen
  buffer_load_dword v47, v28, s[4:7], 0 offen
  buffer_load_dword v47, v28, s[4:7], 0 offen
  s_add_u32 m0, s75, 0
  s_add_u32 s74, s70, 0
  buffer_load_dwordx4 v9, s[8:11], s74 offen offset:0 lds
  buffer_load_dwordx4 v10, s[8:11], s74 offen offset:1024 lds
  buffer_load_dwordx4 v11, s[8:11], s74 offen offset:2048 lds
  buffer_load_dwordx4 v12, s[8:11], s74 offen offset:3072 lds
  s_add_u32 m0, s75, 4096
  s_add_u32 s74, s70, 0
  buffer_load_dwordx4 v13, s[8:11], s74 offen offset:0 lds
  buffer_load_dwordx4 v14, s[8:11], s74 offen offset:1024 lds
  buffer_load_dwordx4 v15, s[8:11], s74 offen offset:2048 lds
  buffer_load_dwordx4 v16, s[8:11], s74 offen offset:3072 lds
  s_add_u32 m0, s75, 32768
  s_add_u32 s74, s70, 128
  buffer_load_dwordx4 v9, s[8:11], s74 offen offset:0 lds
  buffer_load_dwordx4 v10, s[8:11], s74 offen offset:1024 lds
  buffer_load_dwordx4 v11, s[8:11], s74 offen offset:2048 lds
  buffer_load_dwordx4 v12, s[8:11], s74 offen offset:3072 lds
  s_add_u32 m0, s75, 36864
  s_add_u32 s74, s70, 128
  buffer_load_dwordx4 v13, s[8:11], s74 offen offset:0 lds
  buffer_load_dwordx4 v14, s[8:11], s74 offen offset:1024 lds
  buffer_load_dwordx4 v15, s[8:11], s74 offen offset:2048 lds
  buffer_load_dwordx4 v16, s[8:11], s74 offen offset:3072 lds
  s_add_u32 m0, s55, 0
  s_mov_b32 s73, 0
  buffer_load_dwordx4 v25, s[16:19], s73 offen offset:0 nt lds
  buffer_load_dwordx4 v26, s[16:19], s73 offen offset:1024 nt lds
  buffer_load_dwordx4 v27, s[16:19], s73 offen offset:2048 nt lds
  s_mov_b32 s82, 0
  s_cmp_eq_u32 s56, 0
  s_cselect_b32 s20, s32, s42
  s_cselect_b32 s21, s33, s43
  s_mov_b32 s22, 393216
  s_add_u32 s20, s20, s78
  s_addc_u32 s21, s21, 0
  s_add_u32 s62, s55, 98304
  s_mov_b32 s63, s55
  s_add_u32 s64, s55, 49152
  s_mov_b32 s66, 0
  s_mov_b32 s60, 61440
  s_mov_b32 s61, 36864
  v_accvgpr_read_b32 v29, a240
  v_accvgpr_read_b32 v30, a241
  v_accvgpr_read_b32 v31, a242
  v_accvgpr_read_b32 v32, a243
  v_accvgpr_read_b32 v33, a244
  v_accvgpr_read_b32 v34, a245
  s_waitcnt vmcnt(11)
  s_barrier
  ds_read_b128 a[0:3], v29 offset:0
  ds_read_b128 a[16:19], v30 offset:0
  ds_read_b128 a[4:7], v29 offset:2048
  ds_read_b128 a[20:23], v30 offset:2048
  ds_read_b128 a[8:11], v29 offset:4096
  ds_read_b128 a[24:27], v30 offset:4096
  ds_read_b128 a[12:15], v29 offset:6144
  ds_read_b128 a[28:31], v30 offset:6144
  ds_read_b64_tr_b16 a[192:193], v31 offset:12288
  ds_read_b64_tr_b16 a[194:195], v31 offset:13824
  ds_read_b64_tr_b16 a[196:197], v32 offset:12288
  ds_read_b64_tr_b16 a[198:199], v32 offset:13824
  ds_read_b64_tr_b16 a[200:201], v33 offset:12288
  ds_read_b64_tr_b16 a[202:203], v33 offset:13824
  ds_read_b64_tr_b16 a[204:205], v34 offset:12288
  ds_read_b64_tr_b16 a[206:207], v34 offset:13824
  ds_read_b64_tr_b16 a[208:209], v31 offset:12416
  ds_read_b64_tr_b16 a[210:211], v31 offset:13952
  s_waitcnt lgkmcnt(10)
  s_waitcnt lgkmcnt(6)
  v_mfma_f32_16x16x32_bf16 v[64:67], a[192:195], a[0:3], 0
  ds_read_b64_tr_b16 a[212:213], v32 offset:12416
  v_mfma_f32_16x16x32_bf16 v[112:115], a[192:195], a[4:7], 0
  ds_read_b64_tr_b16 a[214:215], v32 offset:13952
  v_mfma_f32_16x16x32_bf16 v[160:163], a[192:195], a[8:11], 0
  s_add_u32 m0, s55, 24576
  s_mov_b32 s73, 12288
  buffer_load_dwordx4 v25, s[16:19], s73 offen offset:0 nt lds
  v_mfma_f32_16x16x32_bf16 v[208:211], a[192:195], a[12:15], 0
  v_mfma_f32_16x16x32_bf16 v[68:71], a[196:199], a[0:3], 0
  ds_read_b64_tr_b16 a[216:217], v33 offset:12416
  v_mfma_f32_16x16x32_bf16 v[116:119], a[196:199], a[4:7], 0
  ds_read_b64_tr_b16 a[218:219], v33 offset:13952
  v_mfma_f32_16x16x32_bf16 v[164:167], a[196:199], a[8:11], 0
  buffer_load_dwordx4 v26, s[16:19], s73 offen offset:1024 nt lds
  v_mfma_f32_16x16x32_bf16 v[212:215], a[196:199], a[12:15], 0
  s_waitcnt lgkmcnt(6)
  v_mfma_f32_16x16x32_bf16 v[72:75], a[200:203], a[0:3], 0
  ds_read_b64_tr_b16 a[220:221], v34 offset:12416
  v_mfma_f32_16x16x32_bf16 v[120:123], a[200:203], a[4:7], 0
  ds_read_b64_tr_b16 a[222:223], v34 offset:13952
  v_mfma_f32_16x16x32_bf16 v[168:171], a[200:203], a[8:11], 0
  buffer_load_dwordx4 v27, s[16:19], s73 offen offset:2048 nt lds
  v_mfma_f32_16x16x32_bf16 v[216:219], a[200:203], a[12:15], 0
  v_mfma_f32_16x16x32_bf16 v[76:79], a[204:207], a[0:3], 0
  ds_read_b64_tr_b16 a[224:225], v31 offset:12544
  v_mfma_f32_16x16x32_bf16 v[124:127], a[204:207], a[4:7], 0
  ds_read_b64_tr_b16 a[226:227], v31 offset:14080
  v_mfma_f32_16x16x32_bf16 v[172:175], a[204:207], a[8:11], 0
  s_add_u32 m0, s55, 12288
  s_mov_b32 s73, 0
  buffer_load_dwordx4 v25, s[20:23], s73 offen offset:0 nt lds
  v_mfma_f32_16x16x32_bf16 v[220:223], a[204:207], a[12:15], 0
  s_waitcnt lgkmcnt(6)
  v_mfma_f32_16x16x32_bf16 v[80:83], a[208:211], a[0:3], 0
  ds_read_b64_tr_b16 a[228:229], v32 offset:12544
  v_mfma_f32_16x16x32_bf16 v[128:131], a[208:211], a[4:7], 0
  ds_read_b64_tr_b16 a[230:231], v32 offset:14080
  v_mfma_f32_16x16x32_bf16 v[176:179], a[208:211], a[8:11], 0
  buffer_load_dwordx4 v26, s[20:23], s73 offen offset:1024 nt lds
  v_mfma_f32_16x16x32_bf16 v[224:227], a[208:211], a[12:15], 0
  v_mfma_f32_16x16x32_bf16 v[84:87], a[212:215], a[0:3], 0
  ds_read_b64_tr_b16 a[232:233], v33 offset:12544
  v_mfma_f32_16x16x32_bf16 v[132:135], a[212:215], a[4:7], 0
  ds_read_b64_tr_b16 a[234:235], v33 offset:14080
  v_mfma_f32_16x16x32_bf16 v[180:183], a[212:215], a[8:11], 0
  buffer_load_dwordx4 v27, s[20:23], s73 offen offset:2048 nt lds
  v_mfma_f32_16x16x32_bf16 v[228:231], a[212:215], a[12:15], 0
  s_waitcnt lgkmcnt(6)
  v_mfma_f32_16x16x32_bf16 v[88:91], a[216:219], a[0:3], 0
  ds_read_b64_tr_b16 a[236:237], v34 offset:12544
  v_mfma_f32_16x16x32_bf16 v[136:139], a[216:219], a[4:7], 0
  ds_read_b64_tr_b16 a[238:239], v34 offset:14080
  v_mfma_f32_16x16x32_bf16 v[184:187], a[216:219], a[8:11], 0
  s_add_u32 m0, s75, 0
  s_add_u32 s74, s70, 256
  buffer_load_dwordx4 v9, s[8:11], s74 offen offset:0 lds
  v_mfma_f32_16x16x32_bf16 v[232:235], a[216:219], a[12:15], 0
  s_barrier
  v_mfma_f32_16x16x32_bf16 v[92:95], a[220:223], a[0:3], 0
  ds_read_b64_tr_b16 a[192:193], v31 offset:36864
  v_mfma_f32_16x16x32_bf16 v[140:143], a[220:223], a[4:7], 0
  ds_read_b64_tr_b16 a[194:195], v31 offset:38400
  v_mfma_f32_16x16x32_bf16 v[188:191], a[220:223], a[8:11], 0
  buffer_load_dwordx4 v10, s[8:11], s74 offen offset:1024 lds
  v_mfma_f32_16x16x32_bf16 v[236:239], a[220:223], a[12:15], 0
  s_waitcnt lgkmcnt(6)
  v_mfma_f32_16x16x32_bf16 v[96:99], a[224:227], a[0:3], 0
  ds_read_b64_tr_b16 a[196:197], v32 offset:36864
  v_mfma_f32_16x16x32_bf16 v[144:147], a[224:227], a[4:7], 0
  ds_read_b64_tr_b16 a[198:199], v32 offset:38400
  v_mfma_f32_16x16x32_bf16 v[192:195], a[224:227], a[8:11], 0
  buffer_load_dwordx4 v11, s[8:11], s74 offen offset:2048 lds
  v_mfma_f32_16x16x32_bf16 v[240:243], a[224:227], a[12:15], 0
  v_mfma_f32_16x16x32_bf16 v[100:103], a[228:231], a[0:3], 0
  ds_read_b64_tr_b16 a[200:201], v33 offset:36864
  v_mfma_f32_16x16x32_bf16 v[148:151], a[228:231], a[4:7], 0
  ds_read_b64_tr_b16 a[202:203], v33 offset:38400
  v_mfma_f32_16x16x32_bf16 v[196:199], a[228:231], a[8:11], 0
  buffer_load_dwordx4 v12, s[8:11], s74 offen offset:3072 lds
  v_mfma_f32_16x16x32_bf16 v[244:247], a[228:231], a[12:15], 0
  s_waitcnt lgkmcnt(6)
  v_mfma_f32_16x16x32_bf16 v[104:107], a[232:235], a[0:3], 0
  ds_read_b64_tr_b16 a[204:205], v34 offset:36864
  v_mfma_f32_16x16x32_bf16 v[152:155], a[232:235], a[4:7], 0
  ds_read_b64_tr_b16 a[206:207], v34 offset:38400
  v_mfma_f32_16x16x32_bf16 v[200:203], a[232:235], a[8:11], 0
  s_add_u32 m0, s75, 4096
  s_add_u32 s74, s70, 256
  buffer_load_dwordx4 v13, s[8:11], s74 offen offset:0 lds
  v_mfma_f32_16x16x32_bf16 v[248:251], a[232:235], a[12:15], 0
  v_mfma_f32_16x16x32_bf16 v[108:111], a[236:239], a[0:3], 0
  ds_read_b64_tr_b16 a[208:209], v31 offset:36992
  v_mfma_f32_16x16x32_bf16 v[156:159], a[236:239], a[4:7], 0
  ds_read_b64_tr_b16 a[210:211], v31 offset:38528
  v_mfma_f32_16x16x32_bf16 v[204:207], a[236:239], a[8:11], 0
  buffer_load_dwordx4 v14, s[8:11], s74 offen offset:1024 lds
  v_mfma_f32_16x16x32_bf16 v[252:255], a[236:239], a[12:15], 0
  s_waitcnt lgkmcnt(6)
  v_mfma_f32_16x16x32_bf16 v[64:67], a[192:195], a[16:19], v[64:67]
  ds_read_b64_tr_b16 a[212:213], v32 offset:36992
  v_mfma_f32_16x16x32_bf16 v[112:115], a[192:195], a[20:23], v[112:115]
  ds_read_b64_tr_b16 a[214:215], v32 offset:38528
  v_mfma_f32_16x16x32_bf16 v[160:163], a[192:195], a[24:27], v[160:163]
  buffer_load_dwordx4 v15, s[8:11], s74 offen offset:2048 lds
  v_mfma_f32_16x16x32_bf16 v[208:211], a[192:195], a[28:31], v[208:211]
  v_mfma_f32_16x16x32_bf16 v[68:71], a[196:199], a[16:19], v[68:71]
  ds_read_b64_tr_b16 a[216:217], v33 offset:36992
  v_mfma_f32_16x16x32_bf16 v[116:119], a[196:199], a[20:23], v[116:119]
  ds_read_b64_tr_b16 a[218:219], v33 offset:38528
  v_mfma_f32_16x16x32_bf16 v[164:167], a[196:199], a[24:27], v[164:167]
  buffer_load_dwordx4 v16, s[8:11], s74 offen offset:3072 lds
  v_mfma_f32_16x16x32_bf16 v[212:215], a[196:199], a[28:31], v[212:215]
  s_waitcnt lgkmcnt(6)
  v_mfma_f32_16x16x32_bf16 v[72:75], a[200:203], a[16:19], v[72:75]
  ds_read_b64_tr_b16 a[220:221], v34 offset:36992
  v_mfma_f32_16x16x32_bf16 v[120:123], a[200:203], a[20:23], v[120:123]
  ds_read_b64_tr_b16 a[222:223], v34 offset:38528
  v_mfma_f32_16x16x32_bf16 v[168:171], a[200:203], a[24:27], v[168:171]
  s_add_u32 m0, s55, 36864
  s_add_u32 s73, s71, 1572864
  buffer_load_dwordx4 v41, s[12:15], s73 offen offset:0 lds
  v_mfma_f32_16x16x32_bf16 v[216:219], a[200:203], a[28:31], v[216:219]
  v_mfma_f32_16x16x32_bf16 v[76:79], a[204:207], a[16:19], v[76:79]
  ds_read_b64_tr_b16 a[224:225], v31 offset:37120
  v_mfma_f32_16x16x32_bf16 v[124:127], a[204:207], a[20:23], v[124:127]
  ds_read_b64_tr_b16 a[226:227], v31 offset:38656
  v_mfma_f32_16x16x32_bf16 v[172:175], a[204:207], a[24:27], v[172:175]
  buffer_load_dwordx4 v42, s[12:15], s73 offen offset:1024 lds
  v_mfma_f32_16x16x32_bf16 v[220:223], a[204:207], a[28:31], v[220:223]
  s_waitcnt vmcnt(19)
  ds_read_b128 a[32:35], v29 offset:32768
  s_waitcnt lgkmcnt(7)
  v_mfma_f32_16x16x32_bf16 v[80:83], a[208:211], a[16:19], v[80:83]
  ds_read_b64_tr_b16 a[228:229], v32 offset:37120
  v_mfma_f32_16x16x32_bf16 v[128:131], a[208:211], a[20:23], v[128:131]
  ds_read_b64_tr_b16 a[230:231], v32 offset:38656
  v_mfma_f32_16x16x32_bf16 v[176:179], a[208:211], a[24:27], v[176:179]
  buffer_load_dwordx4 v43, s[12:15], s73 offen offset:2048 lds
  v_mfma_f32_16x16x32_bf16 v[224:227], a[208:211], a[28:31], v[224:227]
  ds_read_b128 a[48:51], v30 offset:32768
  v_mfma_f32_16x16x32_bf16 v[84:87], a[212:215], a[16:19], v[84:87]
  ds_read_b64_tr_b16 a[232:233], v33 offset:37120
  v_mfma_f32_16x16x32_bf16 v[132:135], a[212:215], a[20:23], v[132:135]
  ds_read_b64_tr_b16 a[234:235], v33 offset:38656
  v_mfma_f32_16x16x32_bf16 v[180:183], a[212:215], a[24:27], v[180:183]
  v_mfma_f32_16x16x32_bf16 v[228:231], a[212:215], a[28:31], v[228:231]
  ds_read_b128 a[36:39], v29 offset:34816
  s_waitcnt lgkmcnt(9)
  v_mfma_f32_16x16x32_bf16 v[88:91], a[216:219], a[16:19], v[88:91]
  ds_read_b64_tr_b16 a[236:237], v34 offset:37120
  v_mfma_f32_16x16x32_bf16 v[136:139], a[216:219], a[20:23], v[136:139]
  ds_read_b64_tr_b16 a[238:239], v34 offset:38656
  v_mfma_f32_16x16x32_bf16 v[184:187], a[216:219], a[24:27], v[184:187]
  v_mfma_f32_16x16x32_bf16 v[232:235], a[216:219], a[28:31], v[232:235]
  ds_read_b128 a[52:55], v30 offset:34816
  s_barrier
  v_mfma_f32_16x16x32_bf16 v[92:95], a[220:223], a[16:19], v[92:95]
  ds_read_b64_tr_b16 a[192:193], v31 offset:24576
  v_mfma_f32_16x16x32_bf16 v[140:143], a[220:223], a[20:23], v[140:143]
  ds_read_b64_tr_b16 a[194:195], v31 offset:26112
  v_mfma_f32_16x16x32_bf16 v[188:191], a[220:223], a[24:27], v[188:191]
  s_add_u32 m0, s55, 49152
  s_add_u32 s73, s71, 1966080
  buffer_load_dwordx4 v41, s[12:15], s73 offen offset:0 lds
  v_mfma_f32_16x16x32_bf16 v[236:239], a[220:223], a[28:31], v[236:239]
  ds_read_b128 a[40:43], v29 offset:36864
  s_waitcnt lgkmcnt(10)
  v_mfma_f32_16x16x32_bf16 v[96:99], a[224:227], a[16:19], v[96:99]
  ds_read_b64_tr_b16 a[196:197], v32 offset:24576
  v_mfma_f32_16x16x32_bf16 v[144:147], a[224:227], a[20:23], v[144:147]
  ds_read_b64_tr_b16 a[198:199], v32 offset:26112
  v_mfma_f32_16x16x32_bf16 v[192:195], a[224:227], a[24:27], v[192:195]
  buffer_load_dwordx4 v42, s[12:15], s73 offen offset:1024 lds
  v_mfma_f32_16x16x32_bf16 v[240:243], a[224:227], a[28:31], v[240:243]
  ds_read_b128 a[56:59], v30 offset:36864
  v_mfma_f32_16x16x32_bf16 v[100:103], a[228:231], a[16:19], v[100:103]
  ds_read_b64_tr_b16 a[200:201], v33 offset:24576
  v_mfma_f32_16x16x32_bf16 v[148:151], a[228:231], a[20:23], v[148:151]
  ds_read_b64_tr_b16 a[202:203], v33 offset:26112
  v_mfma_f32_16x16x32_bf16 v[196:199], a[228:231], a[24:27], v[196:199]
  buffer_load_dwordx4 v43, s[12:15], s73 offen offset:2048 lds
  v_mfma_f32_16x16x32_bf16 v[244:247], a[228:231], a[28:31], v[244:247]
  ds_read_b128 a[44:47], v29 offset:38912
  s_waitcnt lgkmcnt(10)
  v_mfma_f32_16x16x32_bf16 v[104:107], a[232:235], a[16:19], v[104:107]
  ds_read_b64_tr_b16 a[204:205], v34 offset:24576
  v_mfma_f32_16x16x32_bf16 v[152:155], a[232:235], a[20:23], v[152:155]
  ds_read_b64_tr_b16 a[206:207], v34 offset:26112
  v_mfma_f32_16x16x32_bf16 v[200:203], a[232:235], a[24:27], v[200:203]
  v_mfma_f32_16x16x32_bf16 v[248:251], a[232:235], a[28:31], v[248:251]
  ds_read_b128 a[60:63], v30 offset:38912
  v_mfma_f32_16x16x32_bf16 v[108:111], a[236:239], a[16:19], v[108:111]
  ds_read_b64_tr_b16 a[208:209], v31 offset:24704
  v_mfma_f32_16x16x32_bf16 v[156:159], a[236:239], a[20:23], v[156:159]
  ds_read_b64_tr_b16 a[210:211], v31 offset:26240
  v_mfma_f32_16x16x32_bf16 v[204:207], a[236:239], a[24:27], v[204:207]
  v_mfma_f32_16x16x32_bf16 v[252:255], a[236:239], a[28:31], v[252:255]
  s_waitcnt lgkmcnt(2)
  v_mfma_f32_16x16x32_bf16 v[64:67], a[192:195], a[32:35], v[64:67]
  ds_read_b64_tr_b16 a[212:213], v32 offset:24704
  v_mfma_f32_16x16x32_bf16 v[112:115], a[192:195], a[36:39], v[112:115]
  ds_read_b64_tr_b16 a[214:215], v32 offset:26240
  v_mfma_f32_16x16x32_bf16 v[160:163], a[192:195], a[40:43], v[160:163]
  s_add_u32 m0, s75, 32768
  s_add_u32 s74, s70, 384
  buffer_load_dwordx4 v9, s[8:11], s74 offen offset:0 lds
  v_mfma_f32_16x16x32_bf16 v[208:211], a[192:195], a[44:47], v[208:211]
  v_mfma_f32_16x16x32_bf16 v[68:71], a[196:199], a[32:35], v[68:71]
  ds_read_b64_tr_b16 a[216:217], v33 offset:24704
  v_mfma_f32_16x16x32_bf16 v[116:119], a[196:199], a[36:39], v[116:119]
  ds_read_b64_tr_b16 a[218:219], v33 offset:26240
  v_mfma_f32_16x16x32_bf16 v[164:167], a[196:199], a[40:43], v[164:167]
  buffer_load_dwordx4 v10, s[8:11], s74 offen offset:1024 lds
  v_mfma_f32_16x16x32_bf16 v[212:215], a[196:199], a[44:47], v[212:215]
  v_mfma_f32_16x16x32_bf16 v[72:75], a[200:203], a[32:35], v[72:75]
  ds_read_b64_tr_b16 a[220:221], v34 offset:24704
  v_mfma_f32_16x16x32_bf16 v[120:123], a[200:203], a[36:39], v[120:123]
  ds_read_b64_tr_b16 a[222:223], v34 offset:26240
  v_mfma_f32_16x16x32_bf16 v[168:171], a[200:203], a[40:43], v[168:171]
  buffer_load_dwordx4 v11, s[8:11], s74 offen offset:2048 lds
  v_mfma_f32_16x16x32_bf16 v[216:219], a[200:203], a[44:47], v[216:219]
  v_mfma_f32_16x16x32_bf16 v[76:79], a[204:207], a[32:35], v[76:79]
  ds_read_b64_tr_b16 a[224:225], v31 offset:24832
  v_mfma_f32_16x16x32_bf16 v[124:127], a[204:207], a[36:39], v[124:127]
  ds_read_b64_tr_b16 a[226:227], v31 offset:26368
  v_mfma_f32_16x16x32_bf16 v[172:175], a[204:207], a[40:43], v[172:175]
  buffer_load_dwordx4 v12, s[8:11], s74 offen offset:3072 lds
  v_mfma_f32_16x16x32_bf16 v[220:223], a[204:207], a[44:47], v[220:223]
  s_waitcnt lgkmcnt(6)
  v_mfma_f32_16x16x32_bf16 v[80:83], a[208:211], a[32:35], v[80:83]
  ds_read_b64_tr_b16 a[228:229], v32 offset:24832
  v_mfma_f32_16x16x32_bf16 v[128:131], a[208:211], a[36:39], v[128:131]
  ds_read_b64_tr_b16 a[230:231], v32 offset:26368
  v_mfma_f32_16x16x32_bf16 v[176:179], a[208:211], a[40:43], v[176:179]
  s_add_u32 m0, s75, 36864
  s_add_u32 s74, s70, 384
  buffer_load_dwordx4 v13, s[8:11], s74 offen offset:0 lds
  v_mfma_f32_16x16x32_bf16 v[224:227], a[208:211], a[44:47], v[224:227]
  v_mfma_f32_16x16x32_bf16 v[84:87], a[212:215], a[32:35], v[84:87]
  ds_read_b64_tr_b16 a[232:233], v33 offset:24832
  v_mfma_f32_16x16x32_bf16 v[132:135], a[212:215], a[36:39], v[132:135]
  ds_read_b64_tr_b16 a[234:235], v33 offset:26368
  v_mfma_f32_16x16x32_bf16 v[180:183], a[212:215], a[40:43], v[180:183]
  buffer_load_dwordx4 v14, s[8:11], s74 offen offset:1024 lds
  v_mfma_f32_16x16x32_bf16 v[228:231], a[212:215], a[44:47], v[228:231]
  s_waitcnt lgkmcnt(6)
  v_mfma_f32_16x16x32_bf16 v[88:91], a[216:219], a[32:35], v[88:91]
  ds_read_b64_tr_b16 a[236:237], v34 offset:24832
  v_mfma_f32_16x16x32_bf16 v[136:139], a[216:219], a[36:39], v[136:139]
  ds_read_b64_tr_b16 a[238:239], v34 offset:26368
  v_mfma_f32_16x16x32_bf16 v[184:187], a[216:219], a[40:43], v[184:187]
  buffer_load_dwordx4 v15, s[8:11], s74 offen offset:2048 lds
  v_mfma_f32_16x16x32_bf16 v[232:235], a[216:219], a[44:47], v[232:235]
  s_barrier
  v_mfma_f32_16x16x32_bf16 v[92:95], a[220:223], a[32:35], v[92:95]
  ds_read_b64_tr_b16 a[192:193], v31 offset:49152
  v_mfma_f32_16x16x32_bf16 v[140:143], a[220:223], a[36:39], v[140:143]
  ds_read_b64_tr_b16 a[194:195], v31 offset:50688
  v_mfma_f32_16x16x32_bf16 v[188:191], a[220:223], a[40:43], v[188:191]
  buffer_load_dwordx4 v16, s[8:11], s74 offen offset:3072 lds
  v_mfma_f32_16x16x32_bf16 v[236:239], a[220:223], a[44:47], v[236:239]
  s_waitcnt lgkmcnt(6)
  v_mfma_f32_16x16x32_bf16 v[96:99], a[224:227], a[32:35], v[96:99]
  ds_read_b64_tr_b16 a[196:197], v32 offset:49152
  v_mfma_f32_16x16x32_bf16 v[144:147], a[224:227], a[36:39], v[144:147]
  ds_read_b64_tr_b16 a[198:199], v32 offset:50688
  v_mfma_f32_16x16x32_bf16 v[192:195], a[224:227], a[40:43], v[192:195]
  s_add_u32 m0, s55, 73728
  s_add_u32 s73, s71, 2359296
  buffer_load_dwordx4 v41, s[12:15], s73 offen offset:0 lds
  v_mfma_f32_16x16x32_bf16 v[240:243], a[224:227], a[44:47], v[240:243]
  v_mfma_f32_16x16x32_bf16 v[100:103], a[228:231], a[32:35], v[100:103]
  ds_read_b64_tr_b16 a[200:201], v33 offset:49152
  v_mfma_f32_16x16x32_bf16 v[148:151], a[228:231], a[36:39], v[148:151]
  ds_read_b64_tr_b16 a[202:203], v33 offset:50688
  v_mfma_f32_16x16x32_bf16 v[196:199], a[228:231], a[40:43], v[196:199]
  buffer_load_dwordx4 v42, s[12:15], s73 offen offset:1024 lds
  v_mfma_f32_16x16x32_bf16 v[244:247], a[228:231], a[44:47], v[244:247]
  s_waitcnt lgkmcnt(6)
  v_mfma_f32_16x16x32_bf16 v[104:107], a[232:235], a[32:35], v[104:107]
  ds_read_b64_tr_b16 a[204:205], v34 offset:49152
  v_mfma_f32_16x16x32_bf16 v[152:155], a[232:235], a[36:39], v[152:155]
  ds_read_b64_tr_b16 a[206:207], v34 offset:50688
  v_mfma_f32_16x16x32_bf16 v[200:203], a[232:235], a[40:43], v[200:203]
  buffer_load_dwordx4 v43, s[12:15], s73 offen offset:2048 lds
  v_mfma_f32_16x16x32_bf16 v[248:251], a[232:235], a[44:47], v[248:251]
  v_mfma_f32_16x16x32_bf16 v[108:111], a[236:239], a[32:35], v[108:111]
  ds_read_b64_tr_b16 a[208:209], v31 offset:49280
  v_mfma_f32_16x16x32_bf16 v[156:159], a[236:239], a[36:39], v[156:159]
  ds_read_b64_tr_b16 a[210:211], v31 offset:50816
  v_mfma_f32_16x16x32_bf16 v[204:207], a[236:239], a[40:43], v[204:207]
  v_mfma_f32_16x16x32_bf16 v[252:255], a[236:239], a[44:47], v[252:255]
  s_waitcnt lgkmcnt(6)
  v_mfma_f32_16x16x32_bf16 v[64:67], a[192:195], a[48:51], v[64:67]
  ds_read_b64_tr_b16 a[212:213], v32 offset:49280
  v_mfma_f32_16x16x32_bf16 v[112:115], a[192:195], a[52:55], v[112:115]
  ds_read_b64_tr_b16 a[214:215], v32 offset:50816
  v_mfma_f32_16x16x32_bf16 v[160:163], a[192:195], a[56:59], v[160:163]
  v_mfma_f32_16x16x32_bf16 v[208:211], a[192:195], a[60:63], v[208:211]
  v_mfma_f32_16x16x32_bf16 v[68:71], a[196:199], a[48:51], v[68:71]
  ds_read_b64_tr_b16 a[216:217], v33 offset:49280
  v_mfma_f32_16x16x32_bf16 v[116:119], a[196:199], a[52:55], v[116:119]
  ds_read_b64_tr_b16 a[218:219], v33 offset:50816
  v_mfma_f32_16x16x32_bf16 v[164:167], a[196:199], a[56:59], v[164:167]
  v_mfma_f32_16x16x32_bf16 v[212:215], a[196:199], a[60:63], v[212:215]
  s_waitcnt vmcnt(17)
  ds_read_b128 a[0:3], v29 offset:0
  s_waitcnt lgkmcnt(7)
  v_mfma_f32_16x16x32_bf16 v[72:75], a[200:203], a[48:51], v[72:75]
  ds_read_b64_tr_b16 a[220:221], v34 offset:49280
  v_mfma_f32_16x16x32_bf16 v[120:123], a[200:203], a[52:55], v[120:123]
  ds_read_b64_tr_b16 a[222:223], v34 offset:50816
  v_mfma_f32_16x16x32_bf16 v[168:171], a[200:203], a[56:59], v[168:171]
  v_mfma_f32_16x16x32_bf16 v[216:219], a[200:203], a[60:63], v[216:219]
  ds_read_b128 a[16:19], v30 offset:0
  v_mfma_f32_16x16x32_bf16 v[76:79], a[204:207], a[48:51], v[76:79]
  ds_read_b64_tr_b16 a[224:225], v31 offset:49408
  v_mfma_f32_16x16x32_bf16 v[124:127], a[204:207], a[52:55], v[124:127]
  ds_read_b64_tr_b16 a[226:227], v31 offset:50944
  v_mfma_f32_16x16x32_bf16 v[172:175], a[204:207], a[56:59], v[172:175]
  v_mfma_f32_16x16x32_bf16 v[220:223], a[204:207], a[60:63], v[220:223]
  ds_read_b128 a[4:7], v29 offset:2048
  s_waitcnt lgkmcnt(9)
  v_mfma_f32_16x16x32_bf16 v[80:83], a[208:211], a[48:51], v[80:83]
  ds_read_b64_tr_b16 a[228:229], v32 offset:49408
  v_mfma_f32_16x16x32_bf16 v[128:131], a[208:211], a[52:55], v[128:131]
  ds_read_b64_tr_b16 a[230:231], v32 offset:50944
  v_mfma_f32_16x16x32_bf16 v[176:179], a[208:211], a[56:59], v[176:179]
  v_mfma_f32_16x16x32_bf16 v[224:227], a[208:211], a[60:63], v[224:227]
  ds_read_b128 a[20:23], v30 offset:2048
  v_mfma_f32_16x16x32_bf16 v[84:87], a[212:215], a[48:51], v[84:87]
  ds_read_b64_tr_b16 a[232:233], v33 offset:49408
  v_mfma_f32_16x16x32_bf16 v[132:135], a[212:215], a[52:55], v[132:135]
  ds_read_b64_tr_b16 a[234:235], v33 offset:50944
  v_mfma_f32_16x16x32_bf16 v[180:183], a[212:215], a[56:59], v[180:183]
  v_mfma_f32_16x16x32_bf16 v[228:231], a[212:215], a[60:63], v[228:231]
  ds_read_b128 a[8:11], v29 offset:4096
  s_waitcnt lgkmcnt(10)
  v_mfma_f32_16x16x32_bf16 v[88:91], a[216:219], a[48:51], v[88:91]
  ds_read_b64_tr_b16 a[236:237], v34 offset:49408
  v_mfma_f32_16x16x32_bf16 v[136:139], a[216:219], a[52:55], v[136:139]
  ds_read_b64_tr_b16 a[238:239], v34 offset:50944
  v_mfma_f32_16x16x32_bf16 v[184:187], a[216:219], a[56:59], v[184:187]
  v_mfma_f32_16x16x32_bf16 v[232:235], a[216:219], a[60:63], v[232:235]
  ds_read_b128 a[24:27], v30 offset:4096
  s_waitcnt vmcnt(14)
  s_barrier
  v_mfma_f32_16x16x32_bf16 v[92:95], a[220:223], a[48:51], v[92:95]
  ds_read_b64_tr_b16 a[192:193], v31 offset:0
  v_mfma_f32_16x16x32_bf16 v[140:143], a[220:223], a[52:55], v[140:143]
  ds_read_b64_tr_b16 a[194:195], v31 offset:1536
  v_mfma_f32_16x16x32_bf16 v[188:191], a[220:223], a[56:59], v[188:191]
  s_add_u32 m0, s55, 61440
  s_add_u32 s73, s71, 2752512
  buffer_load_dwordx4 v41, s[12:15], s73 offen offset:0 lds
  v_mfma_f32_16x16x32_bf16 v[236:239], a[220:223], a[60:63], v[236:239]
  ds_read_b128 a[12:15], v29 offset:6144
  s_waitcnt lgkmcnt(10)
  v_mfma_f32_16x16x32_bf16 v[96:99], a[224:227], a[48:51], v[96:99]
  ds_read_b64_tr_b16 a[196:197], v32 offset:0
  v_mfma_f32_16x16x32_bf16 v[144:147], a[224:227], a[52:55], v[144:147]
  ds_read_b64_tr_b16 a[198:199], v32 offset:1536
  v_mfma_f32_16x16x32_bf16 v[192:195], a[224:227], a[56:59], v[192:195]
  buffer_load_dwordx4 v42, s[12:15], s73 offen offset:1024 lds
  v_mfma_f32_16x16x32_bf16 v[240:243], a[224:227], a[60:63], v[240:243]
  ds_read_b128 a[28:31], v30 offset:6144
  v_mfma_f32_16x16x32_bf16 v[100:103], a[228:231], a[48:51], v[100:103]
  ds_read_b64_tr_b16 a[200:201], v33 offset:0
  v_mfma_f32_16x16x32_bf16 v[148:151], a[228:231], a[52:55], v[148:151]
  ds_read_b64_tr_b16 a[202:203], v33 offset:1536
  v_mfma_f32_16x16x32_bf16 v[196:199], a[228:231], a[56:59], v[196:199]
  buffer_load_dwordx4 v43, s[12:15], s73 offen offset:2048 lds
  v_mfma_f32_16x16x32_bf16 v[244:247], a[228:231], a[60:63], v[244:247]
  s_waitcnt lgkmcnt(9)
  v_mfma_f32_16x16x32_bf16 v[104:107], a[232:235], a[48:51], v[104:107]
  ds_read_b64_tr_b16 a[204:205], v34 offset:0
  v_mfma_f32_16x16x32_bf16 v[152:155], a[232:235], a[52:55], v[152:155]
  ds_read_b64_tr_b16 a[206:207], v34 offset:1536
  v_mfma_f32_16x16x32_bf16 v[200:203], a[232:235], a[56:59], v[200:203]
  v_mfma_f32_16x16x32_bf16 v[248:251], a[232:235], a[60:63], v[248:251]
  v_mfma_f32_16x16x32_bf16 v[108:111], a[236:239], a[48:51], v[108:111]
  ds_read_b64_tr_b16 a[208:209], v31 offset:128
  v_mfma_f32_16x16x32_bf16 v[156:159], a[236:239], a[52:55], v[156:159]
  ds_read_b64_tr_b16 a[210:211], v31 offset:1664
  v_mfma_f32_16x16x32_bf16 v[204:207], a[236:239], a[56:59], v[204:207]
  v_mfma_f32_16x16x32_bf16 v[252:255], a[236:239], a[60:63], v[252:255]
  s_waitcnt lgkmcnt(6)
  v_mfma_f32_16x16x32_bf16 v[64:67], a[192:195], a[0:3], v[64:67]
  ds_read_b64_tr_b16 a[212:213], v32 offset:128
  v_mfma_f32_16x16x32_bf16 v[112:115], a[192:195], a[4:7], v[112:115]
  ds_read_b64_tr_b16 a[214:215], v32 offset:1664
  v_mfma_f32_16x16x32_bf16 v[160:163], a[192:195], a[8:11], v[160:163]
  s_add_u32 m0, s75, 0
  s_add_u32 s74, s70, 512
  buffer_load_dwordx4 v9, s[8:11], s74 offen offset:0 lds
  v_mfma_f32_16x16x32_bf16 v[208:211], a[192:195], a[12:15], v[208:211]
  v_mfma_f32_16x16x32_bf16 v[68:71], a[196:199], a[0:3], v[68:71]
  ds_read_b64_tr_b16 a[216:217], v33 offset:128
  v_mfma_f32_16x16x32_bf16 v[116:119], a[196:199], a[4:7], v[116:119]
  ds_read_b64_tr_b16 a[218:219], v33 offset:1664
  v_mfma_f32_16x16x32_bf16 v[164:167], a[196:199], a[8:11], v[164:167]
  buffer_load_dwordx4 v10, s[8:11], s74 offen offset:1024 lds
  v_mfma_f32_16x16x32_bf16 v[212:215], a[196:199], a[12:15], v[212:215]
  s_waitcnt lgkmcnt(6)
  v_mfma_f32_16x16x32_bf16 v[72:75], a[200:203], a[0:3], v[72:75]
  ds_read_b64_tr_b16 a[220:221], v34 offset:128
  v_mfma_f32_16x16x32_bf16 v[120:123], a[200:203], a[4:7], v[120:123]
  ds_read_b64_tr_b16 a[222:223], v34 offset:1664
  v_mfma_f32_16x16x32_bf16 v[168:171], a[200:203], a[8:11], v[168:171]
  buffer_load_dwordx4 v11, s[8:11], s74 offen offset:2048 lds
  v_mfma_f32_16x16x32_bf16 v[216:219], a[200:203], a[12:15], v[216:219]
  v_mfma_f32_16x16x32_bf16 v[76:79], a[204:207], a[0:3], v[76:79]
  ds_read_b64_tr_b16 a[224:225], v31 offset:256
  v_mfma_f32_16x16x32_bf16 v[124:127], a[204:207], a[4:7], v[124:127]
  ds_read_b64_tr_b16 a[226:227], v31 offset:1792
  v_mfma_f32_16x16x32_bf16 v[172:175], a[204:207], a[8:11], v[172:175]
  buffer_load_dwordx4 v12, s[8:11], s74 offen offset:3072 lds
  v_mfma_f32_16x16x32_bf16 v[220:223], a[204:207], a[12:15], v[220:223]
  s_waitcnt lgkmcnt(6)
  v_mfma_f32_16x16x32_bf16 v[80:83], a[208:211], a[0:3], v[80:83]
  ds_read_b64_tr_b16 a[228:229], v32 offset:256
  v_mfma_f32_16x16x32_bf16 v[128:131], a[208:211], a[4:7], v[128:131]
  ds_read_b64_tr_b16 a[230:231], v32 offset:1792
  v_mfma_f32_16x16x32_bf16 v[176:179], a[208:211], a[8:11], v[176:179]
  s_add_u32 m0, s75, 4096
  s_add_u32 s74, s70, 512
  buffer_load_dwordx4 v13, s[8:11], s74 offen offset:0 lds
  v_mfma_f32_16x16x32_bf16 v[224:227], a[208:211], a[12:15], v[224:227]
  v_mfma_f32_16x16x32_bf16 v[84:87], a[212:215], a[0:3], v[84:87]
  ds_read_b64_tr_b16 a[232:233], v33 offset:256
  v_mfma_f32_16x16x32_bf16 v[132:135], a[212:215], a[4:7], v[132:135]
  ds_read_b64_tr_b16 a[234:235], v33 offset:1792
  v_mfma_f32_16x16x32_bf16 v[180:183], a[212:215], a[8:11], v[180:183]
  buffer_load_dwordx4 v14, s[8:11], s74 offen offset:1024 lds
  v_mfma_f32_16x16x32_bf16 v[228:231], a[212:215], a[12:15], v[228:231]
  s_waitcnt lgkmcnt(6)
  v_mfma_f32_16x16x32_bf16 v[88:91], a[216:219], a[0:3], v[88:91]
  ds_read_b64_tr_b16 a[236:237], v34 offset:256
  v_mfma_f32_16x16x32_bf16 v[136:139], a[216:219], a[4:7], v[136:139]
  ds_read_b64_tr_b16 a[238:239], v34 offset:1792
  v_mfma_f32_16x16x32_bf16 v[184:187], a[216:219], a[8:11], v[184:187]
  buffer_load_dwordx4 v15, s[8:11], s74 offen offset:2048 lds
  v_mfma_f32_16x16x32_bf16 v[232:235], a[216:219], a[12:15], v[232:235]
  s_waitcnt vmcnt(21)
  s_barrier
  v_mfma_f32_16x16x32_bf16 v[92:95], a[220:223], a[0:3], v[92:95]
  ds_read_b64_tr_b16 a[192:193], v31 offset:12288
  v_mfma_f32_16x16x32_bf16 v[140:143], a[220:223], a[4:7], v[140:143]
  ds_read_b64_tr_b16 a[194:195], v31 offset:13824
  v_mfma_f32_16x16x32_bf16 v[188:191], a[220:223], a[8:11], v[188:191]
  buffer_load_dwordx4 v16, s[8:11], s74 offen offset:3072 lds
  v_mfma_f32_16x16x32_bf16 v[236:239], a[220:223], a[12:15], v[236:239]
  s_waitcnt lgkmcnt(6)
  v_mfma_f32_16x16x32_bf16 v[96:99], a[224:227], a[0:3], v[96:99]
  ds_read_b64_tr_b16 a[196:197], v32 offset:12288
  v_mfma_f32_16x16x32_bf16 v[144:147], a[224:227], a[4:7], v[144:147]
  ds_read_b64_tr_b16 a[198:199], v32 offset:13824
  v_mfma_f32_16x16x32_bf16 v[192:195], a[224:227], a[8:11], v[192:195]
  s_add_u32 m0, s55, 86016
  s_add_u32 s73, s71, 3145728
  buffer_load_dwordx4 v41, s[12:15], s73 offen offset:0 lds
  v_mfma_f32_16x16x32_bf16 v[240:243], a[224:227], a[12:15], v[240:243]
  v_mfma_f32_16x16x32_bf16 v[100:103], a[228:231], a[0:3], v[100:103]
  ds_read_b64_tr_b16 a[200:201], v33 offset:12288
  v_mfma_f32_16x16x32_bf16 v[148:151], a[228:231], a[4:7], v[148:151]
  ds_read_b64_tr_b16 a[202:203], v33 offset:13824
  v_mfma_f32_16x16x32_bf16 v[196:199], a[228:231], a[8:11], v[196:199]
  buffer_load_dwordx4 v42, s[12:15], s73 offen offset:1024 lds
  v_mfma_f32_16x16x32_bf16 v[244:247], a[228:231], a[12:15], v[244:247]
  s_waitcnt lgkmcnt(6)
  v_mfma_f32_16x16x32_bf16 v[104:107], a[232:235], a[0:3], v[104:107]
  ds_read_b64_tr_b16 a[204:205], v34 offset:12288
  v_mfma_f32_16x16x32_bf16 v[152:155], a[232:235], a[4:7], v[152:155]
  ds_read_b64_tr_b16 a[206:207], v34 offset:13824
  v_mfma_f32_16x16x32_bf16 v[200:203], a[232:235], a[8:11], v[200:203]
  buffer_load_dwordx4 v43, s[12:15], s73 offen offset:2048 lds
  v_mfma_f32_16x16x32_bf16 v[248:251], a[232:235], a[12:15], v[248:251]
  v_mfma_f32_16x16x32_bf16 v[108:111], a[236:239], a[0:3], v[108:111]
  ds_read_b64_tr_b16 a[208:209], v31 offset:12416
  v_mfma_f32_16x16x32_bf16 v[156:159], a[236:239], a[4:7], v[156:159]
  ds_read_b64_tr_b16 a[210:211], v31 offset:13952
  v_mfma_f32_16x16x32_bf16 v[204:207], a[236:239], a[8:11], v[204:207]
  v_mfma_f32_16x16x32_bf16 v[252:255], a[236:239], a[12:15], v[252:255]
  s_waitcnt lgkmcnt(6)
  v_mfma_f32_16x16x32_bf16 v[64:67], a[192:195], a[16:19], v[64:67]
  ds_read_b64_tr_b16 a[212:213], v32 offset:12416
  v_mfma_f32_16x16x32_bf16 v[112:115], a[192:195], a[20:23], v[112:115]
  ds_read_b64_tr_b16 a[214:215], v32 offset:13952
  v_mfma_f32_16x16x32_bf16 v[160:163], a[192:195], a[24:27], v[160:163]
  v_mfma_f32_16x16x32_bf16 v[208:211], a[192:195], a[28:31], v[208:211]
  v_mfma_f32_16x16x32_bf16 v[68:71], a[196:199], a[16:19], v[68:71]
  ds_read_b64_tr_b16 a[216:217], v33 offset:12416
  v_mfma_f32_16x16x32_bf16 v[116:119], a[196:199], a[20:23], v[116:119]
  ds_read_b64_tr_b16 a[218:219], v33 offset:13952
  v_mfma_f32_16x16x32_bf16 v[164:167], a[196:199], a[24:27], v[164:167]
  v_mfma_f32_16x16x32_bf16 v[212:215], a[196:199], a[28:31], v[212:215]
  s_waitcnt vmcnt(17)
  ds_read_b128 a[32:35], v29 offset:32768
  s_waitcnt lgkmcnt(7)
  v_mfma_f32_16x16x32_bf16 v[72:75], a[200:203], a[16:19], v[72:75]
  ds_read_b64_tr_b16 a[220:221], v34 offset:12416
  v_mfma_f32_16x16x32_bf16 v[120:123], a[200:203], a[20:23], v[120:123]
  ds_read_b64_tr_b16 a[222:223], v34 offset:13952
  v_mfma_f32_16x16x32_bf16 v[168:171], a[200:203], a[24:27], v[168:171]
  v_mfma_f32_16x16x32_bf16 v[216:219], a[200:203], a[28:31], v[216:219]
  ds_read_b128 a[48:51], v30 offset:32768
  v_mfma_f32_16x16x32_bf16 v[76:79], a[204:207], a[16:19], v[76:79]
  ds_read_b64_tr_b16 a[224:225], v31 offset:12544
  v_mfma_f32_16x16x32_bf16 v[124:127], a[204:207], a[20:23], v[124:127]
  ds_read_b64_tr_b16 a[226:227], v31 offset:14080
  v_mfma_f32_16x16x32_bf16 v[172:175], a[204:207], a[24:27], v[172:175]
  v_mfma_f32_16x16x32_bf16 v[220:223], a[204:207], a[28:31], v[220:223]
  ds_read_b128 a[36:39], v29 offset:34816
  s_waitcnt lgkmcnt(9)
  v_mfma_f32_16x16x32_bf16 v[80:83], a[208:211], a[16:19], v[80:83]
  ds_read_b64_tr_b16 a[228:229], v32 offset:12544
  v_mfma_f32_16x16x32_bf16 v[128:131], a[208:211], a[20:23], v[128:131]
  ds_read_b64_tr_b16 a[230:231], v32 offset:14080
  v_mfma_f32_16x16x32_bf16 v[176:179], a[208:211], a[24:27], v[176:179]
  v_mfma_f32_16x16x32_bf16 v[224:227], a[208:211], a[28:31], v[224:227]
  ds_read_b128 a[52:55], v30 offset:34816
  v_mfma_f32_16x16x32_bf16 v[84:87], a[212:215], a[16:19], v[84:87]
  ds_read_b64_tr_b16 a[232:233], v33 offset:12544
  v_mfma_f32_16x16x32_bf16 v[132:135], a[212:215], a[20:23], v[132:135]
  ds_read_b64_tr_b16 a[234:235], v33 offset:14080
  v_mfma_f32_16x16x32_bf16 v[180:183], a[212:215], a[24:27], v[180:183]
  v_mfma_f32_16x16x32_bf16 v[228:231], a[212:215], a[28:31], v[228:231]
  ds_read_b128 a[40:43], v29 offset:36864
  s_waitcnt lgkmcnt(10)
  v_mfma_f32_16x16x32_bf16 v[88:91], a[216:219], a[16:19], v[88:91]
  ds_read_b64_tr_b16 a[236:237], v34 offset:12544
  v_mfma_f32_16x16x32_bf16 v[136:139], a[216:219], a[20:23], v[136:139]
  ds_read_b64_tr_b16 a[238:239], v34 offset:14080
  v_mfma_f32_16x16x32_bf16 v[184:187], a[216:219], a[24:27], v[184:187]
  v_mfma_f32_16x16x32_bf16 v[232:235], a[216:219], a[28:31], v[232:235]
  ds_read_b128 a[56:59], v30 offset:36864
  s_waitcnt vmcnt(14)
  s_barrier
  v_mfma_f32_16x16x32_bf16 v[92:95], a[220:223], a[16:19], v[92:95]
  ds_read_b64_tr_b16 a[192:193], v31 offset:36864
  v_mfma_f32_16x16x32_bf16 v[140:143], a[220:223], a[20:23], v[140:143]
  ds_read_b64_tr_b16 a[194:195], v31 offset:38400
  v_mfma_f32_16x16x32_bf16 v[188:191], a[220:223], a[24:27], v[188:191]
  s_add_u32 m0, s55, 36864
  s_add_u32 s73, s71, 3538944
  buffer_load_dwordx4 v41, s[12:15], s73 offen offset:0 lds
  v_mfma_f32_16x16x32_bf16 v[236:239], a[220:223], a[28:31], v[236:239]
  ds_read_b128 a[44:47], v29 offset:38912
  s_waitcnt lgkmcnt(10)
  v_mfma_f32_16x16x32_bf16 v[96:99], a[224:227], a[16:19], v[96:99]
  ds_read_b64_tr_b16 a[196:197], v32 offset:36864
  v_mfma_f32_16x16x32_bf16 v[144:147], a[224:227], a[20:23], v[144:147]
  ds_read_b64_tr_b16 a[198:199], v32 offset:38400
  v_mfma_f32_16x16x32_bf16 v[192:195], a[224:227], a[24:27], v[192:195]
  buffer_load_dwordx4 v42, s[12:15], s73 offen offset:1024 lds
  v_mfma_f32_16x16x32_bf16 v[240:243], a[224:227], a[28:31], v[240:243]
  ds_read_b128 a[60:63], v30 offset:38912
  v_mfma_f32_16x16x32_bf16 v[100:103], a[228:231], a[16:19], v[100:103]
  ds_read_b64_tr_b16 a[200:201], v33 offset:36864
  v_mfma_f32_16x16x32_bf16 v[148:151], a[228:231], a[20:23], v[148:151]
  ds_read_b64_tr_b16 a[202:203], v33 offset:38400
  v_mfma_f32_16x16x32_bf16 v[196:199], a[228:231], a[24:27], v[196:199]
  buffer_load_dwordx4 v43, s[12:15], s73 offen offset:2048 lds
  v_mfma_f32_16x16x32_bf16 v[244:247], a[228:231], a[28:31], v[244:247]
  s_waitcnt lgkmcnt(9)
  v_mfma_f32_16x16x32_bf16 v[104:107], a[232:235], a[16:19], v[104:107]
  ds_read_b64_tr_b16 a[204:205], v34 offset:36864
  v_mfma_f32_16x16x32_bf16 v[152:155], a[232:235], a[20:23], v[152:155]
  ds_read_b64_tr_b16 a[206:207], v34 offset:38400
  v_mfma_f32_16x16x32_bf16 v[200:203], a[232:235], a[24:27], v[200:203]
  v_mfma_f32_16x16x32_bf16 v[248:251], a[232:235], a[28:31], v[248:251]
  v_mfma_f32_16x16x32_bf16 v[108:111], a[236:239], a[16:19], v[108:111]
  ds_read_b64_tr_b16 a[208:209], v31 offset:36992
  v_mfma_f32_16x16x32_bf16 v[156:159], a[236:239], a[20:23], v[156:159]
  ds_read_b64_tr_b16 a[210:211], v31 offset:38528
  v_mfma_f32_16x16x32_bf16 v[204:207], a[236:239], a[24:27], v[204:207]
  v_mfma_f32_16x16x32_bf16 v[252:255], a[236:239], a[28:31], v[252:255]
  s_waitcnt lgkmcnt(6)
  v_mfma_f32_16x16x32_bf16 v[64:67], a[192:195], a[32:35], v[64:67]
  ds_read_b64_tr_b16 a[212:213], v32 offset:36992
  v_mfma_f32_16x16x32_bf16 v[112:115], a[192:195], a[36:39], v[112:115]
  ds_read_b64_tr_b16 a[214:215], v32 offset:38528
  v_mfma_f32_16x16x32_bf16 v[160:163], a[192:195], a[40:43], v[160:163]
  s_add_u32 m0, s75, 32768
  s_add_u32 s74, s70, 640
  buffer_load_dwordx4 v9, s[8:11], s74 offen offset:0 lds
  v_mfma_f32_16x16x32_bf16 v[208:211], a[192:195], a[44:47], v[208:211]
  v_mfma_f32_16x16x32_bf16 v[68:71], a[196:199], a[32:35], v[68:71]
  ds_read_b64_tr_b16 a[216:217], v33 offset:36992
  v_mfma_f32_16x16x32_bf16 v[116:119], a[196:199], a[36:39], v[116:119]
  ds_read_b64_tr_b16 a[218:219], v33 offset:38528
  v_mfma_f32_16x16x32_bf16 v[164:167], a[196:199], a[40:43], v[164:167]
  buffer_load_dwordx4 v10, s[8:11], s74 offen offset:1024 lds
  v_mfma_f32_16x16x32_bf16 v[212:215], a[196:199], a[44:47], v[212:215]
  s_waitcnt lgkmcnt(6)
  v_mfma_f32_16x16x32_bf16 v[72:75], a[200:203], a[32:35], v[72:75]
  ds_read_b64_tr_b16 a[220:221], v34 offset:36992
  v_mfma_f32_16x16x32_bf16 v[120:123], a[200:203], a[36:39], v[120:123]
  ds_read_b64_tr_b16 a[222:223], v34 offset:38528
  v_mfma_f32_16x16x32_bf16 v[168:171], a[200:203], a[40:43], v[168:171]
  buffer_load_dwordx4 v11, s[8:11], s74 offen offset:2048 lds
  v_mfma_f32_16x16x32_bf16 v[216:219], a[200:203], a[44:47], v[216:219]
  v_mfma_f32_16x16x32_bf16 v[76:79], a[204:207], a[32:35], v[76:79]
  ds_read_b64_tr_b16 a[224:225], v31 offset:37120
  v_mfma_f32_16x16x32_bf16 v[124:127], a[204:207], a[36:39], v[124:127]
  ds_read_b64_tr_b16 a[226:227], v31 offset:38656
  v_mfma_f32_16x16x32_bf16 v[172:175], a[204:207], a[40:43], v[172:175]
  buffer_load_dwordx4 v12, s[8:11], s74 offen offset:3072 lds
  v_mfma_f32_16x16x32_bf16 v[220:223], a[204:207], a[44:47], v[220:223]
  s_waitcnt lgkmcnt(6)
  v_mfma_f32_16x16x32_bf16 v[80:83], a[208:211], a[32:35], v[80:83]
  ds_read_b64_tr_b16 a[228:229], v32 offset:37120
  v_mfma_f32_16x16x32_bf16 v[128:131], a[208:211], a[36:39], v[128:131]
  ds_read_b64_tr_b16 a[230:231], v32 offset:38656
  v_mfma_f32_16x16x32_bf16 v[176:179], a[208:211], a[40:43], v[176:179]
  s_add_u32 m0, s75, 36864
  s_add_u32 s74, s70, 640
  buffer_load_dwordx4 v13, s[8:11], s74 offen offset:0 lds
  v_mfma_f32_16x16x32_bf16 v[224:227], a[208:211], a[44:47], v[224:227]
  v_mfma_f32_16x16x32_bf16 v[84:87], a[212:215], a[32:35], v[84:87]
  ds_read_b64_tr_b16 a[232:233], v33 offset:37120
  v_mfma_f32_16x16x32_bf16 v[132:135], a[212:215], a[36:39], v[132:135]
  ds_read_b64_tr_b16 a[234:235], v33 offset:38656
  v_mfma_f32_16x16x32_bf16 v[180:183], a[212:215], a[40:43], v[180:183]
  buffer_load_dwordx4 v14, s[8:11], s74 offen offset:1024 lds
  v_mfma_f32_16x16x32_bf16 v[228:231], a[212:215], a[44:47], v[228:231]
  s_waitcnt lgkmcnt(6)
  v_mfma_f32_16x16x32_bf16 v[88:91], a[216:219], a[32:35], v[88:91]
  ds_read_b64_tr_b16 a[236:237], v34 offset:37120
  v_mfma_f32_16x16x32_bf16 v[136:139], a[216:219], a[36:39], v[136:139]
  ds_read_b64_tr_b16 a[238:239], v34 offset:38656
  v_mfma_f32_16x16x32_bf16 v[184:187], a[216:219], a[40:43], v[184:187]
  buffer_load_dwordx4 v15, s[8:11], s74 offen offset:2048 lds
  v_mfma_f32_16x16x32_bf16 v[232:235], a[216:219], a[44:47], v[232:235]
  s_waitcnt vmcnt(21)
  s_barrier
  v_mfma_f32_16x16x32_bf16 v[92:95], a[220:223], a[32:35], v[92:95]
  ds_read_b64_tr_b16 a[192:193], v31 offset:24576
  v_mfma_f32_16x16x32_bf16 v[140:143], a[220:223], a[36:39], v[140:143]
  ds_read_b64_tr_b16 a[194:195], v31 offset:26112
  v_mfma_f32_16x16x32_bf16 v[188:191], a[220:223], a[40:43], v[188:191]
  buffer_load_dwordx4 v16, s[8:11], s74 offen offset:3072 lds
  v_mfma_f32_16x16x32_bf16 v[236:239], a[220:223], a[44:47], v[236:239]
  s_waitcnt lgkmcnt(6)
  v_mfma_f32_16x16x32_bf16 v[96:99], a[224:227], a[32:35], v[96:99]
  ds_read_b64_tr_b16 a[196:197], v32 offset:24576
  v_mfma_f32_16x16x32_bf16 v[144:147], a[224:227], a[36:39], v[144:147]
  ds_read_b64_tr_b16 a[198:199], v32 offset:26112
  v_mfma_f32_16x16x32_bf16 v[192:195], a[224:227], a[40:43], v[192:195]
  s_add_u32 m0, s55, 49152
  s_add_u32 s73, s71, 3932160
  buffer_load_dwordx4 v41, s[12:15], s73 offen offset:0 lds
  v_mfma_f32_16x16x32_bf16 v[240:243], a[224:227], a[44:47], v[240:243]
  v_mfma_f32_16x16x32_bf16 v[100:103], a[228:231], a[32:35], v[100:103]
  ds_read_b64_tr_b16 a[200:201], v33 offset:24576
  v_mfma_f32_16x16x32_bf16 v[148:151], a[228:231], a[36:39], v[148:151]
  ds_read_b64_tr_b16 a[202:203], v33 offset:26112
  v_mfma_f32_16x16x32_bf16 v[196:199], a[228:231], a[40:43], v[196:199]
  buffer_load_dwordx4 v42, s[12:15], s73 offen offset:1024 lds
  v_mfma_f32_16x16x32_bf16 v[244:247], a[228:231], a[44:47], v[244:247]
  s_waitcnt lgkmcnt(6)
  v_mfma_f32_16x16x32_bf16 v[104:107], a[232:235], a[32:35], v[104:107]
  ds_read_b64_tr_b16 a[204:205], v34 offset:24576
  v_mfma_f32_16x16x32_bf16 v[152:155], a[232:235], a[36:39], v[152:155]
  ds_read_b64_tr_b16 a[206:207], v34 offset:26112
  v_mfma_f32_16x16x32_bf16 v[200:203], a[232:235], a[40:43], v[200:203]
  buffer_load_dwordx4 v43, s[12:15], s73 offen offset:2048 lds
  v_mfma_f32_16x16x32_bf16 v[248:251], a[232:235], a[44:47], v[248:251]
  v_mfma_f32_16x16x32_bf16 v[108:111], a[236:239], a[32:35], v[108:111]
  ds_read_b64_tr_b16 a[208:209], v31 offset:24704
  v_mfma_f32_16x16x32_bf16 v[156:159], a[236:239], a[36:39], v[156:159]
  ds_read_b64_tr_b16 a[210:211], v31 offset:26240
  v_mfma_f32_16x16x32_bf16 v[204:207], a[236:239], a[40:43], v[204:207]
  v_mfma_f32_16x16x32_bf16 v[252:255], a[236:239], a[44:47], v[252:255]
  s_waitcnt lgkmcnt(6)
  v_mfma_f32_16x16x32_bf16 v[64:67], a[192:195], a[48:51], v[64:67]
  ds_read_b64_tr_b16 a[212:213], v32 offset:24704
  v_mfma_f32_16x16x32_bf16 v[112:115], a[192:195], a[52:55], v[112:115]
  ds_read_b64_tr_b16 a[214:215], v32 offset:26240
  v_mfma_f32_16x16x32_bf16 v[160:163], a[192:195], a[56:59], v[160:163]
  v_mfma_f32_16x16x32_bf16 v[208:211], a[192:195], a[60:63], v[208:211]
  v_mfma_f32_16x16x32_bf16 v[68:71], a[196:199], a[48:51], v[68:71]
  ds_read_b64_tr_b16 a[216:217], v33 offset:24704
  v_mfma_f32_16x16x32_bf16 v[116:119], a[196:199], a[52:55], v[116:119]
  ds_read_b64_tr_b16 a[218:219], v33 offset:26240
  v_mfma_f32_16x16x32_bf16 v[164:167], a[196:199], a[56:59], v[164:167]
  v_mfma_f32_16x16x32_bf16 v[212:215], a[196:199], a[60:63], v[212:215]
  s_waitcnt vmcnt(17)
  ds_read_b128 a[0:3], v29 offset:0
  s_waitcnt lgkmcnt(7)
  v_mfma_f32_16x16x32_bf16 v[72:75], a[200:203], a[48:51], v[72:75]
  ds_read_b64_tr_b16 a[220:221], v34 offset:24704
  v_mfma_f32_16x16x32_bf16 v[120:123], a[200:203], a[52:55], v[120:123]
  ds_read_b64_tr_b16 a[222:223], v34 offset:26240
  v_mfma_f32_16x16x32_bf16 v[168:171], a[200:203], a[56:59], v[168:171]
  v_mfma_f32_16x16x32_bf16 v[216:219], a[200:203], a[60:63], v[216:219]
  ds_read_b128 a[16:19], v30 offset:0
  v_mfma_f32_16x16x32_bf16 v[76:79], a[204:207], a[48:51], v[76:79]
  ds_read_b64_tr_b16 a[224:225], v31 offset:24832
  v_mfma_f32_16x16x32_bf16 v[124:127], a[204:207], a[52:55], v[124:127]
  ds_read_b64_tr_b16 a[226:227], v31 offset:26368
  v_mfma_f32_16x16x32_bf16 v[172:175], a[204:207], a[56:59], v[172:175]
  v_mfma_f32_16x16x32_bf16 v[220:223], a[204:207], a[60:63], v[220:223]
  ds_read_b128 a[4:7], v29 offset:2048
  s_waitcnt lgkmcnt(9)
  v_mfma_f32_16x16x32_bf16 v[80:83], a[208:211], a[48:51], v[80:83]
  ds_read_b64_tr_b16 a[228:229], v32 offset:24832
  v_mfma_f32_16x16x32_bf16 v[128:131], a[208:211], a[52:55], v[128:131]
  ds_read_b64_tr_b16 a[230:231], v32 offset:26368
  v_mfma_f32_16x16x32_bf16 v[176:179], a[208:211], a[56:59], v[176:179]
  v_mfma_f32_16x16x32_bf16 v[224:227], a[208:211], a[60:63], v[224:227]
  ds_read_b128 a[20:23], v30 offset:2048
  v_mfma_f32_16x16x32_bf16 v[84:87], a[212:215], a[48:51], v[84:87]
  ds_read_b64_tr_b16 a[232:233], v33 offset:24832
  v_mfma_f32_16x16x32_bf16 v[132:135], a[212:215], a[52:55], v[132:135]
  ds_read_b64_tr_b16 a[234:235], v33 offset:26368
  v_mfma_f32_16x16x32_bf16 v[180:183], a[212:215], a[56:59], v[180:183]
  v_mfma_f32_16x16x32_bf16 v[228:231], a[212:215], a[60:63], v[228:231]
  ds_read_b128 a[8:11], v29 offset:4096
  s_waitcnt lgkmcnt(10)
  v_mfma_f32_16x16x32_bf16 v[88:91], a[216:219], a[48:51], v[88:91]
  ds_read_b64_tr_b16 a[236:237], v34 offset:24832
  v_mfma_f32_16x16x32_bf16 v[136:139], a[216:219], a[52:55], v[136:139]
  ds_read_b64_tr_b16 a[238:239], v34 offset:26368
  v_mfma_f32_16x16x32_bf16 v[184:187], a[216:219], a[56:59], v[184:187]
  v_mfma_f32_16x16x32_bf16 v[232:235], a[216:219], a[60:63], v[232:235]
  ds_read_b128 a[24:27], v30 offset:4096
  s_waitcnt vmcnt(14)
  s_barrier
  v_mfma_f32_16x16x32_bf16 v[92:95], a[220:223], a[48:51], v[92:95]
  ds_read_b64_tr_b16 a[192:193], v31 offset:49152
  v_mfma_f32_16x16x32_bf16 v[140:143], a[220:223], a[52:55], v[140:143]
  ds_read_b64_tr_b16 a[194:195], v31 offset:50688
  v_mfma_f32_16x16x32_bf16 v[188:191], a[220:223], a[56:59], v[188:191]
  s_add_u32 m0, s55, 73728
  s_add_u32 s73, s71, 4325376
  buffer_load_dwordx4 v41, s[12:15], s73 offen offset:0 lds
  v_mfma_f32_16x16x32_bf16 v[236:239], a[220:223], a[60:63], v[236:239]
  ds_read_b128 a[12:15], v29 offset:6144
  s_waitcnt lgkmcnt(10)
  v_mfma_f32_16x16x32_bf16 v[96:99], a[224:227], a[48:51], v[96:99]
  ds_read_b64_tr_b16 a[196:197], v32 offset:49152
  v_mfma_f32_16x16x32_bf16 v[144:147], a[224:227], a[52:55], v[144:147]
  ds_read_b64_tr_b16 a[198:199], v32 offset:50688
  v_mfma_f32_16x16x32_bf16 v[192:195], a[224:227], a[56:59], v[192:195]
  buffer_load_dwordx4 v42, s[12:15], s73 offen offset:1024 lds
  v_mfma_f32_16x16x32_bf16 v[240:243], a[224:227], a[60:63], v[240:243]
  ds_read_b128 a[28:31], v30 offset:6144
  v_mfma_f32_16x16x32_bf16 v[100:103], a[228:231], a[48:51], v[100:103]
  ds_read_b64_tr_b16 a[200:201], v33 offset:49152
  v_mfma_f32_16x16x32_bf16 v[148:151], a[228:231], a[52:55], v[148:151]
  ds_read_b64_tr_b16 a[202:203], v33 offset:50688
  v_mfma_f32_16x16x32_bf16 v[196:199], a[228:231], a[56:59], v[196:199]
  buffer_load_dwordx4 v43, s[12:15], s73 offen offset:2048 lds
  v_mfma_f32_16x16x32_bf16 v[244:247], a[228:231], a[60:63], v[244:247]
  s_waitcnt lgkmcnt(9)
  v_mfma_f32_16x16x32_bf16 v[104:107], a[232:235], a[48:51], v[104:107]
  ds_read_b64_tr_b16 a[204:205], v34 offset:49152
  v_mfma_f32_16x16x32_bf16 v[152:155], a[232:235], a[52:55], v[152:155]
  ds_read_b64_tr_b16 a[206:207], v34 offset:50688
  v_mfma_f32_16x16x32_bf16 v[200:203], a[232:235], a[56:59], v[200:203]
  v_mfma_f32_16x16x32_bf16 v[248:251], a[232:235], a[60:63], v[248:251]
  v_mfma_f32_16x16x32_bf16 v[108:111], a[236:239], a[48:51], v[108:111]
  ds_read_b64_tr_b16 a[208:209], v31 offset:49280
  v_mfma_f32_16x16x32_bf16 v[156:159], a[236:239], a[52:55], v[156:159]
  ds_read_b64_tr_b16 a[210:211], v31 offset:50816
  v_mfma_f32_16x16x32_bf16 v[204:207], a[236:239], a[56:59], v[204:207]
  v_mfma_f32_16x16x32_bf16 v[252:255], a[236:239], a[60:63], v[252:255]
  s_waitcnt lgkmcnt(6)
  v_mfma_f32_16x16x32_bf16 v[64:67], a[192:195], a[0:3], v[64:67]
  ds_read_b64_tr_b16 a[212:213], v32 offset:49280
  v_mfma_f32_16x16x32_bf16 v[112:115], a[192:195], a[4:7], v[112:115]
  ds_read_b64_tr_b16 a[214:215], v32 offset:50816
  v_mfma_f32_16x16x32_bf16 v[160:163], a[192:195], a[8:11], v[160:163]
  s_add_u32 m0, s75, 0
  s_add_u32 s74, s70, 768
  buffer_load_dwordx4 v9, s[8:11], s74 offen offset:0 lds
  v_mfma_f32_16x16x32_bf16 v[208:211], a[192:195], a[12:15], v[208:211]
  v_mfma_f32_16x16x32_bf16 v[68:71], a[196:199], a[0:3], v[68:71]
  ds_read_b64_tr_b16 a[216:217], v33 offset:49280
  v_mfma_f32_16x16x32_bf16 v[116:119], a[196:199], a[4:7], v[116:119]
  ds_read_b64_tr_b16 a[218:219], v33 offset:50816
  v_mfma_f32_16x16x32_bf16 v[164:167], a[196:199], a[8:11], v[164:167]
  buffer_load_dwordx4 v10, s[8:11], s74 offen offset:1024 lds
  v_mfma_f32_16x16x32_bf16 v[212:215], a[196:199], a[12:15], v[212:215]
  s_waitcnt lgkmcnt(6)
  v_mfma_f32_16x16x32_bf16 v[72:75], a[200:203], a[0:3], v[72:75]
  ds_read_b64_tr_b16 a[220:221], v34 offset:49280
  v_mfma_f32_16x16x32_bf16 v[120:123], a[200:203], a[4:7], v[120:123]
  ds_read_b64_tr_b16 a[222:223], v34 offset:50816
  v_mfma_f32_16x16x32_bf16 v[168:171], a[200:203], a[8:11], v[168:171]
  buffer_load_dwordx4 v11, s[8:11], s74 offen offset:2048 lds
  v_mfma_f32_16x16x32_bf16 v[216:219], a[200:203], a[12:15], v[216:219]
  v_mfma_f32_16x16x32_bf16 v[76:79], a[204:207], a[0:3], v[76:79]
  ds_read_b64_tr_b16 a[224:225], v31 offset:49408
  v_mfma_f32_16x16x32_bf16 v[124:127], a[204:207], a[4:7], v[124:127]
  ds_read_b64_tr_b16 a[226:227], v31 offset:50944
  v_mfma_f32_16x16x32_bf16 v[172:175], a[204:207], a[8:11], v[172:175]
  buffer_load_dwordx4 v12, s[8:11], s74 offen offset:3072 lds
  v_mfma_f32_16x16x32_bf16 v[220:223], a[204:207], a[12:15], v[220:223]
  s_waitcnt lgkmcnt(6)
  v_mfma_f32_16x16x32_bf16 v[80:83], a[208:211], a[0:3], v[80:83]
  ds_read_b64_tr_b16 a[228:229], v32 offset:49408
  v_mfma_f32_16x16x32_bf16 v[128:131], a[208:211], a[4:7], v[128:131]
  ds_read_b64_tr_b16 a[230:231], v32 offset:50944
  v_mfma_f32_16x16x32_bf16 v[176:179], a[208:211], a[8:11], v[176:179]
  s_add_u32 m0, s75, 4096
  s_add_u32 s74, s70, 768
  buffer_load_dwordx4 v13, s[8:11], s74 offen offset:0 lds
  v_mfma_f32_16x16x32_bf16 v[224:227], a[208:211], a[12:15], v[224:227]
  v_mfma_f32_16x16x32_bf16 v[84:87], a[212:215], a[0:3], v[84:87]
  ds_read_b64_tr_b16 a[232:233], v33 offset:49408
  v_mfma_f32_16x16x32_bf16 v[132:135], a[212:215], a[4:7], v[132:135]
  ds_read_b64_tr_b16 a[234:235], v33 offset:50944
  v_mfma_f32_16x16x32_bf16 v[180:183], a[212:215], a[8:11], v[180:183]
  buffer_load_dwordx4 v14, s[8:11], s74 offen offset:1024 lds
  v_mfma_f32_16x16x32_bf16 v[228:231], a[212:215], a[12:15], v[228:231]
  s_waitcnt lgkmcnt(6)
  v_mfma_f32_16x16x32_bf16 v[88:91], a[216:219], a[0:3], v[88:91]
  ds_read_b64_tr_b16 a[236:237], v34 offset:49408
  v_mfma_f32_16x16x32_bf16 v[136:139], a[216:219], a[4:7], v[136:139]
  ds_read_b64_tr_b16 a[238:239], v34 offset:50944
  v_mfma_f32_16x16x32_bf16 v[184:187], a[216:219], a[8:11], v[184:187]
  buffer_load_dwordx4 v15, s[8:11], s74 offen offset:2048 lds
  v_mfma_f32_16x16x32_bf16 v[232:235], a[216:219], a[12:15], v[232:235]
  s_waitcnt vmcnt(21)
  s_barrier
  v_mfma_f32_16x16x32_bf16 v[92:95], a[220:223], a[0:3], v[92:95]
  ds_read_b64_tr_b16 a[192:193], v31 offset:0
  v_mfma_f32_16x16x32_bf16 v[140:143], a[220:223], a[4:7], v[140:143]
  ds_read_b64_tr_b16 a[194:195], v31 offset:1536
  v_mfma_f32_16x16x32_bf16 v[188:191], a[220:223], a[8:11], v[188:191]
  buffer_load_dwordx4 v16, s[8:11], s74 offen offset:3072 lds
  v_mfma_f32_16x16x32_bf16 v[236:239], a[220:223], a[12:15], v[236:239]
  s_waitcnt lgkmcnt(6)
  v_mfma_f32_16x16x32_bf16 v[96:99], a[224:227], a[0:3], v[96:99]
  ds_read_b64_tr_b16 a[196:197], v32 offset:0
  v_mfma_f32_16x16x32_bf16 v[144:147], a[224:227], a[4:7], v[144:147]
  ds_read_b64_tr_b16 a[198:199], v32 offset:1536
  v_mfma_f32_16x16x32_bf16 v[192:195], a[224:227], a[8:11], v[192:195]
  s_add_u32 m0, s55, 61440
  s_add_u32 s73, s71, 4718592
  buffer_load_dwordx4 v41, s[12:15], s73 offen offset:0 lds
  v_mfma_f32_16x16x32_bf16 v[240:243], a[224:227], a[12:15], v[240:243]
  v_mfma_f32_16x16x32_bf16 v[100:103], a[228:231], a[0:3], v[100:103]
  ds_read_b64_tr_b16 a[200:201], v33 offset:0
  v_mfma_f32_16x16x32_bf16 v[148:151], a[228:231], a[4:7], v[148:151]
  ds_read_b64_tr_b16 a[202:203], v33 offset:1536
  v_mfma_f32_16x16x32_bf16 v[196:199], a[228:231], a[8:11], v[196:199]
  buffer_load_dwordx4 v42, s[12:15], s73 offen offset:1024 lds
  v_mfma_f32_16x16x32_bf16 v[244:247], a[228:231], a[12:15], v[244:247]
  s_waitcnt lgkmcnt(6)
  v_mfma_f32_16x16x32_bf16 v[104:107], a[232:235], a[0:3], v[104:107]
  ds_read_b64_tr_b16 a[204:205], v34 offset:0
  v_mfma_f32_16x16x32_bf16 v[152:155], a[232:235], a[4:7], v[152:155]
  ds_read_b64_tr_b16 a[206:207], v34 offset:1536
  v_mfma_f32_16x16x32_bf16 v[200:203], a[232:235], a[8:11], v[200:203]
  buffer_load_dwordx4 v43, s[12:15], s73 offen offset:2048 lds
  v_mfma_f32_16x16x32_bf16 v[248:251], a[232:235], a[12:15], v[248:251]
  v_mfma_f32_16x16x32_bf16 v[108:111], a[236:239], a[0:3], v[108:111]
  ds_read_b64_tr_b16 a[208:209], v31 offset:128
  v_mfma_f32_16x16x32_bf16 v[156:159], a[236:239], a[4:7], v[156:159]
  ds_read_b64_tr_b16 a[210:211], v31 offset:1664
  v_mfma_f32_16x16x32_bf16 v[204:207], a[236:239], a[8:11], v[204:207]
  v_mfma_f32_16x16x32_bf16 v[252:255], a[236:239], a[12:15], v[252:255]
  s_waitcnt lgkmcnt(6)
  v_mfma_f32_16x16x32_bf16 v[64:67], a[192:195], a[16:19], v[64:67]
  ds_read_b64_tr_b16 a[212:213], v32 offset:128
  v_mfma_f32_16x16x32_bf16 v[112:115], a[192:195], a[20:23], v[112:115]
  ds_read_b64_tr_b16 a[214:215], v32 offset:1664
  v_mfma_f32_16x16x32_bf16 v[160:163], a[192:195], a[24:27], v[160:163]
  v_mfma_f32_16x16x32_bf16 v[208:211], a[192:195], a[28:31], v[208:211]
  v_mfma_f32_16x16x32_bf16 v[68:71], a[196:199], a[16:19], v[68:71]
  ds_read_b64_tr_b16 a[216:217], v33 offset:128
  v_mfma_f32_16x16x32_bf16 v[116:119], a[196:199], a[20:23], v[116:119]
  ds_read_b64_tr_b16 a[218:219], v33 offset:1664
  v_mfma_f32_16x16x32_bf16 v[164:167], a[196:199], a[24:27], v[164:167]
  v_mfma_f32_16x16x32_bf16 v[212:215], a[196:199], a[28:31], v[212:215]
  s_waitcnt vmcnt(17)
  ds_read_b128 a[32:35], v29 offset:32768
  s_waitcnt lgkmcnt(7)
  v_mfma_f32_16x16x32_bf16 v[72:75], a[200:203], a[16:19], v[72:75]
  ds_read_b64_tr_b16 a[220:221], v34 offset:128
  v_mfma_f32_16x16x32_bf16 v[120:123], a[200:203], a[20:23], v[120:123]
  ds_read_b64_tr_b16 a[222:223], v34 offset:1664
  v_mfma_f32_16x16x32_bf16 v[168:171], a[200:203], a[24:27], v[168:171]
  v_mfma_f32_16x16x32_bf16 v[216:219], a[200:203], a[28:31], v[216:219]
  ds_read_b128 a[48:51], v30 offset:32768
  v_mfma_f32_16x16x32_bf16 v[76:79], a[204:207], a[16:19], v[76:79]
  ds_read_b64_tr_b16 a[224:225], v31 offset:256
  v_mfma_f32_16x16x32_bf16 v[124:127], a[204:207], a[20:23], v[124:127]
  ds_read_b64_tr_b16 a[226:227], v31 offset:1792
  v_mfma_f32_16x16x32_bf16 v[172:175], a[204:207], a[24:27], v[172:175]
  v_mfma_f32_16x16x32_bf16 v[220:223], a[204:207], a[28:31], v[220:223]
  ds_read_b128 a[36:39], v29 offset:34816
  s_waitcnt lgkmcnt(9)
  v_mfma_f32_16x16x32_bf16 v[80:83], a[208:211], a[16:19], v[80:83]
  ds_read_b64_tr_b16 a[228:229], v32 offset:256
  v_mfma_f32_16x16x32_bf16 v[128:131], a[208:211], a[20:23], v[128:131]
  ds_read_b64_tr_b16 a[230:231], v32 offset:1792
  v_mfma_f32_16x16x32_bf16 v[176:179], a[208:211], a[24:27], v[176:179]
  v_mfma_f32_16x16x32_bf16 v[224:227], a[208:211], a[28:31], v[224:227]
  ds_read_b128 a[52:55], v30 offset:34816
  v_mfma_f32_16x16x32_bf16 v[84:87], a[212:215], a[16:19], v[84:87]
  ds_read_b64_tr_b16 a[232:233], v33 offset:256
  v_mfma_f32_16x16x32_bf16 v[132:135], a[212:215], a[20:23], v[132:135]
  ds_read_b64_tr_b16 a[234:235], v33 offset:1792
  v_mfma_f32_16x16x32_bf16 v[180:183], a[212:215], a[24:27], v[180:183]
  v_mfma_f32_16x16x32_bf16 v[228:231], a[212:215], a[28:31], v[228:231]
  ds_read_b128 a[40:43], v29 offset:36864
  s_waitcnt lgkmcnt(10)
  v_mfma_f32_16x16x32_bf16 v[88:91], a[216:219], a[16:19], v[88:91]
  ds_read_b64_tr_b16 a[236:237], v34 offset:256
  v_mfma_f32_16x16x32_bf16 v[136:139], a[216:219], a[20:23], v[136:139]
  ds_read_b64_tr_b16 a[238:239], v34 offset:1792
  v_mfma_f32_16x16x32_bf16 v[184:187], a[216:219], a[24:27], v[184:187]
  v_mfma_f32_16x16x32_bf16 v[232:235], a[216:219], a[28:31], v[232:235]
  ds_read_b128 a[56:59], v30 offset:36864
  s_waitcnt vmcnt(14)
  s_barrier
  v_mfma_f32_16x16x32_bf16 v[92:95], a[220:223], a[16:19], v[92:95]
  ds_read_b64_tr_b16 a[192:193], v31 offset:12288
  v_mfma_f32_16x16x32_bf16 v[140:143], a[220:223], a[20:23], v[140:143]
  ds_read_b64_tr_b16 a[194:195], v31 offset:13824
  v_mfma_f32_16x16x32_bf16 v[188:191], a[220:223], a[24:27], v[188:191]
  s_add_u32 m0, s55, 86016
  s_add_u32 s73, s71, 5111808
  buffer_load_dwordx4 v41, s[12:15], s73 offen offset:0 lds
  v_mfma_f32_16x16x32_bf16 v[236:239], a[220:223], a[28:31], v[236:239]
  ds_read_b128 a[44:47], v29 offset:38912
  s_waitcnt lgkmcnt(10)
  v_mfma_f32_16x16x32_bf16 v[96:99], a[224:227], a[16:19], v[96:99]
  ds_read_b64_tr_b16 a[196:197], v32 offset:12288
  v_mfma_f32_16x16x32_bf16 v[144:147], a[224:227], a[20:23], v[144:147]
  ds_read_b64_tr_b16 a[198:199], v32 offset:13824
  v_mfma_f32_16x16x32_bf16 v[192:195], a[224:227], a[24:27], v[192:195]
  buffer_load_dwordx4 v42, s[12:15], s73 offen offset:1024 lds
  v_mfma_f32_16x16x32_bf16 v[240:243], a[224:227], a[28:31], v[240:243]
  ds_read_b128 a[60:63], v30 offset:38912
  v_mfma_f32_16x16x32_bf16 v[100:103], a[228:231], a[16:19], v[100:103]
  ds_read_b64_tr_b16 a[200:201], v33 offset:12288
  v_mfma_f32_16x16x32_bf16 v[148:151], a[228:231], a[20:23], v[148:151]
  ds_read_b64_tr_b16 a[202:203], v33 offset:13824
  v_mfma_f32_16x16x32_bf16 v[196:199], a[228:231], a[24:27], v[196:199]
  buffer_load_dwordx4 v43, s[12:15], s73 offen offset:2048 lds
  v_mfma_f32_16x16x32_bf16 v[244:247], a[228:231], a[28:31], v[244:247]
  s_waitcnt lgkmcnt(9)
  v_mfma_f32_16x16x32_bf16 v[104:107], a[232:235], a[16:19], v[104:107]
  ds_read_b64_tr_b16 a[204:205], v34 offset:12288
  v_mfma_f32_16x16x32_bf16 v[152:155], a[232:235], a[20:23], v[152:155]
  ds_read_b64_tr_b16 a[206:207], v34 offset:13824
  v_mfma_f32_16x16x32_bf16 v[200:203], a[232:235], a[24:27], v[200:203]
  v_mfma_f32_16x16x32_bf16 v[248:251], a[232:235], a[28:31], v[248:251]
  v_mfma_f32_16x16x32_bf16 v[108:111], a[236:239], a[16:19], v[108:111]
  ds_read_b64_tr_b16 a[208:209], v31 offset:12416
  v_mfma_f32_16x16x32_bf16 v[156:159], a[236:239], a[20:23], v[156:159]
  ds_read_b64_tr_b16 a[210:211], v31 offset:13952
  v_mfma_f32_16x16x32_bf16 v[204:207], a[236:239], a[24:27], v[204:207]
  v_mfma_f32_16x16x32_bf16 v[252:255], a[236:239], a[28:31], v[252:255]
  s_waitcnt lgkmcnt(6)
  v_mfma_f32_16x16x32_bf16 v[64:67], a[192:195], a[32:35], v[64:67]
  ds_read_b64_tr_b16 a[212:213], v32 offset:12416
  v_mfma_f32_16x16x32_bf16 v[112:115], a[192:195], a[36:39], v[112:115]
  ds_read_b64_tr_b16 a[214:215], v32 offset:13952
  v_mfma_f32_16x16x32_bf16 v[160:163], a[192:195], a[40:43], v[160:163]
  s_add_u32 m0, s75, 32768
  s_add_u32 s74, s70, 896
  buffer_load_dwordx4 v9, s[8:11], s74 offen offset:0 lds
  v_mfma_f32_16x16x32_bf16 v[208:211], a[192:195], a[44:47], v[208:211]
  v_mfma_f32_16x16x32_bf16 v[68:71], a[196:199], a[32:35], v[68:71]
  ds_read_b64_tr_b16 a[216:217], v33 offset:12416
  v_mfma_f32_16x16x32_bf16 v[116:119], a[196:199], a[36:39], v[116:119]
  ds_read_b64_tr_b16 a[218:219], v33 offset:13952
  v_mfma_f32_16x16x32_bf16 v[164:167], a[196:199], a[40:43], v[164:167]
  buffer_load_dwordx4 v10, s[8:11], s74 offen offset:1024 lds
  v_mfma_f32_16x16x32_bf16 v[212:215], a[196:199], a[44:47], v[212:215]
  s_waitcnt lgkmcnt(6)
  v_mfma_f32_16x16x32_bf16 v[72:75], a[200:203], a[32:35], v[72:75]
  ds_read_b64_tr_b16 a[220:221], v34 offset:12416
  v_mfma_f32_16x16x32_bf16 v[120:123], a[200:203], a[36:39], v[120:123]
  ds_read_b64_tr_b16 a[222:223], v34 offset:13952
  v_mfma_f32_16x16x32_bf16 v[168:171], a[200:203], a[40:43], v[168:171]
  buffer_load_dwordx4 v11, s[8:11], s74 offen offset:2048 lds
  v_mfma_f32_16x16x32_bf16 v[216:219], a[200:203], a[44:47], v[216:219]
  v_mfma_f32_16x16x32_bf16 v[76:79], a[204:207], a[32:35], v[76:79]
  ds_read_b64_tr_b16 a[224:225], v31 offset:12544
  v_mfma_f32_16x16x32_bf16 v[124:127], a[204:207], a[36:39], v[124:127]
  ds_read_b64_tr_b16 a[226:227], v31 offset:14080
  v_mfma_f32_16x16x32_bf16 v[172:175], a[204:207], a[40:43], v[172:175]
  buffer_load_dwordx4 v12, s[8:11], s74 offen offset:3072 lds
  v_mfma_f32_16x16x32_bf16 v[220:223], a[204:207], a[44:47], v[220:223]
  s_waitcnt lgkmcnt(6)
  v_mfma_f32_16x16x32_bf16 v[80:83], a[208:211], a[32:35], v[80:83]
  ds_read_b64_tr_b16 a[228:229], v32 offset:12544
  v_mfma_f32_16x16x32_bf16 v[128:131], a[208:211], a[36:39], v[128:131]
  ds_read_b64_tr_b16 a[230:231], v32 offset:14080
  v_mfma_f32_16x16x32_bf16 v[176:179], a[208:211], a[40:43], v[176:179]
  s_add_u32 m0, s75, 36864
  s_add_u32 s74, s70, 896
  buffer_load_dwordx4 v13, s[8:11], s74 offen offset:0 lds
  v_mfma_f32_16x16x32_bf16 v[224:227], a[208:211], a[44:47], v[224:227]
  v_mfma_f32_16x16x32_bf16 v[84:87], a[212:215], a[32:35], v[84:87]
  ds_read_b64_tr_b16 a[232:233], v33 offset:12544
  v_mfma_f32_16x16x32_bf16 v[132:135], a[212:215], a[36:39], v[132:135]
  ds_read_b64_tr_b16 a[234:235], v33 offset:14080
  v_mfma_f32_16x16x32_bf16 v[180:183], a[212:215], a[40:43], v[180:183]
  buffer_load_dwordx4 v14, s[8:11], s74 offen offset:1024 lds
  v_mfma_f32_16x16x32_bf16 v[228:231], a[212:215], a[44:47], v[228:231]
  s_waitcnt lgkmcnt(6)
  v_mfma_f32_16x16x32_bf16 v[88:91], a[216:219], a[32:35], v[88:91]
  ds_read_b64_tr_b16 a[236:237], v34 offset:12544
  v_mfma_f32_16x16x32_bf16 v[136:139], a[216:219], a[36:39], v[136:139]
  ds_read_b64_tr_b16 a[238:239], v34 offset:14080
  v_mfma_f32_16x16x32_bf16 v[184:187], a[216:219], a[40:43], v[184:187]
  buffer_load_dwordx4 v15, s[8:11], s74 offen offset:2048 lds
  v_mfma_f32_16x16x32_bf16 v[232:235], a[216:219], a[44:47], v[232:235]
  s_waitcnt vmcnt(21)
  s_barrier
  v_mfma_f32_16x16x32_bf16 v[92:95], a[220:223], a[32:35], v[92:95]
  ds_read_b64_tr_b16 a[192:193], v31 offset:36864
  v_mfma_f32_16x16x32_bf16 v[140:143], a[220:223], a[36:39], v[140:143]
  ds_read_b64_tr_b16 a[194:195], v31 offset:38400
  v_mfma_f32_16x16x32_bf16 v[188:191], a[220:223], a[40:43], v[188:191]
  buffer_load_dwordx4 v16, s[8:11], s74 offen offset:3072 lds
  v_mfma_f32_16x16x32_bf16 v[236:239], a[220:223], a[44:47], v[236:239]
  s_waitcnt lgkmcnt(6)
  v_mfma_f32_16x16x32_bf16 v[96:99], a[224:227], a[32:35], v[96:99]
  ds_read_b64_tr_b16 a[196:197], v32 offset:36864
  v_mfma_f32_16x16x32_bf16 v[144:147], a[224:227], a[36:39], v[144:147]
  ds_read_b64_tr_b16 a[198:199], v32 offset:38400
  v_mfma_f32_16x16x32_bf16 v[192:195], a[224:227], a[40:43], v[192:195]
  s_add_u32 m0, s55, 36864
  s_add_u32 s73, s71, 5505024
  buffer_load_dwordx4 v41, s[12:15], s73 offen offset:0 lds
  v_mfma_f32_16x16x32_bf16 v[240:243], a[224:227], a[44:47], v[240:243]
  v_mfma_f32_16x16x32_bf16 v[100:103], a[228:231], a[32:35], v[100:103]
  ds_read_b64_tr_b16 a[200:201], v33 offset:36864
  v_mfma_f32_16x16x32_bf16 v[148:151], a[228:231], a[36:39], v[148:151]
  ds_read_b64_tr_b16 a[202:203], v33 offset:38400
  v_mfma_f32_16x16x32_bf16 v[196:199], a[228:231], a[40:43], v[196:199]
  buffer_load_dwordx4 v42, s[12:15], s73 offen offset:1024 lds
  v_mfma_f32_16x16x32_bf16 v[244:247], a[228:231], a[44:47], v[244:247]
  s_waitcnt lgkmcnt(6)
  v_mfma_f32_16x16x32_bf16 v[104:107], a[232:235], a[32:35], v[104:107]
  ds_read_b64_tr_b16 a[204:205], v34 offset:36864
  v_mfma_f32_16x16x32_bf16 v[152:155], a[232:235], a[36:39], v[152:155]
  ds_read_b64_tr_b16 a[206:207], v34 offset:38400
  v_mfma_f32_16x16x32_bf16 v[200:203], a[232:235], a[40:43], v[200:203]
  buffer_load_dwordx4 v43, s[12:15], s73 offen offset:2048 lds
  v_mfma_f32_16x16x32_bf16 v[248:251], a[232:235], a[44:47], v[248:251]
  v_mfma_f32_16x16x32_bf16 v[108:111], a[236:239], a[32:35], v[108:111]
  ds_read_b64_tr_b16 a[208:209], v31 offset:36992
  v_mfma_f32_16x16x32_bf16 v[156:159], a[236:239], a[36:39], v[156:159]
  ds_read_b64_tr_b16 a[210:211], v31 offset:38528
  v_mfma_f32_16x16x32_bf16 v[204:207], a[236:239], a[40:43], v[204:207]
  v_mfma_f32_16x16x32_bf16 v[252:255], a[236:239], a[44:47], v[252:255]
  s_waitcnt lgkmcnt(6)
  v_mfma_f32_16x16x32_bf16 v[64:67], a[192:195], a[48:51], v[64:67]
  ds_read_b64_tr_b16 a[212:213], v32 offset:36992
  v_mfma_f32_16x16x32_bf16 v[112:115], a[192:195], a[52:55], v[112:115]
  ds_read_b64_tr_b16 a[214:215], v32 offset:38528
  v_mfma_f32_16x16x32_bf16 v[160:163], a[192:195], a[56:59], v[160:163]
  v_mfma_f32_16x16x32_bf16 v[208:211], a[192:195], a[60:63], v[208:211]
  v_mfma_f32_16x16x32_bf16 v[68:71], a[196:199], a[48:51], v[68:71]
  ds_read_b64_tr_b16 a[216:217], v33 offset:36992
  v_mfma_f32_16x16x32_bf16 v[116:119], a[196:199], a[52:55], v[116:119]
  ds_read_b64_tr_b16 a[218:219], v33 offset:38528
  v_mfma_f32_16x16x32_bf16 v[164:167], a[196:199], a[56:59], v[164:167]
  v_mfma_f32_16x16x32_bf16 v[212:215], a[196:199], a[60:63], v[212:215]
  s_waitcnt vmcnt(17)
  ds_read_b128 a[0:3], v29 offset:0
  s_waitcnt lgkmcnt(7)
  v_mfma_f32_16x16x32_bf16 v[72:75], a[200:203], a[48:51], v[72:75]
  ds_read_b64_tr_b16 a[220:221], v34 offset:36992
  v_mfma_f32_16x16x32_bf16 v[120:123], a[200:203], a[52:55], v[120:123]
  ds_read_b64_tr_b16 a[222:223], v34 offset:38528
  v_mfma_f32_16x16x32_bf16 v[168:171], a[200:203], a[56:59], v[168:171]
  v_mfma_f32_16x16x32_bf16 v[216:219], a[200:203], a[60:63], v[216:219]
  ds_read_b128 a[16:19], v30 offset:0
  v_mfma_f32_16x16x32_bf16 v[76:79], a[204:207], a[48:51], v[76:79]
  ds_read_b64_tr_b16 a[224:225], v31 offset:37120
  v_mfma_f32_16x16x32_bf16 v[124:127], a[204:207], a[52:55], v[124:127]
  ds_read_b64_tr_b16 a[226:227], v31 offset:38656
  v_mfma_f32_16x16x32_bf16 v[172:175], a[204:207], a[56:59], v[172:175]
  v_mfma_f32_16x16x32_bf16 v[220:223], a[204:207], a[60:63], v[220:223]
  ds_read_b128 a[4:7], v29 offset:2048
  s_waitcnt lgkmcnt(9)
  v_mfma_f32_16x16x32_bf16 v[80:83], a[208:211], a[48:51], v[80:83]
  ds_read_b64_tr_b16 a[228:229], v32 offset:37120
  v_mfma_f32_16x16x32_bf16 v[128:131], a[208:211], a[52:55], v[128:131]
  ds_read_b64_tr_b16 a[230:231], v32 offset:38656
  v_mfma_f32_16x16x32_bf16 v[176:179], a[208:211], a[56:59], v[176:179]
  v_mfma_f32_16x16x32_bf16 v[224:227], a[208:211], a[60:63], v[224:227]
  ds_read_b128 a[20:23], v30 offset:2048
  v_mfma_f32_16x16x32_bf16 v[84:87], a[212:215], a[48:51], v[84:87]
  ds_read_b64_tr_b16 a[232:233], v33 offset:37120
  v_mfma_f32_16x16x32_bf16 v[132:135], a[212:215], a[52:55], v[132:135]
  ds_read_b64_tr_b16 a[234:235], v33 offset:38656
  v_mfma_f32_16x16x32_bf16 v[180:183], a[212:215], a[56:59], v[180:183]
  v_mfma_f32_16x16x32_bf16 v[228:231], a[212:215], a[60:63], v[228:231]
  ds_read_b128 a[8:11], v29 offset:4096
  s_waitcnt lgkmcnt(10)
  v_mfma_f32_16x16x32_bf16 v[88:91], a[216:219], a[48:51], v[88:91]
  ds_read_b64_tr_b16 a[236:237], v34 offset:37120
  v_mfma_f32_16x16x32_bf16 v[136:139], a[216:219], a[52:55], v[136:139]
  ds_read_b64_tr_b16 a[238:239], v34 offset:38656
  v_mfma_f32_16x16x32_bf16 v[184:187], a[216:219], a[56:59], v[184:187]
  v_mfma_f32_16x16x32_bf16 v[232:235], a[216:219], a[60:63], v[232:235]
  ds_read_b128 a[24:27], v30 offset:4096
  s_waitcnt vmcnt(14)
  s_barrier
  v_mfma_f32_16x16x32_bf16 v[92:95], a[220:223], a[48:51], v[92:95]
  ds_read_b64_tr_b16 a[192:193], v31 offset:24576
  v_mfma_f32_16x16x32_bf16 v[140:143], a[220:223], a[52:55], v[140:143]
  ds_read_b64_tr_b16 a[194:195], v31 offset:26112
  v_mfma_f32_16x16x32_bf16 v[188:191], a[220:223], a[56:59], v[188:191]
  s_add_u32 m0, s55, 49152
  s_add_u32 s73, s71, 5898240
  buffer_load_dwordx4 v41, s[12:15], s73 offen offset:0 lds
  v_mfma_f32_16x16x32_bf16 v[236:239], a[220:223], a[60:63], v[236:239]
  ds_read_b128 a[12:15], v29 offset:6144
  s_waitcnt lgkmcnt(10)
  v_mfma_f32_16x16x32_bf16 v[96:99], a[224:227], a[48:51], v[96:99]
  ds_read_b64_tr_b16 a[196:197], v32 offset:24576
  v_mfma_f32_16x16x32_bf16 v[144:147], a[224:227], a[52:55], v[144:147]
  ds_read_b64_tr_b16 a[198:199], v32 offset:26112
  v_mfma_f32_16x16x32_bf16 v[192:195], a[224:227], a[56:59], v[192:195]
  buffer_load_dwordx4 v42, s[12:15], s73 offen offset:1024 lds
  v_mfma_f32_16x16x32_bf16 v[240:243], a[224:227], a[60:63], v[240:243]
  ds_read_b128 a[28:31], v30 offset:6144
  v_mfma_f32_16x16x32_bf16 v[100:103], a[228:231], a[48:51], v[100:103]
  ds_read_b64_tr_b16 a[200:201], v33 offset:24576
  v_mfma_f32_16x16x32_bf16 v[148:151], a[228:231], a[52:55], v[148:151]
  ds_read_b64_tr_b16 a[202:203], v33 offset:26112
  v_mfma_f32_16x16x32_bf16 v[196:199], a[228:231], a[56:59], v[196:199]
  buffer_load_dwordx4 v43, s[12:15], s73 offen offset:2048 lds
  v_mfma_f32_16x16x32_bf16 v[244:247], a[228:231], a[60:63], v[244:247]
  s_waitcnt lgkmcnt(9)
  v_mfma_f32_16x16x32_bf16 v[104:107], a[232:235], a[48:51], v[104:107]
  ds_read_b64_tr_b16 a[204:205], v34 offset:24576
  v_mfma_f32_16x16x32_bf16 v[152:155], a[232:235], a[52:55], v[152:155]
  ds_read_b64_tr_b16 a[206:207], v34 offset:26112
  v_mfma_f32_16x16x32_bf16 v[200:203], a[232:235], a[56:59], v[200:203]
  v_mfma_f32_16x16x32_bf16 v[248:251], a[232:235], a[60:63], v[248:251]
  v_mfma_f32_16x16x32_bf16 v[108:111], a[236:239], a[48:51], v[108:111]
  ds_read_b64_tr_b16 a[208:209], v31 offset:24704
  v_mfma_f32_16x16x32_bf16 v[156:159], a[236:239], a[52:55], v[156:159]
  ds_read_b64_tr_b16 a[210:211], v31 offset:26240
  v_mfma_f32_16x16x32_bf16 v[204:207], a[236:239], a[56:59], v[204:207]
  v_mfma_f32_16x16x32_bf16 v[252:255], a[236:239], a[60:63], v[252:255]
  s_waitcnt lgkmcnt(6)
  v_mfma_f32_16x16x32_bf16 v[64:67], a[192:195], a[0:3], v[64:67]
  ds_read_b64_tr_b16 a[212:213], v32 offset:24704
  v_mfma_f32_16x16x32_bf16 v[112:115], a[192:195], a[4:7], v[112:115]
  ds_read_b64_tr_b16 a[214:215], v32 offset:26240
  v_mfma_f32_16x16x32_bf16 v[160:163], a[192:195], a[8:11], v[160:163]
  s_add_u32 m0, s75, 0
  s_add_u32 s74, s70, 1024
  buffer_load_dwordx4 v9, s[8:11], s74 offen offset:0 lds
  v_mfma_f32_16x16x32_bf16 v[208:211], a[192:195], a[12:15], v[208:211]
  v_mfma_f32_16x16x32_bf16 v[68:71], a[196:199], a[0:3], v[68:71]
  ds_read_b64_tr_b16 a[216:217], v33 offset:24704
  v_mfma_f32_16x16x32_bf16 v[116:119], a[196:199], a[4:7], v[116:119]
  ds_read_b64_tr_b16 a[218:219], v33 offset:26240
  v_mfma_f32_16x16x32_bf16 v[164:167], a[196:199], a[8:11], v[164:167]
  buffer_load_dwordx4 v10, s[8:11], s74 offen offset:1024 lds
  v_mfma_f32_16x16x32_bf16 v[212:215], a[196:199], a[12:15], v[212:215]
  s_waitcnt lgkmcnt(6)
  v_mfma_f32_16x16x32_bf16 v[72:75], a[200:203], a[0:3], v[72:75]
  ds_read_b64_tr_b16 a[220:221], v34 offset:24704
  v_mfma_f32_16x16x32_bf16 v[120:123], a[200:203], a[4:7], v[120:123]
  ds_read_b64_tr_b16 a[222:223], v34 offset:26240
  v_mfma_f32_16x16x32_bf16 v[168:171], a[200:203], a[8:11], v[168:171]
  buffer_load_dwordx4 v11, s[8:11], s74 offen offset:2048 lds
  v_mfma_f32_16x16x32_bf16 v[216:219], a[200:203], a[12:15], v[216:219]
  v_mfma_f32_16x16x32_bf16 v[76:79], a[204:207], a[0:3], v[76:79]
  ds_read_b64_tr_b16 a[224:225], v31 offset:24832
  v_mfma_f32_16x16x32_bf16 v[124:127], a[204:207], a[4:7], v[124:127]
  ds_read_b64_tr_b16 a[226:227], v31 offset:26368
  v_mfma_f32_16x16x32_bf16 v[172:175], a[204:207], a[8:11], v[172:175]
  buffer_load_dwordx4 v12, s[8:11], s74 offen offset:3072 lds
  v_mfma_f32_16x16x32_bf16 v[220:223], a[204:207], a[12:15], v[220:223]
  s_waitcnt lgkmcnt(6)
  v_mfma_f32_16x16x32_bf16 v[80:83], a[208:211], a[0:3], v[80:83]
  ds_read_b64_tr_b16 a[228:229], v32 offset:24832
  v_mfma_f32_16x16x32_bf16 v[128:131], a[208:211], a[4:7], v[128:131]
  ds_read_b64_tr_b16 a[230:231], v32 offset:26368
  v_mfma_f32_16x16x32_bf16 v[176:179], a[208:211], a[8:11], v[176:179]
  s_add_u32 m0, s75, 4096
  s_add_u32 s74, s70, 1024
  buffer_load_dwordx4 v13, s[8:11], s74 offen offset:0 lds
  v_mfma_f32_16x16x32_bf16 v[224:227], a[208:211], a[12:15], v[224:227]
  v_mfma_f32_16x16x32_bf16 v[84:87], a[212:215], a[0:3], v[84:87]
  ds_read_b64_tr_b16 a[232:233], v33 offset:24832
  v_mfma_f32_16x16x32_bf16 v[132:135], a[212:215], a[4:7], v[132:135]
  ds_read_b64_tr_b16 a[234:235], v33 offset:26368
  v_mfma_f32_16x16x32_bf16 v[180:183], a[212:215], a[8:11], v[180:183]
  buffer_load_dwordx4 v14, s[8:11], s74 offen offset:1024 lds
  v_mfma_f32_16x16x32_bf16 v[228:231], a[212:215], a[12:15], v[228:231]
  s_waitcnt lgkmcnt(6)
  v_mfma_f32_16x16x32_bf16 v[88:91], a[216:219], a[0:3], v[88:91]
  ds_read_b64_tr_b16 a[236:237], v34 offset:24832
  v_mfma_f32_16x16x32_bf16 v[136:139], a[216:219], a[4:7], v[136:139]
  ds_read_b64_tr_b16 a[238:239], v34 offset:26368
  v_mfma_f32_16x16x32_bf16 v[184:187], a[216:219], a[8:11], v[184:187]
  buffer_load_dwordx4 v15, s[8:11], s74 offen offset:2048 lds
  v_mfma_f32_16x16x32_bf16 v[232:235], a[216:219], a[12:15], v[232:235]
  s_waitcnt vmcnt(21)
  s_barrier
  v_mfma_f32_16x16x32_bf16 v[92:95], a[220:223], a[0:3], v[92:95]
  ds_read_b64_tr_b16 a[192:193], v31 offset:49152
  v_mfma_f32_16x16x32_bf16 v[140:143], a[220:223], a[4:7], v[140:143]
  ds_read_b64_tr_b16 a[194:195], v31 offset:50688
  v_mfma_f32_16x16x32_bf16 v[188:191], a[220:223], a[8:11], v[188:191]
  buffer_load_dwordx4 v16, s[8:11], s74 offen offset:3072 lds
  v_mfma_f32_16x16x32_bf16 v[236:239], a[220:223], a[12:15], v[236:239]
  s_waitcnt lgkmcnt(6)
  v_mfma_f32_16x16x32_bf16 v[96:99], a[224:227], a[0:3], v[96:99]
  ds_read_b64_tr_b16 a[196:197], v32 offset:49152
  v_mfma_f32_16x16x32_bf16 v[144:147], a[224:227], a[4:7], v[144:147]
  ds_read_b64_tr_b16 a[198:199], v32 offset:50688
  v_mfma_f32_16x16x32_bf16 v[192:195], a[224:227], a[8:11], v[192:195]
  s_add_u32 m0, s55, 73728
  s_add_u32 s73, s71, 6291456
  buffer_load_dwordx4 v41, s[12:15], s73 offen offset:0 lds
  v_mfma_f32_16x16x32_bf16 v[240:243], a[224:227], a[12:15], v[240:243]
  v_mfma_f32_16x16x32_bf16 v[100:103], a[228:231], a[0:3], v[100:103]
  ds_read_b64_tr_b16 a[200:201], v33 offset:49152
  v_mfma_f32_16x16x32_bf16 v[148:151], a[228:231], a[4:7], v[148:151]
  ds_read_b64_tr_b16 a[202:203], v33 offset:50688
  v_mfma_f32_16x16x32_bf16 v[196:199], a[228:231], a[8:11], v[196:199]
  buffer_load_dwordx4 v42, s[12:15], s73 offen offset:1024 lds
  v_mfma_f32_16x16x32_bf16 v[244:247], a[228:231], a[12:15], v[244:247]
  s_waitcnt lgkmcnt(6)
  v_mfma_f32_16x16x32_bf16 v[104:107], a[232:235], a[0:3], v[104:107]
  ds_read_b64_tr_b16 a[204:205], v34 offset:49152
  v_mfma_f32_16x16x32_bf16 v[152:155], a[232:235], a[4:7], v[152:155]
  ds_read_b64_tr_b16 a[206:207], v34 offset:50688
  v_mfma_f32_16x16x32_bf16 v[200:203], a[232:235], a[8:11], v[200:203]
  buffer_load_dwordx4 v43, s[12:15], s73 offen offset:2048 lds
  v_mfma_f32_16x16x32_bf16 v[248:251], a[232:235], a[12:15], v[248:251]
  v_mfma_f32_16x16x32_bf16 v[108:111], a[236:239], a[0:3], v[108:111]
  ds_read_b64_tr_b16 a[208:209], v31 offset:49280
  v_mfma_f32_16x16x32_bf16 v[156:159], a[236:239], a[4:7], v[156:159]
  ds_read_b64_tr_b16 a[210:211], v31 offset:50816
  v_mfma_f32_16x16x32_bf16 v[204:207], a[236:239], a[8:11], v[204:207]
  v_mfma_f32_16x16x32_bf16 v[252:255], a[236:239], a[12:15], v[252:255]
  s_waitcnt lgkmcnt(6)
  v_mfma_f32_16x16x32_bf16 v[64:67], a[192:195], a[16:19], v[64:67]
  ds_read_b64_tr_b16 a[212:213], v32 offset:49280
  v_mfma_f32_16x16x32_bf16 v[112:115], a[192:195], a[20:23], v[112:115]
  ds_read_b64_tr_b16 a[214:215], v32 offset:50816
  v_mfma_f32_16x16x32_bf16 v[160:163], a[192:195], a[24:27], v[160:163]
  v_mfma_f32_16x16x32_bf16 v[208:211], a[192:195], a[28:31], v[208:211]
  v_mfma_f32_16x16x32_bf16 v[68:71], a[196:199], a[16:19], v[68:71]
  ds_read_b64_tr_b16 a[216:217], v33 offset:49280
  v_mfma_f32_16x16x32_bf16 v[116:119], a[196:199], a[20:23], v[116:119]
  ds_read_b64_tr_b16 a[218:219], v33 offset:50816
  v_mfma_f32_16x16x32_bf16 v[164:167], a[196:199], a[24:27], v[164:167]
  v_mfma_f32_16x16x32_bf16 v[212:215], a[196:199], a[28:31], v[212:215]
  s_waitcnt vmcnt(17)
  ds_read_b128 a[32:35], v29 offset:32768
  s_waitcnt lgkmcnt(7)
  v_mfma_f32_16x16x32_bf16 v[72:75], a[200:203], a[16:19], v[72:75]
  ds_read_b64_tr_b16 a[220:221], v34 offset:49280
  v_mfma_f32_16x16x32_bf16 v[120:123], a[200:203], a[20:23], v[120:123]
  ds_read_b64_tr_b16 a[222:223], v34 offset:50816
  v_mfma_f32_16x16x32_bf16 v[168:171], a[200:203], a[24:27], v[168:171]
  v_mfma_f32_16x16x32_bf16 v[216:219], a[200:203], a[28:31], v[216:219]
  ds_read_b128 a[48:51], v30 offset:32768
  v_mfma_f32_16x16x32_bf16 v[76:79], a[204:207], a[16:19], v[76:79]
  ds_read_b64_tr_b16 a[224:225], v31 offset:49408
  v_mfma_f32_16x16x32_bf16 v[124:127], a[204:207], a[20:23], v[124:127]
  ds_read_b64_tr_b16 a[226:227], v31 offset:50944
  v_mfma_f32_16x16x32_bf16 v[172:175], a[204:207], a[24:27], v[172:175]
  v_mfma_f32_16x16x32_bf16 v[220:223], a[204:207], a[28:31], v[220:223]
  ds_read_b128 a[36:39], v29 offset:34816
  s_waitcnt lgkmcnt(9)
  v_mfma_f32_16x16x32_bf16 v[80:83], a[208:211], a[16:19], v[80:83]
  ds_read_b64_tr_b16 a[228:229], v32 offset:49408
  v_mfma_f32_16x16x32_bf16 v[128:131], a[208:211], a[20:23], v[128:131]
  ds_read_b64_tr_b16 a[230:231], v32 offset:50944
  v_mfma_f32_16x16x32_bf16 v[176:179], a[208:211], a[24:27], v[176:179]
  v_mfma_f32_16x16x32_bf16 v[224:227], a[208:211], a[28:31], v[224:227]
  ds_read_b128 a[52:55], v30 offset:34816
  v_mfma_f32_16x16x32_bf16 v[84:87], a[212:215], a[16:19], v[84:87]
  ds_read_b64_tr_b16 a[232:233], v33 offset:49408
  v_mfma_f32_16x16x32_bf16 v[132:135], a[212:215], a[20:23], v[132:135]
  ds_read_b64_tr_b16 a[234:235], v33 offset:50944
  v_mfma_f32_16x16x32_bf16 v[180:183], a[212:215], a[24:27], v[180:183]
  v_mfma_f32_16x16x32_bf16 v[228:231], a[212:215], a[28:31], v[228:231]
  ds_read_b128 a[40:43], v29 offset:36864
  s_waitcnt lgkmcnt(10)
  v_mfma_f32_16x16x32_bf16 v[88:91], a[216:219], a[16:19], v[88:91]
  ds_read_b64_tr_b16 a[236:237], v34 offset:49408
  v_mfma_f32_16x16x32_bf16 v[136:139], a[216:219], a[20:23], v[136:139]
  ds_read_b64_tr_b16 a[238:239], v34 offset:50944
  v_mfma_f32_16x16x32_bf16 v[184:187], a[216:219], a[24:27], v[184:187]
  v_mfma_f32_16x16x32_bf16 v[232:235], a[216:219], a[28:31], v[232:235]
  ds_read_b128 a[56:59], v30 offset:36864
  s_waitcnt vmcnt(14)
  s_barrier
  v_mfma_f32_16x16x32_bf16 v[92:95], a[220:223], a[16:19], v[92:95]
  ds_read_b64_tr_b16 a[192:193], v31 offset:0
  v_mfma_f32_16x16x32_bf16 v[140:143], a[220:223], a[20:23], v[140:143]
  ds_read_b64_tr_b16 a[194:195], v31 offset:1536
  v_mfma_f32_16x16x32_bf16 v[188:191], a[220:223], a[24:27], v[188:191]
  s_add_u32 m0, s55, 61440
  s_add_u32 s73, s71, 6684672
  buffer_load_dwordx4 v41, s[12:15], s73 offen offset:0 lds
  v_mfma_f32_16x16x32_bf16 v[236:239], a[220:223], a[28:31], v[236:239]
  ds_read_b128 a[44:47], v29 offset:38912
  s_waitcnt lgkmcnt(10)
  v_mfma_f32_16x16x32_bf16 v[96:99], a[224:227], a[16:19], v[96:99]
  ds_read_b64_tr_b16 a[196:197], v32 offset:0
  v_mfma_f32_16x16x32_bf16 v[144:147], a[224:227], a[20:23], v[144:147]
  ds_read_b64_tr_b16 a[198:199], v32 offset:1536
  v_mfma_f32_16x16x32_bf16 v[192:195], a[224:227], a[24:27], v[192:195]
  buffer_load_dwordx4 v42, s[12:15], s73 offen offset:1024 lds
  v_mfma_f32_16x16x32_bf16 v[240:243], a[224:227], a[28:31], v[240:243]
  ds_read_b128 a[60:63], v30 offset:38912
  v_mfma_f32_16x16x32_bf16 v[100:103], a[228:231], a[16:19], v[100:103]
  ds_read_b64_tr_b16 a[200:201], v33 offset:0
  v_mfma_f32_16x16x32_bf16 v[148:151], a[228:231], a[20:23], v[148:151]
  ds_read_b64_tr_b16 a[202:203], v33 offset:1536
  v_mfma_f32_16x16x32_bf16 v[196:199], a[228:231], a[24:27], v[196:199]
  buffer_load_dwordx4 v43, s[12:15], s73 offen offset:2048 lds
  v_mfma_f32_16x16x32_bf16 v[244:247], a[228:231], a[28:31], v[244:247]
  s_waitcnt lgkmcnt(9)
  v_mfma_f32_16x16x32_bf16 v[104:107], a[232:235], a[16:19], v[104:107]
  ds_read_b64_tr_b16 a[204:205], v34 offset:0
  v_mfma_f32_16x16x32_bf16 v[152:155], a[232:235], a[20:23], v[152:155]
  ds_read_b64_tr_b16 a[206:207], v34 offset:1536
  v_mfma_f32_16x16x32_bf16 v[200:203], a[232:235], a[24:27], v[200:203]
  v_mfma_f32_16x16x32_bf16 v[248:251], a[232:235], a[28:31], v[248:251]
  v_mfma_f32_16x16x32_bf16 v[108:111], a[236:239], a[16:19], v[108:111]
  ds_read_b64_tr_b16 a[208:209], v31 offset:128
  v_mfma_f32_16x16x32_bf16 v[156:159], a[236:239], a[20:23], v[156:159]
  ds_read_b64_tr_b16 a[210:211], v31 offset:1664
  v_mfma_f32_16x16x32_bf16 v[204:207], a[236:239], a[24:27], v[204:207]
  v_mfma_f32_16x16x32_bf16 v[252:255], a[236:239], a[28:31], v[252:255]
  s_waitcnt lgkmcnt(6)
  v_mfma_f32_16x16x32_bf16 v[64:67], a[192:195], a[32:35], v[64:67]
  ds_read_b64_tr_b16 a[212:213], v32 offset:128
  v_mfma_f32_16x16x32_bf16 v[112:115], a[192:195], a[36:39], v[112:115]
  ds_read_b64_tr_b16 a[214:215], v32 offset:1664
  v_mfma_f32_16x16x32_bf16 v[160:163], a[192:195], a[40:43], v[160:163]
  s_add_u32 m0, s75, 32768
  s_add_u32 s74, s70, 1152
  buffer_load_dwordx4 v9, s[8:11], s74 offen offset:0 lds
  v_mfma_f32_16x16x32_bf16 v[208:211], a[192:195], a[44:47], v[208:211]
  v_mfma_f32_16x16x32_bf16 v[68:71], a[196:199], a[32:35], v[68:71]
  ds_read_b64_tr_b16 a[216:217], v33 offset:128
  v_mfma_f32_16x16x32_bf16 v[116:119], a[196:199], a[36:39], v[116:119]
  ds_read_b64_tr_b16 a[218:219], v33 offset:1664
  v_mfma_f32_16x16x32_bf16 v[164:167], a[196:199], a[40:43], v[164:167]
  buffer_load_dwordx4 v10, s[8:11], s74 offen offset:1024 lds
  v_mfma_f32_16x16x32_bf16 v[212:215], a[196:199], a[44:47], v[212:215]
  s_waitcnt lgkmcnt(6)
  v_mfma_f32_16x16x32_bf16 v[72:75], a[200:203], a[32:35], v[72:75]
  ds_read_b64_tr_b16 a[220:221], v34 offset:128
  v_mfma_f32_16x16x32_bf16 v[120:123], a[200:203], a[36:39], v[120:123]
  ds_read_b64_tr_b16 a[222:223], v34 offset:1664
  v_mfma_f32_16x16x32_bf16 v[168:171], a[200:203], a[40:43], v[168:171]
  buffer_load_dwordx4 v11, s[8:11], s74 offen offset:2048 lds
  v_mfma_f32_16x16x32_bf16 v[216:219], a[200:203], a[44:47], v[216:219]
  v_mfma_f32_16x16x32_bf16 v[76:79], a[204:207], a[32:35], v[76:79]
  ds_read_b64_tr_b16 a[224:225], v31 offset:256
  v_mfma_f32_16x16x32_bf16 v[124:127], a[204:207], a[36:39], v[124:127]
  ds_read_b64_tr_b16 a[226:227], v31 offset:1792
  v_mfma_f32_16x16x32_bf16 v[172:175], a[204:207], a[40:43], v[172:175]
  buffer_load_dwordx4 v12, s[8:11], s74 offen offset:3072 lds
  v_mfma_f32_16x16x32_bf16 v[220:223], a[204:207], a[44:47], v[220:223]
  s_waitcnt lgkmcnt(6)
  v_mfma_f32_16x16x32_bf16 v[80:83], a[208:211], a[32:35], v[80:83]
  ds_read_b64_tr_b16 a[228:229], v32 offset:256
  v_mfma_f32_16x16x32_bf16 v[128:131], a[208:211], a[36:39], v[128:131]
  ds_read_b64_tr_b16 a[230:231], v32 offset:1792
  v_mfma_f32_16x16x32_bf16 v[176:179], a[208:211], a[40:43], v[176:179]
  s_add_u32 m0, s75, 36864
  s_add_u32 s74, s70, 1152
  buffer_load_dwordx4 v13, s[8:11], s74 offen offset:0 lds
  v_mfma_f32_16x16x32_bf16 v[224:227], a[208:211], a[44:47], v[224:227]
  v_mfma_f32_16x16x32_bf16 v[84:87], a[212:215], a[32:35], v[84:87]
  ds_read_b64_tr_b16 a[232:233], v33 offset:256
  v_mfma_f32_16x16x32_bf16 v[132:135], a[212:215], a[36:39], v[132:135]
  ds_read_b64_tr_b16 a[234:235], v33 offset:1792
  v_mfma_f32_16x16x32_bf16 v[180:183], a[212:215], a[40:43], v[180:183]
  buffer_load_dwordx4 v14, s[8:11], s74 offen offset:1024 lds
  v_mfma_f32_16x16x32_bf16 v[228:231], a[212:215], a[44:47], v[228:231]
  s_waitcnt lgkmcnt(6)
  v_mfma_f32_16x16x32_bf16 v[88:91], a[216:219], a[32:35], v[88:91]
  ds_read_b64_tr_b16 a[236:237], v34 offset:256
  v_mfma_f32_16x16x32_bf16 v[136:139], a[216:219], a[36:39], v[136:139]
  ds_read_b64_tr_b16 a[238:239], v34 offset:1792
  v_mfma_f32_16x16x32_bf16 v[184:187], a[216:219], a[40:43], v[184:187]
  buffer_load_dwordx4 v15, s[8:11], s74 offen offset:2048 lds
  v_mfma_f32_16x16x32_bf16 v[232:235], a[216:219], a[44:47], v[232:235]
  s_waitcnt vmcnt(21)
  s_barrier
  v_mfma_f32_16x16x32_bf16 v[92:95], a[220:223], a[32:35], v[92:95]
  ds_read_b64_tr_b16 a[192:193], v31 offset:12288
  v_mfma_f32_16x16x32_bf16 v[140:143], a[220:223], a[36:39], v[140:143]
  ds_read_b64_tr_b16 a[194:195], v31 offset:13824
  v_mfma_f32_16x16x32_bf16 v[188:191], a[220:223], a[40:43], v[188:191]
  buffer_load_dwordx4 v16, s[8:11], s74 offen offset:3072 lds
  v_mfma_f32_16x16x32_bf16 v[236:239], a[220:223], a[44:47], v[236:239]
  s_waitcnt lgkmcnt(6)
  v_mfma_f32_16x16x32_bf16 v[96:99], a[224:227], a[32:35], v[96:99]
  ds_read_b64_tr_b16 a[196:197], v32 offset:12288
  v_mfma_f32_16x16x32_bf16 v[144:147], a[224:227], a[36:39], v[144:147]
  ds_read_b64_tr_b16 a[198:199], v32 offset:13824
  v_mfma_f32_16x16x32_bf16 v[192:195], a[224:227], a[40:43], v[192:195]
  s_add_u32 m0, s55, 86016
  s_add_u32 s73, s71, 7077888
  buffer_load_dwordx4 v41, s[12:15], s73 offen offset:0 lds
  v_mfma_f32_16x16x32_bf16 v[240:243], a[224:227], a[44:47], v[240:243]
  v_mfma_f32_16x16x32_bf16 v[100:103], a[228:231], a[32:35], v[100:103]
  ds_read_b64_tr_b16 a[200:201], v33 offset:12288
  v_mfma_f32_16x16x32_bf16 v[148:151], a[228:231], a[36:39], v[148:151]
  ds_read_b64_tr_b16 a[202:203], v33 offset:13824
  v_mfma_f32_16x16x32_bf16 v[196:199], a[228:231], a[40:43], v[196:199]
  buffer_load_dwordx4 v42, s[12:15], s73 offen offset:1024 lds
  v_mfma_f32_16x16x32_bf16 v[244:247], a[228:231], a[44:47], v[244:247]
  s_waitcnt lgkmcnt(6)
  v_mfma_f32_16x16x32_bf16 v[104:107], a[232:235], a[32:35], v[104:107]
  ds_read_b64_tr_b16 a[204:205], v34 offset:12288
  v_mfma_f32_16x16x32_bf16 v[152:155], a[232:235], a[36:39], v[152:155]
  ds_read_b64_tr_b16 a[206:207], v34 offset:13824
  v_mfma_f32_16x16x32_bf16 v[200:203], a[232:235], a[40:43], v[200:203]
  buffer_load_dwordx4 v43, s[12:15], s73 offen offset:2048 lds
  v_mfma_f32_16x16x32_bf16 v[248:251], a[232:235], a[44:47], v[248:251]
  v_mfma_f32_16x16x32_bf16 v[108:111], a[236:239], a[32:35], v[108:111]
  ds_read_b64_tr_b16 a[208:209], v31 offset:12416
  v_mfma_f32_16x16x32_bf16 v[156:159], a[236:239], a[36:39], v[156:159]
  ds_read_b64_tr_b16 a[210:211], v31 offset:13952
  v_mfma_f32_16x16x32_bf16 v[204:207], a[236:239], a[40:43], v[204:207]
  v_mfma_f32_16x16x32_bf16 v[252:255], a[236:239], a[44:47], v[252:255]
  s_waitcnt lgkmcnt(6)
  v_mfma_f32_16x16x32_bf16 v[64:67], a[192:195], a[48:51], v[64:67]
  ds_read_b64_tr_b16 a[212:213], v32 offset:12416
  v_mfma_f32_16x16x32_bf16 v[112:115], a[192:195], a[52:55], v[112:115]
  ds_read_b64_tr_b16 a[214:215], v32 offset:13952
  v_mfma_f32_16x16x32_bf16 v[160:163], a[192:195], a[56:59], v[160:163]
  v_mfma_f32_16x16x32_bf16 v[208:211], a[192:195], a[60:63], v[208:211]
  v_mfma_f32_16x16x32_bf16 v[68:71], a[196:199], a[48:51], v[68:71]
  ds_read_b64_tr_b16 a[216:217], v33 offset:12416
  v_mfma_f32_16x16x32_bf16 v[116:119], a[196:199], a[52:55], v[116:119]
  ds_read_b64_tr_b16 a[218:219], v33 offset:13952
  v_mfma_f32_16x16x32_bf16 v[164:167], a[196:199], a[56:59], v[164:167]
  v_mfma_f32_16x16x32_bf16 v[212:215], a[196:199], a[60:63], v[212:215]
  s_waitcnt vmcnt(17)
  ds_read_b128 a[0:3], v29 offset:0
  s_waitcnt lgkmcnt(7)
  v_mfma_f32_16x16x32_bf16 v[72:75], a[200:203], a[48:51], v[72:75]
  ds_read_b64_tr_b16 a[220:221], v34 offset:12416
  v_mfma_f32_16x16x32_bf16 v[120:123], a[200:203], a[52:55], v[120:123]
  ds_read_b64_tr_b16 a[222:223], v34 offset:13952
  v_mfma_f32_16x16x32_bf16 v[168:171], a[200:203], a[56:59], v[168:171]
  v_mfma_f32_16x16x32_bf16 v[216:219], a[200:203], a[60:63], v[216:219]
  ds_read_b128 a[16:19], v30 offset:0
  v_mfma_f32_16x16x32_bf16 v[76:79], a[204:207], a[48:51], v[76:79]
  ds_read_b64_tr_b16 a[224:225], v31 offset:12544
  v_mfma_f32_16x16x32_bf16 v[124:127], a[204:207], a[52:55], v[124:127]
  ds_read_b64_tr_b16 a[226:227], v31 offset:14080
  v_mfma_f32_16x16x32_bf16 v[172:175], a[204:207], a[56:59], v[172:175]
  v_mfma_f32_16x16x32_bf16 v[220:223], a[204:207], a[60:63], v[220:223]
  ds_read_b128 a[4:7], v29 offset:2048
  s_waitcnt lgkmcnt(9)
  v_mfma_f32_16x16x32_bf16 v[80:83], a[208:211], a[48:51], v[80:83]
  ds_read_b64_tr_b16 a[228:229], v32 offset:12544
  v_mfma_f32_16x16x32_bf16 v[128:131], a[208:211], a[52:55], v[128:131]
  ds_read_b64_tr_b16 a[230:231], v32 offset:14080
  v_mfma_f32_16x16x32_bf16 v[176:179], a[208:211], a[56:59], v[176:179]
  v_mfma_f32_16x16x32_bf16 v[224:227], a[208:211], a[60:63], v[224:227]
  ds_read_b128 a[20:23], v30 offset:2048
  v_mfma_f32_16x16x32_bf16 v[84:87], a[212:215], a[48:51], v[84:87]
  ds_read_b64_tr_b16 a[232:233], v33 offset:12544
  v_mfma_f32_16x16x32_bf16 v[132:135], a[212:215], a[52:55], v[132:135]
  ds_read_b64_tr_b16 a[234:235], v33 offset:14080
  v_mfma_f32_16x16x32_bf16 v[180:183], a[212:215], a[56:59], v[180:183]
  v_mfma_f32_16x16x32_bf16 v[228:231], a[212:215], a[60:63], v[228:231]
  ds_read_b128 a[8:11], v29 offset:4096
  s_waitcnt lgkmcnt(10)
  v_mfma_f32_16x16x32_bf16 v[88:91], a[216:219], a[48:51], v[88:91]
  ds_read_b64_tr_b16 a[236:237], v34 offset:12544
  v_mfma_f32_16x16x32_bf16 v[136:139], a[216:219], a[52:55], v[136:139]
  ds_read_b64_tr_b16 a[238:239], v34 offset:14080
  v_mfma_f32_16x16x32_bf16 v[184:187], a[216:219], a[56:59], v[184:187]
  v_mfma_f32_16x16x32_bf16 v[232:235], a[216:219], a[60:63], v[232:235]
  ds_read_b128 a[24:27], v30 offset:4096
  s_waitcnt vmcnt(14)
  s_barrier
  v_mfma_f32_16x16x32_bf16 v[92:95], a[220:223], a[48:51], v[92:95]
  ds_read_b64_tr_b16 a[192:193], v31 offset:36864
  v_mfma_f32_16x16x32_bf16 v[140:143], a[220:223], a[52:55], v[140:143]
  ds_read_b64_tr_b16 a[194:195], v31 offset:38400
  v_mfma_f32_16x16x32_bf16 v[188:191], a[220:223], a[56:59], v[188:191]
  s_add_u32 m0, s55, 36864
  s_add_u32 s73, s71, 7471104
  buffer_load_dwordx4 v41, s[12:15], s73 offen offset:0 lds
  v_mfma_f32_16x16x32_bf16 v[236:239], a[220:223], a[60:63], v[236:239]
  ds_read_b128 a[12:15], v29 offset:6144
  s_waitcnt lgkmcnt(10)
  v_mfma_f32_16x16x32_bf16 v[96:99], a[224:227], a[48:51], v[96:99]
  ds_read_b64_tr_b16 a[196:197], v32 offset:36864
  v_mfma_f32_16x16x32_bf16 v[144:147], a[224:227], a[52:55], v[144:147]
  ds_read_b64_tr_b16 a[198:199], v32 offset:38400
  v_mfma_f32_16x16x32_bf16 v[192:195], a[224:227], a[56:59], v[192:195]
  buffer_load_dwordx4 v42, s[12:15], s73 offen offset:1024 lds
  v_mfma_f32_16x16x32_bf16 v[240:243], a[224:227], a[60:63], v[240:243]
  ds_read_b128 a[28:31], v30 offset:6144
  v_mfma_f32_16x16x32_bf16 v[100:103], a[228:231], a[48:51], v[100:103]
  ds_read_b64_tr_b16 a[200:201], v33 offset:36864
  v_mfma_f32_16x16x32_bf16 v[148:151], a[228:231], a[52:55], v[148:151]
  ds_read_b64_tr_b16 a[202:203], v33 offset:38400
  v_mfma_f32_16x16x32_bf16 v[196:199], a[228:231], a[56:59], v[196:199]
  buffer_load_dwordx4 v43, s[12:15], s73 offen offset:2048 lds
  v_mfma_f32_16x16x32_bf16 v[244:247], a[228:231], a[60:63], v[244:247]
  s_waitcnt lgkmcnt(9)
  v_mfma_f32_16x16x32_bf16 v[104:107], a[232:235], a[48:51], v[104:107]
  ds_read_b64_tr_b16 a[204:205], v34 offset:36864
  v_mfma_f32_16x16x32_bf16 v[152:155], a[232:235], a[52:55], v[152:155]
  ds_read_b64_tr_b16 a[206:207], v34 offset:38400
  v_mfma_f32_16x16x32_bf16 v[200:203], a[232:235], a[56:59], v[200:203]
  v_mfma_f32_16x16x32_bf16 v[248:251], a[232:235], a[60:63], v[248:251]
  v_mfma_f32_16x16x32_bf16 v[108:111], a[236:239], a[48:51], v[108:111]
  ds_read_b64_tr_b16 a[208:209], v31 offset:36992
  v_mfma_f32_16x16x32_bf16 v[156:159], a[236:239], a[52:55], v[156:159]
  ds_read_b64_tr_b16 a[210:211], v31 offset:38528
  v_mfma_f32_16x16x32_bf16 v[204:207], a[236:239], a[56:59], v[204:207]
  v_mfma_f32_16x16x32_bf16 v[252:255], a[236:239], a[60:63], v[252:255]
  s_waitcnt lgkmcnt(6)
  v_mfma_f32_16x16x32_bf16 v[64:67], a[192:195], a[0:3], v[64:67]
  ds_read_b64_tr_b16 a[212:213], v32 offset:36992
  v_mfma_f32_16x16x32_bf16 v[112:115], a[192:195], a[4:7], v[112:115]
  ds_read_b64_tr_b16 a[214:215], v32 offset:38528
  v_mfma_f32_16x16x32_bf16 v[160:163], a[192:195], a[8:11], v[160:163]
  v_mfma_f32_16x16x32_bf16 v[208:211], a[192:195], a[12:15], v[208:211]
  v_mfma_f32_16x16x32_bf16 v[68:71], a[196:199], a[0:3], v[68:71]
  ds_read_b64_tr_b16 a[216:217], v33 offset:36992
  v_mfma_f32_16x16x32_bf16 v[116:119], a[196:199], a[4:7], v[116:119]
  ds_read_b64_tr_b16 a[218:219], v33 offset:38528
  v_mfma_f32_16x16x32_bf16 v[164:167], a[196:199], a[8:11], v[164:167]
  v_mfma_f32_16x16x32_bf16 v[212:215], a[196:199], a[12:15], v[212:215]
  s_waitcnt lgkmcnt(6)
  v_mfma_f32_16x16x32_bf16 v[72:75], a[200:203], a[0:3], v[72:75]
  ds_read_b64_tr_b16 a[220:221], v34 offset:36992
  v_mfma_f32_16x16x32_bf16 v[120:123], a[200:203], a[4:7], v[120:123]
  ds_read_b64_tr_b16 a[222:223], v34 offset:38528
  v_mfma_f32_16x16x32_bf16 v[168:171], a[200:203], a[8:11], v[168:171]
  v_mfma_f32_16x16x32_bf16 v[216:219], a[200:203], a[12:15], v[216:219]
  v_mfma_f32_16x16x32_bf16 v[76:79], a[204:207], a[0:3], v[76:79]
  ds_read_b64_tr_b16 a[224:225], v31 offset:37120
  v_mfma_f32_16x16x32_bf16 v[124:127], a[204:207], a[4:7], v[124:127]
  ds_read_b64_tr_b16 a[226:227], v31 offset:38656
  v_mfma_f32_16x16x32_bf16 v[172:175], a[204:207], a[8:11], v[172:175]
  v_mfma_f32_16x16x32_bf16 v[220:223], a[204:207], a[12:15], v[220:223]
  s_waitcnt lgkmcnt(6)
  v_mfma_f32_16x16x32_bf16 v[80:83], a[208:211], a[0:3], v[80:83]
  ds_read_b64_tr_b16 a[228:229], v32 offset:37120
  v_mfma_f32_16x16x32_bf16 v[128:131], a[208:211], a[4:7], v[128:131]
  ds_read_b64_tr_b16 a[230:231], v32 offset:38656
  v_mfma_f32_16x16x32_bf16 v[176:179], a[208:211], a[8:11], v[176:179]
  v_mfma_f32_16x16x32_bf16 v[224:227], a[208:211], a[12:15], v[224:227]
  v_mfma_f32_16x16x32_bf16 v[84:87], a[212:215], a[0:3], v[84:87]
  ds_read_b64_tr_b16 a[232:233], v33 offset:37120
  v_mfma_f32_16x16x32_bf16 v[132:135], a[212:215], a[4:7], v[132:135]
  ds_read_b64_tr_b16 a[234:235], v33 offset:38656
  v_mfma_f32_16x16x32_bf16 v[180:183], a[212:215], a[8:11], v[180:183]
  v_mfma_f32_16x16x32_bf16 v[228:231], a[212:215], a[12:15], v[228:231]
  s_waitcnt lgkmcnt(6)
  v_mfma_f32_16x16x32_bf16 v[88:91], a[216:219], a[0:3], v[88:91]
  ds_read_b64_tr_b16 a[236:237], v34 offset:37120
  v_mfma_f32_16x16x32_bf16 v[136:139], a[216:219], a[4:7], v[136:139]
  ds_read_b64_tr_b16 a[238:239], v34 offset:38656
  v_mfma_f32_16x16x32_bf16 v[184:187], a[216:219], a[8:11], v[184:187]
  v_mfma_f32_16x16x32_bf16 v[232:235], a[216:219], a[12:15], v[232:235]
  s_waitcnt vmcnt(14)
  s_barrier
  v_mfma_f32_16x16x32_bf16 v[92:95], a[220:223], a[0:3], v[92:95]
  ds_read_b64_tr_b16 a[192:193], v31 offset:24576
  v_mfma_f32_16x16x32_bf16 v[140:143], a[220:223], a[4:7], v[140:143]
  ds_read_b64_tr_b16 a[194:195], v31 offset:26112
  v_mfma_f32_16x16x32_bf16 v[188:191], a[220:223], a[8:11], v[188:191]
  s_add_u32 m0, s55, 49152
  s_mov_b32 s73, 24576
  buffer_load_dwordx4 v25, s[16:19], s73 offen offset:0 nt lds
  v_mfma_f32_16x16x32_bf16 v[236:239], a[220:223], a[12:15], v[236:239]
  s_waitcnt lgkmcnt(6)
  v_mfma_f32_16x16x32_bf16 v[96:99], a[224:227], a[0:3], v[96:99]
  ds_read_b64_tr_b16 a[196:197], v32 offset:24576
  v_mfma_f32_16x16x32_bf16 v[144:147], a[224:227], a[4:7], v[144:147]
  ds_read_b64_tr_b16 a[198:199], v32 offset:26112
  v_mfma_f32_16x16x32_bf16 v[192:195], a[224:227], a[8:11], v[192:195]
  buffer_load_dwordx4 v26, s[16:19], s73 offen offset:1024 nt lds
  v_mfma_f32_16x16x32_bf16 v[240:243], a[224:227], a[12:15], v[240:243]
  v_mfma_f32_16x16x32_bf16 v[100:103], a[228:231], a[0:3], v[100:103]
  ds_read_b64_tr_b16 a[200:201], v33 offset:24576
  v_mfma_f32_16x16x32_bf16 v[148:151], a[228:231], a[4:7], v[148:151]
  ds_read_b64_tr_b16 a[202:203], v33 offset:26112
  v_mfma_f32_16x16x32_bf16 v[196:199], a[228:231], a[8:11], v[196:199]
  buffer_load_dwordx4 v27, s[16:19], s73 offen offset:2048 nt lds
  v_mfma_f32_16x16x32_bf16 v[244:247], a[228:231], a[12:15], v[244:247]
  s_waitcnt lgkmcnt(6)
  v_mfma_f32_16x16x32_bf16 v[104:107], a[232:235], a[0:3], v[104:107]
  ds_read_b64_tr_b16 a[204:205], v34 offset:24576
  v_mfma_f32_16x16x32_bf16 v[152:155], a[232:235], a[4:7], v[152:155]
  ds_read_b64_tr_b16 a[206:207], v34 offset:26112
  v_mfma_f32_16x16x32_bf16 v[200:203], a[232:235], a[8:11], v[200:203]
  v_mfma_f32_16x16x32_bf16 v[248:251], a[232:235], a[12:15], v[248:251]
  v_mfma_f32_16x16x32_bf16 v[108:111], a[236:239], a[0:3], v[108:111]
  ds_read_b64_tr_b16 a[208:209], v31 offset:24704
  v_mfma_f32_16x16x32_bf16 v[156:159], a[236:239], a[4:7], v[156:159]
  ds_read_b64_tr_b16 a[210:211], v31 offset:26240
  v_mfma_f32_16x16x32_bf16 v[204:207], a[236:239], a[8:11], v[204:207]
  v_mfma_f32_16x16x32_bf16 v[252:255], a[236:239], a[12:15], v[252:255]
  s_waitcnt lgkmcnt(6)
  v_mfma_f32_16x16x32_bf16 v[64:67], a[192:195], a[16:19], v[64:67]
  ds_read_b64_tr_b16 a[212:213], v32 offset:24704
  v_mfma_f32_16x16x32_bf16 v[112:115], a[192:195], a[20:23], v[112:115]
  ds_read_b64_tr_b16 a[214:215], v32 offset:26240
  v_mfma_f32_16x16x32_bf16 v[160:163], a[192:195], a[24:27], v[160:163]
  v_mfma_f32_16x16x32_bf16 v[208:211], a[192:195], a[28:31], v[208:211]
  v_mfma_f32_16x16x32_bf16 v[68:71], a[196:199], a[16:19], v[68:71]
  ds_read_b64_tr_b16 a[216:217], v33 offset:24704
  v_mfma_f32_16x16x32_bf16 v[116:119], a[196:199], a[20:23], v[116:119]
  ds_read_b64_tr_b16 a[218:219], v33 offset:26240
  v_mfma_f32_16x16x32_bf16 v[164:167], a[196:199], a[24:27], v[164:167]
  v_mfma_f32_16x16x32_bf16 v[212:215], a[196:199], a[28:31], v[212:215]
  s_waitcnt vmcnt(9)
  ds_read_b128 a[32:35], v29 offset:32768
  s_waitcnt lgkmcnt(7)
  v_mfma_f32_16x16x32_bf16 v[72:75], a[200:203], a[16:19], v[72:75]
  ds_read_b64_tr_b16 a[220:221], v34 offset:24704
  v_mfma_f32_16x16x32_bf16 v[120:123], a[200:203], a[20:23], v[120:123]
  ds_read_b64_tr_b16 a[222:223], v34 offset:26240
  v_mfma_f32_16x16x32_bf16 v[168:171], a[200:203], a[24:27], v[168:171]
  v_mfma_f32_16x16x32_bf16 v[216:219], a[200:203], a[28:31], v[216:219]
  ds_read_b128 a[48:51], v30 offset:32768
  v_mfma_f32_16x16x32_bf16 v[76:79], a[204:207], a[16:19], v[76:79]
  ds_read_b64_tr_b16 a[224:225], v31 offset:24832
  v_mfma_f32_16x16x32_bf16 v[124:127], a[204:207], a[20:23], v[124:127]
  ds_read_b64_tr_b16 a[226:227], v31 offset:26368
  v_mfma_f32_16x16x32_bf16 v[172:175], a[204:207], a[24:27], v[172:175]
  v_mfma_f32_16x16x32_bf16 v[220:223], a[204:207], a[28:31], v[220:223]
  ds_read_b128 a[36:39], v29 offset:34816
  s_waitcnt lgkmcnt(9)
  v_mfma_f32_16x16x32_bf16 v[80:83], a[208:211], a[16:19], v[80:83]
  ds_read_b64_tr_b16 a[228:229], v32 offset:24832
  v_mfma_f32_16x16x32_bf16 v[128:131], a[208:211], a[20:23], v[128:131]
  ds_read_b64_tr_b16 a[230:231], v32 offset:26368
  v_mfma_f32_16x16x32_bf16 v[176:179], a[208:211], a[24:27], v[176:179]
  v_mfma_f32_16x16x32_bf16 v[224:227], a[208:211], a[28:31], v[224:227]
  ds_read_b128 a[52:55], v30 offset:34816
  v_mfma_f32_16x16x32_bf16 v[84:87], a[212:215], a[16:19], v[84:87]
  ds_read_b64_tr_b16 a[232:233], v33 offset:24832
  v_mfma_f32_16x16x32_bf16 v[132:135], a[212:215], a[20:23], v[132:135]
  ds_read_b64_tr_b16 a[234:235], v33 offset:26368
  v_mfma_f32_16x16x32_bf16 v[180:183], a[212:215], a[24:27], v[180:183]
  v_mfma_f32_16x16x32_bf16 v[228:231], a[212:215], a[28:31], v[228:231]
  ds_read_b128 a[40:43], v29 offset:36864
  s_waitcnt lgkmcnt(10)
  v_mfma_f32_16x16x32_bf16 v[88:91], a[216:219], a[16:19], v[88:91]
  ds_read_b64_tr_b16 a[236:237], v34 offset:24832
  v_mfma_f32_16x16x32_bf16 v[136:139], a[216:219], a[20:23], v[136:139]
  ds_read_b64_tr_b16 a[238:239], v34 offset:26368
  v_mfma_f32_16x16x32_bf16 v[184:187], a[216:219], a[24:27], v[184:187]
  v_mfma_f32_16x16x32_bf16 v[232:235], a[216:219], a[28:31], v[232:235]
  ds_read_b128 a[56:59], v30 offset:36864
  s_waitcnt vmcnt(6)
  s_barrier
  v_mfma_f32_16x16x32_bf16 v[92:95], a[220:223], a[16:19], v[92:95]
  ds_read_b64_tr_b16 a[192:193], v31 offset:49152
  v_mfma_f32_16x16x32_bf16 v[140:143], a[220:223], a[20:23], v[140:143]
  ds_read_b64_tr_b16 a[194:195], v31 offset:50688
  v_mfma_f32_16x16x32_bf16 v[188:191], a[220:223], a[24:27], v[188:191]
  s_add_u32 m0, s55, 73728
  s_mov_b32 s73, 36864
  buffer_load_dwordx4 v25, s[16:19], s73 offen offset:0 nt lds
  v_mfma_f32_16x16x32_bf16 v[236:239], a[220:223], a[28:31], v[236:239]
  ds_read_b128 a[44:47], v29 offset:38912
  s_waitcnt lgkmcnt(10)
  v_mfma_f32_16x16x32_bf16 v[96:99], a[224:227], a[16:19], v[96:99]
  ds_read_b64_tr_b16 a[196:197], v32 offset:49152
  v_mfma_f32_16x16x32_bf16 v[144:147], a[224:227], a[20:23], v[144:147]
  ds_read_b64_tr_b16 a[198:199], v32 offset:50688
  v_mfma_f32_16x16x32_bf16 v[192:195], a[224:227], a[24:27], v[192:195]
  buffer_load_dwordx4 v26, s[16:19], s73 offen offset:1024 nt lds
  v_mfma_f32_16x16x32_bf16 v[240:243], a[224:227], a[28:31], v[240:243]
  ds_read_b128 a[60:63], v30 offset:38912
  v_mfma_f32_16x16x32_bf16 v[100:103], a[228:231], a[16:19], v[100:103]
  ds_read_b64_tr_b16 a[200:201], v33 offset:49152
  v_mfma_f32_16x16x32_bf16 v[148:151], a[228:231], a[20:23], v[148:151]
  ds_read_b64_tr_b16 a[202:203], v33 offset:50688
  v_mfma_f32_16x16x32_bf16 v[196:199], a[228:231], a[24:27], v[196:199]
  buffer_load_dwordx4 v27, s[16:19], s73 offen offset:2048 nt lds
  v_mfma_f32_16x16x32_bf16 v[244:247], a[228:231], a[28:31], v[244:247]
  s_waitcnt lgkmcnt(9)
  v_mfma_f32_16x16x32_bf16 v[104:107], a[232:235], a[16:19], v[104:107]
  ds_read_b64_tr_b16 a[204:205], v34 offset:49152
  v_mfma_f32_16x16x32_bf16 v[152:155], a[232:235], a[20:23], v[152:155]
  ds_read_b64_tr_b16 a[206:207], v34 offset:50688
  v_mfma_f32_16x16x32_bf16 v[200:203], a[232:235], a[24:27], v[200:203]
  v_mfma_f32_16x16x32_bf16 v[248:251], a[232:235], a[28:31], v[248:251]
  v_mfma_f32_16x16x32_bf16 v[108:111], a[236:239], a[16:19], v[108:111]
  ds_read_b64_tr_b16 a[208:209], v31 offset:49280
  v_mfma_f32_16x16x32_bf16 v[156:159], a[236:239], a[20:23], v[156:159]
  ds_read_b64_tr_b16 a[210:211], v31 offset:50816
  v_mfma_f32_16x16x32_bf16 v[204:207], a[236:239], a[24:27], v[204:207]
  v_mfma_f32_16x16x32_bf16 v[252:255], a[236:239], a[28:31], v[252:255]
  s_waitcnt lgkmcnt(6)
  v_mfma_f32_16x16x32_bf16 v[64:67], a[192:195], a[32:35], v[64:67]
  ds_read_b64_tr_b16 a[212:213], v32 offset:49280
  v_mfma_f32_16x16x32_bf16 v[112:115], a[192:195], a[36:39], v[112:115]
  ds_read_b64_tr_b16 a[214:215], v32 offset:50816
  v_mfma_f32_16x16x32_bf16 v[160:163], a[192:195], a[40:43], v[160:163]
  v_mfma_f32_16x16x32_bf16 v[208:211], a[192:195], a[44:47], v[208:211]
  v_mfma_f32_16x16x32_bf16 v[68:71], a[196:199], a[32:35], v[68:71]
  ds_read_b64_tr_b16 a[216:217], v33 offset:49280
  v_mfma_f32_16x16x32_bf16 v[116:119], a[196:199], a[36:39], v[116:119]
  ds_read_b64_tr_b16 a[218:219], v33 offset:50816
  v_mfma_f32_16x16x32_bf16 v[164:167], a[196:199], a[40:43], v[164:167]
  v_mfma_f32_16x16x32_bf16 v[212:215], a[196:199], a[44:47], v[212:215]
  s_waitcnt lgkmcnt(6)
  v_mfma_f32_16x16x32_bf16 v[72:75], a[200:203], a[32:35], v[72:75]
  ds_read_b64_tr_b16 a[220:221], v34 offset:49280
  v_mfma_f32_16x16x32_bf16 v[120:123], a[200:203], a[36:39], v[120:123]
  ds_read_b64_tr_b16 a[222:223], v34 offset:50816
  v_mfma_f32_16x16x32_bf16 v[168:171], a[200:203], a[40:43], v[168:171]
  v_mfma_f32_16x16x32_bf16 v[216:219], a[200:203], a[44:47], v[216:219]
  v_mfma_f32_16x16x32_bf16 v[76:79], a[204:207], a[32:35], v[76:79]
  ds_read_b64_tr_b16 a[224:225], v31 offset:49408
  v_mfma_f32_16x16x32_bf16 v[124:127], a[204:207], a[36:39], v[124:127]
  ds_read_b64_tr_b16 a[226:227], v31 offset:50944
  v_mfma_f32_16x16x32_bf16 v[172:175], a[204:207], a[40:43], v[172:175]
  v_mfma_f32_16x16x32_bf16 v[220:223], a[204:207], a[44:47], v[220:223]
  s_waitcnt lgkmcnt(6)
  v_mfma_f32_16x16x32_bf16 v[80:83], a[208:211], a[32:35], v[80:83]
  ds_read_b64_tr_b16 a[228:229], v32 offset:49408
  v_mfma_f32_16x16x32_bf16 v[128:131], a[208:211], a[36:39], v[128:131]
  ds_read_b64_tr_b16 a[230:231], v32 offset:50944
  v_mfma_f32_16x16x32_bf16 v[176:179], a[208:211], a[40:43], v[176:179]
  v_mfma_f32_16x16x32_bf16 v[224:227], a[208:211], a[44:47], v[224:227]
  v_mfma_f32_16x16x32_bf16 v[84:87], a[212:215], a[32:35], v[84:87]
  ds_read_b64_tr_b16 a[232:233], v33 offset:49408
  v_mfma_f32_16x16x32_bf16 v[132:135], a[212:215], a[36:39], v[132:135]
  ds_read_b64_tr_b16 a[234:235], v33 offset:50944
  v_mfma_f32_16x16x32_bf16 v[180:183], a[212:215], a[40:43], v[180:183]
  v_mfma_f32_16x16x32_bf16 v[228:231], a[212:215], a[44:47], v[228:231]
  s_waitcnt lgkmcnt(6)
  v_mfma_f32_16x16x32_bf16 v[88:91], a[216:219], a[32:35], v[88:91]
  ds_read_b64_tr_b16 a[236:237], v34 offset:49408
  v_mfma_f32_16x16x32_bf16 v[136:139], a[216:219], a[36:39], v[136:139]
  ds_read_b64_tr_b16 a[238:239], v34 offset:50944
  v_mfma_f32_16x16x32_bf16 v[184:187], a[216:219], a[40:43], v[184:187]
  v_mfma_f32_16x16x32_bf16 v[232:235], a[216:219], a[44:47], v[232:235]
  s_waitcnt vmcnt(6)
  s_barrier
  v_mfma_f32_16x16x32_bf16 v[92:95], a[220:223], a[32:35], v[92:95]
  ds_read_b64_tr_b16 a[192:193], v31 offset:0
  v_mfma_f32_16x16x32_bf16 v[140:143], a[220:223], a[36:39], v[140:143]
  ds_read_b64_tr_b16 a[194:195], v31 offset:1536
  v_mfma_f32_16x16x32_bf16 v[188:191], a[220:223], a[40:43], v[188:191]
  s_add_u32 m0, s55, 61440
  s_mov_b32 s73, 24576
  buffer_load_dwordx4 v25, s[20:23], s73 offen offset:0 nt lds
  v_mfma_f32_16x16x32_bf16 v[236:239], a[220:223], a[44:47], v[236:239]
  s_waitcnt lgkmcnt(6)
  v_mfma_f32_16x16x32_bf16 v[96:99], a[224:227], a[32:35], v[96:99]
  ds_read_b64_tr_b16 a[196:197], v32 offset:0
  v_mfma_f32_16x16x32_bf16 v[144:147], a[224:227], a[36:39], v[144:147]
  ds_read_b64_tr_b16 a[198:199], v32 offset:1536
  v_mfma_f32_16x16x32_bf16 v[192:195], a[224:227], a[40:43], v[192:195]
  buffer_load_dwordx4 v26, s[20:23], s73 offen offset:1024 nt lds
  v_mfma_f32_16x16x32_bf16 v[240:243], a[224:227], a[44:47], v[240:243]
  v_mfma_f32_16x16x32_bf16 v[100:103], a[228:231], a[32:35], v[100:103]
  ds_read_b64_tr_b16 a[200:201], v33 offset:0
  v_mfma_f32_16x16x32_bf16 v[148:151], a[228:231], a[36:39], v[148:151]
  ds_read_b64_tr_b16 a[202:203], v33 offset:1536
  v_mfma_f32_16x16x32_bf16 v[196:199], a[228:231], a[40:43], v[196:199]
  buffer_load_dwordx4 v27, s[20:23], s73 offen offset:2048 nt lds
  v_mfma_f32_16x16x32_bf16 v[244:247], a[228:231], a[44:47], v[244:247]
  s_waitcnt lgkmcnt(6)
  v_mfma_f32_16x16x32_bf16 v[104:107], a[232:235], a[32:35], v[104:107]
  ds_read_b64_tr_b16 a[204:205], v34 offset:0
  v_mfma_f32_16x16x32_bf16 v[152:155], a[232:235], a[36:39], v[152:155]
  ds_read_b64_tr_b16 a[206:207], v34 offset:1536
  v_mfma_f32_16x16x32_bf16 v[200:203], a[232:235], a[40:43], v[200:203]
  s_add_u32 m0, s55, 98304
  s_mov_b32 s73, 49152
  buffer_load_dwordx4 v25, s[16:19], s73 offen offset:0 nt lds
  v_mfma_f32_16x16x32_bf16 v[248:251], a[232:235], a[44:47], v[248:251]
  v_mfma_f32_16x16x32_bf16 v[108:111], a[236:239], a[32:35], v[108:111]
  ds_read_b64_tr_b16 a[208:209], v31 offset:128
  v_mfma_f32_16x16x32_bf16 v[156:159], a[236:239], a[36:39], v[156:159]
  ds_read_b64_tr_b16 a[210:211], v31 offset:1664
  v_mfma_f32_16x16x32_bf16 v[204:207], a[236:239], a[40:43], v[204:207]
  buffer_load_dwordx4 v26, s[16:19], s73 offen offset:1024 nt lds
  v_mfma_f32_16x16x32_bf16 v[252:255], a[236:239], a[44:47], v[252:255]
  s_waitcnt lgkmcnt(6)
  v_mfma_f32_16x16x32_bf16 v[64:67], a[192:195], a[48:51], v[64:67]
  ds_read_b64_tr_b16 a[212:213], v32 offset:128
  v_mfma_f32_16x16x32_bf16 v[112:115], a[192:195], a[52:55], v[112:115]
  ds_read_b64_tr_b16 a[214:215], v32 offset:1664
  v_mfma_f32_16x16x32_bf16 v[160:163], a[192:195], a[56:59], v[160:163]
  buffer_load_dwordx4 v27, s[16:19], s73 offen offset:2048 nt lds
  v_mfma_f32_16x16x32_bf16 v[208:211], a[192:195], a[60:63], v[208:211]
  v_mfma_f32_16x16x32_bf16 v[68:71], a[196:199], a[48:51], v[68:71]
  ds_read_b64_tr_b16 a[216:217], v33 offset:128
  v_mfma_f32_16x16x32_bf16 v[116:119], a[196:199], a[52:55], v[116:119]
  ds_read_b64_tr_b16 a[218:219], v33 offset:1664
  v_mfma_f32_16x16x32_bf16 v[164:167], a[196:199], a[56:59], v[164:167]
  v_mfma_f32_16x16x32_bf16 v[212:215], a[196:199], a[60:63], v[212:215]
  s_waitcnt lgkmcnt(6)
  v_mfma_f32_16x16x32_bf16 v[72:75], a[200:203], a[48:51], v[72:75]
  ds_read_b64_tr_b16 a[220:221], v34 offset:128
  v_mfma_f32_16x16x32_bf16 v[120:123], a[200:203], a[52:55], v[120:123]
  ds_read_b64_tr_b16 a[222:223], v34 offset:1664
  v_mfma_f32_16x16x32_bf16 v[168:171], a[200:203], a[56:59], v[168:171]
  v_mfma_f32_16x16x32_bf16 v[216:219], a[200:203], a[60:63], v[216:219]
  v_mfma_f32_16x16x32_bf16 v[76:79], a[204:207], a[48:51], v[76:79]
  ds_read_b64_tr_b16 a[224:225], v31 offset:256
  v_mfma_f32_16x16x32_bf16 v[124:127], a[204:207], a[52:55], v[124:127]
  ds_read_b64_tr_b16 a[226:227], v31 offset:1792
  v_mfma_f32_16x16x32_bf16 v[172:175], a[204:207], a[56:59], v[172:175]
  v_mfma_f32_16x16x32_bf16 v[220:223], a[204:207], a[60:63], v[220:223]
  s_waitcnt lgkmcnt(6)
  v_mfma_f32_16x16x32_bf16 v[80:83], a[208:211], a[48:51], v[80:83]
  ds_read_b64_tr_b16 a[228:229], v32 offset:256
  v_mfma_f32_16x16x32_bf16 v[128:131], a[208:211], a[52:55], v[128:131]
  ds_read_b64_tr_b16 a[230:231], v32 offset:1792
  v_mfma_f32_16x16x32_bf16 v[176:179], a[208:211], a[56:59], v[176:179]
  v_mfma_f32_16x16x32_bf16 v[224:227], a[208:211], a[60:63], v[224:227]
  v_mfma_f32_16x16x32_bf16 v[84:87], a[212:215], a[48:51], v[84:87]
  ds_read_b64_tr_b16 a[232:233], v33 offset:256
  v_mfma_f32_16x16x32_bf16 v[132:135], a[212:215], a[52:55], v[132:135]
  ds_read_b64_tr_b16 a[234:235], v33 offset:1792
  v_mfma_f32_16x16x32_bf16 v[180:183], a[212:215], a[56:59], v[180:183]
  v_mfma_f32_16x16x32_bf16 v[228:231], a[212:215], a[60:63], v[228:231]
  s_waitcnt lgkmcnt(6)
  v_mfma_f32_16x16x32_bf16 v[88:91], a[216:219], a[48:51], v[88:91]
  ds_read_b64_tr_b16 a[236:237], v34 offset:256
  v_mfma_f32_16x16x32_bf16 v[136:139], a[216:219], a[52:55], v[136:139]
  ds_read_b64_tr_b16 a[238:239], v34 offset:1792
  v_mfma_f32_16x16x32_bf16 v[184:187], a[216:219], a[56:59], v[184:187]
  v_mfma_f32_16x16x32_bf16 v[232:235], a[216:219], a[60:63], v[232:235]
  v_mfma_f32_16x16x32_bf16 v[92:95], a[220:223], a[48:51], v[92:95]
  v_mfma_f32_16x16x32_bf16 v[140:143], a[220:223], a[52:55], v[140:143]
  v_mfma_f32_16x16x32_bf16 v[188:191], a[220:223], a[56:59], v[188:191]
  v_mfma_f32_16x16x32_bf16 v[236:239], a[220:223], a[60:63], v[236:239]
  s_waitcnt lgkmcnt(4)
  v_mfma_f32_16x16x32_bf16 v[96:99], a[224:227], a[48:51], v[96:99]
  v_mfma_f32_16x16x32_bf16 v[144:147], a[224:227], a[52:55], v[144:147]
  v_mfma_f32_16x16x32_bf16 v[192:195], a[224:227], a[56:59], v[192:195]
  v_mfma_f32_16x16x32_bf16 v[240:243], a[224:227], a[60:63], v[240:243]
  v_mfma_f32_16x16x32_bf16 v[100:103], a[228:231], a[48:51], v[100:103]
  v_mfma_f32_16x16x32_bf16 v[148:151], a[228:231], a[52:55], v[148:151]
  v_mfma_f32_16x16x32_bf16 v[196:199], a[228:231], a[56:59], v[196:199]
  v_mfma_f32_16x16x32_bf16 v[244:247], a[228:231], a[60:63], v[244:247]
  s_waitcnt lgkmcnt(0)
  v_mfma_f32_16x16x32_bf16 v[104:107], a[232:235], a[48:51], v[104:107]
  v_mfma_f32_16x16x32_bf16 v[152:155], a[232:235], a[52:55], v[152:155]
  v_mfma_f32_16x16x32_bf16 v[200:203], a[232:235], a[56:59], v[200:203]
  v_mfma_f32_16x16x32_bf16 v[248:251], a[232:235], a[60:63], v[248:251]
  v_mfma_f32_16x16x32_bf16 v[108:111], a[236:239], a[48:51], v[108:111]
  v_mfma_f32_16x16x32_bf16 v[156:159], a[236:239], a[52:55], v[156:159]
  v_mfma_f32_16x16x32_bf16 v[204:207], a[236:239], a[56:59], v[204:207]
  v_mfma_f32_16x16x32_bf16 v[252:255], a[236:239], a[60:63], v[252:255]
  s_barrier
  s_branch K1_ATT
K1_ITEM:
  s_cmp_eq_u32 s56, 0
  s_cselect_b32 s20, s32, s42
  s_cselect_b32 s21, s33, s43
  s_mov_b32 s22, 393216
  s_add_u32 s20, s20, s78
  s_addc_u32 s21, s21, 0
  s_add_u32 s62, s55, 98304
  s_mov_b32 s63, s55
  s_add_u32 s64, s55, 49152
  s_mov_b32 s66, 0
  s_mov_b32 s60, 61440
  s_mov_b32 s61, 36864
  v_accvgpr_read_b32 v29, a240
  v_accvgpr_read_b32 v30, a241
  v_accvgpr_read_b32 v31, a242
  v_accvgpr_read_b32 v32, a243
  v_accvgpr_read_b32 v33, a244
  v_accvgpr_read_b32 v34, a245
  v_accvgpr_read_b32 v48, a0
  v_accvgpr_read_b32 v49, a1
  v_accvgpr_read_b32 v50, a2
  v_accvgpr_read_b32 v51, a3
  v_accvgpr_read_b32 v52, a16
  v_accvgpr_read_b32 v53, a17
  v_accvgpr_read_b32 v54, a18
  v_accvgpr_read_b32 v55, a19
  v_mul_f32 v48, v48, v37
  v_mul_f32 v49, v49, v37
  v_mul_f32 v50, v50, v37
  v_mul_f32 v51, v51, v37
  v_mul_f32 v52, v52, v37
  v_mul_f32 v53, v53, v37
  v_mul_f32 v54, v54, v37
  v_mul_f32 v55, v55, v37
  v_cvt_pk_bf16_f32 v56, v48, v49
  v_cvt_pk_bf16_f32 v57, v50, v51
  v_cvt_pk_bf16_f32 v58, v52, v53
  v_cvt_pk_bf16_f32 v59, v54, v55
  s_add_u32 s53, s72, 0
  buffer_store_dwordx4 v[56:59], v28, s[80:83], s53 offen sc0 sc1
  v_accvgpr_read_b32 v48, a4
  v_accvgpr_read_b32 v49, a5
  v_accvgpr_read_b32 v50, a6
  v_accvgpr_read_b32 v51, a7
  v_accvgpr_read_b32 v52, a20
  v_accvgpr_read_b32 v53, a21
  v_accvgpr_read_b32 v54, a22
  v_accvgpr_read_b32 v55, a23
  v_mul_f32 v48, v48, v38
  v_mul_f32 v49, v49, v38
  v_mul_f32 v50, v50, v38
  v_mul_f32 v51, v51, v38
  v_mul_f32 v52, v52, v38
  v_mul_f32 v53, v53, v38
  v_mul_f32 v54, v54, v38
  v_mul_f32 v55, v55, v38
  v_cvt_pk_bf16_f32 v60, v48, v49
  v_cvt_pk_bf16_f32 v61, v50, v51
  v_cvt_pk_bf16_f32 v62, v52, v53
  v_cvt_pk_bf16_f32 v63, v54, v55
  s_add_u32 s53, s72, 196608
  buffer_store_dwordx4 v[60:63], v28, s[80:83], s53 offen sc0 sc1
  v_accvgpr_read_b32 v48, a8
  v_accvgpr_read_b32 v49, a9
  v_accvgpr_read_b32 v50, a10
  v_accvgpr_read_b32 v51, a11
  v_accvgpr_read_b32 v52, a24
  v_accvgpr_read_b32 v53, a25
  v_accvgpr_read_b32 v54, a26
  v_accvgpr_read_b32 v55, a27
  v_mul_f32 v48, v48, v39
  v_mul_f32 v49, v49, v39
  v_mul_f32 v50, v50, v39
  v_mul_f32 v51, v51, v39
  v_mul_f32 v52, v52, v39
  v_mul_f32 v53, v53, v39
  v_mul_f32 v54, v54, v39
  v_mul_f32 v55, v55, v39
  v_cvt_pk_bf16_f32 v56, v48, v49
  v_cvt_pk_bf16_f32 v57, v50, v51
  v_cvt_pk_bf16_f32 v58, v52, v53
  v_cvt_pk_bf16_f32 v59, v54, v55
  s_add_u32 s53, s72, 393216
  buffer_store_dwordx4 v[56:59], v28, s[80:83], s53 offen sc0 sc1
  v_accvgpr_read_b32 v48, a12
  v_accvgpr_read_b32 v49, a13
  v_accvgpr_read_b32 v50, a14
  v_accvgpr_read_b32 v51, a15
  v_accvgpr_read_b32 v52, a28
  v_accvgpr_read_b32 v53, a29
  v_accvgpr_read_b32 v54, a30
  v_accvgpr_read_b32 v55, a31
  v_mul_f32 v48, v48, v40
  v_mul_f32 v49, v49, v40
  v_mul_f32 v50, v50, v40
  v_mul_f32 v51, v51, v40
  v_mul_f32 v52, v52, v40
  v_mul_f32 v53, v53, v40
  v_mul_f32 v54, v54, v40
  v_mul_f32 v55, v55, v40
  v_cvt_pk_bf16_f32 v60, v48, v49
  v_cvt_pk_bf16_f32 v61, v50, v51
  v_cvt_pk_bf16_f32 v62, v52, v53
  v_cvt_pk_bf16_f32 v63, v54, v55
  s_add_u32 s53, s72, 589824
  buffer_store_dwordx4 v[60:63], v28, s[80:83], s53 offen sc0 sc1
  s_waitcnt vmcnt(15)
  s_barrier
  ds_read_b128 a[0:3], v29 offset:0
  ds_read_b128 a[16:19], v30 offset:0
  ds_read_b128 a[4:7], v29 offset:2048
  ds_read_b128 a[20:23], v30 offset:2048
  ds_read_b128 a[8:11], v29 offset:4096
  ds_read_b128 a[24:27], v30 offset:4096
  ds_read_b128 a[12:15], v29 offset:6144
  ds_read_b128 a[28:31], v30 offset:6144
  ds_read_b64_tr_b16 a[192:193], v31 offset:12288
  ds_read_b64_tr_b16 a[194:195], v31 offset:13824
  ds_read_b64_tr_b16 a[196:197], v32 offset:12288
  ds_read_b64_tr_b16 a[198:199], v32 offset:13824
  ds_read_b64_tr_b16 a[200:201], v33 offset:12288
  ds_read_b64_tr_b16 a[202:203], v33 offset:13824
  ds_read_b64_tr_b16 a[204:205], v34 offset:12288
  ds_read_b64_tr_b16 a[206:207], v34 offset:13824
  ds_read_b64_tr_b16 a[208:209], v31 offset:12416
  ds_read_b64_tr_b16 a[210:211], v31 offset:13952
  s_waitcnt lgkmcnt(10)
  s_waitcnt lgkmcnt(6)
  v_mfma_f32_16x16x32_bf16 v[64:67], a[192:195], a[0:3], 0
  ds_read_b64_tr_b16 a[212:213], v32 offset:12416
  v_accvgpr_read_b32 v48, a32
  v_mfma_f32_16x16x32_bf16 v[112:115], a[192:195], a[4:7], 0
  ds_read_b64_tr_b16 a[214:215], v32 offset:13952
  v_accvgpr_read_b32 v49, a33
  v_mfma_f32_16x16x32_bf16 v[160:163], a[192:195], a[8:11], 0
  s_add_u32 m0, s55, 24576
  s_mov_b32 s73, 12288
  buffer_load_dwordx4 v25, s[16:19], s73 offen offset:0 nt lds
  v_mfma_f32_16x16x32_bf16 v[208:211], a[192:195], a[12:15], 0
  v_accvgpr_read_b32 v50, a34
  v_accvgpr_read_b32 v51, a35
  v_mfma_f32_16x16x32_bf16 v[68:71], a[196:199], a[0:3], 0
  ds_read_b64_tr_b16 a[216:217], v33 offset:12416
  v_accvgpr_read_b32 v52, a48
  v_mfma_f32_16x16x32_bf16 v[116:119], a[196:199], a[4:7], 0
  ds_read_b64_tr_b16 a[218:219], v33 offset:13952
  v_accvgpr_read_b32 v53, a49
  v_mfma_f32_16x16x32_bf16 v[164:167], a[196:199], a[8:11], 0
  buffer_load_dwordx4 v26, s[16:19], s73 offen offset:1024 nt lds
  v_mfma_f32_16x16x32_bf16 v[212:215], a[196:199], a[12:15], 0
  v_accvgpr_read_b32 v54, a50
  v_accvgpr_read_b32 v55, a51
  s_waitcnt lgkmcnt(6)
  v_mfma_f32_16x16x32_bf16 v[72:75], a[200:203], a[0:3], 0
  ds_read_b64_tr_b16 a[220:221], v34 offset:12416
  v_mul_f32 v48, v48, v37
  v_mfma_f32_16x16x32_bf16 v[120:123], a[200:203], a[4:7], 0
  ds_read_b64_tr_b16 a[222:223], v34 offset:13952
  v_mul_f32 v49, v49, v37
  v_mfma_f32_16x16x32_bf16 v[168:171], a[200:203], a[8:11], 0
  buffer_load_dwordx4 v27, s[16:19], s73 offen offset:2048 nt lds
  v_mfma_f32_16x16x32_bf16 v[216:219], a[200:203], a[12:15], 0
  v_mul_f32 v50, v50, v37
  v_mul_f32 v51, v51, v37
  v_mfma_f32_16x16x32_bf16 v[76:79], a[204:207], a[0:3], 0
  ds_read_b64_tr_b16 a[224:225], v31 offset:12544
  v_mul_f32 v52, v52, v37
  v_mfma_f32_16x16x32_bf16 v[124:127], a[204:207], a[4:7], 0
  ds_read_b64_tr_b16 a[226:227], v31 offset:14080
  v_mul_f32 v53, v53, v37
  v_mfma_f32_16x16x32_bf16 v[172:175], a[204:207], a[8:11], 0
  s_add_u32 m0, s55, 12288
  s_mov_b32 s73, 0
  buffer_load_dwordx4 v25, s[20:23], s73 offen offset:0 nt lds
  v_mfma_f32_16x16x32_bf16 v[220:223], a[204:207], a[12:15], 0
  v_mul_f32 v54, v54, v37
  v_mul_f32 v55, v55, v37
  s_waitcnt lgkmcnt(6)
  v_mfma_f32_16x16x32_bf16 v[80:83], a[208:211], a[0:3], 0
  ds_read_b64_tr_b16 a[228:229], v32 offset:12544
  v_cvt_pk_bf16_f32 v56, v48, v49
  v_mfma_f32_16x16x32_bf16 v[128:131], a[208:211], a[4:7], 0
  ds_read_b64_tr_b16 a[230:231], v32 offset:14080
  v_cvt_pk_bf16_f32 v57, v50, v51
  v_mfma_f32_16x16x32_bf16 v[176:179], a[208:211], a[8:11], 0
  buffer_load_dwordx4 v26, s[20:23], s73 offen offset:1024 nt lds
  v_mfma_f32_16x16x32_bf16 v[224:227], a[208:211], a[12:15], 0
  v_cvt_pk_bf16_f32 v58, v52, v53
  v_cvt_pk_bf16_f32 v59, v54, v55
  s_add_u32 s53, s72, 1024
  v_mfma_f32_16x16x32_bf16 v[84:87], a[212:215], a[0:3], 0
  ds_read_b64_tr_b16 a[232:233], v33 offset:12544
  v_mfma_f32_16x16x32_bf16 v[132:135], a[212:215], a[4:7], 0
  ds_read_b64_tr_b16 a[234:235], v33 offset:14080
  v_mfma_f32_16x16x32_bf16 v[180:183], a[212:215], a[8:11], 0
  buffer_load_dwordx4 v27, s[20:23], s73 offen offset:2048 nt lds
  v_mfma_f32_16x16x32_bf16 v[228:231], a[212:215], a[12:15], 0
  buffer_store_dwordx4 v[56:59], v28, s[80:83], s53 offen sc0 sc1
  s_waitcnt lgkmcnt(6)
  v_mfma_f32_16x16x32_bf16 v[88:91], a[216:219], a[0:3], 0
  ds_read_b64_tr_b16 a[236:237], v34 offset:12544
  v_accvgpr_read_b32 v48, a36
  v_mfma_f32_16x16x32_bf16 v[136:139], a[216:219], a[4:7], 0
  ds_read_b64_tr_b16 a[238:239], v34 offset:14080
  v_accvgpr_read_b32 v49, a37
  v_mfma_f32_16x16x32_bf16 v[184:187], a[216:219], a[8:11], 0
  s_add_u32 m0, s75, 0
  s_add_u32 s74, s70, 256
  buffer_load_dwordx4 v9, s[8:11], s74 offen offset:0 lds
  v_mfma_f32_16x16x32_bf16 v[232:235], a[216:219], a[12:15], 0
  v_accvgpr_read_b32 v50, a38
  v_accvgpr_read_b32 v51, a39
  s_barrier
  v_mfma_f32_16x16x32_bf16 v[92:95], a[220:223], a[0:3], 0
  ds_read_b64_tr_b16 a[192:193], v31 offset:36864
  v_accvgpr_read_b32 v52, a52
  v_mfma_f32_16x16x32_bf16 v[140:143], a[220:223], a[4:7], 0
  ds_read_b64_tr_b16 a[194:195], v31 offset:38400
  v_accvgpr_read_b32 v53, a53
  v_mfma_f32_16x16x32_bf16 v[188:191], a[220:223], a[8:11], 0
  buffer_load_dwordx4 v10, s[8:11], s74 offen offset:1024 lds
  v_mfma_f32_16x16x32_bf16 v[236:239], a[220:223], a[12:15], 0
  v_accvgpr_read_b32 v54, a54
  v_accvgpr_read_b32 v55, a55
  s_waitcnt lgkmcnt(6)
  v_mfma_f32_16x16x32_bf16 v[96:99], a[224:227], a[0:3], 0
  ds_read_b64_tr_b16 a[196:197], v32 offset:36864
  v_mul_f32 v48, v48, v38
  v_mfma_f32_16x16x32_bf16 v[144:147], a[224:227], a[4:7], 0
  ds_read_b64_tr_b16 a[198:199], v32 offset:38400
  v_mul_f32 v49, v49, v38
  v_mfma_f32_16x16x32_bf16 v[192:195], a[224:227], a[8:11], 0
  buffer_load_dwordx4 v11, s[8:11], s74 offen offset:2048 lds
  v_mfma_f32_16x16x32_bf16 v[240:243], a[224:227], a[12:15], 0
  v_mul_f32 v50, v50, v38
  v_mul_f32 v51, v51, v38
  v_mfma_f32_16x16x32_bf16 v[100:103], a[228:231], a[0:3], 0
  ds_read_b64_tr_b16 a[200:201], v33 offset:36864
  v_mul_f32 v52, v52, v38
  v_mfma_f32_16x16x32_bf16 v[148:151], a[228:231], a[4:7], 0
  ds_read_b64_tr_b16 a[202:203], v33 offset:38400
  v_mul_f32 v53, v53, v38
  v_mfma_f32_16x16x32_bf16 v[196:199], a[228:231], a[8:11], 0
  buffer_load_dwordx4 v12, s[8:11], s74 offen offset:3072 lds
  v_mfma_f32_16x16x32_bf16 v[244:247], a[228:231], a[12:15], 0
  v_mul_f32 v54, v54, v38
  v_mul_f32 v55, v55, v38
  s_waitcnt lgkmcnt(6)
  v_mfma_f32_16x16x32_bf16 v[104:107], a[232:235], a[0:3], 0
  ds_read_b64_tr_b16 a[204:205], v34 offset:36864
  v_cvt_pk_bf16_f32 v60, v48, v49
  v_mfma_f32_16x16x32_bf16 v[152:155], a[232:235], a[4:7], 0
  ds_read_b64_tr_b16 a[206:207], v34 offset:38400
  v_cvt_pk_bf16_f32 v61, v50, v51
  v_mfma_f32_16x16x32_bf16 v[200:203], a[232:235], a[8:11], 0
  s_add_u32 m0, s75, 4096
  s_add_u32 s74, s70, 256
  buffer_load_dwordx4 v13, s[8:11], s74 offen offset:0 lds
  v_mfma_f32_16x16x32_bf16 v[248:251], a[232:235], a[12:15], 0
  v_cvt_pk_bf16_f32 v62, v52, v53
  v_cvt_pk_bf16_f32 v63, v54, v55
  s_add_u32 s53, s72, 197632
  v_mfma_f32_16x16x32_bf16 v[108:111], a[236:239], a[0:3], 0
  ds_read_b64_tr_b16 a[208:209], v31 offset:36992
  v_mfma_f32_16x16x32_bf16 v[156:159], a[236:239], a[4:7], 0
  ds_read_b64_tr_b16 a[210:211], v31 offset:38528
  v_mfma_f32_16x16x32_bf16 v[204:207], a[236:239], a[8:11], 0
  buffer_load_dwordx4 v14, s[8:11], s74 offen offset:1024 lds
  v_mfma_f32_16x16x32_bf16 v[252:255], a[236:239], a[12:15], 0
  buffer_store_dwordx4 v[60:63], v28, s[80:83], s53 offen sc0 sc1
  s_waitcnt lgkmcnt(6)
  v_mfma_f32_16x16x32_bf16 v[64:67], a[192:195], a[16:19], v[64:67]
  ds_read_b64_tr_b16 a[212:213], v32 offset:36992
  v_accvgpr_read_b32 v48, a40
  v_mfma_f32_16x16x32_bf16 v[112:115], a[192:195], a[20:23], v[112:115]
  ds_read_b64_tr_b16 a[214:215], v32 offset:38528
  v_accvgpr_read_b32 v49, a41
  v_mfma_f32_16x16x32_bf16 v[160:163], a[192:195], a[24:27], v[160:163]
  buffer_load_dwordx4 v15, s[8:11], s74 offen offset:2048 lds
  v_mfma_f32_16x16x32_bf16 v[208:211], a[192:195], a[28:31], v[208:211]
  v_accvgpr_read_b32 v50, a42
  v_accvgpr_read_b32 v51, a43
  v_mfma_f32_16x16x32_bf16 v[68:71], a[196:199], a[16:19], v[68:71]
  ds_read_b64_tr_b16 a[216:217], v33 offset:36992
  v_accvgpr_read_b32 v52, a56
  v_mfma_f32_16x16x32_bf16 v[116:119], a[196:199], a[20:23], v[116:119]
  ds_read_b64_tr_b16 a[218:219], v33 offset:38528
  v_accvgpr_read_b32 v53, a57
  v_mfma_f32_16x16x32_bf16 v[164:167], a[196:199], a[24:27], v[164:167]
  buffer_load_dwordx4 v16, s[8:11], s74 offen offset:3072 lds
  v_mfma_f32_16x16x32_bf16 v[212:215], a[196:199], a[28:31], v[212:215]
  v_accvgpr_read_b32 v54, a58
  v_accvgpr_read_b32 v55, a59
  s_waitcnt lgkmcnt(6)
  v_mfma_f32_16x16x32_bf16 v[72:75], a[200:203], a[16:19], v[72:75]
  ds_read_b64_tr_b16 a[220:221], v34 offset:36992
  v_mul_f32 v48, v48, v39
  v_mfma_f32_16x16x32_bf16 v[120:123], a[200:203], a[20:23], v[120:123]
  ds_read_b64_tr_b16 a[222:223], v34 offset:38528
  v_mul_f32 v49, v49, v39
  v_mfma_f32_16x16x32_bf16 v[168:171], a[200:203], a[24:27], v[168:171]
  s_add_u32 m0, s55, 36864
  s_add_u32 s73, s71, 1572864
  buffer_load_dwordx4 v41, s[12:15], s73 offen offset:0 lds
  v_mfma_f32_16x16x32_bf16 v[216:219], a[200:203], a[28:31], v[216:219]
  v_mul_f32 v50, v50, v39
  v_mul_f32 v51, v51, v39
  v_mfma_f32_16x16x32_bf16 v[76:79], a[204:207], a[16:19], v[76:79]
  ds_read_b64_tr_b16 a[224:225], v31 offset:37120
  v_mul_f32 v52, v52, v39
  v_mfma_f32_16x16x32_bf16 v[124:127], a[204:207], a[20:23], v[124:127]
  ds_read_b64_tr_b16 a[226:227], v31 offset:38656
  v_mul_f32 v53, v53, v39
  v_mfma_f32_16x16x32_bf16 v[172:175], a[204:207], a[24:27], v[172:175]
  buffer_load_dwordx4 v42, s[12:15], s73 offen offset:1024 lds
  v_mfma_f32_16x16x32_bf16 v[220:223], a[204:207], a[28:31], v[220:223]
  s_waitcnt vmcnt(25)
  ds_read_b128 a[32:35], v29 offset:32768
  v_mul_f32 v54, v54, v39
  s_waitcnt lgkmcnt(7)
  v_mfma_f32_16x16x32_bf16 v[80:83], a[208:211], a[16:19], v[80:83]
  ds_read_b64_tr_b16 a[228:229], v32 offset:37120
  v_mul_f32 v55, v55, v39
  v_mfma_f32_16x16x32_bf16 v[128:131], a[208:211], a[20:23], v[128:131]
  ds_read_b64_tr_b16 a[230:231], v32 offset:38656
  v_cvt_pk_bf16_f32 v56, v48, v49
  v_mfma_f32_16x16x32_bf16 v[176:179], a[208:211], a[24:27], v[176:179]
  buffer_load_dwordx4 v43, s[12:15], s73 offen offset:2048 lds
  v_mfma_f32_16x16x32_bf16 v[224:227], a[208:211], a[28:31], v[224:227]
  ds_read_b128 a[48:51], v30 offset:32768
  v_cvt_pk_bf16_f32 v57, v50, v51
  v_mfma_f32_16x16x32_bf16 v[84:87], a[212:215], a[16:19], v[84:87]
  ds_read_b64_tr_b16 a[232:233], v33 offset:37120
  v_cvt_pk_bf16_f32 v58, v52, v53
  v_mfma_f32_16x16x32_bf16 v[132:135], a[212:215], a[20:23], v[132:135]
  ds_read_b64_tr_b16 a[234:235], v33 offset:38656
  v_cvt_pk_bf16_f32 v59, v54, v55
  s_add_u32 s53, s72, 394240
  v_mfma_f32_16x16x32_bf16 v[180:183], a[212:215], a[24:27], v[180:183]
  buffer_store_dwordx4 v[56:59], v28, s[80:83], s53 offen sc0 sc1
  v_mfma_f32_16x16x32_bf16 v[228:231], a[212:215], a[28:31], v[228:231]
  ds_read_b128 a[36:39], v29 offset:34816
  v_accvgpr_read_b32 v48, a44
  s_waitcnt lgkmcnt(9)
  v_mfma_f32_16x16x32_bf16 v[88:91], a[216:219], a[16:19], v[88:91]
  ds_read_b64_tr_b16 a[236:237], v34 offset:37120
  v_accvgpr_read_b32 v49, a45
  v_mfma_f32_16x16x32_bf16 v[136:139], a[216:219], a[20:23], v[136:139]
  ds_read_b64_tr_b16 a[238:239], v34 offset:38656
  v_accvgpr_read_b32 v50, a46
  v_mfma_f32_16x16x32_bf16 v[184:187], a[216:219], a[24:27], v[184:187]
  v_accvgpr_read_b32 v51, a47
  v_accvgpr_read_b32 v52, a60
  v_mfma_f32_16x16x32_bf16 v[232:235], a[216:219], a[28:31], v[232:235]
  ds_read_b128 a[52:55], v30 offset:34816
  v_accvgpr_read_b32 v53, a61
  s_barrier
  v_mfma_f32_16x16x32_bf16 v[92:95], a[220:223], a[16:19], v[92:95]
  ds_read_b64_tr_b16 a[192:193], v31 offset:24576
  v_accvgpr_read_b32 v54, a62
  v_mfma_f32_16x16x32_bf16 v[140:143], a[220:223], a[20:23], v[140:143]
  ds_read_b64_tr_b16 a[194:195], v31 offset:26112
  v_accvgpr_read_b32 v55, a63
  v_mfma_f32_16x16x32_bf16 v[188:191], a[220:223], a[24:27], v[188:191]
  s_add_u32 m0, s55, 49152
  s_add_u32 s73, s71, 1966080
  buffer_load_dwordx4 v41, s[12:15], s73 offen offset:0 lds
  v_mfma_f32_16x16x32_bf16 v[236:239], a[220:223], a[28:31], v[236:239]
  ds_read_b128 a[40:43], v29 offset:36864
  v_mul_f32 v48, v48, v40
  s_waitcnt lgkmcnt(10)
  v_mfma_f32_16x16x32_bf16 v[96:99], a[224:227], a[16:19], v[96:99]
  ds_read_b64_tr_b16 a[196:197], v32 offset:24576
  v_mul_f32 v49, v49, v40
  v_mfma_f32_16x16x32_bf16 v[144:147], a[224:227], a[20:23], v[144:147]
  ds_read_b64_tr_b16 a[198:199], v32 offset:26112
  v_mul_f32 v50, v50, v40
  v_mfma_f32_16x16x32_bf16 v[192:195], a[224:227], a[24:27], v[192:195]
  buffer_load_dwordx4 v42, s[12:15], s73 offen offset:1024 lds
  v_mfma_f32_16x16x32_bf16 v[240:243], a[224:227], a[28:31], v[240:243]
  ds_read_b128 a[56:59], v30 offset:36864
  v_mul_f32 v51, v51, v40
  v_mfma_f32_16x16x32_bf16 v[100:103], a[228:231], a[16:19], v[100:103]
  ds_read_b64_tr_b16 a[200:201], v33 offset:24576
  v_mul_f32 v52, v52, v40
  v_mfma_f32_16x16x32_bf16 v[148:151], a[228:231], a[20:23], v[148:151]
  ds_read_b64_tr_b16 a[202:203], v33 offset:26112
  v_mul_f32 v53, v53, v40
  v_mfma_f32_16x16x32_bf16 v[196:199], a[228:231], a[24:27], v[196:199]
  buffer_load_dwordx4 v43, s[12:15], s73 offen offset:2048 lds
  v_mfma_f32_16x16x32_bf16 v[244:247], a[228:231], a[28:31], v[244:247]
  v_mul_f32 v54, v54, v40
  v_mul_f32 v55, v55, v40
  v_cvt_pk_bf16_f32 v60, v48, v49
  v_cvt_pk_bf16_f32 v61, v50, v51
  v_cvt_pk_bf16_f32 v62, v52, v53
  v_cvt_pk_bf16_f32 v63, v54, v55
  s_add_u32 s53, s72, 590848
  buffer_store_dwordx4 v[60:63], v28, s[80:83], s53 offen sc0 sc1
  ds_read_b128 a[44:47], v29 offset:38912
  v_accvgpr_read_b32 v48, a64
  s_waitcnt lgkmcnt(10)
  v_mfma_f32_16x16x32_bf16 v[104:107], a[232:235], a[16:19], v[104:107]
  ds_read_b64_tr_b16 a[204:205], v34 offset:24576
  v_accvgpr_read_b32 v49, a65
  v_mfma_f32_16x16x32_bf16 v[152:155], a[232:235], a[20:23], v[152:155]
  ds_read_b64_tr_b16 a[206:207], v34 offset:26112
  v_accvgpr_read_b32 v50, a66
  v_mfma_f32_16x16x32_bf16 v[200:203], a[232:235], a[24:27], v[200:203]
  v_accvgpr_read_b32 v51, a67
  v_accvgpr_read_b32 v52, a80
  v_mfma_f32_16x16x32_bf16 v[248:251], a[232:235], a[28:31], v[248:251]
  ds_read_b128 a[60:63], v30 offset:38912
  v_accvgpr_read_b32 v53, a81
  v_mfma_f32_16x16x32_bf16 v[108:111], a[236:239], a[16:19], v[108:111]
  ds_read_b64_tr_b16 a[208:209], v31 offset:24704
  v_accvgpr_read_b32 v54, a82
  v_mfma_f32_16x16x32_bf16 v[156:159], a[236:239], a[20:23], v[156:159]
  ds_read_b64_tr_b16 a[210:211], v31 offset:26240
  v_accvgpr_read_b32 v55, a83
  v_mfma_f32_16x16x32_bf16 v[204:207], a[236:239], a[24:27], v[204:207]
  v_mul_f32 v48, v48, v37
  v_mul_f32 v49, v49, v37
  v_mfma_f32_16x16x32_bf16 v[252:255], a[236:239], a[28:31], v[252:255]
  v_mul_f32 v50, v50, v37
  v_mul_f32 v51, v51, v37
  s_waitcnt lgkmcnt(2)
  v_mfma_f32_16x16x32_bf16 v[64:67], a[192:195], a[32:35], v[64:67]
  ds_read_b64_tr_b16 a[212:213], v32 offset:24704
  v_mul_f32 v52, v52, v37
  v_mfma_f32_16x16x32_bf16 v[112:115], a[192:195], a[36:39], v[112:115]
  ds_read_b64_tr_b16 a[214:215], v32 offset:26240
  v_mul_f32 v53, v53, v37
  v_mfma_f32_16x16x32_bf16 v[160:163], a[192:195], a[40:43], v[160:163]
  s_add_u32 m0, s75, 32768
  s_add_u32 s74, s70, 384
  buffer_load_dwordx4 v9, s[8:11], s74 offen offset:0 lds
  v_mfma_f32_16x16x32_bf16 v[208:211], a[192:195], a[44:47], v[208:211]
  v_mul_f32 v54, v54, v37
  v_mul_f32 v55, v55, v37
  v_mfma_f32_16x16x32_bf16 v[68:71], a[196:199], a[32:35], v[68:71]
  ds_read_b64_tr_b16 a[216:217], v33 offset:24704
  v_cvt_pk_bf16_f32 v56, v48, v49
  v_mfma_f32_16x16x32_bf16 v[116:119], a[196:199], a[36:39], v[116:119]
  ds_read_b64_tr_b16 a[218:219], v33 offset:26240
  v_cvt_pk_bf16_f32 v57, v50, v51
  v_mfma_f32_16x16x32_bf16 v[164:167], a[196:199], a[40:43], v[164:167]
  buffer_load_dwordx4 v10, s[8:11], s74 offen offset:1024 lds
  v_mfma_f32_16x16x32_bf16 v[212:215], a[196:199], a[44:47], v[212:215]
  v_cvt_pk_bf16_f32 v58, v52, v53
  v_cvt_pk_bf16_f32 v59, v54, v55
  s_add_u32 s53, s72, 2048
  v_mfma_f32_16x16x32_bf16 v[72:75], a[200:203], a[32:35], v[72:75]
  ds_read_b64_tr_b16 a[220:221], v34 offset:24704
  v_mfma_f32_16x16x32_bf16 v[120:123], a[200:203], a[36:39], v[120:123]
  ds_read_b64_tr_b16 a[222:223], v34 offset:26240
  v_mfma_f32_16x16x32_bf16 v[168:171], a[200:203], a[40:43], v[168:171]
  buffer_load_dwordx4 v11, s[8:11], s74 offen offset:2048 lds
  v_mfma_f32_16x16x32_bf16 v[216:219], a[200:203], a[44:47], v[216:219]
  buffer_store_dwordx4 v[56:59], v28, s[80:83], s53 offen sc0 sc1
  v_mfma_f32_16x16x32_bf16 v[76:79], a[204:207], a[32:35], v[76:79]
  ds_read_b64_tr_b16 a[224:225], v31 offset:24832
  v_accvgpr_read_b32 v48, a68
  v_mfma_f32_16x16x32_bf16 v[124:127], a[204:207], a[36:39], v[124:127]
  ds_read_b64_tr_b16 a[226:227], v31 offset:26368
  v_accvgpr_read_b32 v49, a69
  v_mfma_f32_16x16x32_bf16 v[172:175], a[204:207], a[40:43], v[172:175]
  buffer_load_dwordx4 v12, s[8:11], s74 offen offset:3072 lds
  v_mfma_f32_16x16x32_bf16 v[220:223], a[204:207], a[44:47], v[220:223]
  v_accvgpr_read_b32 v50, a70
  v_accvgpr_read_b32 v51, a71
  s_waitcnt lgkmcnt(6)
  v_mfma_f32_16x16x32_bf16 v[80:83], a[208:211], a[32:35], v[80:83]
  ds_read_b64_tr_b16 a[228:229], v32 offset:24832
  v_accvgpr_read_b32 v52, a84
  v_mfma_f32_16x16x32_bf16 v[128:131], a[208:211], a[36:39], v[128:131]
  ds_read_b64_tr_b16 a[230:231], v32 offset:26368
  v_accvgpr_read_b32 v53, a85
  v_mfma_f32_16x16x32_bf16 v[176:179], a[208:211], a[40:43], v[176:179]
  s_add_u32 m0, s75, 36864
  s_add_u32 s74, s70, 384
  buffer_load_dwordx4 v13, s[8:11], s74 offen offset:0 lds
  v_mfma_f32_16x16x32_bf16 v[224:227], a[208:211], a[44:47], v[224:227]
  v_accvgpr_read_b32 v54, a86
  v_accvgpr_read_b32 v55, a87
  v_mfma_f32_16x16x32_bf16 v[84:87], a[212:215], a[32:35], v[84:87]
  ds_read_b64_tr_b16 a[232:233], v33 offset:24832
  v_mul_f32 v48, v48, v38
  v_mfma_f32_16x16x32_bf16 v[132:135], a[212:215], a[36:39], v[132:135]
  ds_read_b64_tr_b16 a[234:235], v33 offset:26368
  v_mul_f32 v49, v49, v38
  v_mfma_f32_16x16x32_bf16 v[180:183], a[212:215], a[40:43], v[180:183]
  buffer_load_dwordx4 v14, s[8:11], s74 offen offset:1024 lds
  v_mfma_f32_16x16x32_bf16 v[228:231], a[212:215], a[44:47], v[228:231]
  v_mul_f32 v50, v50, v38
  v_mul_f32 v51, v51, v38
  s_waitcnt lgkmcnt(6)
  v_mfma_f32_16x16x32_bf16 v[88:91], a[216:219], a[32:35], v[88:91]
  ds_read_b64_tr_b16 a[236:237], v34 offset:24832
  v_mul_f32 v52, v52, v38
  v_mfma_f32_16x16x32_bf16 v[136:139], a[216:219], a[36:39], v[136:139]
  ds_read_b64_tr_b16 a[238:239], v34 offset:26368
  v_mul_f32 v53, v53, v38
  v_mfma_f32_16x16x32_bf16 v[184:187], a[216:219], a[40:43], v[184:187]
  buffer_load_dwordx4 v15, s[8:11], s74 offen offset:2048 lds
  v_mfma_f32_16x16x32_bf16 v[232:235], a[216:219], a[44:47], v[232:235]
  v_mul_f32 v54, v54, v38
  v_mul_f32 v55, v55, v38
  s_barrier
  v_mfma_f32_16x16x32_bf16 v[92:95], a[220:223], a[32:35], v[92:95]
  ds_read_b64_tr_b16 a[192:193], v31 offset:49152
  v_cvt_pk_bf16_f32 v60, v48, v49
  v_mfma_f32_16x16x32_bf16 v[140:143], a[220:223], a[36:39], v[140:143]
  ds_read_b64_tr_b16 a[194:195], v31 offset:50688
  v_cvt_pk_bf16_f32 v61, v50, v51
  v_mfma_f32_16x16x32_bf16 v[188:191], a[220:223], a[40:43], v[188:191]
  buffer_load_dwordx4 v16, s[8:11], s74 offen offset:3072 lds
  v_mfma_f32_16x16x32_bf16 v[236:239], a[220:223], a[44:47], v[236:239]
  v_cvt_pk_bf16_f32 v62, v52, v53
  v_cvt_pk_bf16_f32 v63, v54, v55
  s_add_u32 s53, s72, 198656
  s_waitcnt lgkmcnt(6)
  v_mfma_f32_16x16x32_bf16 v[96:99], a[224:227], a[32:35], v[96:99]
  ds_read_b64_tr_b16 a[196:197], v32 offset:49152
  v_mfma_f32_16x16x32_bf16 v[144:147], a[224:227], a[36:39], v[144:147]
  ds_read_b64_tr_b16 a[198:199], v32 offset:50688
  v_mfma_f32_16x16x32_bf16 v[192:195], a[224:227], a[40:43], v[192:195]
  s_add_u32 m0, s55, 73728
  s_add_u32 s73, s71, 2359296
  buffer_load_dwordx4 v41, s[12:15], s73 offen offset:0 lds
  v_mfma_f32_16x16x32_bf16 v[240:243], a[224:227], a[44:47], v[240:243]
  buffer_store_dwordx4 v[60:63], v28, s[80:83], s53 offen sc0 sc1
  v_mfma_f32_16x16x32_bf16 v[100:103], a[228:231], a[32:35], v[100:103]
  ds_read_b64_tr_b16 a[200:201], v33 offset:49152
  v_accvgpr_read_b32 v48, a72
  v_mfma_f32_16x16x32_bf16 v[148:151], a[228:231], a[36:39], v[148:151]
  ds_read_b64_tr_b16 a[202:203], v33 offset:50688
  v_accvgpr_read_b32 v49, a73
  v_mfma_f32_16x16x32_bf16 v[196:199], a[228:231], a[40:43], v[196:199]
  buffer_load_dwordx4 v42, s[12:15], s73 offen offset:1024 lds
  v_mfma_f32_16x16x32_bf16 v[244:247], a[228:231], a[44:47], v[244:247]
  v_accvgpr_read_b32 v50, a74
  v_accvgpr_read_b32 v51, a75
  s_waitcnt lgkmcnt(6)
  v_mfma_f32_16x16x32_bf16 v[104:107], a[232:235], a[32:35], v[104:107]
  ds_read_b64_tr_b16 a[204:205], v34 offset:49152
  v_accvgpr_read_b32 v52, a88
  v_mfma_f32_16x16x32_bf16 v[152:155], a[232:235], a[36:39], v[152:155]
  ds_read_b64_tr_b16 a[206:207], v34 offset:50688
  v_accvgpr_read_b32 v53, a89
  v_mfma_f32_16x16x32_bf16 v[200:203], a[232:235], a[40:43], v[200:203]
  buffer_load_dwordx4 v43, s[12:15], s73 offen offset:2048 lds
  v_mfma_f32_16x16x32_bf16 v[248:251], a[232:235], a[44:47], v[248:251]
  v_accvgpr_read_b32 v54, a90
  v_accvgpr_read_b32 v55, a91
  v_mfma_f32_16x16x32_bf16 v[108:111], a[236:239], a[32:35], v[108:111]
  ds_read_b64_tr_b16 a[208:209], v31 offset:49280
  v_mul_f32 v48, v48, v39
  v_mfma_f32_16x16x32_bf16 v[156:159], a[236:239], a[36:39], v[156:159]
  ds_read_b64_tr_b16 a[210:211], v31 offset:50816
  v_mul_f32 v49, v49, v39
  v_mfma_f32_16x16x32_bf16 v[204:207], a[236:239], a[40:43], v[204:207]
  v_mul_f32 v50, v50, v39
  v_mul_f32 v51, v51, v39
  v_mfma_f32_16x16x32_bf16 v[252:255], a[236:239], a[44:47], v[252:255]
  v_mul_f32 v52, v52, v39
  v_mul_f32 v53, v53, v39
  s_waitcnt lgkmcnt(6)
  v_mfma_f32_16x16x32_bf16 v[64:67], a[192:195], a[48:51], v[64:67]
  ds_read_b64_tr_b16 a[212:213], v32 offset:49280
  v_mul_f32 v54, v54, v39
  v_mfma_f32_16x16x32_bf16 v[112:115], a[192:195], a[52:55], v[112:115]
  ds_read_b64_tr_b16 a[214:215], v32 offset:50816
  v_mul_f32 v55, v55, v39
  v_mfma_f32_16x16x32_bf16 v[160:163], a[192:195], a[56:59], v[160:163]
  v_cvt_pk_bf16_f32 v56, v48, v49
  v_cvt_pk_bf16_f32 v57, v50, v51
  v_mfma_f32_16x16x32_bf16 v[208:211], a[192:195], a[60:63], v[208:211]
  v_cvt_pk_bf16_f32 v58, v52, v53
  v_cvt_pk_bf16_f32 v59, v54, v55
  s_add_u32 s53, s72, 395264
  v_mfma_f32_16x16x32_bf16 v[68:71], a[196:199], a[48:51], v[68:71]
  ds_read_b64_tr_b16 a[216:217], v33 offset:49280
  v_mfma_f32_16x16x32_bf16 v[116:119], a[196:199], a[52:55], v[116:119]
  ds_read_b64_tr_b16 a[218:219], v33 offset:50816
  v_mfma_f32_16x16x32_bf16 v[164:167], a[196:199], a[56:59], v[164:167]
  buffer_store_dwordx4 v[56:59], v28, s[80:83], s53 offen sc0 sc1
  v_mfma_f32_16x16x32_bf16 v[212:215], a[196:199], a[60:63], v[212:215]
  s_waitcnt vmcnt(22)
  ds_read_b128 a[0:3], v29 offset:0
  v_accvgpr_read_b32 v48, a76
  s_waitcnt lgkmcnt(7)
  v_mfma_f32_16x16x32_bf16 v[72:75], a[200:203], a[48:51], v[72:75]
  ds_read_b64_tr_b16 a[220:221], v34 offset:49280
  v_accvgpr_read_b32 v49, a77
  v_mfma_f32_16x16x32_bf16 v[120:123], a[200:203], a[52:55], v[120:123]
  ds_read_b64_tr_b16 a[222:223], v34 offset:50816
  v_accvgpr_read_b32 v50, a78
  v_mfma_f32_16x16x32_bf16 v[168:171], a[200:203], a[56:59], v[168:171]
  v_accvgpr_read_b32 v51, a79
  v_accvgpr_read_b32 v52, a92
  v_mfma_f32_16x16x32_bf16 v[216:219], a[200:203], a[60:63], v[216:219]
  ds_read_b128 a[16:19], v30 offset:0
  v_accvgpr_read_b32 v53, a93
  v_mfma_f32_16x16x32_bf16 v[76:79], a[204:207], a[48:51], v[76:79]
  ds_read_b64_tr_b16 a[224:225], v31 offset:49408
  v_accvgpr_read_b32 v54, a94
  v_mfma_f32_16x16x32_bf16 v[124:127], a[204:207], a[52:55], v[124:127]
  ds_read_b64_tr_b16 a[226:227], v31 offset:50944
  v_accvgpr_read_b32 v55, a95
  v_mfma_f32_16x16x32_bf16 v[172:175], a[204:207], a[56:59], v[172:175]
  v_mul_f32 v48, v48, v40
  v_mul_f32 v49, v49, v40
  v_mfma_f32_16x16x32_bf16 v[220:223], a[204:207], a[60:63], v[220:223]
  ds_read_b128 a[4:7], v29 offset:2048
  v_mul_f32 v50, v50, v40
  s_waitcnt lgkmcnt(9)
  v_mfma_f32_16x16x32_bf16 v[80:83], a[208:211], a[48:51], v[80:83]
  ds_read_b64_tr_b16 a[228:229], v32 offset:49408
  v_mul_f32 v51, v51, v40
  v_mfma_f32_16x16x32_bf16 v[128:131], a[208:211], a[52:55], v[128:131]
  ds_read_b64_tr_b16 a[230:231], v32 offset:50944
  v_mul_f32 v52, v52, v40
  v_mfma_f32_16x16x32_bf16 v[176:179], a[208:211], a[56:59], v[176:179]
  v_mul_f32 v53, v53, v40
  v_mul_f32 v54, v54, v40
  v_mfma_f32_16x16x32_bf16 v[224:227], a[208:211], a[60:63], v[224:227]
  ds_read_b128 a[20:23], v30 offset:2048
  v_mul_f32 v55, v55, v40
  v_mfma_f32_16x16x32_bf16 v[84:87], a[212:215], a[48:51], v[84:87]
  ds_read_b64_tr_b16 a[232:233], v33 offset:49408
  v_cvt_pk_bf16_f32 v60, v48, v49
  v_mfma_f32_16x16x32_bf16 v[132:135], a[212:215], a[52:55], v[132:135]
  ds_read_b64_tr_b16 a[234:235], v33 offset:50944
  v_cvt_pk_bf16_f32 v61, v50, v51
  v_mfma_f32_16x16x32_bf16 v[180:183], a[212:215], a[56:59], v[180:183]
  v_cvt_pk_bf16_f32 v62, v52, v53
  v_cvt_pk_bf16_f32 v63, v54, v55
  s_add_u32 s53, s72, 591872
  v_mfma_f32_16x16x32_bf16 v[228:231], a[212:215], a[60:63], v[228:231]
  ds_read_b128 a[8:11], v29 offset:4096
  s_waitcnt lgkmcnt(10)
  v_mfma_f32_16x16x32_bf16 v[88:91], a[216:219], a[48:51], v[88:91]
  ds_read_b64_tr_b16 a[236:237], v34 offset:49408
  v_mfma_f32_16x16x32_bf16 v[136:139], a[216:219], a[52:55], v[136:139]
  ds_read_b64_tr_b16 a[238:239], v34 offset:50944
  v_mfma_f32_16x16x32_bf16 v[184:187], a[216:219], a[56:59], v[184:187]
  buffer_store_dwordx4 v[60:63], v28, s[80:83], s53 offen sc0 sc1
  v_mfma_f32_16x16x32_bf16 v[232:235], a[216:219], a[60:63], v[232:235]
  ds_read_b128 a[24:27], v30 offset:4096
  v_accvgpr_read_b32 v48, a96
  s_waitcnt vmcnt(20)
  s_barrier
  v_mfma_f32_16x16x32_bf16 v[92:95], a[220:223], a[48:51], v[92:95]
  ds_read_b64_tr_b16 a[192:193], v31 offset:0
  v_accvgpr_read_b32 v49, a97
  v_mfma_f32_16x16x32_bf16 v[140:143], a[220:223], a[52:55], v[140:143]
  ds_read_b64_tr_b16 a[194:195], v31 offset:1536
  v_accvgpr_read_b32 v50, a98
  v_mfma_f32_16x16x32_bf16 v[188:191], a[220:223], a[56:59], v[188:191]
  s_add_u32 m0, s55, 61440
  s_add_u32 s73, s71, 2752512
  buffer_load_dwordx4 v41, s[12:15], s73 offen offset:0 lds
  v_mfma_f32_16x16x32_bf16 v[236:239], a[220:223], a[60:63], v[236:239]
  ds_read_b128 a[12:15], v29 offset:6144
  v_accvgpr_read_b32 v51, a99
  s_waitcnt lgkmcnt(10)
  v_mfma_f32_16x16x32_bf16 v[96:99], a[224:227], a[48:51], v[96:99]
  ds_read_b64_tr_b16 a[196:197], v32 offset:0
  v_accvgpr_read_b32 v52, a112
  v_mfma_f32_16x16x32_bf16 v[144:147], a[224:227], a[52:55], v[144:147]
  ds_read_b64_tr_b16 a[198:199], v32 offset:1536
  v_accvgpr_read_b32 v53, a113
  v_mfma_f32_16x16x32_bf16 v[192:195], a[224:227], a[56:59], v[192:195]
  buffer_load_dwordx4 v42, s[12:15], s73 offen offset:1024 lds
  v_mfma_f32_16x16x32_bf16 v[240:243], a[224:227], a[60:63], v[240:243]
  ds_read_b128 a[28:31], v30 offset:6144
  v_accvgpr_read_b32 v54, a114
  v_mfma_f32_16x16x32_bf16 v[100:103], a[228:231], a[48:51], v[100:103]
  ds_read_b64_tr_b16 a[200:201], v33 offset:0
  v_accvgpr_read_b32 v55, a115
  v_mfma_f32_16x16x32_bf16 v[148:151], a[228:231], a[52:55], v[148:151]
  ds_read_b64_tr_b16 a[202:203], v33 offset:1536
  v_mul_f32 v48, v48, v37
  v_mfma_f32_16x16x32_bf16 v[196:199], a[228:231], a[56:59], v[196:199]
  buffer_load_dwordx4 v43, s[12:15], s73 offen offset:2048 lds
  v_mfma_f32_16x16x32_bf16 v[244:247], a[228:231], a[60:63], v[244:247]
  v_mul_f32 v49, v49, v37
  v_mul_f32 v50, v50, v37
  s_waitcnt lgkmcnt(9)
  v_mfma_f32_16x16x32_bf16 v[104:107], a[232:235], a[48:51], v[104:107]
  ds_read_b64_tr_b16 a[204:205], v34 offset:0
  v_mul_f32 v51, v51, v37
  v_mfma_f32_16x16x32_bf16 v[152:155], a[232:235], a[52:55], v[152:155]
  ds_read_b64_tr_b16 a[206:207], v34 offset:1536
  v_mul_f32 v52, v52, v37
  v_mfma_f32_16x16x32_bf16 v[200:203], a[232:235], a[56:59], v[200:203]
  v_mul_f32 v53, v53, v37
  v_mul_f32 v54, v54, v37
  v_mfma_f32_16x16x32_bf16 v[248:251], a[232:235], a[60:63], v[248:251]
  v_mul_f32 v55, v55, v37
  v_cvt_pk_bf16_f32 v56, v48, v49
  v_mfma_f32_16x16x32_bf16 v[108:111], a[236:239], a[48:51], v[108:111]
  ds_read_b64_tr_b16 a[208:209], v31 offset:128
  v_cvt_pk_bf16_f32 v57, v50, v51
  v_mfma_f32_16x16x32_bf16 v[156:159], a[236:239], a[52:55], v[156:159]
  ds_read_b64_tr_b16 a[210:211], v31 offset:1664
  v_cvt_pk_bf16_f32 v58, v52, v53
  v_mfma_f32_16x16x32_bf16 v[204:207], a[236:239], a[56:59], v[204:207]
  v_cvt_pk_bf16_f32 v59, v54, v55
  s_add_u32 s53, s72, 3072
  v_mfma_f32_16x16x32_bf16 v[252:255], a[236:239], a[60:63], v[252:255]
  buffer_store_dwordx4 v[56:59], v28, s[80:83], s53 offen sc0 sc1
  s_waitcnt lgkmcnt(6)
  v_mfma_f32_16x16x32_bf16 v[64:67], a[192:195], a[0:3], v[64:67]
  ds_read_b64_tr_b16 a[212:213], v32 offset:128
  v_accvgpr_read_b32 v48, a100
  v_mfma_f32_16x16x32_bf16 v[112:115], a[192:195], a[4:7], v[112:115]
  ds_read_b64_tr_b16 a[214:215], v32 offset:1664
  v_accvgpr_read_b32 v49, a101
  v_mfma_f32_16x16x32_bf16 v[160:163], a[192:195], a[8:11], v[160:163]
  s_add_u32 m0, s75, 0
  s_add_u32 s74, s70, 512
  buffer_load_dwordx4 v9, s[8:11], s74 offen offset:0 lds
  v_mfma_f32_16x16x32_bf16 v[208:211], a[192:195], a[12:15], v[208:211]
  v_accvgpr_read_b32 v50, a102
  v_accvgpr_read_b32 v51, a103
  v_mfma_f32_16x16x32_bf16 v[68:71], a[196:199], a[0:3], v[68:71]
  ds_read_b64_tr_b16 a[216:217], v33 offset:128
  v_accvgpr_read_b32 v52, a116
  v_mfma_f32_16x16x32_bf16 v[116:119], a[196:199], a[4:7], v[116:119]
  ds_read_b64_tr_b16 a[218:219], v33 offset:1664
  v_accvgpr_read_b32 v53, a117
  v_mfma_f32_16x16x32_bf16 v[164:167], a[196:199], a[8:11], v[164:167]
  buffer_load_dwordx4 v10, s[8:11], s74 offen offset:1024 lds
  v_mfma_f32_16x16x32_bf16 v[212:215], a[196:199], a[12:15], v[212:215]
  v_accvgpr_read_b32 v54, a118
  v_accvgpr_read_b32 v55, a119
  s_waitcnt lgkmcnt(6)
  v_mfma_f32_16x16x32_bf16 v[72:75], a[200:203], a[0:3], v[72:75]
  ds_read_b64_tr_b16 a[220:221], v34 offset:128
  v_mul_f32 v48, v48, v38
  v_mfma_f32_16x16x32_bf16 v[120:123], a[200:203], a[4:7], v[120:123]
  ds_read_b64_tr_b16 a[222:223], v34 offset:1664
  v_mul_f32 v49, v49, v38
  v_mfma_f32_16x16x32_bf16 v[168:171], a[200:203], a[8:11], v[168:171]
  buffer_load_dwordx4 v11, s[8:11], s74 offen offset:2048 lds
  v_mfma_f32_16x16x32_bf16 v[216:219], a[200:203], a[12:15], v[216:219]
  v_mul_f32 v50, v50, v38
  v_mul_f32 v51, v51, v38
  v_mfma_f32_16x16x32_bf16 v[76:79], a[204:207], a[0:3], v[76:79]
  ds_read_b64_tr_b16 a[224:225], v31 offset:256
  v_mul_f32 v52, v52, v38
  v_mfma_f32_16x16x32_bf16 v[124:127], a[204:207], a[4:7], v[124:127]
  ds_read_b64_tr_b16 a[226:227], v31 offset:1792
  v_mul_f32 v53, v53, v38
  v_mfma_f32_16x16x32_bf16 v[172:175], a[204:207], a[8:11], v[172:175]
  buffer_load_dwordx4 v12, s[8:11], s74 offen offset:3072 lds
  v_mfma_f32_16x16x32_bf16 v[220:223], a[204:207], a[12:15], v[220:223]
  v_mul_f32 v54, v54, v38
  v_mul_f32 v55, v55, v38
  s_waitcnt lgkmcnt(6)
  v_mfma_f32_16x16x32_bf16 v[80:83], a[208:211], a[0:3], v[80:83]
  ds_read_b64_tr_b16 a[228:229], v32 offset:256
  v_cvt_pk_bf16_f32 v60, v48, v49
  v_mfma_f32_16x16x32_bf16 v[128:131], a[208:211], a[4:7], v[128:131]
  ds_read_b64_tr_b16 a[230:231], v32 offset:1792
  v_cvt_pk_bf16_f32 v61, v50, v51
  v_mfma_f32_16x16x32_bf16 v[176:179], a[208:211], a[8:11], v[176:179]
  s_add_u32 m0, s75, 4096
  s_add_u32 s74, s70, 512
  buffer_load_dwordx4 v13, s[8:11], s74 offen offset:0 lds
  v_mfma_f32_16x16x32_bf16 v[224:227], a[208:211], a[12:15], v[224:227]
  v_cvt_pk_bf16_f32 v62, v52, v53
  v_cvt_pk_bf16_f32 v63, v54, v55
  s_add_u32 s53, s72, 199680
  v_mfma_f32_16x16x32_bf16 v[84:87], a[212:215], a[0:3], v[84:87]
  ds_read_b64_tr_b16 a[232:233], v33 offset:256
  v_mfma_f32_16x16x32_bf16 v[132:135], a[212:215], a[4:7], v[132:135]
  ds_read_b64_tr_b16 a[234:235], v33 offset:1792
  v_mfma_f32_16x16x32_bf16 v[180:183], a[212:215], a[8:11], v[180:183]
  buffer_load_dwordx4 v14, s[8:11], s74 offen offset:1024 lds
  v_mfma_f32_16x16x32_bf16 v[228:231], a[212:215], a[12:15], v[228:231]
  buffer_store_dwordx4 v[60:63], v28, s[80:83], s53 offen sc0 sc1
  s_waitcnt lgkmcnt(6)
  v_mfma_f32_16x16x32_bf16 v[88:91], a[216:219], a[0:3], v[88:91]
  ds_read_b64_tr_b16 a[236:237], v34 offset:256
  v_accvgpr_read_b32 v48, a104
  v_mfma_f32_16x16x32_bf16 v[136:139], a[216:219], a[4:7], v[136:139]
  ds_read_b64_tr_b16 a[238:239], v34 offset:1792
  v_accvgpr_read_b32 v49, a105
  v_mfma_f32_16x16x32_bf16 v[184:187], a[216:219], a[8:11], v[184:187]
  buffer_load_dwordx4 v15, s[8:11], s74 offen offset:2048 lds
  v_mfma_f32_16x16x32_bf16 v[232:235], a[216:219], a[12:15], v[232:235]
  v_accvgpr_read_b32 v50, a106
  v_accvgpr_read_b32 v51, a107
  s_waitcnt vmcnt(28)
  s_barrier
  v_mfma_f32_16x16x32_bf16 v[92:95], a[220:223], a[0:3], v[92:95]
  ds_read_b64_tr_b16 a[192:193], v31 offset:12288
  v_accvgpr_read_b32 v52, a120
  v_mfma_f32_16x16x32_bf16 v[140:143], a[220:223], a[4:7], v[140:143]
  ds_read_b64_tr_b16 a[194:195], v31 offset:13824
  v_accvgpr_read_b32 v53, a121
  v_mfma_f32_16x16x32_bf16 v[188:191], a[220:223], a[8:11], v[188:191]
  buffer_load_dwordx4 v16, s[8:11], s74 offen offset:3072 lds
  v_mfma_f32_16x16x32_bf16 v[236:239], a[220:223], a[12:15], v[236:239]
  v_accvgpr_read_b32 v54, a122
  v_accvgpr_read_b32 v55, a123
  s_waitcnt lgkmcnt(6)
  v_mfma_f32_16x16x32_bf16 v[96:99], a[224:227], a[0:3], v[96:99]
  ds_read_b64_tr_b16 a[196:197], v32 offset:12288
  v_mul_f32 v48, v48, v39
  v_mfma_f32_16x16x32_bf16 v[144:147], a[224:227], a[4:7], v[144:147]
  ds_read_b64_tr_b16 a[198:199], v32 offset:13824
  v_mul_f32 v49, v49, v39
  v_mfma_f32_16x16x32_bf16 v[192:195], a[224:227], a[8:11], v[192:195]
  s_add_u32 m0, s55, 86016
  s_add_u32 s73, s71, 3145728
  buffer_load_dwordx4 v41, s[12:15], s73 offen offset:0 lds
  v_mfma_f32_16x16x32_bf16 v[240:243], a[224:227], a[12:15], v[240:243]
  v_mul_f32 v50, v50, v39
  v_mul_f32 v51, v51, v39
  v_mfma_f32_16x16x32_bf16 v[100:103], a[228:231], a[0:3], v[100:103]
  ds_read_b64_tr_b16 a[200:201], v33 offset:12288
  v_mul_f32 v52, v52, v39
  v_mfma_f32_16x16x32_bf16 v[148:151], a[228:231], a[4:7], v[148:151]
  ds_read_b64_tr_b16 a[202:203], v33 offset:13824
  v_mul_f32 v53, v53, v39
  v_mfma_f32_16x16x32_bf16 v[196:199], a[228:231], a[8:11], v[196:199]
  buffer_load_dwordx4 v42, s[12:15], s73 offen offset:1024 lds
  v_mfma_f32_16x16x32_bf16 v[244:247], a[228:231], a[12:15], v[244:247]
  v_mul_f32 v54, v54, v39
  v_mul_f32 v55, v55, v39
  s_waitcnt lgkmcnt(6)
  v_mfma_f32_16x16x32_bf16 v[104:107], a[232:235], a[0:3], v[104:107]
  ds_read_b64_tr_b16 a[204:205], v34 offset:12288
  v_cvt_pk_bf16_f32 v56, v48, v49
  v_mfma_f32_16x16x32_bf16 v[152:155], a[232:235], a[4:7], v[152:155]
  ds_read_b64_tr_b16 a[206:207], v34 offset:13824
  v_cvt_pk_bf16_f32 v57, v50, v51
  v_mfma_f32_16x16x32_bf16 v[200:203], a[232:235], a[8:11], v[200:203]
  buffer_load_dwordx4 v43, s[12:15], s73 offen offset:2048 lds
  v_mfma_f32_16x16x32_bf16 v[248:251], a[232:235], a[12:15], v[248:251]
  v_cvt_pk_bf16_f32 v58, v52, v53
  v_cvt_pk_bf16_f32 v59, v54, v55
  s_add_u32 s53, s72, 396288
  v_mfma_f32_16x16x32_bf16 v[108:111], a[236:239], a[0:3], v[108:111]
  ds_read_b64_tr_b16 a[208:209], v31 offset:12416
  v_mfma_f32_16x16x32_bf16 v[156:159], a[236:239], a[4:7], v[156:159]
  ds_read_b64_tr_b16 a[210:211], v31 offset:13952
  v_mfma_f32_16x16x32_bf16 v[204:207], a[236:239], a[8:11], v[204:207]
  buffer_store_dwordx4 v[56:59], v28, s[80:83], s53 offen sc0 sc1
  v_mfma_f32_16x16x32_bf16 v[252:255], a[236:239], a[12:15], v[252:255]
  v_accvgpr_read_b32 v48, a108
  v_accvgpr_read_b32 v49, a109
  s_waitcnt lgkmcnt(6)
  v_mfma_f32_16x16x32_bf16 v[64:67], a[192:195], a[16:19], v[64:67]
  ds_read_b64_tr_b16 a[212:213], v32 offset:12416
  v_accvgpr_read_b32 v50, a110
  v_mfma_f32_16x16x32_bf16 v[112:115], a[192:195], a[20:23], v[112:115]
  ds_read_b64_tr_b16 a[214:215], v32 offset:13952
  v_accvgpr_read_b32 v51, a111
  v_mfma_f32_16x16x32_bf16 v[160:163], a[192:195], a[24:27], v[160:163]
  v_accvgpr_read_b32 v52, a124
  v_accvgpr_read_b32 v53, a125
  v_mfma_f32_16x16x32_bf16 v[208:211], a[192:195], a[28:31], v[208:211]
  v_accvgpr_read_b32 v54, a126
  v_accvgpr_read_b32 v55, a127
  v_mfma_f32_16x16x32_bf16 v[68:71], a[196:199], a[16:19], v[68:71]
  ds_read_b64_tr_b16 a[216:217], v33 offset:12416
  v_mul_f32 v48, v48, v40
  v_mfma_f32_16x16x32_bf16 v[116:119], a[196:199], a[20:23], v[116:119]
  ds_read_b64_tr_b16 a[218:219], v33 offset:13952
  v_mul_f32 v49, v49, v40
  v_mfma_f32_16x16x32_bf16 v[164:167], a[196:199], a[24:27], v[164:167]
  v_mul_f32 v50, v50, v40
  v_mul_f32 v51, v51, v40
  v_mfma_f32_16x16x32_bf16 v[212:215], a[196:199], a[28:31], v[212:215]
  s_waitcnt vmcnt(23)
  ds_read_b128 a[32:35], v29 offset:32768
  v_mul_f32 v52, v52, v40
  s_waitcnt lgkmcnt(7)
  v_mfma_f32_16x16x32_bf16 v[72:75], a[200:203], a[16:19], v[72:75]
  ds_read_b64_tr_b16 a[220:221], v34 offset:12416
  v_mul_f32 v53, v53, v40
  v_mfma_f32_16x16x32_bf16 v[120:123], a[200:203], a[20:23], v[120:123]
  ds_read_b64_tr_b16 a[222:223], v34 offset:13952
  v_mul_f32 v54, v54, v40
  v_mfma_f32_16x16x32_bf16 v[168:171], a[200:203], a[24:27], v[168:171]
  v_mul_f32 v55, v55, v40
  v_cvt_pk_bf16_f32 v60, v48, v49
  v_mfma_f32_16x16x32_bf16 v[216:219], a[200:203], a[28:31], v[216:219]
  ds_read_b128 a[48:51], v30 offset:32768
  v_cvt_pk_bf16_f32 v61, v50, v51
  v_mfma_f32_16x16x32_bf16 v[76:79], a[204:207], a[16:19], v[76:79]
  ds_read_b64_tr_b16 a[224:225], v31 offset:12544
  v_cvt_pk_bf16_f32 v62, v52, v53
  v_mfma_f32_16x16x32_bf16 v[124:127], a[204:207], a[20:23], v[124:127]
  ds_read_b64_tr_b16 a[226:227], v31 offset:14080
  v_cvt_pk_bf16_f32 v63, v54, v55
  s_add_u32 s53, s72, 592896
  v_mfma_f32_16x16x32_bf16 v[172:175], a[204:207], a[24:27], v[172:175]
  buffer_store_dwordx4 v[60:63], v28, s[80:83], s53 offen sc0 sc1
  v_mfma_f32_16x16x32_bf16 v[220:223], a[204:207], a[28:31], v[220:223]
  ds_read_b128 a[36:39], v29 offset:34816
  v_accvgpr_read_b32 v48, a128
  s_waitcnt lgkmcnt(9)
  v_mfma_f32_16x16x32_bf16 v[80:83], a[208:211], a[16:19], v[80:83]
  ds_read_b64_tr_b16 a[228:229], v32 offset:12544
  v_accvgpr_read_b32 v49, a129
  v_mfma_f32_16x16x32_bf16 v[128:131], a[208:211], a[20:23], v[128:131]
  ds_read_b64_tr_b16 a[230:231], v32 offset:14080
  v_accvgpr_read_b32 v50, a130
  v_mfma_f32_16x16x32_bf16 v[176:179], a[208:211], a[24:27], v[176:179]
  v_accvgpr_read_b32 v51, a131
  v_accvgpr_read_b32 v52, a144
  v_mfma_f32_16x16x32_bf16 v[224:227], a[208:211], a[28:31], v[224:227]
  ds_read_b128 a[52:55], v30 offset:34816
  v_accvgpr_read_b32 v53, a145
  v_mfma_f32_16x16x32_bf16 v[84:87], a[212:215], a[16:19], v[84:87]
  ds_read_b64_tr_b16 a[232:233], v33 offset:12544
  v_accvgpr_read_b32 v54, a146
  v_mfma_f32_16x16x32_bf16 v[132:135], a[212:215], a[20:23], v[132:135]
  ds_read_b64_tr_b16 a[234:235], v33 offset:14080
  v_accvgpr_read_b32 v55, a147
  v_mfma_f32_16x16x32_bf16 v[180:183], a[212:215], a[24:27], v[180:183]
  v_mul_f32 v48, v48, v37
  v_mul_f32 v49, v49, v37
  v_mfma_f32_16x16x32_bf16 v[228:231], a[212:215], a[28:31], v[228:231]
  ds_read_b128 a[40:43], v29 offset:36864
  v_mul_f32 v50, v50, v37
  s_waitcnt lgkmcnt(10)
  v_mfma_f32_16x16x32_bf16 v[88:91], a[216:219], a[16:19], v[88:91]
  ds_read_b64_tr_b16 a[236:237], v34 offset:12544
  v_mul_f32 v51, v51, v37
  v_mfma_f32_16x16x32_bf16 v[136:139], a[216:219], a[20:23], v[136:139]
  ds_read_b64_tr_b16 a[238:239], v34 offset:14080
  v_mul_f32 v52, v52, v37
  v_mfma_f32_16x16x32_bf16 v[184:187], a[216:219], a[24:27], v[184:187]
  v_mul_f32 v53, v53, v37
  v_mul_f32 v54, v54, v37
  v_mfma_f32_16x16x32_bf16 v[232:235], a[216:219], a[28:31], v[232:235]
  ds_read_b128 a[56:59], v30 offset:36864
  v_mul_f32 v55, v55, v37
  s_waitcnt vmcnt(20)
  s_barrier
  v_mfma_f32_16x16x32_bf16 v[92:95], a[220:223], a[16:19], v[92:95]
  ds_read_b64_tr_b16 a[192:193], v31 offset:36864
  v_cvt_pk_bf16_f32 v56, v48, v49
  v_mfma_f32_16x16x32_bf16 v[140:143], a[220:223], a[20:23], v[140:143]
  ds_read_b64_tr_b16 a[194:195], v31 offset:38400
  v_cvt_pk_bf16_f32 v57, v50, v51
  v_mfma_f32_16x16x32_bf16 v[188:191], a[220:223], a[24:27], v[188:191]
  s_add_u32 m0, s55, 36864
  s_add_u32 s73, s71, 3538944
  buffer_load_dwordx4 v41, s[12:15], s73 offen offset:0 lds
  v_mfma_f32_16x16x32_bf16 v[236:239], a[220:223], a[28:31], v[236:239]
  ds_read_b128 a[44:47], v29 offset:38912
  v_cvt_pk_bf16_f32 v58, v52, v53
  s_waitcnt lgkmcnt(10)
  v_mfma_f32_16x16x32_bf16 v[96:99], a[224:227], a[16:19], v[96:99]
  ds_read_b64_tr_b16 a[196:197], v32 offset:36864
  v_cvt_pk_bf16_f32 v59, v54, v55
  s_add_u32 s53, s72, 4096
  v_mfma_f32_16x16x32_bf16 v[144:147], a[224:227], a[20:23], v[144:147]
  ds_read_b64_tr_b16 a[198:199], v32 offset:38400
  v_mfma_f32_16x16x32_bf16 v[192:195], a[224:227], a[24:27], v[192:195]
  buffer_load_dwordx4 v42, s[12:15], s73 offen offset:1024 lds
  v_mfma_f32_16x16x32_bf16 v[240:243], a[224:227], a[28:31], v[240:243]
  ds_read_b128 a[60:63], v30 offset:38912
  v_mfma_f32_16x16x32_bf16 v[100:103], a[228:231], a[16:19], v[100:103]
  ds_read_b64_tr_b16 a[200:201], v33 offset:36864
  v_mfma_f32_16x16x32_bf16 v[148:151], a[228:231], a[20:23], v[148:151]
  ds_read_b64_tr_b16 a[202:203], v33 offset:38400
  v_mfma_f32_16x16x32_bf16 v[196:199], a[228:231], a[24:27], v[196:199]
  buffer_load_dwordx4 v43, s[12:15], s73 offen offset:2048 lds
  v_mfma_f32_16x16x32_bf16 v[244:247], a[228:231], a[28:31], v[244:247]
  buffer_store_dwordx4 v[56:59], v28, s[80:83], s53 offen sc0 sc1
  s_waitcnt lgkmcnt(9)
  v_mfma_f32_16x16x32_bf16 v[104:107], a[232:235], a[16:19], v[104:107]
  ds_read_b64_tr_b16 a[204:205], v34 offset:36864
  v_accvgpr_read_b32 v48, a132
  v_mfma_f32_16x16x32_bf16 v[152:155], a[232:235], a[20:23], v[152:155]
  ds_read_b64_tr_b16 a[206:207], v34 offset:38400
  v_accvgpr_read_b32 v49, a133
  v_mfma_f32_16x16x32_bf16 v[200:203], a[232:235], a[24:27], v[200:203]
  v_accvgpr_read_b32 v50, a134
  v_accvgpr_read_b32 v51, a135
  v_mfma_f32_16x16x32_bf16 v[248:251], a[232:235], a[28:31], v[248:251]
  v_accvgpr_read_b32 v52, a148
  v_accvgpr_read_b32 v53, a149
  v_mfma_f32_16x16x32_bf16 v[108:111], a[236:239], a[16:19], v[108:111]
  ds_read_b64_tr_b16 a[208:209], v31 offset:36992
  v_accvgpr_read_b32 v54, a150
  v_mfma_f32_16x16x32_bf16 v[156:159], a[236:239], a[20:23], v[156:159]
  ds_read_b64_tr_b16 a[210:211], v31 offset:38528
  v_accvgpr_read_b32 v55, a151
  v_mfma_f32_16x16x32_bf16 v[204:207], a[236:239], a[24:27], v[204:207]
  v_mul_f32 v48, v48, v38
  v_mul_f32 v49, v49, v38
  v_mfma_f32_16x16x32_bf16 v[252:255], a[236:239], a[28:31], v[252:255]
  v_mul_f32 v50, v50, v38
  v_mul_f32 v51, v51, v38
  s_waitcnt lgkmcnt(6)
  v_mfma_f32_16x16x32_bf16 v[64:67], a[192:195], a[32:35], v[64:67]
  ds_read_b64_tr_b16 a[212:213], v32 offset:36992
  v_mul_f32 v52, v52, v38
  v_mfma_f32_16x16x32_bf16 v[112:115], a[192:195], a[36:39], v[112:115]
  ds_read_b64_tr_b16 a[214:215], v32 offset:38528
  v_mul_f32 v53, v53, v38
  v_mfma_f32_16x16x32_bf16 v[160:163], a[192:195], a[40:43], v[160:163]
  s_add_u32 m0, s75, 32768
  s_add_u32 s74, s70, 640
  buffer_load_dwordx4 v9, s[8:11], s74 offen offset:0 lds
  v_mfma_f32_16x16x32_bf16 v[208:211], a[192:195], a[44:47], v[208:211]
  v_mul_f32 v54, v54, v38
  v_mul_f32 v55, v55, v38
  v_mfma_f32_16x16x32_bf16 v[68:71], a[196:199], a[32:35], v[68:71]
  ds_read_b64_tr_b16 a[216:217], v33 offset:36992
  v_cvt_pk_bf16_f32 v60, v48, v49
  v_mfma_f32_16x16x32_bf16 v[116:119], a[196:199], a[36:39], v[116:119]
  ds_read_b64_tr_b16 a[218:219], v33 offset:38528
  v_cvt_pk_bf16_f32 v61, v50, v51
  v_mfma_f32_16x16x32_bf16 v[164:167], a[196:199], a[40:43], v[164:167]
  buffer_load_dwordx4 v10, s[8:11], s74 offen offset:1024 lds
  v_mfma_f32_16x16x32_bf16 v[212:215], a[196:199], a[44:47], v[212:215]
  v_cvt_pk_bf16_f32 v62, v52, v53
  v_cvt_pk_bf16_f32 v63, v54, v55
  s_add_u32 s53, s72, 200704
  s_waitcnt lgkmcnt(6)
  v_mfma_f32_16x16x32_bf16 v[72:75], a[200:203], a[32:35], v[72:75]
  ds_read_b64_tr_b16 a[220:221], v34 offset:36992
  v_mfma_f32_16x16x32_bf16 v[120:123], a[200:203], a[36:39], v[120:123]
  ds_read_b64_tr_b16 a[222:223], v34 offset:38528
  v_mfma_f32_16x16x32_bf16 v[168:171], a[200:203], a[40:43], v[168:171]
  buffer_load_dwordx4 v11, s[8:11], s74 offen offset:2048 lds
  v_mfma_f32_16x16x32_bf16 v[216:219], a[200:203], a[44:47], v[216:219]
  buffer_store_dwordx4 v[60:63], v28, s[80:83], s53 offen sc0 sc1
  v_mfma_f32_16x16x32_bf16 v[76:79], a[204:207], a[32:35], v[76:79]
  ds_read_b64_tr_b16 a[224:225], v31 offset:37120
  v_accvgpr_read_b32 v48, a136
  v_mfma_f32_16x16x32_bf16 v[124:127], a[204:207], a[36:39], v[124:127]
  ds_read_b64_tr_b16 a[226:227], v31 offset:38656
  v_accvgpr_read_b32 v49, a137
  v_mfma_f32_16x16x32_bf16 v[172:175], a[204:207], a[40:43], v[172:175]
  buffer_load_dwordx4 v12, s[8:11], s74 offen offset:3072 lds
  v_mfma_f32_16x16x32_bf16 v[220:223], a[204:207], a[44:47], v[220:223]
  v_accvgpr_read_b32 v50, a138
  v_accvgpr_read_b32 v51, a139
  s_waitcnt lgkmcnt(6)
  v_mfma_f32_16x16x32_bf16 v[80:83], a[208:211], a[32:35], v[80:83]
  ds_read_b64_tr_b16 a[228:229], v32 offset:37120
  v_accvgpr_read_b32 v52, a152
  v_mfma_f32_16x16x32_bf16 v[128:131], a[208:211], a[36:39], v[128:131]
  ds_read_b64_tr_b16 a[230:231], v32 offset:38656
  v_accvgpr_read_b32 v53, a153
  v_mfma_f32_16x16x32_bf16 v[176:179], a[208:211], a[40:43], v[176:179]
  s_add_u32 m0, s75, 36864
  s_add_u32 s74, s70, 640
  buffer_load_dwordx4 v13, s[8:11], s74 offen offset:0 lds
  v_mfma_f32_16x16x32_bf16 v[224:227], a[208:211], a[44:47], v[224:227]
  v_accvgpr_read_b32 v54, a154
  v_accvgpr_read_b32 v55, a155
  v_mfma_f32_16x16x32_bf16 v[84:87], a[212:215], a[32:35], v[84:87]
  ds_read_b64_tr_b16 a[232:233], v33 offset:37120
  v_mul_f32 v48, v48, v39
  v_mfma_f32_16x16x32_bf16 v[132:135], a[212:215], a[36:39], v[132:135]
  ds_read_b64_tr_b16 a[234:235], v33 offset:38656
  v_mul_f32 v49, v49, v39
  v_mfma_f32_16x16x32_bf16 v[180:183], a[212:215], a[40:43], v[180:183]
  buffer_load_dwordx4 v14, s[8:11], s74 offen offset:1024 lds
  v_mfma_f32_16x16x32_bf16 v[228:231], a[212:215], a[44:47], v[228:231]
  v_mul_f32 v50, v50, v39
  v_mul_f32 v51, v51, v39
  s_waitcnt lgkmcnt(6)
  v_mfma_f32_16x16x32_bf16 v[88:91], a[216:219], a[32:35], v[88:91]
  ds_read_b64_tr_b16 a[236:237], v34 offset:37120
  v_mul_f32 v52, v52, v39
  v_mfma_f32_16x16x32_bf16 v[136:139], a[216:219], a[36:39], v[136:139]
  ds_read_b64_tr_b16 a[238:239], v34 offset:38656
  v_mul_f32 v53, v53, v39
  v_mfma_f32_16x16x32_bf16 v[184:187], a[216:219], a[40:43], v[184:187]
  buffer_load_dwordx4 v15, s[8:11], s74 offen offset:2048 lds
  v_mfma_f32_16x16x32_bf16 v[232:235], a[216:219], a[44:47], v[232:235]
  v_mul_f32 v54, v54, v39
  v_mul_f32 v55, v55, v39
  s_waitcnt vmcnt(27)
  s_barrier
  v_mfma_f32_16x16x32_bf16 v[92:95], a[220:223], a[32:35], v[92:95]
  ds_read_b64_tr_b16 a[192:193], v31 offset:24576
  v_cvt_pk_bf16_f32 v56, v48, v49
  v_mfma_f32_16x16x32_bf16 v[140:143], a[220:223], a[36:39], v[140:143]
  ds_read_b64_tr_b16 a[194:195], v31 offset:26112
  v_cvt_pk_bf16_f32 v57, v50, v51
  v_mfma_f32_16x16x32_bf16 v[188:191], a[220:223], a[40:43], v[188:191]
  buffer_load_dwordx4 v16, s[8:11], s74 offen offset:3072 lds
  v_mfma_f32_16x16x32_bf16 v[236:239], a[220:223], a[44:47], v[236:239]
  v_cvt_pk_bf16_f32 v58, v52, v53
  v_cvt_pk_bf16_f32 v59, v54, v55
  s_add_u32 s53, s72, 397312
  s_waitcnt lgkmcnt(6)
  v_mfma_f32_16x16x32_bf16 v[96:99], a[224:227], a[32:35], v[96:99]
  ds_read_b64_tr_b16 a[196:197], v32 offset:24576
  v_mfma_f32_16x16x32_bf16 v[144:147], a[224:227], a[36:39], v[144:147]
  ds_read_b64_tr_b16 a[198:199], v32 offset:26112
  v_mfma_f32_16x16x32_bf16 v[192:195], a[224:227], a[40:43], v[192:195]
  s_add_u32 m0, s55, 49152
  s_add_u32 s73, s71, 3932160
  buffer_load_dwordx4 v41, s[12:15], s73 offen offset:0 lds
  v_mfma_f32_16x16x32_bf16 v[240:243], a[224:227], a[44:47], v[240:243]
  buffer_store_dwordx4 v[56:59], v28, s[80:83], s53 offen sc0 sc1
  v_mfma_f32_16x16x32_bf16 v[100:103], a[228:231], a[32:35], v[100:103]
  ds_read_b64_tr_b16 a[200:201], v33 offset:24576
  v_accvgpr_read_b32 v48, a140
  v_mfma_f32_16x16x32_bf16 v[148:151], a[228:231], a[36:39], v[148:151]
  ds_read_b64_tr_b16 a[202:203], v33 offset:26112
  v_accvgpr_read_b32 v49, a141
  v_mfma_f32_16x16x32_bf16 v[196:199], a[228:231], a[40:43], v[196:199]
  buffer_load_dwordx4 v42, s[12:15], s73 offen offset:1024 lds
  v_mfma_f32_16x16x32_bf16 v[244:247], a[228:231], a[44:47], v[244:247]
  v_accvgpr_read_b32 v50, a142
  v_accvgpr_read_b32 v51, a143
  s_waitcnt lgkmcnt(6)
  v_mfma_f32_16x16x32_bf16 v[104:107], a[232:235], a[32:35], v[104:107]
  ds_read_b64_tr_b16 a[204:205], v34 offset:24576
  v_accvgpr_read_b32 v52, a156
  v_mfma_f32_16x16x32_bf16 v[152:155], a[232:235], a[36:39], v[152:155]
  ds_read_b64_tr_b16 a[206:207], v34 offset:26112
  v_accvgpr_read_b32 v53, a157
  v_mfma_f32_16x16x32_bf16 v[200:203], a[232:235], a[40:43], v[200:203]
  buffer_load_dwordx4 v43, s[12:15], s73 offen offset:2048 lds
  v_mfma_f32_16x16x32_bf16 v[248:251], a[232:235], a[44:47], v[248:251]
  v_accvgpr_read_b32 v54, a158
  v_accvgpr_read_b32 v55, a159
  v_mfma_f32_16x16x32_bf16 v[108:111], a[236:239], a[32:35], v[108:111]
  ds_read_b64_tr_b16 a[208:209], v31 offset:24704
  v_mul_f32 v48, v48, v40
  v_mfma_f32_16x16x32_bf16 v[156:159], a[236:239], a[36:39], v[156:159]
  ds_read_b64_tr_b16 a[210:211], v31 offset:26240
  v_mul_f32 v49, v49, v40
  v_mfma_f32_16x16x32_bf16 v[204:207], a[236:239], a[40:43], v[204:207]
  v_mul_f32 v50, v50, v40
  v_mul_f32 v51, v51, v40
  v_mfma_f32_16x16x32_bf16 v[252:255], a[236:239], a[44:47], v[252:255]
  v_mul_f32 v52, v52, v40
  v_mul_f32 v53, v53, v40
  s_waitcnt lgkmcnt(6)
  v_mfma_f32_16x16x32_bf16 v[64:67], a[192:195], a[48:51], v[64:67]
  ds_read_b64_tr_b16 a[212:213], v32 offset:24704
  v_mul_f32 v54, v54, v40
  v_mfma_f32_16x16x32_bf16 v[112:115], a[192:195], a[52:55], v[112:115]
  ds_read_b64_tr_b16 a[214:215], v32 offset:26240
  v_mul_f32 v55, v55, v40
  v_mfma_f32_16x16x32_bf16 v[160:163], a[192:195], a[56:59], v[160:163]
  v_cvt_pk_bf16_f32 v60, v48, v49
  v_cvt_pk_bf16_f32 v61, v50, v51
  v_mfma_f32_16x16x32_bf16 v[208:211], a[192:195], a[60:63], v[208:211]
  v_cvt_pk_bf16_f32 v62, v52, v53
  v_cvt_pk_bf16_f32 v63, v54, v55
  s_add_u32 s53, s72, 593920
  v_mfma_f32_16x16x32_bf16 v[68:71], a[196:199], a[48:51], v[68:71]
  ds_read_b64_tr_b16 a[216:217], v33 offset:24704
  v_mfma_f32_16x16x32_bf16 v[116:119], a[196:199], a[52:55], v[116:119]
  ds_read_b64_tr_b16 a[218:219], v33 offset:26240
  v_mfma_f32_16x16x32_bf16 v[164:167], a[196:199], a[56:59], v[164:167]
  buffer_store_dwordx4 v[60:63], v28, s[80:83], s53 offen sc0 sc1
  v_mfma_f32_16x16x32_bf16 v[212:215], a[196:199], a[60:63], v[212:215]
  s_waitcnt vmcnt(23)
  ds_read_b128 a[0:3], v29 offset:0
  v_accvgpr_read_b32 v48, a160
  s_waitcnt lgkmcnt(7)
  v_mfma_f32_16x16x32_bf16 v[72:75], a[200:203], a[48:51], v[72:75]
  ds_read_b64_tr_b16 a[220:221], v34 offset:24704
  v_accvgpr_read_b32 v49, a161
  v_mfma_f32_16x16x32_bf16 v[120:123], a[200:203], a[52:55], v[120:123]
  ds_read_b64_tr_b16 a[222:223], v34 offset:26240
  v_accvgpr_read_b32 v50, a162
  v_mfma_f32_16x16x32_bf16 v[168:171], a[200:203], a[56:59], v[168:171]
  v_accvgpr_read_b32 v51, a163
  v_accvgpr_read_b32 v52, a176
  v_mfma_f32_16x16x32_bf16 v[216:219], a[200:203], a[60:63], v[216:219]
  ds_read_b128 a[16:19], v30 offset:0
  v_accvgpr_read_b32 v53, a177
  v_mfma_f32_16x16x32_bf16 v[76:79], a[204:207], a[48:51], v[76:79]
  ds_read_b64_tr_b16 a[224:225], v31 offset:24832
  v_accvgpr_read_b32 v54, a178
  v_mfma_f32_16x16x32_bf16 v[124:127], a[204:207], a[52:55], v[124:127]
  ds_read_b64_tr_b16 a[226:227], v31 offset:26368
  v_accvgpr_read_b32 v55, a179
  v_mfma_f32_16x16x32_bf16 v[172:175], a[204:207], a[56:59], v[172:175]
  v_mul_f32 v48, v48, v37
  v_mul_f32 v49, v49, v37
  v_mfma_f32_16x16x32_bf16 v[220:223], a[204:207], a[60:63], v[220:223]
  ds_read_b128 a[4:7], v29 offset:2048
  v_mul_f32 v50, v50, v37
  s_waitcnt lgkmcnt(9)
  v_mfma_f32_16x16x32_bf16 v[80:83], a[208:211], a[48:51], v[80:83]
  ds_read_b64_tr_b16 a[228:229], v32 offset:24832
  v_mul_f32 v51, v51, v37
  v_mfma_f32_16x16x32_bf16 v[128:131], a[208:211], a[52:55], v[128:131]
  ds_read_b64_tr_b16 a[230:231], v32 offset:26368
  v_mul_f32 v52, v52, v37
  v_mfma_f32_16x16x32_bf16 v[176:179], a[208:211], a[56:59], v[176:179]
  v_mul_f32 v53, v53, v37
  v_mul_f32 v54, v54, v37
  v_mfma_f32_16x16x32_bf16 v[224:227], a[208:211], a[60:63], v[224:227]
  ds_read_b128 a[20:23], v30 offset:2048
  v_mul_f32 v55, v55, v37
  v_mfma_f32_16x16x32_bf16 v[84:87], a[212:215], a[48:51], v[84:87]
  ds_read_b64_tr_b16 a[232:233], v33 offset:24832
  v_cvt_pk_bf16_f32 v56, v48, v49
  v_mfma_f32_16x16x32_bf16 v[132:135], a[212:215], a[52:55], v[132:135]
  ds_read_b64_tr_b16 a[234:235], v33 offset:26368
  v_cvt_pk_bf16_f32 v57, v50, v51
  v_mfma_f32_16x16x32_bf16 v[180:183], a[212:215], a[56:59], v[180:183]
  v_cvt_pk_bf16_f32 v58, v52, v53
  v_cvt_pk_bf16_f32 v59, v54, v55
  s_add_u32 s53, s72, 5120
  v_mfma_f32_16x16x32_bf16 v[228:231], a[212:215], a[60:63], v[228:231]
  ds_read_b128 a[8:11], v29 offset:4096
  s_waitcnt lgkmcnt(10)
  v_mfma_f32_16x16x32_bf16 v[88:91], a[216:219], a[48:51], v[88:91]
  ds_read_b64_tr_b16 a[236:237], v34 offset:24832
  v_mfma_f32_16x16x32_bf16 v[136:139], a[216:219], a[52:55], v[136:139]
  ds_read_b64_tr_b16 a[238:239], v34 offset:26368
  v_mfma_f32_16x16x32_bf16 v[184:187], a[216:219], a[56:59], v[184:187]
  buffer_store_dwordx4 v[56:59], v28, s[80:83], s53 offen sc0 sc1
  v_mfma_f32_16x16x32_bf16 v[232:235], a[216:219], a[60:63], v[232:235]
  ds_read_b128 a[24:27], v30 offset:4096
  v_accvgpr_read_b32 v48, a164
  s_waitcnt vmcnt(21)
  s_barrier
  v_mfma_f32_16x16x32_bf16 v[92:95], a[220:223], a[48:51], v[92:95]
  ds_read_b64_tr_b16 a[192:193], v31 offset:49152
  v_accvgpr_read_b32 v49, a165
  v_mfma_f32_16x16x32_bf16 v[140:143], a[220:223], a[52:55], v[140:143]
  ds_read_b64_tr_b16 a[194:195], v31 offset:50688
  v_accvgpr_read_b32 v50, a166
  v_mfma_f32_16x16x32_bf16 v[188:191], a[220:223], a[56:59], v[188:191]
  s_add_u32 m0, s55, 73728
  s_add_u32 s73, s71, 4325376
  buffer_load_dwordx4 v41, s[12:15], s73 offen offset:0 lds
  v_mfma_f32_16x16x32_bf16 v[236:239], a[220:223], a[60:63], v[236:239]
  ds_read_b128 a[12:15], v29 offset:6144
  v_accvgpr_read_b32 v51, a167
  s_waitcnt lgkmcnt(10)
  v_mfma_f32_16x16x32_bf16 v[96:99], a[224:227], a[48:51], v[96:99]
  ds_read_b64_tr_b16 a[196:197], v32 offset:49152
  v_accvgpr_read_b32 v52, a180
  v_mfma_f32_16x16x32_bf16 v[144:147], a[224:227], a[52:55], v[144:147]
  ds_read_b64_tr_b16 a[198:199], v32 offset:50688
  v_accvgpr_read_b32 v53, a181
  v_mfma_f32_16x16x32_bf16 v[192:195], a[224:227], a[56:59], v[192:195]
  buffer_load_dwordx4 v42, s[12:15], s73 offen offset:1024 lds
  v_mfma_f32_16x16x32_bf16 v[240:243], a[224:227], a[60:63], v[240:243]
  ds_read_b128 a[28:31], v30 offset:6144
  v_accvgpr_read_b32 v54, a182
  v_mfma_f32_16x16x32_bf16 v[100:103], a[228:231], a[48:51], v[100:103]
  ds_read_b64_tr_b16 a[200:201], v33 offset:49152
  v_accvgpr_read_b32 v55, a183
  v_mfma_f32_16x16x32_bf16 v[148:151], a[228:231], a[52:55], v[148:151]
  ds_read_b64_tr_b16 a[202:203], v33 offset:50688
  v_mul_f32 v48, v48, v38
  v_mfma_f32_16x16x32_bf16 v[196:199], a[228:231], a[56:59], v[196:199]
  buffer_load_dwordx4 v43, s[12:15], s73 offen offset:2048 lds
  v_mfma_f32_16x16x32_bf16 v[244:247], a[228:231], a[60:63], v[244:247]
  v_mul_f32 v49, v49, v38
  v_mul_f32 v50, v50, v38
  s_waitcnt lgkmcnt(9)
  v_mfma_f32_16x16x32_bf16 v[104:107], a[232:235], a[48:51], v[104:107]
  ds_read_b64_tr_b16 a[204:205], v34 offset:49152
  v_mul_f32 v51, v51, v38
  v_mfma_f32_16x16x32_bf16 v[152:155], a[232:235], a[52:55], v[152:155]
  ds_read_b64_tr_b16 a[206:207], v34 offset:50688
  v_mul_f32 v52, v52, v38
  v_mfma_f32_16x16x32_bf16 v[200:203], a[232:235], a[56:59], v[200:203]
  v_mul_f32 v53, v53, v38
  v_mul_f32 v54, v54, v38
  v_mfma_f32_16x16x32_bf16 v[248:251], a[232:235], a[60:63], v[248:251]
  v_mul_f32 v55, v55, v38
  v_cvt_pk_bf16_f32 v60, v48, v49
  v_mfma_f32_16x16x32_bf16 v[108:111], a[236:239], a[48:51], v[108:111]
  ds_read_b64_tr_b16 a[208:209], v31 offset:49280
  v_cvt_pk_bf16_f32 v61, v50, v51
  v_mfma_f32_16x16x32_bf16 v[156:159], a[236:239], a[52:55], v[156:159]
  ds_read_b64_tr_b16 a[210:211], v31 offset:50816
  v_cvt_pk_bf16_f32 v62, v52, v53
  v_mfma_f32_16x16x32_bf16 v[204:207], a[236:239], a[56:59], v[204:207]
  v_cvt_pk_bf16_f32 v63, v54, v55
  s_add_u32 s53, s72, 201728
  v_mfma_f32_16x16x32_bf16 v[252:255], a[236:239], a[60:63], v[252:255]
  buffer_store_dwordx4 v[60:63], v28, s[80:83], s53 offen sc0 sc1
  s_waitcnt lgkmcnt(6)
  v_mfma_f32_16x16x32_bf16 v[64:67], a[192:195], a[0:3], v[64:67]
  ds_read_b64_tr_b16 a[212:213], v32 offset:49280
  v_accvgpr_read_b32 v48, a168
  v_mfma_f32_16x16x32_bf16 v[112:115], a[192:195], a[4:7], v[112:115]
  ds_read_b64_tr_b16 a[214:215], v32 offset:50816
  v_accvgpr_read_b32 v49, a169
  v_mfma_f32_16x16x32_bf16 v[160:163], a[192:195], a[8:11], v[160:163]
  s_add_u32 m0, s75, 0
  s_add_u32 s74, s70, 768
  buffer_load_dwordx4 v9, s[8:11], s74 offen offset:0 lds
  v_mfma_f32_16x16x32_bf16 v[208:211], a[192:195], a[12:15], v[208:211]
  v_accvgpr_read_b32 v50, a170
  v_accvgpr_read_b32 v51, a171
  v_mfma_f32_16x16x32_bf16 v[68:71], a[196:199], a[0:3], v[68:71]
  ds_read_b64_tr_b16 a[216:217], v33 offset:49280
  v_accvgpr_read_b32 v52, a184
  v_mfma_f32_16x16x32_bf16 v[116:119], a[196:199], a[4:7], v[116:119]
  ds_read_b64_tr_b16 a[218:219], v33 offset:50816
  v_accvgpr_read_b32 v53, a185
  v_mfma_f32_16x16x32_bf16 v[164:167], a[196:199], a[8:11], v[164:167]
  buffer_load_dwordx4 v10, s[8:11], s74 offen offset:1024 lds
  v_mfma_f32_16x16x32_bf16 v[212:215], a[196:199], a[12:15], v[212:215]
  v_accvgpr_read_b32 v54, a186
  v_accvgpr_read_b32 v55, a187
  s_waitcnt lgkmcnt(6)
  v_mfma_f32_16x16x32_bf16 v[72:75], a[200:203], a[0:3], v[72:75]
  ds_read_b64_tr_b16 a[220:221], v34 offset:49280
  v_mul_f32 v48, v48, v39
  v_mfma_f32_16x16x32_bf16 v[120:123], a[200:203], a[4:7], v[120:123]
  ds_read_b64_tr_b16 a[222:223], v34 offset:50816
  v_mul_f32 v49, v49, v39
  v_mfma_f32_16x16x32_bf16 v[168:171], a[200:203], a[8:11], v[168:171]
  buffer_load_dwordx4 v11, s[8:11], s74 offen offset:2048 lds
  v_mfma_f32_16x16x32_bf16 v[216:219], a[200:203], a[12:15], v[216:219]
  v_mul_f32 v50, v50, v39
  v_mul_f32 v51, v51, v39
  v_mfma_f32_16x16x32_bf16 v[76:79], a[204:207], a[0:3], v[76:79]
  ds_read_b64_tr_b16 a[224:225], v31 offset:49408
  v_mul_f32 v52, v52, v39
  v_mfma_f32_16x16x32_bf16 v[124:127], a[204:207], a[4:7], v[124:127]
  ds_read_b64_tr_b16 a[226:227], v31 offset:50944
  v_mul_f32 v53, v53, v39
  v_mfma_f32_16x16x32_bf16 v[172:175], a[204:207], a[8:11], v[172:175]
  buffer_load_dwordx4 v12, s[8:11], s74 offen offset:3072 lds
  v_mfma_f32_16x16x32_bf16 v[220:223], a[204:207], a[12:15], v[220:223]
  v_mul_f32 v54, v54, v39
  v_mul_f32 v55, v55, v39
  s_waitcnt lgkmcnt(6)
  v_mfma_f32_16x16x32_bf16 v[80:83], a[208:211], a[0:3], v[80:83]
  ds_read_b64_tr_b16 a[228:229], v32 offset:49408
  v_cvt_pk_bf16_f32 v56, v48, v49
  v_mfma_f32_16x16x32_bf16 v[128:131], a[208:211], a[4:7], v[128:131]
  ds_read_b64_tr_b16 a[230:231], v32 offset:50944
  v_cvt_pk_bf16_f32 v57, v50, v51
  v_mfma_f32_16x16x32_bf16 v[176:179], a[208:211], a[8:11], v[176:179]
  s_add_u32 m0, s75, 4096
  s_add_u32 s74, s70, 768
  buffer_load_dwordx4 v13, s[8:11], s74 offen offset:0 lds
  v_mfma_f32_16x16x32_bf16 v[224:227], a[208:211], a[12:15], v[224:227]
  v_cvt_pk_bf16_f32 v58, v52, v53
  v_cvt_pk_bf16_f32 v59, v54, v55
  s_add_u32 s53, s72, 398336
  v_mfma_f32_16x16x32_bf16 v[84:87], a[212:215], a[0:3], v[84:87]
  ds_read_b64_tr_b16 a[232:233], v33 offset:49408
  v_mfma_f32_16x16x32_bf16 v[132:135], a[212:215], a[4:7], v[132:135]
  ds_read_b64_tr_b16 a[234:235], v33 offset:50944
  v_mfma_f32_16x16x32_bf16 v[180:183], a[212:215], a[8:11], v[180:183]
  buffer_load_dwordx4 v14, s[8:11], s74 offen offset:1024 lds
  v_mfma_f32_16x16x32_bf16 v[228:231], a[212:215], a[12:15], v[228:231]
  buffer_store_dwordx4 v[56:59], v28, s[80:83], s53 offen sc0 sc1
  s_waitcnt lgkmcnt(6)
  v_mfma_f32_16x16x32_bf16 v[88:91], a[216:219], a[0:3], v[88:91]
  ds_read_b64_tr_b16 a[236:237], v34 offset:49408
  v_accvgpr_read_b32 v48, a172
  v_mfma_f32_16x16x32_bf16 v[136:139], a[216:219], a[4:7], v[136:139]
  ds_read_b64_tr_b16 a[238:239], v34 offset:50944
  v_accvgpr_read_b32 v49, a173
  v_mfma_f32_16x16x32_bf16 v[184:187], a[216:219], a[8:11], v[184:187]
  buffer_load_dwordx4 v15, s[8:11], s74 offen offset:2048 lds
  v_mfma_f32_16x16x32_bf16 v[232:235], a[216:219], a[12:15], v[232:235]
  v_accvgpr_read_b32 v50, a174
  v_accvgpr_read_b32 v51, a175
  s_waitcnt vmcnt(28)
  s_barrier
  v_mfma_f32_16x16x32_bf16 v[92:95], a[220:223], a[0:3], v[92:95]
  ds_read_b64_tr_b16 a[192:193], v31 offset:0
  v_accvgpr_read_b32 v52, a188
  v_mfma_f32_16x16x32_bf16 v[140:143], a[220:223], a[4:7], v[140:143]
  ds_read_b64_tr_b16 a[194:195], v31 offset:1536
  v_accvgpr_read_b32 v53, a189
  v_mfma_f32_16x16x32_bf16 v[188:191], a[220:223], a[8:11], v[188:191]
  buffer_load_dwordx4 v16, s[8:11], s74 offen offset:3072 lds
  v_mfma_f32_16x16x32_bf16 v[236:239], a[220:223], a[12:15], v[236:239]
  v_accvgpr_read_b32 v54, a190
  v_accvgpr_read_b32 v55, a191
  s_waitcnt lgkmcnt(6)
  v_mfma_f32_16x16x32_bf16 v[96:99], a[224:227], a[0:3], v[96:99]
  ds_read_b64_tr_b16 a[196:197], v32 offset:0
  v_mul_f32 v48, v48, v40
  v_mfma_f32_16x16x32_bf16 v[144:147], a[224:227], a[4:7], v[144:147]
  ds_read_b64_tr_b16 a[198:199], v32 offset:1536
  v_mul_f32 v49, v49, v40
  v_mfma_f32_16x16x32_bf16 v[192:195], a[224:227], a[8:11], v[192:195]
  s_add_u32 m0, s55, 61440
  s_add_u32 s73, s71, 4718592
  buffer_load_dwordx4 v41, s[12:15], s73 offen offset:0 lds
  v_mfma_f32_16x16x32_bf16 v[240:243], a[224:227], a[12:15], v[240:243]
  v_mul_f32 v50, v50, v40
  v_mul_f32 v51, v51, v40
  v_mfma_f32_16x16x32_bf16 v[100:103], a[228:231], a[0:3], v[100:103]
  ds_read_b64_tr_b16 a[200:201], v33 offset:0
  v_mul_f32 v52, v52, v40
  v_mfma_f32_16x16x32_bf16 v[148:151], a[228:231], a[4:7], v[148:151]
  ds_read_b64_tr_b16 a[202:203], v33 offset:1536
  v_mul_f32 v53, v53, v40
  v_mfma_f32_16x16x32_bf16 v[196:199], a[228:231], a[8:11], v[196:199]
  buffer_load_dwordx4 v42, s[12:15], s73 offen offset:1024 lds
  v_mfma_f32_16x16x32_bf16 v[244:247], a[228:231], a[12:15], v[244:247]
  v_mul_f32 v54, v54, v40
  v_mul_f32 v55, v55, v40
  s_waitcnt lgkmcnt(6)
  v_mfma_f32_16x16x32_bf16 v[104:107], a[232:235], a[0:3], v[104:107]
  ds_read_b64_tr_b16 a[204:205], v34 offset:0
  v_cvt_pk_bf16_f32 v60, v48, v49
  v_mfma_f32_16x16x32_bf16 v[152:155], a[232:235], a[4:7], v[152:155]
  ds_read_b64_tr_b16 a[206:207], v34 offset:1536
  v_cvt_pk_bf16_f32 v61, v50, v51
  v_mfma_f32_16x16x32_bf16 v[200:203], a[232:235], a[8:11], v[200:203]
  buffer_load_dwordx4 v43, s[12:15], s73 offen offset:2048 lds
  v_mfma_f32_16x16x32_bf16 v[248:251], a[232:235], a[12:15], v[248:251]
  v_cvt_pk_bf16_f32 v62, v52, v53
  v_cvt_pk_bf16_f32 v63, v54, v55
  s_add_u32 s53, s72, 594944
  v_mfma_f32_16x16x32_bf16 v[108:111], a[236:239], a[0:3], v[108:111]
  ds_read_b64_tr_b16 a[208:209], v31 offset:128
  v_mfma_f32_16x16x32_bf16 v[156:159], a[236:239], a[4:7], v[156:159]
  ds_read_b64_tr_b16 a[210:211], v31 offset:1664
  v_mfma_f32_16x16x32_bf16 v[204:207], a[236:239], a[8:11], v[204:207]
  buffer_store_dwordx4 v[60:63], v28, s[80:83], s53 offen sc0 sc1
  v_mfma_f32_16x16x32_bf16 v[252:255], a[236:239], a[12:15], v[252:255]
  s_waitcnt lgkmcnt(6)
  v_mfma_f32_16x16x32_bf16 v[64:67], a[192:195], a[16:19], v[64:67]
  ds_read_b64_tr_b16 a[212:213], v32 offset:128
  v_mfma_f32_16x16x32_bf16 v[112:115], a[192:195], a[20:23], v[112:115]
  ds_read_b64_tr_b16 a[214:215], v32 offset:1664
  v_mfma_f32_16x16x32_bf16 v[160:163], a[192:195], a[24:27], v[160:163]
  v_mfma_f32_16x16x32_bf16 v[208:211], a[192:195], a[28:31], v[208:211]
  v_mfma_f32_16x16x32_bf16 v[68:71], a[196:199], a[16:19], v[68:71]
  ds_read_b64_tr_b16 a[216:217], v33 offset:128
  v_mfma_f32_16x16x32_bf16 v[116:119], a[196:199], a[20:23], v[116:119]
  ds_read_b64_tr_b16 a[218:219], v33 offset:1664
  v_mfma_f32_16x16x32_bf16 v[164:167], a[196:199], a[24:27], v[164:167]
  v_mfma_f32_16x16x32_bf16 v[212:215], a[196:199], a[28:31], v[212:215]
  s_waitcnt vmcnt(23)
  ds_read_b128 a[32:35], v29 offset:32768
  s_waitcnt lgkmcnt(7)
  v_mfma_f32_16x16x32_bf16 v[72:75], a[200:203], a[16:19], v[72:75]
  ds_read_b64_tr_b16 a[220:221], v34 offset:128
  v_mfma_f32_16x16x32_bf16 v[120:123], a[200:203], a[20:23], v[120:123]
  ds_read_b64_tr_b16 a[222:223], v34 offset:1664
  v_mfma_f32_16x16x32_bf16 v[168:171], a[200:203], a[24:27], v[168:171]
  v_mfma_f32_16x16x32_bf16 v[216:219], a[200:203], a[28:31], v[216:219]
  ds_read_b128 a[48:51], v30 offset:32768
  v_mfma_f32_16x16x32_bf16 v[76:79], a[204:207], a[16:19], v[76:79]
  ds_read_b64_tr_b16 a[224:225], v31 offset:256
  v_mfma_f32_16x16x32_bf16 v[124:127], a[204:207], a[20:23], v[124:127]
  ds_read_b64_tr_b16 a[226:227], v31 offset:1792
  v_mfma_f32_16x16x32_bf16 v[172:175], a[204:207], a[24:27], v[172:175]
  v_mfma_f32_16x16x32_bf16 v[220:223], a[204:207], a[28:31], v[220:223]
  ds_read_b128 a[36:39], v29 offset:34816
  s_waitcnt lgkmcnt(9)
  v_mfma_f32_16x16x32_bf16 v[80:83], a[208:211], a[16:19], v[80:83]
  ds_read_b64_tr_b16 a[228:229], v32 offset:256
  v_mfma_f32_16x16x32_bf16 v[128:131], a[208:211], a[20:23], v[128:131]
  ds_read_b64_tr_b16 a[230:231], v32 offset:1792
  v_mfma_f32_16x16x32_bf16 v[176:179], a[208:211], a[24:27], v[176:179]
  v_mfma_f32_16x16x32_bf16 v[224:227], a[208:211], a[28:31], v[224:227]
  ds_read_b128 a[52:55], v30 offset:34816
  v_mfma_f32_16x16x32_bf16 v[84:87], a[212:215], a[16:19], v[84:87]
  ds_read_b64_tr_b16 a[232:233], v33 offset:256
  v_mfma_f32_16x16x32_bf16 v[132:135], a[212:215], a[20:23], v[132:135]
  ds_read_b64_tr_b16 a[234:235], v33 offset:1792
  v_mfma_f32_16x16x32_bf16 v[180:183], a[212:215], a[24:27], v[180:183]
  v_mfma_f32_16x16x32_bf16 v[228:231], a[212:215], a[28:31], v[228:231]
  ds_read_b128 a[40:43], v29 offset:36864
  s_waitcnt lgkmcnt(10)
  v_mfma_f32_16x16x32_bf16 v[88:91], a[216:219], a[16:19], v[88:91]
  ds_read_b64_tr_b16 a[236:237], v34 offset:256
  v_mfma_f32_16x16x32_bf16 v[136:139], a[216:219], a[20:23], v[136:139]
  ds_read_b64_tr_b16 a[238:239], v34 offset:1792
  v_mfma_f32_16x16x32_bf16 v[184:187], a[216:219], a[24:27], v[184:187]
  v_mfma_f32_16x16x32_bf16 v[232:235], a[216:219], a[28:31], v[232:235]
  ds_read_b128 a[56:59], v30 offset:36864
  s_waitcnt vmcnt(19)
  s_barrier
  v_mfma_f32_16x16x32_bf16 v[92:95], a[220:223], a[16:19], v[92:95]
  ds_read_b64_tr_b16 a[192:193], v31 offset:12288
  v_mfma_f32_16x16x32_bf16 v[140:143], a[220:223], a[20:23], v[140:143]
  ds_read_b64_tr_b16 a[194:195], v31 offset:13824
  v_mfma_f32_16x16x32_bf16 v[188:191], a[220:223], a[24:27], v[188:191]
  s_add_u32 m0, s55, 86016
  s_add_u32 s73, s71, 5111808
  buffer_load_dwordx4 v41, s[12:15], s73 offen offset:0 lds
  v_mfma_f32_16x16x32_bf16 v[236:239], a[220:223], a[28:31], v[236:239]
  ds_read_b128 a[44:47], v29 offset:38912
  s_waitcnt lgkmcnt(10)
  v_mfma_f32_16x16x32_bf16 v[96:99], a[224:227], a[16:19], v[96:99]
  ds_read_b64_tr_b16 a[196:197], v32 offset:12288
  v_mfma_f32_16x16x32_bf16 v[144:147], a[224:227], a[20:23], v[144:147]
  ds_read_b64_tr_b16 a[198:199], v32 offset:13824
  v_mfma_f32_16x16x32_bf16 v[192:195], a[224:227], a[24:27], v[192:195]
  buffer_load_dwordx4 v42, s[12:15], s73 offen offset:1024 lds
  v_mfma_f32_16x16x32_bf16 v[240:243], a[224:227], a[28:31], v[240:243]
  ds_read_b128 a[60:63], v30 offset:38912
  v_mfma_f32_16x16x32_bf16 v[100:103], a[228:231], a[16:19], v[100:103]
  ds_read_b64_tr_b16 a[200:201], v33 offset:12288
  v_mfma_f32_16x16x32_bf16 v[148:151], a[228:231], a[20:23], v[148:151]
  ds_read_b64_tr_b16 a[202:203], v33 offset:13824
  v_mfma_f32_16x16x32_bf16 v[196:199], a[228:231], a[24:27], v[196:199]
  buffer_load_dwordx4 v43, s[12:15], s73 offen offset:2048 lds
  v_mfma_f32_16x16x32_bf16 v[244:247], a[228:231], a[28:31], v[244:247]
  s_waitcnt lgkmcnt(9)
  v_mfma_f32_16x16x32_bf16 v[104:107], a[232:235], a[16:19], v[104:107]
  ds_read_b64_tr_b16 a[204:205], v34 offset:12288
  v_mfma_f32_16x16x32_bf16 v[152:155], a[232:235], a[20:23], v[152:155]
  ds_read_b64_tr_b16 a[206:207], v34 offset:13824
  v_mfma_f32_16x16x32_bf16 v[200:203], a[232:235], a[24:27], v[200:203]
  v_mfma_f32_16x16x32_bf16 v[248:251], a[232:235], a[28:31], v[248:251]
  v_mfma_f32_16x16x32_bf16 v[108:111], a[236:239], a[16:19], v[108:111]
  ds_read_b64_tr_b16 a[208:209], v31 offset:12416
  v_mfma_f32_16x16x32_bf16 v[156:159], a[236:239], a[20:23], v[156:159]
  ds_read_b64_tr_b16 a[210:211], v31 offset:13952
  v_mfma_f32_16x16x32_bf16 v[204:207], a[236:239], a[24:27], v[204:207]
  v_mfma_f32_16x16x32_bf16 v[252:255], a[236:239], a[28:31], v[252:255]
  s_waitcnt lgkmcnt(6)
  v_mfma_f32_16x16x32_bf16 v[64:67], a[192:195], a[32:35], v[64:67]
  ds_read_b64_tr_b16 a[212:213], v32 offset:12416
  v_mfma_f32_16x16x32_bf16 v[112:115], a[192:195], a[36:39], v[112:115]
  ds_read_b64_tr_b16 a[214:215], v32 offset:13952
  v_mfma_f32_16x16x32_bf16 v[160:163], a[192:195], a[40:43], v[160:163]
  s_add_u32 m0, s75, 32768
  s_add_u32 s74, s70, 896
  buffer_load_dwordx4 v9, s[8:11], s74 offen offset:0 lds
  v_mfma_f32_16x16x32_bf16 v[208:211], a[192:195], a[44:47], v[208:211]
  v_mfma_f32_16x16x32_bf16 v[68:71], a[196:199], a[32:35], v[68:71]
  ds_read_b64_tr_b16 a[216:217], v33 offset:12416
  v_mfma_f32_16x16x32_bf16 v[116:119], a[196:199], a[36:39], v[116:119]
  ds_read_b64_tr_b16 a[218:219], v33 offset:13952
  v_mfma_f32_16x16x32_bf16 v[164:167], a[196:199], a[40:43], v[164:167]
  buffer_load_dwordx4 v10, s[8:11], s74 offen offset:1024 lds
  v_mfma_f32_16x16x32_bf16 v[212:215], a[196:199], a[44:47], v[212:215]
  s_waitcnt lgkmcnt(6)
  v_mfma_f32_16x16x32_bf16 v[72:75], a[200:203], a[32:35], v[72:75]
  ds_read_b64_tr_b16 a[220:221], v34 offset:12416
  v_mfma_f32_16x16x32_bf16 v[120:123], a[200:203], a[36:39], v[120:123]
  ds_read_b64_tr_b16 a[222:223], v34 offset:13952
  v_mfma_f32_16x16x32_bf16 v[168:171], a[200:203], a[40:43], v[168:171]
  buffer_load_dwordx4 v11, s[8:11], s74 offen offset:2048 lds
  v_mfma_f32_16x16x32_bf16 v[216:219], a[200:203], a[44:47], v[216:219]
  v_mfma_f32_16x16x32_bf16 v[76:79], a[204:207], a[32:35], v[76:79]
  ds_read_b64_tr_b16 a[224:225], v31 offset:12544
  v_mfma_f32_16x16x32_bf16 v[124:127], a[204:207], a[36:39], v[124:127]
  ds_read_b64_tr_b16 a[226:227], v31 offset:14080
  v_mfma_f32_16x16x32_bf16 v[172:175], a[204:207], a[40:43], v[172:175]
  buffer_load_dwordx4 v12, s[8:11], s74 offen offset:3072 lds
  v_mfma_f32_16x16x32_bf16 v[220:223], a[204:207], a[44:47], v[220:223]
  s_waitcnt lgkmcnt(6)
  v_mfma_f32_16x16x32_bf16 v[80:83], a[208:211], a[32:35], v[80:83]
  ds_read_b64_tr_b16 a[228:229], v32 offset:12544
  v_mfma_f32_16x16x32_bf16 v[128:131], a[208:211], a[36:39], v[128:131]
  ds_read_b64_tr_b16 a[230:231], v32 offset:14080
  v_mfma_f32_16x16x32_bf16 v[176:179], a[208:211], a[40:43], v[176:179]
  s_add_u32 m0, s75, 36864
  s_add_u32 s74, s70, 896
  buffer_load_dwordx4 v13, s[8:11], s74 offen offset:0 lds
  v_mfma_f32_16x16x32_bf16 v[224:227], a[208:211], a[44:47], v[224:227]
  v_mfma_f32_16x16x32_bf16 v[84:87], a[212:215], a[32:35], v[84:87]
  ds_read_b64_tr_b16 a[232:233], v33 offset:12544
  v_mfma_f32_16x16x32_bf16 v[132:135], a[212:215], a[36:39], v[132:135]
  ds_read_b64_tr_b16 a[234:235], v33 offset:14080
  v_mfma_f32_16x16x32_bf16 v[180:183], a[212:215], a[40:43], v[180:183]
  buffer_load_dwordx4 v14, s[8:11], s74 offen offset:1024 lds
  v_mfma_f32_16x16x32_bf16 v[228:231], a[212:215], a[44:47], v[228:231]
  s_waitcnt lgkmcnt(6)
  v_mfma_f32_16x16x32_bf16 v[88:91], a[216:219], a[32:35], v[88:91]
  ds_read_b64_tr_b16 a[236:237], v34 offset:12544
  v_mfma_f32_16x16x32_bf16 v[136:139], a[216:219], a[36:39], v[136:139]
  ds_read_b64_tr_b16 a[238:239], v34 offset:14080
  v_mfma_f32_16x16x32_bf16 v[184:187], a[216:219], a[40:43], v[184:187]
  buffer_load_dwordx4 v15, s[8:11], s74 offen offset:2048 lds
  v_mfma_f32_16x16x32_bf16 v[232:235], a[216:219], a[44:47], v[232:235]
  s_waitcnt vmcnt(24)
  s_barrier
  v_mfma_f32_16x16x32_bf16 v[92:95], a[220:223], a[32:35], v[92:95]
  ds_read_b64_tr_b16 a[192:193], v31 offset:36864
  v_mfma_f32_16x16x32_bf16 v[140:143], a[220:223], a[36:39], v[140:143]
  ds_read_b64_tr_b16 a[194:195], v31 offset:38400
  v_mfma_f32_16x16x32_bf16 v[188:191], a[220:223], a[40:43], v[188:191]
  buffer_load_dwordx4 v16, s[8:11], s74 offen offset:3072 lds
  v_mfma_f32_16x16x32_bf16 v[236:239], a[220:223], a[44:47], v[236:239]
  s_waitcnt lgkmcnt(6)
  v_mfma_f32_16x16x32_bf16 v[96:99], a[224:227], a[32:35], v[96:99]
  ds_read_b64_tr_b16 a[196:197], v32 offset:36864
  v_mfma_f32_16x16x32_bf16 v[144:147], a[224:227], a[36:39], v[144:147]
  ds_read_b64_tr_b16 a[198:199], v32 offset:38400
  v_mfma_f32_16x16x32_bf16 v[192:195], a[224:227], a[40:43], v[192:195]
  s_add_u32 m0, s55, 36864
  s_add_u32 s73, s71, 5505024
  buffer_load_dwordx4 v41, s[12:15], s73 offen offset:0 lds
  v_mfma_f32_16x16x32_bf16 v[240:243], a[224:227], a[44:47], v[240:243]
  v_mfma_f32_16x16x32_bf16 v[100:103], a[228:231], a[32:35], v[100:103]
  ds_read_b64_tr_b16 a[200:201], v33 offset:36864
  v_mfma_f32_16x16x32_bf16 v[148:151], a[228:231], a[36:39], v[148:151]
  ds_read_b64_tr_b16 a[202:203], v33 offset:38400
  v_mfma_f32_16x16x32_bf16 v[196:199], a[228:231], a[40:43], v[196:199]
  buffer_load_dwordx4 v42, s[12:15], s73 offen offset:1024 lds
  v_mfma_f32_16x16x32_bf16 v[244:247], a[228:231], a[44:47], v[244:247]
  s_waitcnt lgkmcnt(6)
  v_mfma_f32_16x16x32_bf16 v[104:107], a[232:235], a[32:35], v[104:107]
  ds_read_b64_tr_b16 a[204:205], v34 offset:36864
  v_mfma_f32_16x16x32_bf16 v[152:155], a[232:235], a[36:39], v[152:155]
  ds_read_b64_tr_b16 a[206:207], v34 offset:38400
  v_mfma_f32_16x16x32_bf16 v[200:203], a[232:235], a[40:43], v[200:203]
  buffer_load_dwordx4 v43, s[12:15], s73 offen offset:2048 lds
  v_mfma_f32_16x16x32_bf16 v[248:251], a[232:235], a[44:47], v[248:251]
  v_mfma_f32_16x16x32_bf16 v[108:111], a[236:239], a[32:35], v[108:111]
  ds_read_b64_tr_b16 a[208:209], v31 offset:36992
  v_mfma_f32_16x16x32_bf16 v[156:159], a[236:239], a[36:39], v[156:159]
  ds_read_b64_tr_b16 a[210:211], v31 offset:38528
  v_mfma_f32_16x16x32_bf16 v[204:207], a[236:239], a[40:43], v[204:207]
  v_mfma_f32_16x16x32_bf16 v[252:255], a[236:239], a[44:47], v[252:255]
  s_waitcnt lgkmcnt(6)
  v_mfma_f32_16x16x32_bf16 v[64:67], a[192:195], a[48:51], v[64:67]
  ds_read_b64_tr_b16 a[212:213], v32 offset:36992
  v_mfma_f32_16x16x32_bf16 v[112:115], a[192:195], a[52:55], v[112:115]
  ds_read_b64_tr_b16 a[214:215], v32 offset:38528
  v_mfma_f32_16x16x32_bf16 v[160:163], a[192:195], a[56:59], v[160:163]
  v_mfma_f32_16x16x32_bf16 v[208:211], a[192:195], a[60:63], v[208:211]
  v_mfma_f32_16x16x32_bf16 v[68:71], a[196:199], a[48:51], v[68:71]
  ds_read_b64_tr_b16 a[216:217], v33 offset:36992
  v_mfma_f32_16x16x32_bf16 v[116:119], a[196:199], a[52:55], v[116:119]
  ds_read_b64_tr_b16 a[218:219], v33 offset:38528
  v_mfma_f32_16x16x32_bf16 v[164:167], a[196:199], a[56:59], v[164:167]
  v_mfma_f32_16x16x32_bf16 v[212:215], a[196:199], a[60:63], v[212:215]
  s_waitcnt vmcnt(18)
  ds_read_b128 a[0:3], v29 offset:0
  s_waitcnt lgkmcnt(7)
  v_mfma_f32_16x16x32_bf16 v[72:75], a[200:203], a[48:51], v[72:75]
  ds_read_b64_tr_b16 a[220:221], v34 offset:36992
  v_mfma_f32_16x16x32_bf16 v[120:123], a[200:203], a[52:55], v[120:123]
  ds_read_b64_tr_b16 a[222:223], v34 offset:38528
  v_mfma_f32_16x16x32_bf16 v[168:171], a[200:203], a[56:59], v[168:171]
  v_mfma_f32_16x16x32_bf16 v[216:219], a[200:203], a[60:63], v[216:219]
  ds_read_b128 a[16:19], v30 offset:0
  v_mfma_f32_16x16x32_bf16 v[76:79], a[204:207], a[48:51], v[76:79]
  ds_read_b64_tr_b16 a[224:225], v31 offset:37120
  v_mfma_f32_16x16x32_bf16 v[124:127], a[204:207], a[52:55], v[124:127]
  ds_read_b64_tr_b16 a[226:227], v31 offset:38656
  v_mfma_f32_16x16x32_bf16 v[172:175], a[204:207], a[56:59], v[172:175]
  v_mfma_f32_16x16x32_bf16 v[220:223], a[204:207], a[60:63], v[220:223]
  ds_read_b128 a[4:7], v29 offset:2048
  s_waitcnt lgkmcnt(9)
  v_mfma_f32_16x16x32_bf16 v[80:83], a[208:211], a[48:51], v[80:83]
  ds_read_b64_tr_b16 a[228:229], v32 offset:37120
  v_mfma_f32_16x16x32_bf16 v[128:131], a[208:211], a[52:55], v[128:131]
  ds_read_b64_tr_b16 a[230:231], v32 offset:38656
  v_mfma_f32_16x16x32_bf16 v[176:179], a[208:211], a[56:59], v[176:179]
  v_mfma_f32_16x16x32_bf16 v[224:227], a[208:211], a[60:63], v[224:227]
  ds_read_b128 a[20:23], v30 offset:2048
  v_mfma_f32_16x16x32_bf16 v[84:87], a[212:215], a[48:51], v[84:87]
  ds_read_b64_tr_b16 a[232:233], v33 offset:37120
  v_mfma_f32_16x16x32_bf16 v[132:135], a[212:215], a[52:55], v[132:135]
  ds_read_b64_tr_b16 a[234:235], v33 offset:38656
  v_mfma_f32_16x16x32_bf16 v[180:183], a[212:215], a[56:59], v[180:183]
  v_mfma_f32_16x16x32_bf16 v[228:231], a[212:215], a[60:63], v[228:231]
  ds_read_b128 a[8:11], v29 offset:4096
  s_waitcnt lgkmcnt(10)
  v_mfma_f32_16x16x32_bf16 v[88:91], a[216:219], a[48:51], v[88:91]
  ds_read_b64_tr_b16 a[236:237], v34 offset:37120
  v_mfma_f32_16x16x32_bf16 v[136:139], a[216:219], a[52:55], v[136:139]
  ds_read_b64_tr_b16 a[238:239], v34 offset:38656
  v_mfma_f32_16x16x32_bf16 v[184:187], a[216:219], a[56:59], v[184:187]
  v_mfma_f32_16x16x32_bf16 v[232:235], a[216:219], a[60:63], v[232:235]
  ds_read_b128 a[24:27], v30 offset:4096
  s_waitcnt vmcnt(15)
  s_barrier
  v_mfma_f32_16x16x32_bf16 v[92:95], a[220:223], a[48:51], v[92:95]
  ds_read_b64_tr_b16 a[192:193], v31 offset:24576
  v_mfma_f32_16x16x32_bf16 v[140:143], a[220:223], a[52:55], v[140:143]
  ds_read_b64_tr_b16 a[194:195], v31 offset:26112
  v_mfma_f32_16x16x32_bf16 v[188:191], a[220:223], a[56:59], v[188:191]
  s_add_u32 m0, s55, 49152
  s_add_u32 s73, s71, 5898240
  buffer_load_dwordx4 v41, s[12:15], s73 offen offset:0 lds
  v_mfma_f32_16x16x32_bf16 v[236:239], a[220:223], a[60:63], v[236:239]
  ds_read_b128 a[12:15], v29 offset:6144
  s_waitcnt lgkmcnt(10)
  v_mfma_f32_16x16x32_bf16 v[96:99], a[224:227], a[48:51], v[96:99]
  ds_read_b64_tr_b16 a[196:197], v32 offset:24576
  v_mfma_f32_16x16x32_bf16 v[144:147], a[224:227], a[52:55], v[144:147]
  ds_read_b64_tr_b16 a[198:199], v32 offset:26112
  v_mfma_f32_16x16x32_bf16 v[192:195], a[224:227], a[56:59], v[192:195]
  buffer_load_dwordx4 v42, s[12:15], s73 offen offset:1024 lds
  v_mfma_f32_16x16x32_bf16 v[240:243], a[224:227], a[60:63], v[240:243]
  ds_read_b128 a[28:31], v30 offset:6144
  v_mfma_f32_16x16x32_bf16 v[100:103], a[228:231], a[48:51], v[100:103]
  ds_read_b64_tr_b16 a[200:201], v33 offset:24576
  v_mfma_f32_16x16x32_bf16 v[148:151], a[228:231], a[52:55], v[148:151]
  ds_read_b64_tr_b16 a[202:203], v33 offset:26112
  v_mfma_f32_16x16x32_bf16 v[196:199], a[228:231], a[56:59], v[196:199]
  buffer_load_dwordx4 v43, s[12:15], s73 offen offset:2048 lds
  v_mfma_f32_16x16x32_bf16 v[244:247], a[228:231], a[60:63], v[244:247]
  s_waitcnt lgkmcnt(9)
  v_mfma_f32_16x16x32_bf16 v[104:107], a[232:235], a[48:51], v[104:107]
  ds_read_b64_tr_b16 a[204:205], v34 offset:24576
  v_mfma_f32_16x16x32_bf16 v[152:155], a[232:235], a[52:55], v[152:155]
  ds_read_b64_tr_b16 a[206:207], v34 offset:26112
  v_mfma_f32_16x16x32_bf16 v[200:203], a[232:235], a[56:59], v[200:203]
  v_mfma_f32_16x16x32_bf16 v[248:251], a[232:235], a[60:63], v[248:251]
  v_mfma_f32_16x16x32_bf16 v[108:111], a[236:239], a[48:51], v[108:111]
  ds_read_b64_tr_b16 a[208:209], v31 offset:24704
  v_mfma_f32_16x16x32_bf16 v[156:159], a[236:239], a[52:55], v[156:159]
  ds_read_b64_tr_b16 a[210:211], v31 offset:26240
  v_mfma_f32_16x16x32_bf16 v[204:207], a[236:239], a[56:59], v[204:207]
  v_mfma_f32_16x16x32_bf16 v[252:255], a[236:239], a[60:63], v[252:255]
  s_waitcnt lgkmcnt(6)
  v_mfma_f32_16x16x32_bf16 v[64:67], a[192:195], a[0:3], v[64:67]
  ds_read_b64_tr_b16 a[212:213], v32 offset:24704
  v_mfma_f32_16x16x32_bf16 v[112:115], a[192:195], a[4:7], v[112:115]
  ds_read_b64_tr_b16 a[214:215], v32 offset:26240
  v_mfma_f32_16x16x32_bf16 v[160:163], a[192:195], a[8:11], v[160:163]
  s_add_u32 m0, s75, 0
  s_add_u32 s74, s70, 1024
  buffer_load_dwordx4 v9, s[8:11], s74 offen offset:0 lds
  v_mfma_f32_16x16x32_bf16 v[208:211], a[192:195], a[12:15], v[208:211]
  v_mfma_f32_16x16x32_bf16 v[68:71], a[196:199], a[0:3], v[68:71]
  ds_read_b64_tr_b16 a[216:217], v33 offset:24704
  v_mfma_f32_16x16x32_bf16 v[116:119], a[196:199], a[4:7], v[116:119]
  ds_read_b64_tr_b16 a[218:219], v33 offset:26240
  v_mfma_f32_16x16x32_bf16 v[164:167], a[196:199], a[8:11], v[164:167]
  buffer_load_dwordx4 v10, s[8:11], s74 offen offset:1024 lds
  v_mfma_f32_16x16x32_bf16 v[212:215], a[196:199], a[12:15], v[212:215]
  s_waitcnt lgkmcnt(6)
  v_mfma_f32_16x16x32_bf16 v[72:75], a[200:203], a[0:3], v[72:75]
  ds_read_b64_tr_b16 a[220:221], v34 offset:24704
  v_mfma_f32_16x16x32_bf16 v[120:123], a[200:203], a[4:7], v[120:123]
  ds_read_b64_tr_b16 a[222:223], v34 offset:26240
  v_mfma_f32_16x16x32_bf16 v[168:171], a[200:203], a[8:11], v[168:171]
  buffer_load_dwordx4 v11, s[8:11], s74 offen offset:2048 lds
  v_mfma_f32_16x16x32_bf16 v[216:219], a[200:203], a[12:15], v[216:219]
  v_mfma_f32_16x16x32_bf16 v[76:79], a[204:207], a[0:3], v[76:79]
  ds_read_b64_tr_b16 a[224:225], v31 offset:24832
  v_mfma_f32_16x16x32_bf16 v[124:127], a[204:207], a[4:7], v[124:127]
  ds_read_b64_tr_b16 a[226:227], v31 offset:26368
  v_mfma_f32_16x16x32_bf16 v[172:175], a[204:207], a[8:11], v[172:175]
  buffer_load_dwordx4 v12, s[8:11], s74 offen offset:3072 lds
  v_mfma_f32_16x16x32_bf16 v[220:223], a[204:207], a[12:15], v[220:223]
  s_waitcnt lgkmcnt(6)
  v_mfma_f32_16x16x32_bf16 v[80:83], a[208:211], a[0:3], v[80:83]
  ds_read_b64_tr_b16 a[228:229], v32 offset:24832
  v_mfma_f32_16x16x32_bf16 v[128:131], a[208:211], a[4:7], v[128:131]
  ds_read_b64_tr_b16 a[230:231], v32 offset:26368
  v_mfma_f32_16x16x32_bf16 v[176:179], a[208:211], a[8:11], v[176:179]
  s_add_u32 m0, s75, 4096
  s_add_u32 s74, s70, 1024
  buffer_load_dwordx4 v13, s[8:11], s74 offen offset:0 lds
  v_mfma_f32_16x16x32_bf16 v[224:227], a[208:211], a[12:15], v[224:227]
  v_mfma_f32_16x16x32_bf16 v[84:87], a[212:215], a[0:3], v[84:87]
  ds_read_b64_tr_b16 a[232:233], v33 offset:24832
  v_mfma_f32_16x16x32_bf16 v[132:135], a[212:215], a[4:7], v[132:135]
  ds_read_b64_tr_b16 a[234:235], v33 offset:26368
  v_mfma_f32_16x16x32_bf16 v[180:183], a[212:215], a[8:11], v[180:183]
  buffer_load_dwordx4 v14, s[8:11], s74 offen offset:1024 lds
  v_mfma_f32_16x16x32_bf16 v[228:231], a[212:215], a[12:15], v[228:231]
  s_waitcnt lgkmcnt(6)
  v_mfma_f32_16x16x32_bf16 v[88:91], a[216:219], a[0:3], v[88:91]
  ds_read_b64_tr_b16 a[236:237], v34 offset:24832
  v_mfma_f32_16x16x32_bf16 v[136:139], a[216:219], a[4:7], v[136:139]
  ds_read_b64_tr_b16 a[238:239], v34 offset:26368
  v_mfma_f32_16x16x32_bf16 v[184:187], a[216:219], a[8:11], v[184:187]
  buffer_load_dwordx4 v15, s[8:11], s74 offen offset:2048 lds
  v_mfma_f32_16x16x32_bf16 v[232:235], a[216:219], a[12:15], v[232:235]
  s_waitcnt vmcnt(21)
  s_barrier
  v_mfma_f32_16x16x32_bf16 v[92:95], a[220:223], a[0:3], v[92:95]
  ds_read_b64_tr_b16 a[192:193], v31 offset:49152
  v_mfma_f32_16x16x32_bf16 v[140:143], a[220:223], a[4:7], v[140:143]
  ds_read_b64_tr_b16 a[194:195], v31 offset:50688
  v_mfma_f32_16x16x32_bf16 v[188:191], a[220:223], a[8:11], v[188:191]
  buffer_load_dwordx4 v16, s[8:11], s74 offen offset:3072 lds
  v_mfma_f32_16x16x32_bf16 v[236:239], a[220:223], a[12:15], v[236:239]
  s_waitcnt lgkmcnt(6)
  v_mfma_f32_16x16x32_bf16 v[96:99], a[224:227], a[0:3], v[96:99]
  ds_read_b64_tr_b16 a[196:197], v32 offset:49152
  v_mfma_f32_16x16x32_bf16 v[144:147], a[224:227], a[4:7], v[144:147]
  ds_read_b64_tr_b16 a[198:199], v32 offset:50688
  v_mfma_f32_16x16x32_bf16 v[192:195], a[224:227], a[8:11], v[192:195]
  s_add_u32 m0, s55, 73728
  s_add_u32 s73, s71, 6291456
  buffer_load_dwordx4 v41, s[12:15], s73 offen offset:0 lds
  v_mfma_f32_16x16x32_bf16 v[240:243], a[224:227], a[12:15], v[240:243]
  v_mfma_f32_16x16x32_bf16 v[100:103], a[228:231], a[0:3], v[100:103]
  ds_read_b64_tr_b16 a[200:201], v33 offset:49152
  v_mfma_f32_16x16x32_bf16 v[148:151], a[228:231], a[4:7], v[148:151]
  ds_read_b64_tr_b16 a[202:203], v33 offset:50688
  v_mfma_f32_16x16x32_bf16 v[196:199], a[228:231], a[8:11], v[196:199]
  buffer_load_dwordx4 v42, s[12:15], s73 offen offset:1024 lds
  v_mfma_f32_16x16x32_bf16 v[244:247], a[228:231], a[12:15], v[244:247]
  s_waitcnt lgkmcnt(6)
  v_mfma_f32_16x16x32_bf16 v[104:107], a[232:235], a[0:3], v[104:107]
  ds_read_b64_tr_b16 a[204:205], v34 offset:49152
  v_mfma_f32_16x16x32_bf16 v[152:155], a[232:235], a[4:7], v[152:155]
  ds_read_b64_tr_b16 a[206:207], v34 offset:50688
  v_mfma_f32_16x16x32_bf16 v[200:203], a[232:235], a[8:11], v[200:203]
  buffer_load_dwordx4 v43, s[12:15], s73 offen offset:2048 lds
  v_mfma_f32_16x16x32_bf16 v[248:251], a[232:235], a[12:15], v[248:251]
  v_mfma_f32_16x16x32_bf16 v[108:111], a[236:239], a[0:3], v[108:111]
  ds_read_b64_tr_b16 a[208:209], v31 offset:49280
  v_mfma_f32_16x16x32_bf16 v[156:159], a[236:239], a[4:7], v[156:159]
  ds_read_b64_tr_b16 a[210:211], v31 offset:50816
  v_mfma_f32_16x16x32_bf16 v[204:207], a[236:239], a[8:11], v[204:207]
  v_mfma_f32_16x16x32_bf16 v[252:255], a[236:239], a[12:15], v[252:255]
  s_waitcnt lgkmcnt(6)
  v_mfma_f32_16x16x32_bf16 v[64:67], a[192:195], a[16:19], v[64:67]
  ds_read_b64_tr_b16 a[212:213], v32 offset:49280
  v_mfma_f32_16x16x32_bf16 v[112:115], a[192:195], a[20:23], v[112:115]
  ds_read_b64_tr_b16 a[214:215], v32 offset:50816
  v_mfma_f32_16x16x32_bf16 v[160:163], a[192:195], a[24:27], v[160:163]
  v_mfma_f32_16x16x32_bf16 v[208:211], a[192:195], a[28:31], v[208:211]
  v_mfma_f32_16x16x32_bf16 v[68:71], a[196:199], a[16:19], v[68:71]
  ds_read_b64_tr_b16 a[216:217], v33 offset:49280
  v_mfma_f32_16x16x32_bf16 v[116:119], a[196:199], a[20:23], v[116:119]
  ds_read_b64_tr_b16 a[218:219], v33 offset:50816
  v_mfma_f32_16x16x32_bf16 v[164:167], a[196:199], a[24:27], v[164:167]
  v_mfma_f32_16x16x32_bf16 v[212:215], a[196:199], a[28:31], v[212:215]
  s_waitcnt vmcnt(17)
  ds_read_b128 a[32:35], v29 offset:32768
  s_waitcnt lgkmcnt(7)
  v_mfma_f32_16x16x32_bf16 v[72:75], a[200:203], a[16:19], v[72:75]
  ds_read_b64_tr_b16 a[220:221], v34 offset:49280
  v_mfma_f32_16x16x32_bf16 v[120:123], a[200:203], a[20:23], v[120:123]
  ds_read_b64_tr_b16 a[222:223], v34 offset:50816
  v_mfma_f32_16x16x32_bf16 v[168:171], a[200:203], a[24:27], v[168:171]
  v_mfma_f32_16x16x32_bf16 v[216:219], a[200:203], a[28:31], v[216:219]
  ds_read_b128 a[48:51], v30 offset:32768
  v_mfma_f32_16x16x32_bf16 v[76:79], a[204:207], a[16:19], v[76:79]
  ds_read_b64_tr_b16 a[224:225], v31 offset:49408
  v_mfma_f32_16x16x32_bf16 v[124:127], a[204:207], a[20:23], v[124:127]
  ds_read_b64_tr_b16 a[226:227], v31 offset:50944
  v_mfma_f32_16x16x32_bf16 v[172:175], a[204:207], a[24:27], v[172:175]
  v_mfma_f32_16x16x32_bf16 v[220:223], a[204:207], a[28:31], v[220:223]
  ds_read_b128 a[36:39], v29 offset:34816
  s_waitcnt lgkmcnt(9)
  v_mfma_f32_16x16x32_bf16 v[80:83], a[208:211], a[16:19], v[80:83]
  ds_read_b64_tr_b16 a[228:229], v32 offset:49408
  v_mfma_f32_16x16x32_bf16 v[128:131], a[208:211], a[20:23], v[128:131]
  ds_read_b64_tr_b16 a[230:231], v32 offset:50944
  v_mfma_f32_16x16x32_bf16 v[176:179], a[208:211], a[24:27], v[176:179]
  v_mfma_f32_16x16x32_bf16 v[224:227], a[208:211], a[28:31], v[224:227]
  ds_read_b128 a[52:55], v30 offset:34816
  v_mfma_f32_16x16x32_bf16 v[84:87], a[212:215], a[16:19], v[84:87]
  ds_read_b64_tr_b16 a[232:233], v33 offset:49408
  v_mfma_f32_16x16x32_bf16 v[132:135], a[212:215], a[20:23], v[132:135]
  ds_read_b64_tr_b16 a[234:235], v33 offset:50944
  v_mfma_f32_16x16x32_bf16 v[180:183], a[212:215], a[24:27], v[180:183]
  v_mfma_f32_16x16x32_bf16 v[228:231], a[212:215], a[28:31], v[228:231]
  ds_read_b128 a[40:43], v29 offset:36864
  s_waitcnt lgkmcnt(10)
  v_mfma_f32_16x16x32_bf16 v[88:91], a[216:219], a[16:19], v[88:91]
  ds_read_b64_tr_b16 a[236:237], v34 offset:49408
  v_mfma_f32_16x16x32_bf16 v[136:139], a[216:219], a[20:23], v[136:139]
  ds_read_b64_tr_b16 a[238:239], v34 offset:50944
  v_mfma_f32_16x16x32_bf16 v[184:187], a[216:219], a[24:27], v[184:187]
  v_mfma_f32_16x16x32_bf16 v[232:235], a[216:219], a[28:31], v[232:235]
  ds_read_b128 a[56:59], v30 offset:36864
  s_waitcnt vmcnt(14)
  s_barrier
  v_mfma_f32_16x16x32_bf16 v[92:95], a[220:223], a[16:19], v[92:95]
  ds_read_b64_tr_b16 a[192:193], v31 offset:0
  v_mfma_f32_16x16x32_bf16 v[140:143], a[220:223], a[20:23], v[140:143]
  ds_read_b64_tr_b16 a[194:195], v31 offset:1536
  v_mfma_f32_16x16x32_bf16 v[188:191], a[220:223], a[24:27], v[188:191]
  s_add_u32 m0, s55, 61440
  s_add_u32 s73, s71, 6684672
  buffer_load_dwordx4 v41, s[12:15], s73 offen offset:0 lds
  v_mfma_f32_16x16x32_bf16 v[236:239], a[220:223], a[28:31], v[236:239]
  ds_read_b128 a[44:47], v29 offset:38912
  s_waitcnt lgkmcnt(10)
  v_mfma_f32_16x16x32_bf16 v[96:99], a[224:227], a[16:19], v[96:99]
  ds_read_b64_tr_b16 a[196:197], v32 offset:0
  v_mfma_f32_16x16x32_bf16 v[144:147], a[224:227], a[20:23], v[144:147]
  ds_read_b64_tr_b16 a[198:199], v32 offset:1536
  v_mfma_f32_16x16x32_bf16 v[192:195], a[224:227], a[24:27], v[192:195]
  buffer_load_dwordx4 v42, s[12:15], s73 offen offset:1024 lds
  v_mfma_f32_16x16x32_bf16 v[240:243], a[224:227], a[28:31], v[240:243]
  ds_read_b128 a[60:63], v30 offset:38912
  v_mfma_f32_16x16x32_bf16 v[100:103], a[228:231], a[16:19], v[100:103]
  ds_read_b64_tr_b16 a[200:201], v33 offset:0
  v_mfma_f32_16x16x32_bf16 v[148:151], a[228:231], a[20:23], v[148:151]
  ds_read_b64_tr_b16 a[202:203], v33 offset:1536
  v_mfma_f32_16x16x32_bf16 v[196:199], a[228:231], a[24:27], v[196:199]
  buffer_load_dwordx4 v43, s[12:15], s73 offen offset:2048 lds
  v_mfma_f32_16x16x32_bf16 v[244:247], a[228:231], a[28:31], v[244:247]
  s_waitcnt lgkmcnt(9)
  v_mfma_f32_16x16x32_bf16 v[104:107], a[232:235], a[16:19], v[104:107]
  ds_read_b64_tr_b16 a[204:205], v34 offset:0
  v_mfma_f32_16x16x32_bf16 v[152:155], a[232:235], a[20:23], v[152:155]
  ds_read_b64_tr_b16 a[206:207], v34 offset:1536
  v_mfma_f32_16x16x32_bf16 v[200:203], a[232:235], a[24:27], v[200:203]
  v_mfma_f32_16x16x32_bf16 v[248:251], a[232:235], a[28:31], v[248:251]
  v_mfma_f32_16x16x32_bf16 v[108:111], a[236:239], a[16:19], v[108:111]
  ds_read_b64_tr_b16 a[208:209], v31 offset:128
  v_mfma_f32_16x16x32_bf16 v[156:159], a[236:239], a[20:23], v[156:159]
  ds_read_b64_tr_b16 a[210:211], v31 offset:1664
  v_mfma_f32_16x16x32_bf16 v[204:207], a[236:239], a[24:27], v[204:207]
  v_mfma_f32_16x16x32_bf16 v[252:255], a[236:239], a[28:31], v[252:255]
  s_waitcnt lgkmcnt(6)
  v_mfma_f32_16x16x32_bf16 v[64:67], a[192:195], a[32:35], v[64:67]
  ds_read_b64_tr_b16 a[212:213], v32 offset:128
  v_mfma_f32_16x16x32_bf16 v[112:115], a[192:195], a[36:39], v[112:115]
  ds_read_b64_tr_b16 a[214:215], v32 offset:1664
  v_mfma_f32_16x16x32_bf16 v[160:163], a[192:195], a[40:43], v[160:163]
  s_add_u32 m0, s75, 32768
  s_add_u32 s74, s70, 1152
  buffer_load_dwordx4 v9, s[8:11], s74 offen offset:0 lds
  v_mfma_f32_16x16x32_bf16 v[208:211], a[192:195], a[44:47], v[208:211]
  v_mfma_f32_16x16x32_bf16 v[68:71], a[196:199], a[32:35], v[68:71]
  ds_read_b64_tr_b16 a[216:217], v33 offset:128
  v_mfma_f32_16x16x32_bf16 v[116:119], a[196:199], a[36:39], v[116:119]
  ds_read_b64_tr_b16 a[218:219], v33 offset:1664
  v_mfma_f32_16x16x32_bf16 v[164:167], a[196:199], a[40:43], v[164:167]
  buffer_load_dwordx4 v10, s[8:11], s74 offen offset:1024 lds
  v_mfma_f32_16x16x32_bf16 v[212:215], a[196:199], a[44:47], v[212:215]
  s_waitcnt lgkmcnt(6)
  v_mfma_f32_16x16x32_bf16 v[72:75], a[200:203], a[32:35], v[72:75]
  ds_read_b64_tr_b16 a[220:221], v34 offset:128
  v_mfma_f32_16x16x32_bf16 v[120:123], a[200:203], a[36:39], v[120:123]
  ds_read_b64_tr_b16 a[222:223], v34 offset:1664
  v_mfma_f32_16x16x32_bf16 v[168:171], a[200:203], a[40:43], v[168:171]
  buffer_load_dwordx4 v11, s[8:11], s74 offen offset:2048 lds
  v_mfma_f32_16x16x32_bf16 v[216:219], a[200:203], a[44:47], v[216:219]
  v_mfma_f32_16x16x32_bf16 v[76:79], a[204:207], a[32:35], v[76:79]
  ds_read_b64_tr_b16 a[224:225], v31 offset:256
  v_mfma_f32_16x16x32_bf16 v[124:127], a[204:207], a[36:39], v[124:127]
  ds_read_b64_tr_b16 a[226:227], v31 offset:1792
  v_mfma_f32_16x16x32_bf16 v[172:175], a[204:207], a[40:43], v[172:175]
  buffer_load_dwordx4 v12, s[8:11], s74 offen offset:3072 lds
  v_mfma_f32_16x16x32_bf16 v[220:223], a[204:207], a[44:47], v[220:223]
  s_waitcnt lgkmcnt(6)
  v_mfma_f32_16x16x32_bf16 v[80:83], a[208:211], a[32:35], v[80:83]
  ds_read_b64_tr_b16 a[228:229], v32 offset:256
  v_mfma_f32_16x16x32_bf16 v[128:131], a[208:211], a[36:39], v[128:131]
  ds_read_b64_tr_b16 a[230:231], v32 offset:1792
  v_mfma_f32_16x16x32_bf16 v[176:179], a[208:211], a[40:43], v[176:179]
  s_add_u32 m0, s75, 36864
  s_add_u32 s74, s70, 1152
  buffer_load_dwordx4 v13, s[8:11], s74 offen offset:0 lds
  v_mfma_f32_16x16x32_bf16 v[224:227], a[208:211], a[44:47], v[224:227]
  v_mfma_f32_16x16x32_bf16 v[84:87], a[212:215], a[32:35], v[84:87]
  ds_read_b64_tr_b16 a[232:233], v33 offset:256
  v_mfma_f32_16x16x32_bf16 v[132:135], a[212:215], a[36:39], v[132:135]
  ds_read_b64_tr_b16 a[234:235], v33 offset:1792
  v_mfma_f32_16x16x32_bf16 v[180:183], a[212:215], a[40:43], v[180:183]
  buffer_load_dwordx4 v14, s[8:11], s74 offen offset:1024 lds
  v_mfma_f32_16x16x32_bf16 v[228:231], a[212:215], a[44:47], v[228:231]
  s_waitcnt lgkmcnt(6)
  v_mfma_f32_16x16x32_bf16 v[88:91], a[216:219], a[32:35], v[88:91]
  ds_read_b64_tr_b16 a[236:237], v34 offset:256
  v_mfma_f32_16x16x32_bf16 v[136:139], a[216:219], a[36:39], v[136:139]
  ds_read_b64_tr_b16 a[238:239], v34 offset:1792
  v_mfma_f32_16x16x32_bf16 v[184:187], a[216:219], a[40:43], v[184:187]
  buffer_load_dwordx4 v15, s[8:11], s74 offen offset:2048 lds
  v_mfma_f32_16x16x32_bf16 v[232:235], a[216:219], a[44:47], v[232:235]
  s_waitcnt vmcnt(21)
  s_barrier
  v_mfma_f32_16x16x32_bf16 v[92:95], a[220:223], a[32:35], v[92:95]
  ds_read_b64_tr_b16 a[192:193], v31 offset:12288
  v_mfma_f32_16x16x32_bf16 v[140:143], a[220:223], a[36:39], v[140:143]
  ds_read_b64_tr_b16 a[194:195], v31 offset:13824
  v_mfma_f32_16x16x32_bf16 v[188:191], a[220:223], a[40:43], v[188:191]
  buffer_load_dwordx4 v16, s[8:11], s74 offen offset:3072 lds
  v_mfma_f32_16x16x32_bf16 v[236:239], a[220:223], a[44:47], v[236:239]
  s_waitcnt lgkmcnt(6)
  v_mfma_f32_16x16x32_bf16 v[96:99], a[224:227], a[32:35], v[96:99]
  ds_read_b64_tr_b16 a[196:197], v32 offset:12288
  v_mfma_f32_16x16x32_bf16 v[144:147], a[224:227], a[36:39], v[144:147]
  ds_read_b64_tr_b16 a[198:199], v32 offset:13824
  v_mfma_f32_16x16x32_bf16 v[192:195], a[224:227], a[40:43], v[192:195]
  s_add_u32 m0, s55, 86016
  s_add_u32 s73, s71, 7077888
  buffer_load_dwordx4 v41, s[12:15], s73 offen offset:0 lds
  v_mfma_f32_16x16x32_bf16 v[240:243], a[224:227], a[44:47], v[240:243]
  v_mfma_f32_16x16x32_bf16 v[100:103], a[228:231], a[32:35], v[100:103]
  ds_read_b64_tr_b16 a[200:201], v33 offset:12288
  v_mfma_f32_16x16x32_bf16 v[148:151], a[228:231], a[36:39], v[148:151]
  ds_read_b64_tr_b16 a[202:203], v33 offset:13824
  v_mfma_f32_16x16x32_bf16 v[196:199], a[228:231], a[40:43], v[196:199]
  buffer_load_dwordx4 v42, s[12:15], s73 offen offset:1024 lds
  v_mfma_f32_16x16x32_bf16 v[244:247], a[228:231], a[44:47], v[244:247]
  s_waitcnt lgkmcnt(6)
  v_mfma_f32_16x16x32_bf16 v[104:107], a[232:235], a[32:35], v[104:107]
  ds_read_b64_tr_b16 a[204:205], v34 offset:12288
  v_mfma_f32_16x16x32_bf16 v[152:155], a[232:235], a[36:39], v[152:155]
  ds_read_b64_tr_b16 a[206:207], v34 offset:13824
  v_mfma_f32_16x16x32_bf16 v[200:203], a[232:235], a[40:43], v[200:203]
  buffer_load_dwordx4 v43, s[12:15], s73 offen offset:2048 lds
  v_mfma_f32_16x16x32_bf16 v[248:251], a[232:235], a[44:47], v[248:251]
  v_mfma_f32_16x16x32_bf16 v[108:111], a[236:239], a[32:35], v[108:111]
  ds_read_b64_tr_b16 a[208:209], v31 offset:12416
  v_mfma_f32_16x16x32_bf16 v[156:159], a[236:239], a[36:39], v[156:159]
  ds_read_b64_tr_b16 a[210:211], v31 offset:13952
  v_mfma_f32_16x16x32_bf16 v[204:207], a[236:239], a[40:43], v[204:207]
  v_mfma_f32_16x16x32_bf16 v[252:255], a[236:239], a[44:47], v[252:255]
  s_waitcnt lgkmcnt(6)
  v_mfma_f32_16x16x32_bf16 v[64:67], a[192:195], a[48:51], v[64:67]
  ds_read_b64_tr_b16 a[212:213], v32 offset:12416
  v_mfma_f32_16x16x32_bf16 v[112:115], a[192:195], a[52:55], v[112:115]
  ds_read_b64_tr_b16 a[214:215], v32 offset:13952
  v_mfma_f32_16x16x32_bf16 v[160:163], a[192:195], a[56:59], v[160:163]
  v_mfma_f32_16x16x32_bf16 v[208:211], a[192:195], a[60:63], v[208:211]
  v_mfma_f32_16x16x32_bf16 v[68:71], a[196:199], a[48:51], v[68:71]
  ds_read_b64_tr_b16 a[216:217], v33 offset:12416
  v_mfma_f32_16x16x32_bf16 v[116:119], a[196:199], a[52:55], v[116:119]
  ds_read_b64_tr_b16 a[218:219], v33 offset:13952
  v_mfma_f32_16x16x32_bf16 v[164:167], a[196:199], a[56:59], v[164:167]
  v_mfma_f32_16x16x32_bf16 v[212:215], a[196:199], a[60:63], v[212:215]
  s_waitcnt vmcnt(17)
  ds_read_b128 a[0:3], v29 offset:0
  s_waitcnt lgkmcnt(7)
  v_mfma_f32_16x16x32_bf16 v[72:75], a[200:203], a[48:51], v[72:75]
  ds_read_b64_tr_b16 a[220:221], v34 offset:12416
  v_mfma_f32_16x16x32_bf16 v[120:123], a[200:203], a[52:55], v[120:123]
  ds_read_b64_tr_b16 a[222:223], v34 offset:13952
  v_mfma_f32_16x16x32_bf16 v[168:171], a[200:203], a[56:59], v[168:171]
  v_mfma_f32_16x16x32_bf16 v[216:219], a[200:203], a[60:63], v[216:219]
  ds_read_b128 a[16:19], v30 offset:0
  v_mfma_f32_16x16x32_bf16 v[76:79], a[204:207], a[48:51], v[76:79]
  ds_read_b64_tr_b16 a[224:225], v31 offset:12544
  v_mfma_f32_16x16x32_bf16 v[124:127], a[204:207], a[52:55], v[124:127]
  ds_read_b64_tr_b16 a[226:227], v31 offset:14080
  v_mfma_f32_16x16x32_bf16 v[172:175], a[204:207], a[56:59], v[172:175]
  v_mfma_f32_16x16x32_bf16 v[220:223], a[204:207], a[60:63], v[220:223]
  ds_read_b128 a[4:7], v29 offset:2048
  s_waitcnt lgkmcnt(9)
  v_mfma_f32_16x16x32_bf16 v[80:83], a[208:211], a[48:51], v[80:83]
  ds_read_b64_tr_b16 a[228:229], v32 offset:12544
  v_mfma_f32_16x16x32_bf16 v[128:131], a[208:211], a[52:55], v[128:131]
  ds_read_b64_tr_b16 a[230:231], v32 offset:14080
  v_mfma_f32_16x16x32_bf16 v[176:179], a[208:211], a[56:59], v[176:179]
  v_mfma_f32_16x16x32_bf16 v[224:227], a[208:211], a[60:63], v[224:227]
  ds_read_b128 a[20:23], v30 offset:2048
  v_mfma_f32_16x16x32_bf16 v[84:87], a[212:215], a[48:51], v[84:87]
  ds_read_b64_tr_b16 a[232:233], v33 offset:12544
  v_mfma_f32_16x16x32_bf16 v[132:135], a[212:215], a[52:55], v[132:135]
  ds_read_b64_tr_b16 a[234:235], v33 offset:14080
  v_mfma_f32_16x16x32_bf16 v[180:183], a[212:215], a[56:59], v[180:183]
  v_mfma_f32_16x16x32_bf16 v[228:231], a[212:215], a[60:63], v[228:231]
  ds_read_b128 a[8:11], v29 offset:4096
  s_waitcnt lgkmcnt(10)
  v_mfma_f32_16x16x32_bf16 v[88:91], a[216:219], a[48:51], v[88:91]
  ds_read_b64_tr_b16 a[236:237], v34 offset:12544
  v_mfma_f32_16x16x32_bf16 v[136:139], a[216:219], a[52:55], v[136:139]
  ds_read_b64_tr_b16 a[238:239], v34 offset:14080
  v_mfma_f32_16x16x32_bf16 v[184:187], a[216:219], a[56:59], v[184:187]
  v_mfma_f32_16x16x32_bf16 v[232:235], a[216:219], a[60:63], v[232:235]
  ds_read_b128 a[24:27], v30 offset:4096
  s_waitcnt vmcnt(14)
  s_barrier
  v_mfma_f32_16x16x32_bf16 v[92:95], a[220:223], a[48:51], v[92:95]
  ds_read_b64_tr_b16 a[192:193], v31 offset:36864
  v_mfma_f32_16x16x32_bf16 v[140:143], a[220:223], a[52:55], v[140:143]
  ds_read_b64_tr_b16 a[194:195], v31 offset:38400
  v_mfma_f32_16x16x32_bf16 v[188:191], a[220:223], a[56:59], v[188:191]
  s_add_u32 m0, s55, 36864
  s_add_u32 s73, s71, 7471104
  buffer_load_dwordx4 v41, s[12:15], s73 offen offset:0 lds
  v_mfma_f32_16x16x32_bf16 v[236:239], a[220:223], a[60:63], v[236:239]
  ds_read_b128 a[12:15], v29 offset:6144
  s_waitcnt lgkmcnt(10)
  v_mfma_f32_16x16x32_bf16 v[96:99], a[224:227], a[48:51], v[96:99]
  ds_read_b64_tr_b16 a[196:197], v32 offset:36864
  v_mfma_f32_16x16x32_bf16 v[144:147], a[224:227], a[52:55], v[144:147]
  ds_read_b64_tr_b16 a[198:199], v32 offset:38400
  v_mfma_f32_16x16x32_bf16 v[192:195], a[224:227], a[56:59], v[192:195]
  buffer_load_dwordx4 v42, s[12:15], s73 offen offset:1024 lds
  v_mfma_f32_16x16x32_bf16 v[240:243], a[224:227], a[60:63], v[240:243]
  ds_read_b128 a[28:31], v30 offset:6144
  v_mfma_f32_16x16x32_bf16 v[100:103], a[228:231], a[48:51], v[100:103]
  ds_read_b64_tr_b16 a[200:201], v33 offset:36864
  v_mfma_f32_16x16x32_bf16 v[148:151], a[228:231], a[52:55], v[148:151]
  ds_read_b64_tr_b16 a[202:203], v33 offset:38400
  v_mfma_f32_16x16x32_bf16 v[196:199], a[228:231], a[56:59], v[196:199]
  buffer_load_dwordx4 v43, s[12:15], s73 offen offset:2048 lds
  v_mfma_f32_16x16x32_bf16 v[244:247], a[228:231], a[60:63], v[244:247]
  s_waitcnt lgkmcnt(9)
  v_mfma_f32_16x16x32_bf16 v[104:107], a[232:235], a[48:51], v[104:107]
  ds_read_b64_tr_b16 a[204:205], v34 offset:36864
  v_mfma_f32_16x16x32_bf16 v[152:155], a[232:235], a[52:55], v[152:155]
  ds_read_b64_tr_b16 a[206:207], v34 offset:38400
  v_mfma_f32_16x16x32_bf16 v[200:203], a[232:235], a[56:59], v[200:203]
  v_mfma_f32_16x16x32_bf16 v[248:251], a[232:235], a[60:63], v[248:251]
  v_mfma_f32_16x16x32_bf16 v[108:111], a[236:239], a[48:51], v[108:111]
  ds_read_b64_tr_b16 a[208:209], v31 offset:36992
  v_mfma_f32_16x16x32_bf16 v[156:159], a[236:239], a[52:55], v[156:159]
  ds_read_b64_tr_b16 a[210:211], v31 offset:38528
  v_mfma_f32_16x16x32_bf16 v[204:207], a[236:239], a[56:59], v[204:207]
  v_mfma_f32_16x16x32_bf16 v[252:255], a[236:239], a[60:63], v[252:255]
  s_waitcnt lgkmcnt(6)
  v_mfma_f32_16x16x32_bf16 v[64:67], a[192:195], a[0:3], v[64:67]
  ds_read_b64_tr_b16 a[212:213], v32 offset:36992
  v_mfma_f32_16x16x32_bf16 v[112:115], a[192:195], a[4:7], v[112:115]
  ds_read_b64_tr_b16 a[214:215], v32 offset:38528
  v_mfma_f32_16x16x32_bf16 v[160:163], a[192:195], a[8:11], v[160:163]
  v_mfma_f32_16x16x32_bf16 v[208:211], a[192:195], a[12:15], v[208:211]
  v_mfma_f32_16x16x32_bf16 v[68:71], a[196:199], a[0:3], v[68:71]
  ds_read_b64_tr_b16 a[216:217], v33 offset:36992
  v_mfma_f32_16x16x32_bf16 v[116:119], a[196:199], a[4:7], v[116:119]
  ds_read_b64_tr_b16 a[218:219], v33 offset:38528
  v_mfma_f32_16x16x32_bf16 v[164:167], a[196:199], a[8:11], v[164:167]
  v_mfma_f32_16x16x32_bf16 v[212:215], a[196:199], a[12:15], v[212:215]
  s_waitcnt lgkmcnt(6)
  v_mfma_f32_16x16x32_bf16 v[72:75], a[200:203], a[0:3], v[72:75]
  ds_read_b64_tr_b16 a[220:221], v34 offset:36992
  v_mfma_f32_16x16x32_bf16 v[120:123], a[200:203], a[4:7], v[120:123]
  ds_read_b64_tr_b16 a[222:223], v34 offset:38528
  v_mfma_f32_16x16x32_bf16 v[168:171], a[200:203], a[8:11], v[168:171]
  v_mfma_f32_16x16x32_bf16 v[216:219], a[200:203], a[12:15], v[216:219]
  v_mfma_f32_16x16x32_bf16 v[76:79], a[204:207], a[0:3], v[76:79]
  ds_read_b64_tr_b16 a[224:225], v31 offset:37120
  v_mfma_f32_16x16x32_bf16 v[124:127], a[204:207], a[4:7], v[124:127]
  ds_read_b64_tr_b16 a[226:227], v31 offset:38656
  v_mfma_f32_16x16x32_bf16 v[172:175], a[204:207], a[8:11], v[172:175]
  v_mfma_f32_16x16x32_bf16 v[220:223], a[204:207], a[12:15], v[220:223]
  s_waitcnt lgkmcnt(6)
  v_mfma_f32_16x16x32_bf16 v[80:83], a[208:211], a[0:3], v[80:83]
  ds_read_b64_tr_b16 a[228:229], v32 offset:37120
  v_mfma_f32_16x16x32_bf16 v[128:131], a[208:211], a[4:7], v[128:131]
  ds_read_b64_tr_b16 a[230:231], v32 offset:38656
  v_mfma_f32_16x16x32_bf16 v[176:179], a[208:211], a[8:11], v[176:179]
  v_mfma_f32_16x16x32_bf16 v[224:227], a[208:211], a[12:15], v[224:227]
  v_mfma_f32_16x16x32_bf16 v[84:87], a[212:215], a[0:3], v[84:87]
  ds_read_b64_tr_b16 a[232:233], v33 offset:37120
  v_mfma_f32_16x16x32_bf16 v[132:135], a[212:215], a[4:7], v[132:135]
  ds_read_b64_tr_b16 a[234:235], v33 offset:38656
  v_mfma_f32_16x16x32_bf16 v[180:183], a[212:215], a[8:11], v[180:183]
  v_mfma_f32_16x16x32_bf16 v[228:231], a[212:215], a[12:15], v[228:231]
  s_waitcnt lgkmcnt(6)
  v_mfma_f32_16x16x32_bf16 v[88:91], a[216:219], a[0:3], v[88:91]
  ds_read_b64_tr_b16 a[236:237], v34 offset:37120
  v_mfma_f32_16x16x32_bf16 v[136:139], a[216:219], a[4:7], v[136:139]
  ds_read_b64_tr_b16 a[238:239], v34 offset:38656
  v_mfma_f32_16x16x32_bf16 v[184:187], a[216:219], a[8:11], v[184:187]
  v_mfma_f32_16x16x32_bf16 v[232:235], a[216:219], a[12:15], v[232:235]
  s_waitcnt vmcnt(14)
  s_barrier
  v_mfma_f32_16x16x32_bf16 v[92:95], a[220:223], a[0:3], v[92:95]
  ds_read_b64_tr_b16 a[192:193], v31 offset:24576
  v_mfma_f32_16x16x32_bf16 v[140:143], a[220:223], a[4:7], v[140:143]
  ds_read_b64_tr_b16 a[194:195], v31 offset:26112
  v_mfma_f32_16x16x32_bf16 v[188:191], a[220:223], a[8:11], v[188:191]
  s_add_u32 m0, s55, 49152
  s_mov_b32 s73, 24576
  buffer_load_dwordx4 v25, s[16:19], s73 offen offset:0 nt lds
  v_mfma_f32_16x16x32_bf16 v[236:239], a[220:223], a[12:15], v[236:239]
  s_waitcnt lgkmcnt(6)
  v_mfma_f32_16x16x32_bf16 v[96:99], a[224:227], a[0:3], v[96:99]
  ds_read_b64_tr_b16 a[196:197], v32 offset:24576
  v_mfma_f32_16x16x32_bf16 v[144:147], a[224:227], a[4:7], v[144:147]
  ds_read_b64_tr_b16 a[198:199], v32 offset:26112
  v_mfma_f32_16x16x32_bf16 v[192:195], a[224:227], a[8:11], v[192:195]
  buffer_load_dwordx4 v26, s[16:19], s73 offen offset:1024 nt lds
  v_mfma_f32_16x16x32_bf16 v[240:243], a[224:227], a[12:15], v[240:243]
  v_mfma_f32_16x16x32_bf16 v[100:103], a[228:231], a[0:3], v[100:103]
  ds_read_b64_tr_b16 a[200:201], v33 offset:24576
  v_mfma_f32_16x16x32_bf16 v[148:151], a[228:231], a[4:7], v[148:151]
  ds_read_b64_tr_b16 a[202:203], v33 offset:26112
  v_mfma_f32_16x16x32_bf16 v[196:199], a[228:231], a[8:11], v[196:199]
  buffer_load_dwordx4 v27, s[16:19], s73 offen offset:2048 nt lds
  v_mfma_f32_16x16x32_bf16 v[244:247], a[228:231], a[12:15], v[244:247]
  s_waitcnt lgkmcnt(6)
  v_mfma_f32_16x16x32_bf16 v[104:107], a[232:235], a[0:3], v[104:107]
  ds_read_b64_tr_b16 a[204:205], v34 offset:24576
  v_mfma_f32_16x16x32_bf16 v[152:155], a[232:235], a[4:7], v[152:155]
  ds_read_b64_tr_b16 a[206:207], v34 offset:26112
  v_mfma_f32_16x16x32_bf16 v[200:203], a[232:235], a[8:11], v[200:203]
  v_mfma_f32_16x16x32_bf16 v[248:251], a[232:235], a[12:15], v[248:251]
  v_mfma_f32_16x16x32_bf16 v[108:111], a[236:239], a[0:3], v[108:111]
  ds_read_b64_tr_b16 a[208:209], v31 offset:24704
  v_mfma_f32_16x16x32_bf16 v[156:159], a[236:239], a[4:7], v[156:159]
  ds_read_b64_tr_b16 a[210:211], v31 offset:26240
  v_mfma_f32_16x16x32_bf16 v[204:207], a[236:239], a[8:11], v[204:207]
  v_mfma_f32_16x16x32_bf16 v[252:255], a[236:239], a[12:15], v[252:255]
  s_waitcnt lgkmcnt(6)
  v_mfma_f32_16x16x32_bf16 v[64:67], a[192:195], a[16:19], v[64:67]
  ds_read_b64_tr_b16 a[212:213], v32 offset:24704
  v_mfma_f32_16x16x32_bf16 v[112:115], a[192:195], a[20:23], v[112:115]
  ds_read_b64_tr_b16 a[214:215], v32 offset:26240
  v_mfma_f32_16x16x32_bf16 v[160:163], a[192:195], a[24:27], v[160:163]
  v_mfma_f32_16x16x32_bf16 v[208:211], a[192:195], a[28:31], v[208:211]
  v_mfma_f32_16x16x32_bf16 v[68:71], a[196:199], a[16:19], v[68:71]
  ds_read_b64_tr_b16 a[216:217], v33 offset:24704
  v_mfma_f32_16x16x32_bf16 v[116:119], a[196:199], a[20:23], v[116:119]
  ds_read_b64_tr_b16 a[218:219], v33 offset:26240
  v_mfma_f32_16x16x32_bf16 v[164:167], a[196:199], a[24:27], v[164:167]
  v_mfma_f32_16x16x32_bf16 v[212:215], a[196:199], a[28:31], v[212:215]
  s_waitcnt vmcnt(9)
  ds_read_b128 a[32:35], v29 offset:32768
  s_waitcnt lgkmcnt(7)
  v_mfma_f32_16x16x32_bf16 v[72:75], a[200:203], a[16:19], v[72:75]
  ds_read_b64_tr_b16 a[220:221], v34 offset:24704
  v_mfma_f32_16x16x32_bf16 v[120:123], a[200:203], a[20:23], v[120:123]
  ds_read_b64_tr_b16 a[222:223], v34 offset:26240
  v_mfma_f32_16x16x32_bf16 v[168:171], a[200:203], a[24:27], v[168:171]
  v_mfma_f32_16x16x32_bf16 v[216:219], a[200:203], a[28:31], v[216:219]
  ds_read_b128 a[48:51], v30 offset:32768
  v_mfma_f32_16x16x32_bf16 v[76:79], a[204:207], a[16:19], v[76:79]
  ds_read_b64_tr_b16 a[224:225], v31 offset:24832
  v_mfma_f32_16x16x32_bf16 v[124:127], a[204:207], a[20:23], v[124:127]
  ds_read_b64_tr_b16 a[226:227], v31 offset:26368
  v_mfma_f32_16x16x32_bf16 v[172:175], a[204:207], a[24:27], v[172:175]
  v_mfma_f32_16x16x32_bf16 v[220:223], a[204:207], a[28:31], v[220:223]
  ds_read_b128 a[36:39], v29 offset:34816
  s_waitcnt lgkmcnt(9)
  v_mfma_f32_16x16x32_bf16 v[80:83], a[208:211], a[16:19], v[80:83]
  ds_read_b64_tr_b16 a[228:229], v32 offset:24832
  v_mfma_f32_16x16x32_bf16 v[128:131], a[208:211], a[20:23], v[128:131]
  ds_read_b64_tr_b16 a[230:231], v32 offset:26368
  v_mfma_f32_16x16x32_bf16 v[176:179], a[208:211], a[24:27], v[176:179]
  v_mfma_f32_16x16x32_bf16 v[224:227], a[208:211], a[28:31], v[224:227]
  ds_read_b128 a[52:55], v30 offset:34816
  v_mfma_f32_16x16x32_bf16 v[84:87], a[212:215], a[16:19], v[84:87]
  ds_read_b64_tr_b16 a[232:233], v33 offset:24832
  v_mfma_f32_16x16x32_bf16 v[132:135], a[212:215], a[20:23], v[132:135]
  ds_read_b64_tr_b16 a[234:235], v33 offset:26368
  v_mfma_f32_16x16x32_bf16 v[180:183], a[212:215], a[24:27], v[180:183]
  v_mfma_f32_16x16x32_bf16 v[228:231], a[212:215], a[28:31], v[228:231]
  ds_read_b128 a[40:43], v29 offset:36864
  s_waitcnt lgkmcnt(10)
  v_mfma_f32_16x16x32_bf16 v[88:91], a[216:219], a[16:19], v[88:91]
  ds_read_b64_tr_b16 a[236:237], v34 offset:24832
  v_mfma_f32_16x16x32_bf16 v[136:139], a[216:219], a[20:23], v[136:139]
  ds_read_b64_tr_b16 a[238:239], v34 offset:26368
  v_mfma_f32_16x16x32_bf16 v[184:187], a[216:219], a[24:27], v[184:187]
  v_mfma_f32_16x16x32_bf16 v[232:235], a[216:219], a[28:31], v[232:235]
  ds_read_b128 a[56:59], v30 offset:36864
  s_waitcnt vmcnt(6)
  s_barrier
  v_mfma_f32_16x16x32_bf16 v[92:95], a[220:223], a[16:19], v[92:95]
  ds_read_b64_tr_b16 a[192:193], v31 offset:49152
  v_mfma_f32_16x16x32_bf16 v[140:143], a[220:223], a[20:23], v[140:143]
  ds_read_b64_tr_b16 a[194:195], v31 offset:50688
  v_mfma_f32_16x16x32_bf16 v[188:191], a[220:223], a[24:27], v[188:191]
  s_add_u32 m0, s55, 73728
  s_mov_b32 s73, 36864
  buffer_load_dwordx4 v25, s[16:19], s73 offen offset:0 nt lds
  v_mfma_f32_16x16x32_bf16 v[236:239], a[220:223], a[28:31], v[236:239]
  ds_read_b128 a[44:47], v29 offset:38912
  s_waitcnt lgkmcnt(10)
  v_mfma_f32_16x16x32_bf16 v[96:99], a[224:227], a[16:19], v[96:99]
  ds_read_b64_tr_b16 a[196:197], v32 offset:49152
  v_mfma_f32_16x16x32_bf16 v[144:147], a[224:227], a[20:23], v[144:147]
  ds_read_b64_tr_b16 a[198:199], v32 offset:50688
  v_mfma_f32_16x16x32_bf16 v[192:195], a[224:227], a[24:27], v[192:195]
  buffer_load_dwordx4 v26, s[16:19], s73 offen offset:1024 nt lds
  v_mfma_f32_16x16x32_bf16 v[240:243], a[224:227], a[28:31], v[240:243]
  ds_read_b128 a[60:63], v30 offset:38912
  v_mfma_f32_16x16x32_bf16 v[100:103], a[228:231], a[16:19], v[100:103]
  ds_read_b64_tr_b16 a[200:201], v33 offset:49152
  v_mfma_f32_16x16x32_bf16 v[148:151], a[228:231], a[20:23], v[148:151]
  ds_read_b64_tr_b16 a[202:203], v33 offset:50688
  v_mfma_f32_16x16x32_bf16 v[196:199], a[228:231], a[24:27], v[196:199]
  buffer_load_dwordx4 v27, s[16:19], s73 offen offset:2048 nt lds
  v_mfma_f32_16x16x32_bf16 v[244:247], a[228:231], a[28:31], v[244:247]
  s_waitcnt lgkmcnt(9)
  v_mfma_f32_16x16x32_bf16 v[104:107], a[232:235], a[16:19], v[104:107]
  ds_read_b64_tr_b16 a[204:205], v34 offset:49152
  v_mfma_f32_16x16x32_bf16 v[152:155], a[232:235], a[20:23], v[152:155]
  ds_read_b64_tr_b16 a[206:207], v34 offset:50688
  v_mfma_f32_16x16x32_bf16 v[200:203], a[232:235], a[24:27], v[200:203]
  v_mfma_f32_16x16x32_bf16 v[248:251], a[232:235], a[28:31], v[248:251]
  v_mfma_f32_16x16x32_bf16 v[108:111], a[236:239], a[16:19], v[108:111]
  ds_read_b64_tr_b16 a[208:209], v31 offset:49280
  v_mfma_f32_16x16x32_bf16 v[156:159], a[236:239], a[20:23], v[156:159]
  ds_read_b64_tr_b16 a[210:211], v31 offset:50816
  v_mfma_f32_16x16x32_bf16 v[204:207], a[236:239], a[24:27], v[204:207]
  v_mfma_f32_16x16x32_bf16 v[252:255], a[236:239], a[28:31], v[252:255]
  s_waitcnt lgkmcnt(6)
  v_mfma_f32_16x16x32_bf16 v[64:67], a[192:195], a[32:35], v[64:67]
  ds_read_b64_tr_b16 a[212:213], v32 offset:49280
  v_mfma_f32_16x16x32_bf16 v[112:115], a[192:195], a[36:39], v[112:115]
  ds_read_b64_tr_b16 a[214:215], v32 offset:50816
  v_mfma_f32_16x16x32_bf16 v[160:163], a[192:195], a[40:43], v[160:163]
  v_mfma_f32_16x16x32_bf16 v[208:211], a[192:195], a[44:47], v[208:211]
  v_mfma_f32_16x16x32_bf16 v[68:71], a[196:199], a[32:35], v[68:71]
  ds_read_b64_tr_b16 a[216:217], v33 offset:49280
  v_mfma_f32_16x16x32_bf16 v[116:119], a[196:199], a[36:39], v[116:119]
  ds_read_b64_tr_b16 a[218:219], v33 offset:50816
  v_mfma_f32_16x16x32_bf16 v[164:167], a[196:199], a[40:43], v[164:167]
  v_mfma_f32_16x16x32_bf16 v[212:215], a[196:199], a[44:47], v[212:215]
  s_waitcnt lgkmcnt(6)
  v_mfma_f32_16x16x32_bf16 v[72:75], a[200:203], a[32:35], v[72:75]
  ds_read_b64_tr_b16 a[220:221], v34 offset:49280
  v_mfma_f32_16x16x32_bf16 v[120:123], a[200:203], a[36:39], v[120:123]
  ds_read_b64_tr_b16 a[222:223], v34 offset:50816
  v_mfma_f32_16x16x32_bf16 v[168:171], a[200:203], a[40:43], v[168:171]
  v_mfma_f32_16x16x32_bf16 v[216:219], a[200:203], a[44:47], v[216:219]
  v_mfma_f32_16x16x32_bf16 v[76:79], a[204:207], a[32:35], v[76:79]
  ds_read_b64_tr_b16 a[224:225], v31 offset:49408
  v_mfma_f32_16x16x32_bf16 v[124:127], a[204:207], a[36:39], v[124:127]
  ds_read_b64_tr_b16 a[226:227], v31 offset:50944
  v_mfma_f32_16x16x32_bf16 v[172:175], a[204:207], a[40:43], v[172:175]
  v_mfma_f32_16x16x32_bf16 v[220:223], a[204:207], a[44:47], v[220:223]
  s_waitcnt lgkmcnt(6)
  v_mfma_f32_16x16x32_bf16 v[80:83], a[208:211], a[32:35], v[80:83]
  ds_read_b64_tr_b16 a[228:229], v32 offset:49408
  v_mfma_f32_16x16x32_bf16 v[128:131], a[208:211], a[36:39], v[128:131]
  ds_read_b64_tr_b16 a[230:231], v32 offset:50944
  v_mfma_f32_16x16x32_bf16 v[176:179], a[208:211], a[40:43], v[176:179]
  v_mfma_f32_16x16x32_bf16 v[224:227], a[208:211], a[44:47], v[224:227]
  v_mfma_f32_16x16x32_bf16 v[84:87], a[212:215], a[32:35], v[84:87]
  ds_read_b64_tr_b16 a[232:233], v33 offset:49408
  v_mfma_f32_16x16x32_bf16 v[132:135], a[212:215], a[36:39], v[132:135]
  ds_read_b64_tr_b16 a[234:235], v33 offset:50944
  v_mfma_f32_16x16x32_bf16 v[180:183], a[212:215], a[40:43], v[180:183]
  v_mfma_f32_16x16x32_bf16 v[228:231], a[212:215], a[44:47], v[228:231]
  s_waitcnt lgkmcnt(6)
  v_mfma_f32_16x16x32_bf16 v[88:91], a[216:219], a[32:35], v[88:91]
  ds_read_b64_tr_b16 a[236:237], v34 offset:49408
  v_mfma_f32_16x16x32_bf16 v[136:139], a[216:219], a[36:39], v[136:139]
  ds_read_b64_tr_b16 a[238:239], v34 offset:50944
  v_mfma_f32_16x16x32_bf16 v[184:187], a[216:219], a[40:43], v[184:187]
  v_mfma_f32_16x16x32_bf16 v[232:235], a[216:219], a[44:47], v[232:235]
  s_waitcnt vmcnt(6)
  s_barrier
  v_mfma_f32_16x16x32_bf16 v[92:95], a[220:223], a[32:35], v[92:95]
  ds_read_b64_tr_b16 a[192:193], v31 offset:0
  v_mfma_f32_16x16x32_bf16 v[140:143], a[220:223], a[36:39], v[140:143]
  ds_read_b64_tr_b16 a[194:195], v31 offset:1536
  v_mfma_f32_16x16x32_bf16 v[188:191], a[220:223], a[40:43], v[188:191]
  s_add_u32 m0, s55, 61440
  s_mov_b32 s73, 24576
  buffer_load_dwordx4 v25, s[20:23], s73 offen offset:0 nt lds
  v_mfma_f32_16x16x32_bf16 v[236:239], a[220:223], a[44:47], v[236:239]
  s_waitcnt lgkmcnt(6)
  v_mfma_f32_16x16x32_bf16 v[96:99], a[224:227], a[32:35], v[96:99]
  ds_read_b64_tr_b16 a[196:197], v32 offset:0
  v_mfma_f32_16x16x32_bf16 v[144:147], a[224:227], a[36:39], v[144:147]
  ds_read_b64_tr_b16 a[198:199], v32 offset:1536
  v_mfma_f32_16x16x32_bf16 v[192:195], a[224:227], a[40:43], v[192:195]
  buffer_load_dwordx4 v26, s[20:23], s73 offen offset:1024 nt lds
  v_mfma_f32_16x16x32_bf16 v[240:243], a[224:227], a[44:47], v[240:243]
  v_mfma_f32_16x16x32_bf16 v[100:103], a[228:231], a[32:35], v[100:103]
  ds_read_b64_tr_b16 a[200:201], v33 offset:0
  v_mfma_f32_16x16x32_bf16 v[148:151], a[228:231], a[36:39], v[148:151]
  ds_read_b64_tr_b16 a[202:203], v33 offset:1536
  v_mfma_f32_16x16x32_bf16 v[196:199], a[228:231], a[40:43], v[196:199]
  buffer_load_dwordx4 v27, s[20:23], s73 offen offset:2048 nt lds
  v_mfma_f32_16x16x32_bf16 v[244:247], a[228:231], a[44:47], v[244:247]
  s_waitcnt lgkmcnt(6)
  v_mfma_f32_16x16x32_bf16 v[104:107], a[232:235], a[32:35], v[104:107]
  ds_read_b64_tr_b16 a[204:205], v34 offset:0
  v_mfma_f32_16x16x32_bf16 v[152:155], a[232:235], a[36:39], v[152:155]
  ds_read_b64_tr_b16 a[206:207], v34 offset:1536
  v_mfma_f32_16x16x32_bf16 v[200:203], a[232:235], a[40:43], v[200:203]
  s_add_u32 m0, s55, 98304
  s_mov_b32 s73, 49152
  buffer_load_dwordx4 v25, s[16:19], s73 offen offset:0 nt lds
  v_mfma_f32_16x16x32_bf16 v[248:251], a[232:235], a[44:47], v[248:251]
  v_mfma_f32_16x16x32_bf16 v[108:111], a[236:239], a[32:35], v[108:111]
  ds_read_b64_tr_b16 a[208:209], v31 offset:128
  v_mfma_f32_16x16x32_bf16 v[156:159], a[236:239], a[36:39], v[156:159]
  ds_read_b64_tr_b16 a[210:211], v31 offset:1664
  v_mfma_f32_16x16x32_bf16 v[204:207], a[236:239], a[40:43], v[204:207]
  buffer_load_dwordx4 v26, s[16:19], s73 offen offset:1024 nt lds
  v_mfma_f32_16x16x32_bf16 v[252:255], a[236:239], a[44:47], v[252:255]
  s_waitcnt lgkmcnt(6)
  v_mfma_f32_16x16x32_bf16 v[64:67], a[192:195], a[48:51], v[64:67]
  ds_read_b64_tr_b16 a[212:213], v32 offset:128
  v_mfma_f32_16x16x32_bf16 v[112:115], a[192:195], a[52:55], v[112:115]
  ds_read_b64_tr_b16 a[214:215], v32 offset:1664
  v_mfma_f32_16x16x32_bf16 v[160:163], a[192:195], a[56:59], v[160:163]
  buffer_load_dwordx4 v27, s[16:19], s73 offen offset:2048 nt lds
  v_mfma_f32_16x16x32_bf16 v[208:211], a[192:195], a[60:63], v[208:211]
  v_mfma_f32_16x16x32_bf16 v[68:71], a[196:199], a[48:51], v[68:71]
  ds_read_b64_tr_b16 a[216:217], v33 offset:128
  v_mfma_f32_16x16x32_bf16 v[116:119], a[196:199], a[52:55], v[116:119]
  ds_read_b64_tr_b16 a[218:219], v33 offset:1664
  v_mfma_f32_16x16x32_bf16 v[164:167], a[196:199], a[56:59], v[164:167]
  v_mfma_f32_16x16x32_bf16 v[212:215], a[196:199], a[60:63], v[212:215]
  s_waitcnt lgkmcnt(6)
  v_mfma_f32_16x16x32_bf16 v[72:75], a[200:203], a[48:51], v[72:75]
  ds_read_b64_tr_b16 a[220:221], v34 offset:128
  v_mfma_f32_16x16x32_bf16 v[120:123], a[200:203], a[52:55], v[120:123]
  ds_read_b64_tr_b16 a[222:223], v34 offset:1664
  v_mfma_f32_16x16x32_bf16 v[168:171], a[200:203], a[56:59], v[168:171]
  v_mfma_f32_16x16x32_bf16 v[216:219], a[200:203], a[60:63], v[216:219]
  v_mfma_f32_16x16x32_bf16 v[76:79], a[204:207], a[48:51], v[76:79]
  ds_read_b64_tr_b16 a[224:225], v31 offset:256
  v_mfma_f32_16x16x32_bf16 v[124:127], a[204:207], a[52:55], v[124:127]
  ds_read_b64_tr_b16 a[226:227], v31 offset:1792
  v_mfma_f32_16x16x32_bf16 v[172:175], a[204:207], a[56:59], v[172:175]
  v_mfma_f32_16x16x32_bf16 v[220:223], a[204:207], a[60:63], v[220:223]
  s_waitcnt lgkmcnt(6)
  v_mfma_f32_16x16x32_bf16 v[80:83], a[208:211], a[48:51], v[80:83]
  ds_read_b64_tr_b16 a[228:229], v32 offset:256
  v_mfma_f32_16x16x32_bf16 v[128:131], a[208:211], a[52:55], v[128:131]
  ds_read_b64_tr_b16 a[230:231], v32 offset:1792
  v_mfma_f32_16x16x32_bf16 v[176:179], a[208:211], a[56:59], v[176:179]
  v_mfma_f32_16x16x32_bf16 v[224:227], a[208:211], a[60:63], v[224:227]
  v_mfma_f32_16x16x32_bf16 v[84:87], a[212:215], a[48:51], v[84:87]
  ds_read_b64_tr_b16 a[232:233], v33 offset:256
  v_mfma_f32_16x16x32_bf16 v[132:135], a[212:215], a[52:55], v[132:135]
  ds_read_b64_tr_b16 a[234:235], v33 offset:1792
  v_mfma_f32_16x16x32_bf16 v[180:183], a[212:215], a[56:59], v[180:183]
  v_mfma_f32_16x16x32_bf16 v[228:231], a[212:215], a[60:63], v[228:231]
  s_waitcnt lgkmcnt(6)
  v_mfma_f32_16x16x32_bf16 v[88:91], a[216:219], a[48:51], v[88:91]
  ds_read_b64_tr_b16 a[236:237], v34 offset:256
  v_mfma_f32_16x16x32_bf16 v[136:139], a[216:219], a[52:55], v[136:139]
  ds_read_b64_tr_b16 a[238:239], v34 offset:1792
  v_mfma_f32_16x16x32_bf16 v[184:187], a[216:219], a[56:59], v[184:187]
  v_mfma_f32_16x16x32_bf16 v[232:235], a[216:219], a[60:63], v[232:235]
  v_mfma_f32_16x16x32_bf16 v[92:95], a[220:223], a[48:51], v[92:95]
  v_mfma_f32_16x16x32_bf16 v[140:143], a[220:223], a[52:55], v[140:143]
  v_mfma_f32_16x16x32_bf16 v[188:191], a[220:223], a[56:59], v[188:191]
  v_mfma_f32_16x16x32_bf16 v[236:239], a[220:223], a[60:63], v[236:239]
  s_waitcnt lgkmcnt(4)
  v_mfma_f32_16x16x32_bf16 v[96:99], a[224:227], a[48:51], v[96:99]
  v_mfma_f32_16x16x32_bf16 v[144:147], a[224:227], a[52:55], v[144:147]
  v_mfma_f32_16x16x32_bf16 v[192:195], a[224:227], a[56:59], v[192:195]
  v_mfma_f32_16x16x32_bf16 v[240:243], a[224:227], a[60:63], v[240:243]
  v_mfma_f32_16x16x32_bf16 v[100:103], a[228:231], a[48:51], v[100:103]
  v_mfma_f32_16x16x32_bf16 v[148:151], a[228:231], a[52:55], v[148:151]
  v_mfma_f32_16x16x32_bf16 v[196:199], a[228:231], a[56:59], v[196:199]
  v_mfma_f32_16x16x32_bf16 v[244:247], a[228:231], a[60:63], v[244:247]
  s_waitcnt lgkmcnt(0)
  v_mfma_f32_16x16x32_bf16 v[104:107], a[232:235], a[48:51], v[104:107]
  v_mfma_f32_16x16x32_bf16 v[152:155], a[232:235], a[52:55], v[152:155]
  v_mfma_f32_16x16x32_bf16 v[200:203], a[232:235], a[56:59], v[200:203]
  v_mfma_f32_16x16x32_bf16 v[248:251], a[232:235], a[60:63], v[248:251]
  v_mfma_f32_16x16x32_bf16 v[108:111], a[236:239], a[48:51], v[108:111]
  v_mfma_f32_16x16x32_bf16 v[156:159], a[236:239], a[52:55], v[156:159]
  v_mfma_f32_16x16x32_bf16 v[204:207], a[236:239], a[56:59], v[204:207]
  v_mfma_f32_16x16x32_bf16 v[252:255], a[236:239], a[60:63], v[252:255]
  s_barrier
K1_ATT:
  s_add_u32 m0, s55, 36864
  s_mov_b32 s73, 12288
  buffer_load_dwordx4 v25, s[20:23], s73 offen offset:0 nt lds
  buffer_load_dwordx4 v26, s[20:23], s73 offen offset:1024 nt lds
  buffer_load_dwordx4 v27, s[20:23], s73 offen offset:2048 nt lds
  ds_read_b128 a[192:195], v17 offset:0
  ds_read_b128 a[196:199], v18 offset:0
  ds_read_b128 a[200:203], v17 offset:128
  ds_read_b128 a[204:207], v18 offset:128
  ds_read_b128 a[208:211], v17 offset:256
  s_nop 7
  v_mul_f32 v1, s59, v248
  v_mul_f32 v2, s59, v249
  v_mul_f32 v3, s59, v250
  v_mul_f32 v4, s59, v251
  v_mul_f32 v5, s59, v252
  v_mul_f32 v6, s59, v253
  v_mul_f32 v7, s59, v254
  v_mul_f32 v8, s59, v255
  v_cvt_pk_bf16_f32 v252, v1, v2
  v_cvt_pk_bf16_f32 v253, v3, v4
  v_cvt_pk_bf16_f32 v254, v5, v6
  v_cvt_pk_bf16_f32 v255, v7, v8
  s_nop 0
  v_permlane32_swap_b32 v252, v254
  v_permlane32_swap_b32 v253, v255
  v_mul_f32 v240, s59, v240
  v_mul_f32 v241, s59, v241
  v_mul_f32 v242, s59, v242
  v_mul_f32 v243, s59, v243
  v_mul_f32 v244, s59, v244
  v_mul_f32 v245, s59, v245
  v_mul_f32 v246, s59, v246
  v_mul_f32 v247, s59, v247
  v_permlane16_swap_b32 v252, v254
  v_permlane16_swap_b32 v253, v255
  v_cvt_pk_bf16_f32 v248, v240, v241
  v_cvt_pk_bf16_f32 v249, v242, v243
  v_cvt_pk_bf16_f32 v250, v244, v245
  v_cvt_pk_bf16_f32 v251, v246, v247
  s_nop 0
  v_permlane32_swap_b32 v248, v250
  v_permlane32_swap_b32 v249, v251
  v_mul_f32 v232, s59, v232
  v_mul_f32 v233, s59, v233
  v_mul_f32 v234, s59, v234
  v_mul_f32 v235, s59, v235
  v_mul_f32 v236, s59, v236
  v_mul_f32 v237, s59, v237
  v_mul_f32 v238, s59, v238
  v_mul_f32 v239, s59, v239
  v_permlane16_swap_b32 v248, v250
  v_permlane16_swap_b32 v249, v251
  v_cvt_pk_bf16_f32 v244, v232, v233
  v_cvt_pk_bf16_f32 v245, v234, v235
  v_cvt_pk_bf16_f32 v246, v236, v237
  v_cvt_pk_bf16_f32 v247, v238, v239
  s_nop 0
  v_permlane32_swap_b32 v244, v246
  v_permlane32_swap_b32 v245, v247
  v_mul_f32 v224, s59, v224
  v_mul_f32 v225, s59, v225
  v_mul_f32 v226, s59, v226
  v_mul_f32 v227, s59, v227
  v_mul_f32 v228, s59, v228
  v_mul_f32 v229, s59, v229
  v_mul_f32 v230, s59, v230
  v_mul_f32 v231, s59, v231
  v_permlane16_swap_b32 v244, v246
  v_permlane16_swap_b32 v245, v247
  v_cvt_pk_bf16_f32 v240, v224, v225
  v_cvt_pk_bf16_f32 v241, v226, v227
  v_cvt_pk_bf16_f32 v242, v228, v229
  v_cvt_pk_bf16_f32 v243, v230, v231
  s_nop 0
  v_permlane32_swap_b32 v240, v242
  v_permlane32_swap_b32 v241, v243
  v_mul_f32 v216, s59, v216
  v_mul_f32 v217, s59, v217
  v_mul_f32 v218, s59, v218
  v_mul_f32 v219, s59, v219
  v_mul_f32 v220, s59, v220
  v_mul_f32 v221, s59, v221
  v_mul_f32 v222, s59, v222
  v_mul_f32 v223, s59, v223
  v_permlane16_swap_b32 v240, v242
  v_permlane16_swap_b32 v241, v243
  v_cvt_pk_bf16_f32 v236, v216, v217
  v_cvt_pk_bf16_f32 v237, v218, v219
  v_cvt_pk_bf16_f32 v238, v220, v221
  v_cvt_pk_bf16_f32 v239, v222, v223
  s_nop 0
  v_permlane32_swap_b32 v236, v238
  v_permlane32_swap_b32 v237, v239
  v_mul_f32 v208, s59, v208
  v_mul_f32 v209, s59, v209
  v_mul_f32 v210, s59, v210
  v_mul_f32 v211, s59, v211
  v_mul_f32 v212, s59, v212
  v_mul_f32 v213, s59, v213
  v_mul_f32 v214, s59, v214
  v_mul_f32 v215, s59, v215
  v_permlane16_swap_b32 v236, v238
  v_permlane16_swap_b32 v237, v239
  v_cvt_pk_bf16_f32 v232, v208, v209
  v_cvt_pk_bf16_f32 v233, v210, v211
  v_cvt_pk_bf16_f32 v234, v212, v213
  v_cvt_pk_bf16_f32 v235, v214, v215
  s_nop 0
  v_permlane32_swap_b32 v232, v234
  v_permlane32_swap_b32 v233, v235
  v_mul_f32 v200, s59, v200
  v_mul_f32 v201, s59, v201
  v_mul_f32 v202, s59, v202
  v_mul_f32 v203, s59, v203
  v_mul_f32 v204, s59, v204
  v_mul_f32 v205, s59, v205
  v_mul_f32 v206, s59, v206
  v_mul_f32 v207, s59, v207
  v_permlane16_swap_b32 v232, v234
  v_permlane16_swap_b32 v233, v235
  v_cvt_pk_bf16_f32 v228, v200, v201
  v_cvt_pk_bf16_f32 v229, v202, v203
  v_cvt_pk_bf16_f32 v230, v204, v205
  v_cvt_pk_bf16_f32 v231, v206, v207
  s_nop 0
  v_permlane32_swap_b32 v228, v230
  v_permlane32_swap_b32 v229, v231
  v_mul_f32 v192, s59, v192
  v_mul_f32 v193, s59, v193
  v_mul_f32 v194, s59, v194
  v_mul_f32 v195, s59, v195
  v_mul_f32 v196, s59, v196
  v_mul_f32 v197, s59, v197
  v_mul_f32 v198, s59, v198
  v_mul_f32 v199, s59, v199
  v_permlane16_swap_b32 v228, v230
  v_permlane16_swap_b32 v229, v231
  v_cvt_pk_bf16_f32 v224, v192, v193
  v_cvt_pk_bf16_f32 v225, v194, v195
  v_cvt_pk_bf16_f32 v226, v196, v197
  v_cvt_pk_bf16_f32 v227, v198, v199
  s_nop 0
  v_permlane32_swap_b32 v224, v226
  v_permlane32_swap_b32 v225, v227
  v_mul_f32 v184, s59, v184
  v_mul_f32 v185, s59, v185
  v_mul_f32 v186, s59, v186
  v_mul_f32 v187, s59, v187
  v_mul_f32 v188, s59, v188
  v_mul_f32 v189, s59, v189
  v_mul_f32 v190, s59, v190
  v_mul_f32 v191, s59, v191
  v_permlane16_swap_b32 v224, v226
  v_permlane16_swap_b32 v225, v227
  v_cvt_pk_bf16_f32 v220, v184, v185
  v_cvt_pk_bf16_f32 v221, v186, v187
  v_cvt_pk_bf16_f32 v222, v188, v189
  v_cvt_pk_bf16_f32 v223, v190, v191
  s_nop 0
  v_permlane32_swap_b32 v220, v222
  v_permlane32_swap_b32 v221, v223
  v_mul_f32 v176, s59, v176
  v_mul_f32 v177, s59, v177
  v_mul_f32 v178, s59, v178
  v_mul_f32 v179, s59, v179
  v_mul_f32 v180, s59, v180
  v_mul_f32 v181, s59, v181
  v_mul_f32 v182, s59, v182
  v_mul_f32 v183, s59, v183
  v_permlane16_swap_b32 v220, v222
  v_permlane16_swap_b32 v221, v223
  v_cvt_pk_bf16_f32 v216, v176, v177
  v_cvt_pk_bf16_f32 v217, v178, v179
  v_cvt_pk_bf16_f32 v218, v180, v181
  v_cvt_pk_bf16_f32 v219, v182, v183
  s_nop 0
  v_permlane32_swap_b32 v216, v218
  v_permlane32_swap_b32 v217, v219
  v_mul_f32 v168, s59, v168
  v_mul_f32 v169, s59, v169
  v_mul_f32 v170, s59, v170
  v_mul_f32 v171, s59, v171
  v_mul_f32 v172, s59, v172
  v_mul_f32 v173, s59, v173
  v_mul_f32 v174, s59, v174
  v_mul_f32 v175, s59, v175
  v_permlane16_swap_b32 v216, v218
  v_permlane16_swap_b32 v217, v219
  v_cvt_pk_bf16_f32 v212, v168, v169
  v_cvt_pk_bf16_f32 v213, v170, v171
  v_cvt_pk_bf16_f32 v214, v172, v173
  v_cvt_pk_bf16_f32 v215, v174, v175
  s_nop 0
  v_permlane32_swap_b32 v212, v214
  v_permlane32_swap_b32 v213, v215
  v_mul_f32 v160, s59, v160
  v_mul_f32 v161, s59, v161
  v_mul_f32 v162, s59, v162
  v_mul_f32 v163, s59, v163
  v_mul_f32 v164, s59, v164
  v_mul_f32 v165, s59, v165
  v_mul_f32 v166, s59, v166
  v_mul_f32 v167, s59, v167
  v_permlane16_swap_b32 v212, v214
  v_permlane16_swap_b32 v213, v215
  v_cvt_pk_bf16_f32 v208, v160, v161
  v_cvt_pk_bf16_f32 v209, v162, v163
  v_cvt_pk_bf16_f32 v210, v164, v165
  v_cvt_pk_bf16_f32 v211, v166, v167
  s_nop 0
  v_permlane32_swap_b32 v208, v210
  v_permlane32_swap_b32 v209, v211
  v_mul_f32 v152, s59, v152
  v_mul_f32 v153, s59, v153
  v_mul_f32 v154, s59, v154
  v_mul_f32 v155, s59, v155
  v_mul_f32 v156, s59, v156
  v_mul_f32 v157, s59, v157
  v_mul_f32 v158, s59, v158
  v_mul_f32 v159, s59, v159
  v_permlane16_swap_b32 v208, v210
  v_permlane16_swap_b32 v209, v211
  v_cvt_pk_bf16_f32 v204, v152, v153
  v_cvt_pk_bf16_f32 v205, v154, v155
  v_cvt_pk_bf16_f32 v206, v156, v157
  v_cvt_pk_bf16_f32 v207, v158, v159
  s_nop 0
  v_permlane32_swap_b32 v204, v206
  v_permlane32_swap_b32 v205, v207
  v_mul_f32 v144, s59, v144
  v_mul_f32 v145, s59, v145
  v_mul_f32 v146, s59, v146
  v_mul_f32 v147, s59, v147
  v_mul_f32 v148, s59, v148
  v_mul_f32 v149, s59, v149
  v_mul_f32 v150, s59, v150
  v_mul_f32 v151, s59, v151
  v_permlane16_swap_b32 v204, v206
  v_permlane16_swap_b32 v205, v207
  v_cvt_pk_bf16_f32 v200, v144, v145
  v_cvt_pk_bf16_f32 v201, v146, v147
  v_cvt_pk_bf16_f32 v202, v148, v149
  v_cvt_pk_bf16_f32 v203, v150, v151
  s_nop 0
  v_permlane32_swap_b32 v200, v202
  v_permlane32_swap_b32 v201, v203
  v_mul_f32 v136, s59, v136
  v_mul_f32 v137, s59, v137
  v_mul_f32 v138, s59, v138
  v_mul_f32 v139, s59, v139
  v_mul_f32 v140, s59, v140
  v_mul_f32 v141, s59, v141
  v_mul_f32 v142, s59, v142
  v_mul_f32 v143, s59, v143
  v_permlane16_swap_b32 v200, v202
  v_permlane16_swap_b32 v201, v203
  v_cvt_pk_bf16_f32 v196, v136, v137
  v_cvt_pk_bf16_f32 v197, v138, v139
  v_cvt_pk_bf16_f32 v198, v140, v141
  v_cvt_pk_bf16_f32 v199, v142, v143
  s_nop 0
  v_permlane32_swap_b32 v196, v198
  v_permlane32_swap_b32 v197, v199
  v_mul_f32 v128, s59, v128
  v_mul_f32 v129, s59, v129
  v_mul_f32 v130, s59, v130
  v_mul_f32 v131, s59, v131
  v_mul_f32 v132, s59, v132
  v_mul_f32 v133, s59, v133
  v_mul_f32 v134, s59, v134
  v_mul_f32 v135, s59, v135
  v_permlane16_swap_b32 v196, v198
  v_permlane16_swap_b32 v197, v199
  v_cvt_pk_bf16_f32 v192, v128, v129
  v_cvt_pk_bf16_f32 v193, v130, v131
  v_cvt_pk_bf16_f32 v194, v132, v133
  v_cvt_pk_bf16_f32 v195, v134, v135
  s_nop 0
  v_permlane32_swap_b32 v192, v194
  v_permlane32_swap_b32 v193, v195
  v_mul_f32 v120, s59, v120
  v_mul_f32 v121, s59, v121
  v_mul_f32 v122, s59, v122
  v_mul_f32 v123, s59, v123
  v_mul_f32 v124, s59, v124
  v_mul_f32 v125, s59, v125
  v_mul_f32 v126, s59, v126
  v_mul_f32 v127, s59, v127
  v_permlane16_swap_b32 v192, v194
  v_permlane16_swap_b32 v193, v195
  v_cvt_pk_bf16_f32 v188, v120, v121
  v_cvt_pk_bf16_f32 v189, v122, v123
  v_cvt_pk_bf16_f32 v190, v124, v125
  v_cvt_pk_bf16_f32 v191, v126, v127
  s_nop 0
  v_permlane32_swap_b32 v188, v190
  v_permlane32_swap_b32 v189, v191
  v_mul_f32 v112, s59, v112
  v_mul_f32 v113, s59, v113
  v_mul_f32 v114, s59, v114
  v_mul_f32 v115, s59, v115
  v_mul_f32 v116, s59, v116
  v_mul_f32 v117, s59, v117
  v_mul_f32 v118, s59, v118
  v_mul_f32 v119, s59, v119
  v_permlane16_swap_b32 v188, v190
  v_permlane16_swap_b32 v189, v191
  v_cvt_pk_bf16_f32 v184, v112, v113
  v_cvt_pk_bf16_f32 v185, v114, v115
  v_cvt_pk_bf16_f32 v186, v116, v117
  v_cvt_pk_bf16_f32 v187, v118, v119
  s_nop 0
  v_permlane32_swap_b32 v184, v186
  v_permlane32_swap_b32 v185, v187
  v_mul_f32 v104, s59, v104
  v_mul_f32 v105, s59, v105
  v_mul_f32 v106, s59, v106
  v_mul_f32 v107, s59, v107
  v_mul_f32 v108, s59, v108
  v_mul_f32 v109, s59, v109
  v_mul_f32 v110, s59, v110
  v_mul_f32 v111, s59, v111
  v_permlane16_swap_b32 v184, v186
  v_permlane16_swap_b32 v185, v187
  v_cvt_pk_bf16_f32 v180, v104, v105
  v_cvt_pk_bf16_f32 v181, v106, v107
  v_cvt_pk_bf16_f32 v182, v108, v109
  v_cvt_pk_bf16_f32 v183, v110, v111
  s_nop 0
  v_permlane32_swap_b32 v180, v182
  v_permlane32_swap_b32 v181, v183
  v_mul_f32 v96, s59, v96
  v_mul_f32 v97, s59, v97
  v_mul_f32 v98, s59, v98
  v_mul_f32 v99, s59, v99
  v_mul_f32 v100, s59, v100
  v_mul_f32 v101, s59, v101
  v_mul_f32 v102, s59, v102
  v_mul_f32 v103, s59, v103
  v_permlane16_swap_b32 v180, v182
  v_permlane16_swap_b32 v181, v183
  v_cvt_pk_bf16_f32 v176, v96, v97
  v_cvt_pk_bf16_f32 v177, v98, v99
  v_cvt_pk_bf16_f32 v178, v100, v101
  v_cvt_pk_bf16_f32 v179, v102, v103
  s_nop 0
  v_permlane32_swap_b32 v176, v178
  v_permlane32_swap_b32 v177, v179
  v_mul_f32 v88, s59, v88
  v_mul_f32 v89, s59, v89
  v_mul_f32 v90, s59, v90
  v_mul_f32 v91, s59, v91
  v_mul_f32 v92, s59, v92
  v_mul_f32 v93, s59, v93
  v_mul_f32 v94, s59, v94
  v_mul_f32 v95, s59, v95
  v_permlane16_swap_b32 v176, v178
  v_permlane16_swap_b32 v177, v179
  v_cvt_pk_bf16_f32 v172, v88, v89
  v_cvt_pk_bf16_f32 v173, v90, v91
  v_cvt_pk_bf16_f32 v174, v92, v93
  v_cvt_pk_bf16_f32 v175, v94, v95
  s_nop 0
  v_permlane32_swap_b32 v172, v174
  v_permlane32_swap_b32 v173, v175
  v_mul_f32 v80, s59, v80
  v_mul_f32 v81, s59, v81
  v_mul_f32 v82, s59, v82
  v_mul_f32 v83, s59, v83
  v_mul_f32 v84, s59, v84
  v_mul_f32 v85, s59, v85
  v_mul_f32 v86, s59, v86
  v_mul_f32 v87, s59, v87
  v_permlane16_swap_b32 v172, v174
  v_permlane16_swap_b32 v173, v175
  v_cvt_pk_bf16_f32 v168, v80, v81
  v_cvt_pk_bf16_f32 v169, v82, v83
  v_cvt_pk_bf16_f32 v170, v84, v85
  v_cvt_pk_bf16_f32 v171, v86, v87
  s_nop 0
  v_permlane32_swap_b32 v168, v170
  v_permlane32_swap_b32 v169, v171
  v_mul_f32 v72, s59, v72
  v_mul_f32 v73, s59, v73
  v_mul_f32 v74, s59, v74
  v_mul_f32 v75, s59, v75
  v_mul_f32 v76, s59, v76
  v_mul_f32 v77, s59, v77
  v_mul_f32 v78, s59, v78
  v_mul_f32 v79, s59, v79
  v_permlane16_swap_b32 v168, v170
  v_permlane16_swap_b32 v169, v171
  v_cvt_pk_bf16_f32 v164, v72, v73
  v_cvt_pk_bf16_f32 v165, v74, v75
  v_cvt_pk_bf16_f32 v166, v76, v77
  v_cvt_pk_bf16_f32 v167, v78, v79
  s_nop 0
  v_permlane32_swap_b32 v164, v166
  v_permlane32_swap_b32 v165, v167
  v_mul_f32 v64, s59, v64
  v_mul_f32 v65, s59, v65
  v_mul_f32 v66, s59, v66
  v_mul_f32 v67, s59, v67
  v_mul_f32 v68, s59, v68
  v_mul_f32 v69, s59, v69
  v_mul_f32 v70, s59, v70
  v_mul_f32 v71, s59, v71
  v_permlane16_swap_b32 v164, v166
  v_permlane16_swap_b32 v165, v167
  v_cvt_pk_bf16_f32 v160, v64, v65
  v_cvt_pk_bf16_f32 v161, v66, v67
  v_cvt_pk_bf16_f32 v162, v68, v69
  v_cvt_pk_bf16_f32 v163, v70, v71
  s_nop 0
  v_permlane32_swap_b32 v160, v162
  v_permlane32_swap_b32 v161, v163
  s_nop 1
  v_permlane16_swap_b32 v160, v162
  v_permlane16_swap_b32 v161, v163
  s_nop 1
  s_waitcnt lgkmcnt(3)
  v_mfma_f32_16x16x32_bf16 v[96:99], a[192:195], v[160:163], 0
  ds_read_b128 a[212:215], v18 offset:256
  s_add_u32 m0, s62, 24576
  v_mfma_f32_16x16x32_bf16 v[100:103], a[192:195], v[184:187], 0
  buffer_load_dwordx4 v25, s[16:19], s60 offen offset:0 nt lds
  v_mfma_f32_16x16x32_bf16 v[104:107], a[192:195], v[208:211], 0
  v_mfma_f32_16x16x32_bf16 v[108:111], a[192:195], v[232:235], 0
  v_mfma_f32_16x16x32_bf16 v[96:99], a[196:199], v[164:167], v[96:99]
  ds_read_b128 a[216:219], v17 offset:6144
  v_mfma_f32_16x16x32_bf16 v[100:103], a[196:199], v[188:191], v[100:103]
  v_mfma_f32_16x16x32_bf16 v[104:107], a[196:199], v[212:215], v[104:107]
  v_mfma_f32_16x16x32_bf16 v[108:111], a[196:199], v[236:239], v[108:111]
  buffer_load_dwordx4 v26, s[16:19], s60 offen offset:1024 nt lds
  s_waitcnt lgkmcnt(3)
  v_mfma_f32_16x16x32_bf16 v[96:99], a[200:203], v[168:171], v[96:99]
  ds_read_b128 a[220:223], v18 offset:6144
  v_mfma_f32_16x16x32_bf16 v[100:103], a[200:203], v[192:195], v[100:103]
  v_mfma_f32_16x16x32_bf16 v[104:107], a[200:203], v[216:219], v[104:107]
  v_mfma_f32_16x16x32_bf16 v[108:111], a[200:203], v[240:243], v[108:111]
  v_mfma_f32_16x16x32_bf16 v[96:99], a[204:207], v[172:175], v[96:99]
  ds_read_b128 a[224:227], v17 offset:6272
  v_mfma_f32_16x16x32_bf16 v[100:103], a[204:207], v[196:199], v[100:103]
  buffer_load_dwordx4 v27, s[16:19], s60 offen offset:2048 nt lds
  v_mfma_f32_16x16x32_bf16 v[104:107], a[204:207], v[220:223], v[104:107]
  s_add_u32 s60, s60, 12288
  s_add_u32 m0, s64, 36864
  v_mfma_f32_16x16x32_bf16 v[108:111], a[204:207], v[244:247], v[108:111]
  s_waitcnt lgkmcnt(3)
  v_mfma_f32_16x16x32_bf16 v[96:99], a[208:211], v[176:179], v[96:99]
  ds_read_b128 a[228:231], v18 offset:6272
  v_mfma_f32_16x16x32_bf16 v[100:103], a[208:211], v[200:203], v[100:103]
  v_mfma_f32_16x16x32_bf16 v[104:107], a[208:211], v[224:227], v[104:107]
  v_mfma_f32_16x16x32_bf16 v[108:111], a[208:211], v[248:251], v[108:111]
  buffer_load_dwordx4 v25, s[20:23], s61 offen offset:0 nt lds
  v_mfma_f32_16x16x32_bf16 v[96:99], a[212:215], v[180:183], v[96:99]
  ds_read_b128 a[232:235], v17 offset:6400
  v_mfma_f32_16x16x32_bf16 v[100:103], a[212:215], v[204:207], v[100:103]
  v_mfma_f32_16x16x32_bf16 v[104:107], a[212:215], v[228:231], v[104:107]
  v_mfma_f32_16x16x32_bf16 v[108:111], a[212:215], v[252:255], v[108:111]
  s_waitcnt lgkmcnt(3)
  v_mfma_f32_16x16x32_bf16 v[112:115], a[216:219], v[160:163], 0
  ds_read_b128 a[236:239], v18 offset:6400
  v_mfma_f32_16x16x32_bf16 v[116:119], a[216:219], v[184:187], 0
  buffer_load_dwordx4 v26, s[20:23], s61 offen offset:1024 nt lds
  v_mfma_f32_16x16x32_bf16 v[120:123], a[216:219], v[208:211], 0
  v_mfma_f32_16x16x32_bf16 v[124:127], a[216:219], v[232:235], 0
  v_mfma_f32_16x16x32_bf16 v[112:115], a[220:223], v[164:167], v[112:115]
  v_mfma_f32_16x16x32_bf16 v[116:119], a[220:223], v[188:191], v[116:119]
  v_mfma_f32_16x16x32_bf16 v[120:123], a[220:223], v[212:215], v[120:123]
  v_mfma_f32_16x16x32_bf16 v[124:127], a[220:223], v[236:239], v[124:127]
  buffer_load_dwordx4 v27, s[20:23], s61 offen offset:2048 nt lds
  s_waitcnt lgkmcnt(2)
  v_mfma_f32_16x16x32_bf16 v[112:115], a[224:227], v[168:171], v[112:115]
  s_add_u32 s61, s61, 12288
  v_mfma_f32_16x16x32_bf16 v[116:119], a[224:227], v[192:195], v[116:119]
  v_mfma_f32_16x16x32_bf16 v[120:123], a[224:227], v[216:219], v[120:123]
  v_mfma_f32_16x16x32_bf16 v[124:127], a[224:227], v[240:243], v[124:127]
  v_mfma_f32_16x16x32_bf16 v[112:115], a[228:231], v[172:175], v[112:115]
  v_mfma_f32_16x16x32_bf16 v[116:119], a[228:231], v[196:199], v[116:119]
  v_mfma_f32_16x16x32_bf16 v[120:123], a[228:231], v[220:223], v[120:123]
  v_mfma_f32_16x16x32_bf16 v[124:127], a[228:231], v[244:247], v[124:127]
  s_waitcnt lgkmcnt(0)
  v_mfma_f32_16x16x32_bf16 v[112:115], a[232:235], v[176:179], v[112:115]
  v_mfma_f32_16x16x32_bf16 v[116:119], a[232:235], v[200:203], v[116:119]
  v_mfma_f32_16x16x32_bf16 v[120:123], a[232:235], v[224:227], v[120:123]
  v_mfma_f32_16x16x32_bf16 v[124:127], a[232:235], v[248:251], v[124:127]
  v_mfma_f32_16x16x32_bf16 v[112:115], a[236:239], v[180:183], v[112:115]
  v_mfma_f32_16x16x32_bf16 v[116:119], a[236:239], v[204:207], v[116:119]
  v_mfma_f32_16x16x32_bf16 v[120:123], a[236:239], v[228:231], v[120:123]
  v_mfma_f32_16x16x32_bf16 v[124:127], a[236:239], v[252:255], v[124:127]
  s_nop 7
  s_nop 3
  s_barrier
  ds_read_b128 a[192:195], v17 offset:24576
  ds_read_b128 a[196:199], v18 offset:24576
  ds_read_b128 a[200:203], v17 offset:24704
  ds_read_b128 a[204:207], v18 offset:24704
  ds_read_b128 a[208:211], v17 offset:24832
  v_max3_f32 v92, v96, v97, v98
  v_max3_f32 v92, v92, v99, v112
  v_max3_f32 v92, v92, v113, v114
  v_max_f32 v92, v92, v115
  v_mov_b32 v1, v92
  s_nop 1
  v_permlane32_swap_b32 v92, v1
  v_max_f32 v92, v92, v1
  v_mov_b32 v1, v92
  s_nop 1
  v_permlane16_swap_b32 v92, v1
  v_max_f32 v92, v92, v1
  v_mov_b32 v84, v92
  v_sub_f32 v88, 0, v92
  v_mov_b32 v80, 0
  v_mov_b32 v64, v88
  v_mov_b32 v65, v88
  v_mov_b32 v66, v88
  v_mov_b32 v67, v88
  v_max3_f32 v93, v100, v101, v102
  v_max3_f32 v93, v93, v103, v116
  v_max3_f32 v93, v93, v117, v118
  v_max_f32 v93, v93, v119
  v_mov_b32 v2, v93
  s_nop 1
  v_permlane32_swap_b32 v93, v2
  v_max_f32 v93, v93, v2
  v_mov_b32 v2, v93
  s_nop 1
  v_permlane16_swap_b32 v93, v2
  v_max_f32 v93, v93, v2
  v_mov_b32 v85, v93
  v_sub_f32 v89, 0, v93
  v_mov_b32 v81, 0
  v_mov_b32 v68, v89
  v_mov_b32 v69, v89
  v_mov_b32 v70, v89
  v_mov_b32 v71, v89
  v_max3_f32 v94, v104, v105, v106
  v_max3_f32 v94, v94, v107, v120
  v_max3_f32 v94, v94, v121, v122
  v_max_f32 v94, v94, v123
  v_mov_b32 v3, v94
  s_nop 1
  v_permlane32_swap_b32 v94, v3
  v_max_f32 v94, v94, v3
  v_mov_b32 v3, v94
  s_nop 1
  v_permlane16_swap_b32 v94, v3
  v_max_f32 v94, v94, v3
  v_mov_b32 v86, v94
  v_sub_f32 v90, 0, v94
  v_mov_b32 v82, 0
  v_mov_b32 v72, v90
  v_mov_b32 v73, v90
  v_mov_b32 v74, v90
  v_mov_b32 v75, v90
  v_max3_f32 v95, v108, v109, v110
  v_max3_f32 v95, v95, v111, v124
  v_max3_f32 v95, v95, v125, v126
  v_max_f32 v95, v95, v127
  v_mov_b32 v4, v95
  s_nop 1
  v_permlane32_swap_b32 v95, v4
  v_max_f32 v95, v95, v4
  v_mov_b32 v4, v95
  s_nop 1
  v_permlane16_swap_b32 v95, v4
  v_max_f32 v95, v95, v4
  v_mov_b32 v87, v95
  v_sub_f32 v91, 0, v95
  v_mov_b32 v83, 0
  v_mov_b32 v76, v91
  v_mov_b32 v77, v91
  v_mov_b32 v78, v91
  v_mov_b32 v79, v91
  v_add_f32 v96, v96, v88
  v_add_f32 v97, v97, v88
  v_add_f32 v98, v98, v88
  v_add_f32 v99, v99, v88
  v_add_f32 v100, v100, v89
  v_add_f32 v101, v101, v89
  v_add_f32 v102, v102, v89
  v_add_f32 v103, v103, v89
  v_add_f32 v104, v104, v90
  v_add_f32 v105, v105, v90
  v_add_f32 v106, v106, v90
  v_add_f32 v107, v107, v90
  v_add_f32 v108, v108, v91
  v_add_f32 v109, v109, v91
  v_add_f32 v110, v110, v91
  v_add_f32 v111, v111, v91
  v_add_f32 v112, v112, v88
  v_add_f32 v113, v113, v88
  v_add_f32 v114, v114, v88
  v_add_f32 v115, v115, v88
  v_add_f32 v116, v116, v89
  v_add_f32 v117, v117, v89
  v_add_f32 v118, v118, v89
  v_add_f32 v119, v119, v89
  v_add_f32 v120, v120, v90
  v_add_f32 v121, v121, v90
  v_add_f32 v122, v122, v90
  v_add_f32 v123, v123, v90
  v_add_f32 v124, v124, v91
  v_add_f32 v125, v125, v91
  v_add_f32 v126, v126, v91
  v_add_f32 v127, v127, v91
  v_exp_f32 v96, v96
  v_exp_f32 v97, v97
  v_add_f32 v80, v80, v96
  v_exp_f32 v98, v98
  v_add_f32 v80, v80, v97
  v_exp_f32 v99, v99
  v_add_f32 v80, v80, v98
  v_exp_f32 v100, v100
  v_add_f32 v80, v80, v99
  v_exp_f32 v101, v101
  v_add_f32 v81, v81, v100
  v_exp_f32 v102, v102
  v_add_f32 v81, v81, v101
  v_exp_f32 v103, v103
  v_add_f32 v81, v81, v102
  v_exp_f32 v104, v104
  v_add_f32 v81, v81, v103
  v_exp_f32 v105, v105
  v_add_f32 v82, v82, v104
  v_exp_f32 v106, v106
  v_add_f32 v82, v82, v105
  v_exp_f32 v107, v107
  v_add_f32 v82, v82, v106
  v_exp_f32 v108, v108
  v_add_f32 v82, v82, v107
  v_exp_f32 v109, v109
  v_add_f32 v83, v83, v108
  v_exp_f32 v110, v110
  v_add_f32 v83, v83, v109
  v_exp_f32 v111, v111
  v_add_f32 v83, v83, v110
  v_exp_f32 v112, v112
  v_add_f32 v83, v83, v111
  v_exp_f32 v113, v113
  v_add_f32 v80, v80, v112
  v_exp_f32 v114, v114
  v_add_f32 v80, v80, v113
  v_exp_f32 v115, v115
  v_add_f32 v80, v80, v114
  v_add_f32 v80, v80, v115
  s_waitcnt lgkmcnt(3)
  v_mfma_f32_16x16x32_bf16 v[128:131], a[192:195], v[160:163], v[64:67]
  ds_read_b128 a[212:215], v18 offset:24832
  s_mov_b32 m0, s63
  v_cvt_pk_bf16_f32 v48, v96, v97
  v_mfma_f32_16x16x32_bf16 v[132:135], a[192:195], v[184:187], v[68:71]
  buffer_load_dwordx4 v25, s[16:19], s60 offen offset:0 nt lds
  v_mfma_f32_16x16x32_bf16 v[136:139], a[192:195], v[208:211], v[72:75]
  v_exp_f32 v116, v116
  v_mfma_f32_16x16x32_bf16 v[140:143], a[192:195], v[232:235], v[76:79]
  v_exp_f32 v117, v117
  v_mfma_f32_16x16x32_bf16 v[128:131], a[196:199], v[164:167], v[128:131]
  ds_read_b128 a[216:219], v17 offset:30720
  v_cvt_pk_bf16_f32 v49, v98, v99
  v_mfma_f32_16x16x32_bf16 v[132:135], a[196:199], v[188:191], v[132:135]
  v_add_f32 v81, v81, v116
  v_cvt_pk_bf16_f32 v52, v100, v101
  v_mfma_f32_16x16x32_bf16 v[136:139], a[196:199], v[212:215], v[136:139]
  v_exp_f32 v118, v118
  v_mfma_f32_16x16x32_bf16 v[140:143], a[196:199], v[236:239], v[140:143]
  buffer_load_dwordx4 v26, s[16:19], s60 offen offset:1024 nt lds
  s_waitcnt lgkmcnt(3)
  v_mfma_f32_16x16x32_bf16 v[128:131], a[200:203], v[168:171], v[128:131]
  ds_read_b128 a[220:223], v18 offset:30720
  v_cvt_pk_bf16_f32 v53, v102, v103
  v_mfma_f32_16x16x32_bf16 v[132:135], a[200:203], v[192:195], v[132:135]
  v_add_f32 v81, v81, v117
  v_cvt_pk_bf16_f32 v56, v104, v105
  v_mfma_f32_16x16x32_bf16 v[136:139], a[200:203], v[216:219], v[136:139]
  v_exp_f32 v119, v119
  v_mfma_f32_16x16x32_bf16 v[140:143], a[200:203], v[240:243], v[140:143]
  v_cvt_pk_bf16_f32 v57, v106, v107
  v_add_f32 v81, v81, v118
  v_mfma_f32_16x16x32_bf16 v[128:131], a[204:207], v[172:175], v[128:131]
  ds_read_b128 a[224:227], v17 offset:30848
  v_cvt_pk_bf16_f32 v60, v108, v109
  v_mfma_f32_16x16x32_bf16 v[132:135], a[204:207], v[196:199], v[132:135]
  buffer_load_dwordx4 v27, s[16:19], s60 offen offset:2048 nt lds
  v_mfma_f32_16x16x32_bf16 v[136:139], a[204:207], v[220:223], v[136:139]
  s_add_u32 s60, s60, 12288
  s_add_u32 m0, s62, 12288
  v_exp_f32 v120, v120
  v_mfma_f32_16x16x32_bf16 v[140:143], a[204:207], v[244:247], v[140:143]
  v_cvt_pk_bf16_f32 v61, v110, v111
  v_add_f32 v81, v81, v119
  s_waitcnt lgkmcnt(3)
  v_mfma_f32_16x16x32_bf16 v[128:131], a[208:211], v[176:179], v[128:131]
  ds_read_b128 a[228:231], v18 offset:30848
  v_add_f32 v82, v82, v120
  v_mfma_f32_16x16x32_bf16 v[132:135], a[208:211], v[200:203], v[132:135]
  v_exp_f32 v121, v121
  v_mfma_f32_16x16x32_bf16 v[136:139], a[208:211], v[224:227], v[136:139]
  v_exp_f32 v122, v122
  v_mfma_f32_16x16x32_bf16 v[140:143], a[208:211], v[248:251], v[140:143]
  buffer_load_dwordx4 v25, s[20:23], s61 offen offset:0 nt lds
  v_mfma_f32_16x16x32_bf16 v[128:131], a[212:215], v[180:183], v[128:131]
  ds_read_b128 a[232:235], v17 offset:30976
  v_add_f32 v82, v82, v121
  v_mfma_f32_16x16x32_bf16 v[132:135], a[212:215], v[204:207], v[132:135]
  v_exp_f32 v123, v123
  v_mfma_f32_16x16x32_bf16 v[136:139], a[212:215], v[228:231], v[136:139]
  v_add_f32 v82, v82, v122
  v_add_f32 v82, v82, v123
  v_mfma_f32_16x16x32_bf16 v[140:143], a[212:215], v[252:255], v[140:143]
  v_exp_f32 v124, v124
  s_waitcnt lgkmcnt(3)
  v_mfma_f32_16x16x32_bf16 v[144:147], a[216:219], v[160:163], v[64:67]
  ds_read_b128 a[236:239], v18 offset:30976
  v_add_f32 v83, v83, v124
  v_mfma_f32_16x16x32_bf16 v[148:151], a[216:219], v[184:187], v[68:71]
  buffer_load_dwordx4 v26, s[20:23], s61 offen offset:1024 nt lds
  v_mfma_f32_16x16x32_bf16 v[152:155], a[216:219], v[208:211], v[72:75]
  v_exp_f32 v125, v125
  v_mfma_f32_16x16x32_bf16 v[156:159], a[216:219], v[232:235], v[76:79]
  v_exp_f32 v126, v126
  v_mfma_f32_16x16x32_bf16 v[144:147], a[220:223], v[164:167], v[144:147]
  ds_read_b64_tr_b16 a[192:193], v21 offset:12288
  v_add_f32 v83, v83, v125
  v_mfma_f32_16x16x32_bf16 v[148:151], a[220:223], v[188:191], v[148:151]
  v_exp_f32 v127, v127
  v_mfma_f32_16x16x32_bf16 v[152:155], a[220:223], v[212:215], v[152:155]
  ds_read_b64_tr_b16 a[194:195], v21 offset:18432
  v_add_f32 v83, v83, v126
  v_mfma_f32_16x16x32_bf16 v[156:159], a[220:223], v[236:239], v[156:159]
  buffer_load_dwordx4 v27, s[20:23], s61 offen offset:2048 nt lds
  s_waitcnt lgkmcnt(4)
  v_mfma_f32_16x16x32_bf16 v[144:147], a[224:227], v[168:171], v[144:147]
  ds_read_b64_tr_b16 a[196:197], v22 offset:12288
  s_add_u32 s61, s61, 12288
  v_add_f32 v83, v83, v127
  v_mfma_f32_16x16x32_bf16 v[148:151], a[224:227], v[192:195], v[148:151]
  v_cvt_pk_bf16_f32 v50, v112, v113
  v_cvt_pk_bf16_f32 v51, v114, v115
  v_mfma_f32_16x16x32_bf16 v[152:155], a[224:227], v[216:219], v[152:155]
  ds_read_b64_tr_b16 a[198:199], v22 offset:18432
  v_cvt_pk_bf16_f32 v54, v116, v117
  v_mfma_f32_16x16x32_bf16 v[156:159], a[224:227], v[240:243], v[156:159]
  v_cvt_pk_bf16_f32 v55, v118, v119
  v_cvt_pk_bf16_f32 v58, v120, v121
  v_mfma_f32_16x16x32_bf16 v[144:147], a[228:231], v[172:175], v[144:147]
  ds_read_b64_tr_b16 a[200:201], v23 offset:12288
  v_cvt_pk_bf16_f32 v59, v122, v123
  v_mfma_f32_16x16x32_bf16 v[148:151], a[228:231], v[196:199], v[148:151]
  v_cvt_pk_bf16_f32 v62, v124, v125
  v_cvt_pk_bf16_f32 v63, v126, v127
  v_mfma_f32_16x16x32_bf16 v[152:155], a[228:231], v[220:223], v[152:155]
  ds_read_b64_tr_b16 a[202:203], v23 offset:18432
  v_mfma_f32_16x16x32_bf16 v[156:159], a[228:231], v[244:247], v[156:159]
  s_waitcnt lgkmcnt(6)
  v_mfma_f32_16x16x32_bf16 v[144:147], a[232:235], v[176:179], v[144:147]
  ds_read_b64_tr_b16 a[204:205], v24 offset:12288
  v_mfma_f32_16x16x32_bf16 v[148:151], a[232:235], v[200:203], v[148:151]
  v_mfma_f32_16x16x32_bf16 v[152:155], a[232:235], v[224:227], v[152:155]
  ds_read_b64_tr_b16 a[206:207], v24 offset:18432
  v_mfma_f32_16x16x32_bf16 v[156:159], a[232:235], v[248:251], v[156:159]
  v_mfma_f32_16x16x32_bf16 v[144:147], a[236:239], v[180:183], v[144:147]
  ds_read_b64_tr_b16 a[208:209], v21 offset:12416
  v_mfma_f32_16x16x32_bf16 v[148:151], a[236:239], v[204:207], v[148:151]
  v_mfma_f32_16x16x32_bf16 v[152:155], a[236:239], v[228:231], v[152:155]
  ds_read_b64_tr_b16 a[210:211], v21 offset:18560
  v_mfma_f32_16x16x32_bf16 v[156:159], a[236:239], v[252:255], v[156:159]
  s_waitcnt lgkmcnt(6)
  v_mfma_f32_16x16x32_bf16 a[0:3], a[192:195], v[48:51], 0
  ds_read_b64_tr_b16 a[212:213], v22 offset:12416
  s_sub_u32 s79, s64, s63
  v_add_u32 v17, s79, v17
  v_mfma_f32_16x16x32_bf16 a[4:7], a[192:195], v[52:55], 0
  v_add_u32 v18, s79, v18
  v_mfma_f32_16x16x32_bf16 a[8:11], a[192:195], v[56:59], 0
  ds_read_b64_tr_b16 a[214:215], v22 offset:18560
  v_mfma_f32_16x16x32_bf16 a[12:15], a[192:195], v[60:63], 0
  v_exp_f32 v128, v128
  v_mfma_f32_16x16x32_bf16 a[16:19], a[196:199], v[48:51], 0
  ds_read_b64_tr_b16 a[216:217], v23 offset:12416
  v_add_f32 v80, v80, v128
  v_mfma_f32_16x16x32_bf16 a[20:23], a[196:199], v[52:55], 0
  v_exp_f32 v129, v129
  v_mfma_f32_16x16x32_bf16 a[24:27], a[196:199], v[56:59], 0
  ds_read_b64_tr_b16 a[218:219], v23 offset:18560
  v_add_f32 v80, v80, v129
  v_mfma_f32_16x16x32_bf16 a[28:31], a[196:199], v[60:63], 0
  v_exp_f32 v130, v130
  s_waitcnt lgkmcnt(6)
  v_mfma_f32_16x16x32_bf16 a[32:35], a[200:203], v[48:51], 0
  ds_read_b64_tr_b16 a[220:221], v24 offset:12416
  v_add_f32 v80, v80, v130
  v_mfma_f32_16x16x32_bf16 a[36:39], a[200:203], v[52:55], 0
  v_exp_f32 v131, v131
  v_mfma_f32_16x16x32_bf16 a[40:43], a[200:203], v[56:59], 0
  ds_read_b64_tr_b16 a[222:223], v24 offset:18560
  v_add_f32 v80, v80, v131
  v_mfma_f32_16x16x32_bf16 a[44:47], a[200:203], v[60:63], 0
  v_exp_f32 v132, v132
  v_mfma_f32_16x16x32_bf16 a[48:51], a[204:207], v[48:51], 0
  ds_read_b64_tr_b16 a[224:225], v21 offset:12544
  v_add_f32 v81, v81, v132
  v_mfma_f32_16x16x32_bf16 a[52:55], a[204:207], v[52:55], 0
  v_exp_f32 v133, v133
  v_mfma_f32_16x16x32_bf16 a[56:59], a[204:207], v[56:59], 0
  ds_read_b64_tr_b16 a[226:227], v21 offset:18688
  v_add_f32 v81, v81, v133
  v_mfma_f32_16x16x32_bf16 a[60:63], a[204:207], v[60:63], 0
  v_exp_f32 v134, v134
  s_waitcnt lgkmcnt(6)
  v_mfma_f32_16x16x32_bf16 a[64:67], a[208:211], v[48:51], 0
  ds_read_b64_tr_b16 a[228:229], v22 offset:12544
  v_add_f32 v81, v81, v134
  v_mfma_f32_16x16x32_bf16 a[68:71], a[208:211], v[52:55], 0
  v_exp_f32 v135, v135
  v_mfma_f32_16x16x32_bf16 a[72:75], a[208:211], v[56:59], 0
  ds_read_b64_tr_b16 a[230:231], v22 offset:18688
  v_add_f32 v81, v81, v135
  v_mfma_f32_16x16x32_bf16 a[76:79], a[208:211], v[60:63], 0
  v_exp_f32 v136, v136
  v_mfma_f32_16x16x32_bf16 a[80:83], a[212:215], v[48:51], 0
  ds_read_b64_tr_b16 a[232:233], v23 offset:12544
  s_waitcnt vmcnt(12)
  s_barrier
  v_add_f32 v82, v82, v136
  v_mfma_f32_16x16x32_bf16 a[84:87], a[212:215], v[52:55], 0
  v_exp_f32 v137, v137
  v_mfma_f32_16x16x32_bf16 a[88:91], a[212:215], v[56:59], 0
  ds_read_b64_tr_b16 a[234:235], v23 offset:18688
  v_add_f32 v82, v82, v137
  v_mfma_f32_16x16x32_bf16 a[92:95], a[212:215], v[60:63], 0
  v_exp_f32 v138, v138
  s_waitcnt lgkmcnt(6)
  v_mfma_f32_16x16x32_bf16 a[96:99], a[216:219], v[48:51], 0
  ds_read_b64_tr_b16 a[236:237], v24 offset:12544
  v_add_f32 v82, v82, v138
  v_mfma_f32_16x16x32_bf16 a[100:103], a[216:219], v[52:55], 0
  v_exp_f32 v139, v139
  v_mfma_f32_16x16x32_bf16 a[104:107], a[216:219], v[56:59], 0
  ds_read_b64_tr_b16 a[238:239], v24 offset:18688
  v_add_f32 v82, v82, v139
  v_mfma_f32_16x16x32_bf16 a[108:111], a[216:219], v[60:63], 0
  v_exp_f32 v140, v140
  v_mfma_f32_16x16x32_bf16 a[112:115], a[220:223], v[48:51], 0
  ds_read_b128 a[192:195], v17 offset:0
  v_add_f32 v83, v83, v140
  v_mfma_f32_16x16x32_bf16 a[116:119], a[220:223], v[52:55], 0
  v_exp_f32 v141, v141
  v_mfma_f32_16x16x32_bf16 a[120:123], a[220:223], v[56:59], 0
  v_exp_f32 v142, v142
  v_mfma_f32_16x16x32_bf16 a[124:127], a[220:223], v[60:63], 0
  v_add_f32 v83, v83, v141
  v_add_f32 v83, v83, v142
  s_waitcnt lgkmcnt(5)
  v_mfma_f32_16x16x32_bf16 a[128:131], a[224:227], v[48:51], 0
  ds_read_b128 a[196:199], v18 offset:0
  v_mfma_f32_16x16x32_bf16 a[132:135], a[224:227], v[52:55], 0
  v_exp_f32 v143, v143
  v_mfma_f32_16x16x32_bf16 a[136:139], a[224:227], v[56:59], 0
  v_exp_f32 v144, v144
  v_mfma_f32_16x16x32_bf16 a[140:143], a[224:227], v[60:63], 0
  v_add_f32 v83, v83, v143
  v_add_f32 v80, v80, v144
  v_mfma_f32_16x16x32_bf16 a[144:147], a[228:231], v[48:51], 0
  ds_read_b128 a[200:203], v17 offset:128
  v_mfma_f32_16x16x32_bf16 a[148:151], a[228:231], v[52:55], 0
  v_exp_f32 v145, v145
  v_mfma_f32_16x16x32_bf16 a[152:155], a[228:231], v[56:59], 0
  v_exp_f32 v146, v146
  v_mfma_f32_16x16x32_bf16 a[156:159], a[228:231], v[60:63], 0
  v_add_f32 v80, v80, v145
  v_add_f32 v80, v80, v146
  s_waitcnt lgkmcnt(3)
  v_mfma_f32_16x16x32_bf16 a[160:163], a[232:235], v[48:51], 0
  ds_read_b128 a[204:207], v18 offset:128
  v_mfma_f32_16x16x32_bf16 a[164:167], a[232:235], v[52:55], 0
  v_exp_f32 v147, v147
  v_mfma_f32_16x16x32_bf16 a[168:171], a[232:235], v[56:59], 0
  v_add_f32 v80, v80, v147
  v_mfma_f32_16x16x32_bf16 a[172:175], a[232:235], v[60:63], 0
  v_mfma_f32_16x16x32_bf16 a[176:179], a[236:239], v[48:51], 0
  ds_read_b128 a[208:211], v17 offset:256
  v_mfma_f32_16x16x32_bf16 a[180:183], a[236:239], v[52:55], 0
  v_mfma_f32_16x16x32_bf16 a[184:187], a[236:239], v[56:59], 0
  v_mfma_f32_16x16x32_bf16 a[188:191], a[236:239], v[60:63], 0
  s_mov_b32 s68, s62
  s_mov_b32 s62, s63
  s_mov_b32 s63, s64
  s_mov_b32 s64, s68
  s_mov_b32 s65, 12
.p2align 3
K1_LOOP:
  s_waitcnt lgkmcnt(3)
  v_mfma_f32_16x16x32_bf16 v[96:99], a[192:195], v[160:163], v[64:67]
  ds_read_b128 a[212:215], v18 offset:256
  s_add_u32 m0, s62, 24576
  v_cvt_pk_bf16_f32 v48, v128, v129
  v_mfma_f32_16x16x32_bf16 v[100:103], a[192:195], v[184:187], v[68:71]
  buffer_load_dwordx4 v25, s[16:19], s60 offen offset:0 nt lds
  v_mfma_f32_16x16x32_bf16 v[104:107], a[192:195], v[208:211], v[72:75]
  v_exp_f32 v148, v148
  v_mfma_f32_16x16x32_bf16 v[108:111], a[192:195], v[232:235], v[76:79]
  v_exp_f32 v149, v149
  v_mfma_f32_16x16x32_bf16 v[96:99], a[196:199], v[164:167], v[96:99]
  ds_read_b128 a[216:219], v17 offset:6144
  v_cvt_pk_bf16_f32 v49, v130, v131
  v_mfma_f32_16x16x32_bf16 v[100:103], a[196:199], v[188:191], v[100:103]
  v_add_f32 v81, v81, v148
  v_cvt_pk_bf16_f32 v52, v132, v133
  v_mfma_f32_16x16x32_bf16 v[104:107], a[196:199], v[212:215], v[104:107]
  v_exp_f32 v150, v150
  v_mfma_f32_16x16x32_bf16 v[108:111], a[196:199], v[236:239], v[108:111]
  buffer_load_dwordx4 v26, s[16:19], s60 offen offset:1024 nt lds
  s_waitcnt lgkmcnt(3)
  v_mfma_f32_16x16x32_bf16 v[96:99], a[200:203], v[168:171], v[96:99]
  ds_read_b128 a[220:223], v18 offset:6144
  v_cvt_pk_bf16_f32 v53, v134, v135
  v_mfma_f32_16x16x32_bf16 v[100:103], a[200:203], v[192:195], v[100:103]
  v_add_f32 v81, v81, v149
  v_cvt_pk_bf16_f32 v56, v136, v137
  v_mfma_f32_16x16x32_bf16 v[104:107], a[200:203], v[216:219], v[104:107]
  v_exp_f32 v151, v151
  v_mfma_f32_16x16x32_bf16 v[108:111], a[200:203], v[240:243], v[108:111]
  v_cvt_pk_bf16_f32 v57, v138, v139
  v_add_f32 v81, v81, v150
  v_mfma_f32_16x16x32_bf16 v[96:99], a[204:207], v[172:175], v[96:99]
  ds_read_b128 a[224:227], v17 offset:6272
  v_cvt_pk_bf16_f32 v60, v140, v141
  v_mfma_f32_16x16x32_bf16 v[100:103], a[204:207], v[196:199], v[100:103]
  buffer_load_dwordx4 v27, s[16:19], s60 offen offset:2048 nt lds
  v_mfma_f32_16x16x32_bf16 v[104:107], a[204:207], v[220:223], v[104:107]
  s_add_u32 s60, s60, 12288
  s_add_u32 m0, s64, 36864
  v_exp_f32 v152, v152
  v_mfma_f32_16x16x32_bf16 v[108:111], a[204:207], v[244:247], v[108:111]
  v_cvt_pk_bf16_f32 v61, v142, v143
  v_add_f32 v81, v81, v151
  s_waitcnt lgkmcnt(3)
  v_mfma_f32_16x16x32_bf16 v[96:99], a[208:211], v[176:179], v[96:99]
  ds_read_b128 a[228:231], v18 offset:6272
  v_add_f32 v82, v82, v152
  v_mfma_f32_16x16x32_bf16 v[100:103], a[208:211], v[200:203], v[100:103]
  v_exp_f32 v153, v153
  v_mfma_f32_16x16x32_bf16 v[104:107], a[208:211], v[224:227], v[104:107]
  v_exp_f32 v154, v154
  v_mfma_f32_16x16x32_bf16 v[108:111], a[208:211], v[248:251], v[108:111]
  buffer_load_dwordx4 v25, s[20:23], s61 offen offset:0 nt lds
  v_mfma_f32_16x16x32_bf16 v[96:99], a[212:215], v[180:183], v[96:99]
  ds_read_b128 a[232:235], v17 offset:6400
  v_add_f32 v82, v82, v153
  v_mfma_f32_16x16x32_bf16 v[100:103], a[212:215], v[204:207], v[100:103]
  v_exp_f32 v155, v155
  v_mfma_f32_16x16x32_bf16 v[104:107], a[212:215], v[228:231], v[104:107]
  v_add_f32 v82, v82, v154
  v_add_f32 v82, v82, v155
  v_mfma_f32_16x16x32_bf16 v[108:111], a[212:215], v[252:255], v[108:111]
  v_exp_f32 v156, v156
  s_waitcnt lgkmcnt(3)
  v_mfma_f32_16x16x32_bf16 v[112:115], a[216:219], v[160:163], v[64:67]
  ds_read_b128 a[236:239], v18 offset:6400
  v_add_f32 v83, v83, v156
  v_mfma_f32_16x16x32_bf16 v[116:119], a[216:219], v[184:187], v[68:71]
  buffer_load_dwordx4 v26, s[20:23], s61 offen offset:1024 nt lds
  v_mfma_f32_16x16x32_bf16 v[120:123], a[216:219], v[208:211], v[72:75]
  v_exp_f32 v157, v157
  v_mfma_f32_16x16x32_bf16 v[124:127], a[216:219], v[232:235], v[76:79]
  v_exp_f32 v158, v158
  v_mfma_f32_16x16x32_bf16 v[112:115], a[220:223], v[164:167], v[112:115]
  ds_read_b64_tr_b16 a[192:193], v21 offset:36864
  v_add_f32 v83, v83, v157
  v_mfma_f32_16x16x32_bf16 v[116:119], a[220:223], v[188:191], v[116:119]
  v_exp_f32 v159, v159
  v_mfma_f32_16x16x32_bf16 v[120:123], a[220:223], v[212:215], v[120:123]
  ds_read_b64_tr_b16 a[194:195], v21 offset:43008
  v_add_f32 v83, v83, v158
  v_mfma_f32_16x16x32_bf16 v[124:127], a[220:223], v[236:239], v[124:127]
  buffer_load_dwordx4 v27, s[20:23], s61 offen offset:2048 nt lds
  s_waitcnt lgkmcnt(4)
  v_mfma_f32_16x16x32_bf16 v[112:115], a[224:227], v[168:171], v[112:115]
  ds_read_b64_tr_b16 a[196:197], v22 offset:36864
  s_add_u32 s61, s61, 12288
  v_add_f32 v83, v83, v159
  v_mfma_f32_16x16x32_bf16 v[116:119], a[224:227], v[192:195], v[116:119]
  v_cvt_pk_bf16_f32 v50, v144, v145
  v_cvt_pk_bf16_f32 v51, v146, v147
  v_mfma_f32_16x16x32_bf16 v[120:123], a[224:227], v[216:219], v[120:123]
  ds_read_b64_tr_b16 a[198:199], v22 offset:43008
  v_cvt_pk_bf16_f32 v54, v148, v149
  v_mfma_f32_16x16x32_bf16 v[124:127], a[224:227], v[240:243], v[124:127]
  v_cvt_pk_bf16_f32 v55, v150, v151
  v_cvt_pk_bf16_f32 v58, v152, v153
  v_mfma_f32_16x16x32_bf16 v[112:115], a[228:231], v[172:175], v[112:115]
  ds_read_b64_tr_b16 a[200:201], v23 offset:36864
  v_cvt_pk_bf16_f32 v59, v154, v155
  v_mfma_f32_16x16x32_bf16 v[116:119], a[228:231], v[196:199], v[116:119]
  v_cvt_pk_bf16_f32 v62, v156, v157
  v_cvt_pk_bf16_f32 v63, v158, v159
  v_mfma_f32_16x16x32_bf16 v[120:123], a[228:231], v[220:223], v[120:123]
  ds_read_b64_tr_b16 a[202:203], v23 offset:43008
  v_mfma_f32_16x16x32_bf16 v[124:127], a[228:231], v[244:247], v[124:127]
  s_waitcnt lgkmcnt(6)
  v_mfma_f32_16x16x32_bf16 v[112:115], a[232:235], v[176:179], v[112:115]
  ds_read_b64_tr_b16 a[204:205], v24 offset:36864
  v_mfma_f32_16x16x32_bf16 v[116:119], a[232:235], v[200:203], v[116:119]
  v_mfma_f32_16x16x32_bf16 v[120:123], a[232:235], v[224:227], v[120:123]
  ds_read_b64_tr_b16 a[206:207], v24 offset:43008
  v_mfma_f32_16x16x32_bf16 v[124:127], a[232:235], v[248:251], v[124:127]
  v_mfma_f32_16x16x32_bf16 v[112:115], a[236:239], v[180:183], v[112:115]
  ds_read_b64_tr_b16 a[208:209], v21 offset:36992
  v_mfma_f32_16x16x32_bf16 v[116:119], a[236:239], v[204:207], v[116:119]
  v_mfma_f32_16x16x32_bf16 v[120:123], a[236:239], v[228:231], v[120:123]
  ds_read_b64_tr_b16 a[210:211], v21 offset:43136
  v_mfma_f32_16x16x32_bf16 v[124:127], a[236:239], v[252:255], v[124:127]
  s_waitcnt lgkmcnt(6)
  v_mfma_f32_16x16x32_bf16 a[0:3], a[192:195], v[48:51], a[0:3]
  ds_read_b64_tr_b16 a[212:213], v22 offset:36992
  v_mfma_f32_16x16x32_bf16 a[4:7], a[192:195], v[52:55], a[4:7]
  v_exp_f32 v96, v96
  v_mfma_f32_16x16x32_bf16 a[8:11], a[192:195], v[56:59], a[8:11]
  ds_read_b64_tr_b16 a[214:215], v22 offset:43136
  v_add_f32 v80, v80, v96
  v_mfma_f32_16x16x32_bf16 a[12:15], a[192:195], v[60:63], a[12:15]
  v_exp_f32 v97, v97
  v_mfma_f32_16x16x32_bf16 a[16:19], a[196:199], v[48:51], a[16:19]
  ds_read_b64_tr_b16 a[216:217], v23 offset:36992
  v_add_f32 v80, v80, v97
  v_mfma_f32_16x16x32_bf16 a[20:23], a[196:199], v[52:55], a[20:23]
  v_exp_f32 v98, v98
  v_mfma_f32_16x16x32_bf16 a[24:27], a[196:199], v[56:59], a[24:27]
  ds_read_b64_tr_b16 a[218:219], v23 offset:43136
  v_add_f32 v80, v80, v98
  v_mfma_f32_16x16x32_bf16 a[28:31], a[196:199], v[60:63], a[28:31]
  v_exp_f32 v99, v99
  s_waitcnt lgkmcnt(6)
  v_mfma_f32_16x16x32_bf16 a[32:35], a[200:203], v[48:51], a[32:35]
  ds_read_b64_tr_b16 a[220:221], v24 offset:36992
  v_add_f32 v80, v80, v99
  v_mfma_f32_16x16x32_bf16 a[36:39], a[200:203], v[52:55], a[36:39]
  v_exp_f32 v100, v100
  v_mfma_f32_16x16x32_bf16 a[40:43], a[200:203], v[56:59], a[40:43]
  ds_read_b64_tr_b16 a[222:223], v24 offset:43136
  v_add_f32 v81, v81, v100
  v_mfma_f32_16x16x32_bf16 a[44:47], a[200:203], v[60:63], a[44:47]
  v_exp_f32 v101, v101
  v_mfma_f32_16x16x32_bf16 a[48:51], a[204:207], v[48:51], a[48:51]
  ds_read_b64_tr_b16 a[224:225], v21 offset:37120
  v_add_f32 v81, v81, v101
  v_mfma_f32_16x16x32_bf16 a[52:55], a[204:207], v[52:55], a[52:55]
  v_exp_f32 v102, v102
  v_mfma_f32_16x16x32_bf16 a[56:59], a[204:207], v[56:59], a[56:59]
  ds_read_b64_tr_b16 a[226:227], v21 offset:43264
  v_add_f32 v81, v81, v102
  v_mfma_f32_16x16x32_bf16 a[60:63], a[204:207], v[60:63], a[60:63]
  v_exp_f32 v103, v103
  s_waitcnt lgkmcnt(6)
  v_mfma_f32_16x16x32_bf16 a[64:67], a[208:211], v[48:51], a[64:67]
  ds_read_b64_tr_b16 a[228:229], v22 offset:37120
  v_add_f32 v81, v81, v103
  v_mfma_f32_16x16x32_bf16 a[68:71], a[208:211], v[52:55], a[68:71]
  v_exp_f32 v104, v104
  v_mfma_f32_16x16x32_bf16 a[72:75], a[208:211], v[56:59], a[72:75]
  ds_read_b64_tr_b16 a[230:231], v22 offset:43264
  v_add_f32 v82, v82, v104
  v_mfma_f32_16x16x32_bf16 a[76:79], a[208:211], v[60:63], a[76:79]
  v_exp_f32 v105, v105
  v_mfma_f32_16x16x32_bf16 a[80:83], a[212:215], v[48:51], a[80:83]
  ds_read_b64_tr_b16 a[232:233], v23 offset:37120
  s_waitcnt vmcnt(18)
  s_barrier
  v_add_f32 v82, v82, v105
  v_mfma_f32_16x16x32_bf16 a[84:87], a[212:215], v[52:55], a[84:87]
  v_exp_f32 v106, v106
  v_mfma_f32_16x16x32_bf16 a[88:91], a[212:215], v[56:59], a[88:91]
  ds_read_b64_tr_b16 a[234:235], v23 offset:43264
  v_add_f32 v82, v82, v106
  v_mfma_f32_16x16x32_bf16 a[92:95], a[212:215], v[60:63], a[92:95]
  v_exp_f32 v107, v107
  s_waitcnt lgkmcnt(6)
  v_mfma_f32_16x16x32_bf16 a[96:99], a[216:219], v[48:51], a[96:99]
  ds_read_b64_tr_b16 a[236:237], v24 offset:37120
  v_add_f32 v82, v82, v107
  v_mfma_f32_16x16x32_bf16 a[100:103], a[216:219], v[52:55], a[100:103]
  v_exp_f32 v108, v108
  v_mfma_f32_16x16x32_bf16 a[104:107], a[216:219], v[56:59], a[104:107]
  ds_read_b64_tr_b16 a[238:239], v24 offset:43264
  v_add_f32 v83, v83, v108
  v_mfma_f32_16x16x32_bf16 a[108:111], a[216:219], v[60:63], a[108:111]
  v_exp_f32 v109, v109
  v_mfma_f32_16x16x32_bf16 a[112:115], a[220:223], v[48:51], a[112:115]
  ds_read_b128 a[192:195], v17 offset:24576
  v_add_f32 v83, v83, v109
  v_mfma_f32_16x16x32_bf16 a[116:119], a[220:223], v[52:55], a[116:119]
  v_exp_f32 v110, v110
  v_mfma_f32_16x16x32_bf16 a[120:123], a[220:223], v[56:59], a[120:123]
  v_exp_f32 v111, v111
  v_mfma_f32_16x16x32_bf16 a[124:127], a[220:223], v[60:63], a[124:127]
  v_add_f32 v83, v83, v110
  v_add_f32 v83, v83, v111
  s_waitcnt lgkmcnt(5)
  v_mfma_f32_16x16x32_bf16 a[128:131], a[224:227], v[48:51], a[128:131]
  ds_read_b128 a[196:199], v18 offset:24576
  v_mfma_f32_16x16x32_bf16 a[132:135], a[224:227], v[52:55], a[132:135]
  v_exp_f32 v112, v112
  v_mfma_f32_16x16x32_bf16 a[136:139], a[224:227], v[56:59], a[136:139]
  v_exp_f32 v113, v113
  v_mfma_f32_16x16x32_bf16 a[140:143], a[224:227], v[60:63], a[140:143]
  v_add_f32 v80, v80, v112
  v_add_f32 v80, v80, v113
  v_mfma_f32_16x16x32_bf16 a[144:147], a[228:231], v[48:51], a[144:147]
  ds_read_b128 a[200:203], v17 offset:24704
  v_mfma_f32_16x16x32_bf16 a[148:151], a[228:231], v[52:55], a[148:151]
  v_exp_f32 v114, v114
  v_mfma_f32_16x16x32_bf16 a[152:155], a[228:231], v[56:59], a[152:155]
  v_exp_f32 v115, v115
  v_mfma_f32_16x16x32_bf16 a[156:159], a[228:231], v[60:63], a[156:159]
  v_add_f32 v80, v80, v114
  v_add_f32 v80, v80, v115
  s_waitcnt lgkmcnt(3)
  v_mfma_f32_16x16x32_bf16 a[160:163], a[232:235], v[48:51], a[160:163]
  ds_read_b128 a[204:207], v18 offset:24704
  v_mfma_f32_16x16x32_bf16 a[164:167], a[232:235], v[52:55], a[164:167]
  v_mfma_f32_16x16x32_bf16 a[168:171], a[232:235], v[56:59], a[168:171]
  v_mfma_f32_16x16x32_bf16 a[172:175], a[232:235], v[60:63], a[172:175]
  v_mfma_f32_16x16x32_bf16 a[176:179], a[236:239], v[48:51], a[176:179]
  ds_read_b128 a[208:211], v17 offset:24832
  v_mfma_f32_16x16x32_bf16 a[180:183], a[236:239], v[52:55], a[180:183]
  v_mfma_f32_16x16x32_bf16 a[184:187], a[236:239], v[56:59], a[184:187]
  v_mfma_f32_16x16x32_bf16 a[188:191], a[236:239], v[60:63], a[188:191]
  s_waitcnt lgkmcnt(3)
  v_mfma_f32_16x16x32_bf16 v[128:131], a[192:195], v[160:163], v[64:67]
  ds_read_b128 a[212:215], v18 offset:24832
  s_sub_u32 s3, s63, s62
  v_add_u32 v21, s3, v21
  s_mov_b32 m0, s63
  v_mfma_f32_16x16x32_bf16 v[132:135], a[192:195], v[184:187], v[68:71]
  v_add_u32 v22, s3, v22
  v_add_u32 v23, s3, v23
  v_mfma_f32_16x16x32_bf16 v[136:139], a[192:195], v[208:211], v[72:75]
  v_add_u32 v24, s3, v24
  v_cvt_pk_bf16_f32 v48, v96, v97
  v_mfma_f32_16x16x32_bf16 v[140:143], a[192:195], v[232:235], v[76:79]
  buffer_load_dwordx4 v25, s[16:19], s60 offen offset:0 nt lds
  v_mfma_f32_16x16x32_bf16 v[128:131], a[196:199], v[164:167], v[128:131]
  ds_read_b128 a[216:219], v17 offset:30720
  v_cvt_pk_bf16_f32 v49, v98, v99
  v_mfma_f32_16x16x32_bf16 v[132:135], a[196:199], v[188:191], v[132:135]
  v_exp_f32 v116, v116
  v_mfma_f32_16x16x32_bf16 v[136:139], a[196:199], v[212:215], v[136:139]
  v_exp_f32 v117, v117
  v_mfma_f32_16x16x32_bf16 v[140:143], a[196:199], v[236:239], v[140:143]
  v_add_f32 v81, v81, v116
  v_cvt_pk_bf16_f32 v52, v100, v101
  s_waitcnt lgkmcnt(3)
  v_mfma_f32_16x16x32_bf16 v[128:131], a[200:203], v[168:171], v[128:131]
  ds_read_b128 a[220:223], v18 offset:30720
  v_cvt_pk_bf16_f32 v53, v102, v103
  v_mfma_f32_16x16x32_bf16 v[132:135], a[200:203], v[192:195], v[132:135]
  buffer_load_dwordx4 v26, s[16:19], s60 offen offset:1024 nt lds
  v_mfma_f32_16x16x32_bf16 v[136:139], a[200:203], v[216:219], v[136:139]
  v_exp_f32 v118, v118
  v_mfma_f32_16x16x32_bf16 v[140:143], a[200:203], v[240:243], v[140:143]
  v_add_f32 v81, v81, v117
  v_cvt_pk_bf16_f32 v56, v104, v105
  v_mfma_f32_16x16x32_bf16 v[128:131], a[204:207], v[172:175], v[128:131]
  ds_read_b128 a[224:227], v17 offset:30848
  v_cvt_pk_bf16_f32 v57, v106, v107
  v_mfma_f32_16x16x32_bf16 v[132:135], a[204:207], v[196:199], v[132:135]
  v_exp_f32 v119, v119
  v_mfma_f32_16x16x32_bf16 v[136:139], a[204:207], v[220:223], v[136:139]
  v_add_f32 v81, v81, v118
  v_cvt_pk_bf16_f32 v60, v108, v109
  v_mfma_f32_16x16x32_bf16 v[140:143], a[204:207], v[244:247], v[140:143]
  buffer_load_dwordx4 v27, s[16:19], s60 offen offset:2048 nt lds
  s_waitcnt lgkmcnt(3)
  v_mfma_f32_16x16x32_bf16 v[128:131], a[208:211], v[176:179], v[128:131]
  ds_read_b128 a[228:231], v18 offset:30848
  s_add_u32 s60, s60, 12288
  s_add_u32 m0, s62, 12288
  v_cvt_pk_bf16_f32 v61, v110, v111
  v_mfma_f32_16x16x32_bf16 v[132:135], a[208:211], v[200:203], v[132:135]
  v_exp_f32 v120, v120
  v_mfma_f32_16x16x32_bf16 v[136:139], a[208:211], v[224:227], v[136:139]
  v_add_f32 v81, v81, v119
  v_add_f32 v82, v82, v120
  v_mfma_f32_16x16x32_bf16 v[140:143], a[208:211], v[248:251], v[140:143]
  v_exp_f32 v121, v121
  v_mfma_f32_16x16x32_bf16 v[128:131], a[212:215], v[180:183], v[128:131]
  ds_read_b128 a[232:235], v17 offset:30976
  v_add_f32 v82, v82, v121
  v_mfma_f32_16x16x32_bf16 v[132:135], a[212:215], v[204:207], v[132:135]
  buffer_load_dwordx4 v25, s[20:23], s61 offen offset:0 nt lds
  v_mfma_f32_16x16x32_bf16 v[136:139], a[212:215], v[228:231], v[136:139]
  v_exp_f32 v122, v122
  v_mfma_f32_16x16x32_bf16 v[140:143], a[212:215], v[252:255], v[140:143]
  v_exp_f32 v123, v123
  s_waitcnt lgkmcnt(3)
  v_mfma_f32_16x16x32_bf16 v[144:147], a[216:219], v[160:163], v[64:67]
  ds_read_b128 a[236:239], v18 offset:30976
  v_add_f32 v82, v82, v122
  v_mfma_f32_16x16x32_bf16 v[148:151], a[216:219], v[184:187], v[68:71]
  v_exp_f32 v124, v124
  v_mfma_f32_16x16x32_bf16 v[152:155], a[216:219], v[208:211], v[72:75]
  v_add_f32 v82, v82, v123
  v_add_f32 v83, v83, v124
  v_mfma_f32_16x16x32_bf16 v[156:159], a[216:219], v[232:235], v[76:79]
  buffer_load_dwordx4 v26, s[20:23], s61 offen offset:1024 nt lds
  v_mfma_f32_16x16x32_bf16 v[144:147], a[220:223], v[164:167], v[144:147]
  ds_read_b64_tr_b16 a[192:193], v21 offset:12288
  v_cvt_pk_bf16_f32 v50, v112, v113
  v_mfma_f32_16x16x32_bf16 v[148:151], a[220:223], v[188:191], v[148:151]
  v_exp_f32 v125, v125
  v_mfma_f32_16x16x32_bf16 v[152:155], a[220:223], v[212:215], v[152:155]
  ds_read_b64_tr_b16 a[194:195], v21 offset:18432
  v_add_f32 v83, v83, v125
  v_mfma_f32_16x16x32_bf16 v[156:159], a[220:223], v[236:239], v[156:159]
  v_exp_f32 v126, v126
  s_waitcnt lgkmcnt(4)
  v_mfma_f32_16x16x32_bf16 v[144:147], a[224:227], v[168:171], v[144:147]
  ds_read_b64_tr_b16 a[196:197], v22 offset:12288
  v_add_f32 v83, v83, v126
  v_mfma_f32_16x16x32_bf16 v[148:151], a[224:227], v[192:195], v[148:151]
  buffer_load_dwordx4 v27, s[20:23], s61 offen offset:2048 nt lds
  v_mfma_f32_16x16x32_bf16 v[152:155], a[224:227], v[216:219], v[152:155]
  ds_read_b64_tr_b16 a[198:199], v22 offset:18432
  s_add_u32 s61, s61, 12288
  v_cvt_pk_bf16_f32 v51, v114, v115
  v_mfma_f32_16x16x32_bf16 v[156:159], a[224:227], v[240:243], v[156:159]
  v_exp_f32 v127, v127
  v_mfma_f32_16x16x32_bf16 v[144:147], a[228:231], v[172:175], v[144:147]
  ds_read_b64_tr_b16 a[200:201], v23 offset:12288
  v_add_f32 v83, v83, v127
  v_mfma_f32_16x16x32_bf16 v[148:151], a[228:231], v[196:199], v[148:151]
  v_cvt_pk_bf16_f32 v54, v116, v117
  v_cvt_pk_bf16_f32 v55, v118, v119
  v_mfma_f32_16x16x32_bf16 v[152:155], a[228:231], v[220:223], v[152:155]
  ds_read_b64_tr_b16 a[202:203], v23 offset:18432
  v_cvt_pk_bf16_f32 v58, v120, v121
  v_mfma_f32_16x16x32_bf16 v[156:159], a[228:231], v[244:247], v[156:159]
  v_cvt_pk_bf16_f32 v59, v122, v123
  v_cvt_pk_bf16_f32 v62, v124, v125
  s_waitcnt lgkmcnt(6)
  v_mfma_f32_16x16x32_bf16 v[144:147], a[232:235], v[176:179], v[144:147]
  ds_read_b64_tr_b16 a[204:205], v24 offset:12288
  v_cvt_pk_bf16_f32 v63, v126, v127
  v_mfma_f32_16x16x32_bf16 v[148:151], a[232:235], v[200:203], v[148:151]
  v_mfma_f32_16x16x32_bf16 v[152:155], a[232:235], v[224:227], v[152:155]
  ds_read_b64_tr_b16 a[206:207], v24 offset:18432
  v_mfma_f32_16x16x32_bf16 v[156:159], a[232:235], v[248:251], v[156:159]
  v_mfma_f32_16x16x32_bf16 v[144:147], a[236:239], v[180:183], v[144:147]
  ds_read_b64_tr_b16 a[208:209], v21 offset:12416
  v_mfma_f32_16x16x32_bf16 v[148:151], a[236:239], v[204:207], v[148:151]
  v_mfma_f32_16x16x32_bf16 v[152:155], a[236:239], v[228:231], v[152:155]
  ds_read_b64_tr_b16 a[210:211], v21 offset:18560
  v_mfma_f32_16x16x32_bf16 v[156:159], a[236:239], v[252:255], v[156:159]
  s_waitcnt lgkmcnt(6)
  v_mfma_f32_16x16x32_bf16 a[0:3], a[192:195], v[48:51], a[0:3]
  ds_read_b64_tr_b16 a[212:213], v22 offset:12416
  s_sub_u32 s79, s64, s63
  v_add_u32 v17, s79, v17
  v_mfma_f32_16x16x32_bf16 a[4:7], a[192:195], v[52:55], a[4:7]
  v_add_u32 v18, s79, v18
  v_mfma_f32_16x16x32_bf16 a[8:11], a[192:195], v[56:59], a[8:11]
  ds_read_b64_tr_b16 a[214:215], v22 offset:18560
  v_mfma_f32_16x16x32_bf16 a[12:15], a[192:195], v[60:63], a[12:15]
  v_exp_f32 v128, v128
  v_mfma_f32_16x16x32_bf16 a[16:19], a[196:199], v[48:51], a[16:19]
  ds_read_b64_tr_b16 a[216:217], v23 offset:12416
  v_add_f32 v80, v80, v128
  v_mfma_f32_16x16x32_bf16 a[20:23], a[196:199], v[52:55], a[20:23]
  v_exp_f32 v129, v129
  v_mfma_f32_16x16x32_bf16 a[24:27], a[196:199], v[56:59], a[24:27]
  ds_read_b64_tr_b16 a[218:219], v23 offset:18560
  v_add_f32 v80, v80, v129
  v_mfma_f32_16x16x32_bf16 a[28:31], a[196:199], v[60:63], a[28:31]
  v_exp_f32 v130, v130
  s_waitcnt lgkmcnt(6)
  v_mfma_f32_16x16x32_bf16 a[32:35], a[200:203], v[48:51], a[32:35]
  ds_read_b64_tr_b16 a[220:221], v24 offset:12416
  v_add_f32 v80, v80, v130
  v_mfma_f32_16x16x32_bf16 a[36:39], a[200:203], v[52:55], a[36:39]
  v_exp_f32 v131, v131
  v_mfma_f32_16x16x32_bf16 a[40:43], a[200:203], v[56:59], a[40:43]
  ds_read_b64_tr_b16 a[222:223], v24 offset:18560
  v_add_f32 v80, v80, v131
  v_mfma_f32_16x16x32_bf16 a[44:47], a[200:203], v[60:63], a[44:47]
  v_exp_f32 v132, v132
  v_mfma_f32_16x16x32_bf16 a[48:51], a[204:207], v[48:51], a[48:51]
  ds_read_b64_tr_b16 a[224:225], v21 offset:12544
  v_add_f32 v81, v81, v132
  v_mfma_f32_16x16x32_bf16 a[52:55], a[204:207], v[52:55], a[52:55]
  v_exp_f32 v133, v133
  v_mfma_f32_16x16x32_bf16 a[56:59], a[204:207], v[56:59], a[56:59]
  ds_read_b64_tr_b16 a[226:227], v21 offset:18688
  v_add_f32 v81, v81, v133
  v_mfma_f32_16x16x32_bf16 a[60:63], a[204:207], v[60:63], a[60:63]
  v_exp_f32 v134, v134
  s_waitcnt lgkmcnt(6)
  v_mfma_f32_16x16x32_bf16 a[64:67], a[208:211], v[48:51], a[64:67]
  ds_read_b64_tr_b16 a[228:229], v22 offset:12544
  v_add_f32 v81, v81, v134
  v_mfma_f32_16x16x32_bf16 a[68:71], a[208:211], v[52:55], a[68:71]
  v_exp_f32 v135, v135
  v_mfma_f32_16x16x32_bf16 a[72:75], a[208:211], v[56:59], a[72:75]
  ds_read_b64_tr_b16 a[230:231], v22 offset:18688
  v_add_f32 v81, v81, v135
  v_mfma_f32_16x16x32_bf16 a[76:79], a[208:211], v[60:63], a[76:79]
  v_exp_f32 v136, v136
  v_mfma_f32_16x16x32_bf16 a[80:83], a[212:215], v[48:51], a[80:83]
  ds_read_b64_tr_b16 a[232:233], v23 offset:12544
  s_waitcnt vmcnt(18)
  s_barrier
  v_add_f32 v82, v82, v136
  v_mfma_f32_16x16x32_bf16 a[84:87], a[212:215], v[52:55], a[84:87]
  v_exp_f32 v137, v137
  v_mfma_f32_16x16x32_bf16 a[88:91], a[212:215], v[56:59], a[88:91]
  ds_read_b64_tr_b16 a[234:235], v23 offset:18688
  v_add_f32 v82, v82, v137
  v_mfma_f32_16x16x32_bf16 a[92:95], a[212:215], v[60:63], a[92:95]
  v_exp_f32 v138, v138
  s_waitcnt lgkmcnt(6)
  v_mfma_f32_16x16x32_bf16 a[96:99], a[216:219], v[48:51], a[96:99]
  ds_read_b64_tr_b16 a[236:237], v24 offset:12544
  v_add_f32 v82, v82, v138
  v_mfma_f32_16x16x32_bf16 a[100:103], a[216:219], v[52:55], a[100:103]
  v_exp_f32 v139, v139
  v_mfma_f32_16x16x32_bf16 a[104:107], a[216:219], v[56:59], a[104:107]
  ds_read_b64_tr_b16 a[238:239], v24 offset:18688
  v_add_f32 v82, v82, v139
  v_mfma_f32_16x16x32_bf16 a[108:111], a[216:219], v[60:63], a[108:111]
  v_exp_f32 v140, v140
  v_mfma_f32_16x16x32_bf16 a[112:115], a[220:223], v[48:51], a[112:115]
  ds_read_b128 a[192:195], v17 offset:0
  v_add_f32 v83, v83, v140
  v_mfma_f32_16x16x32_bf16 a[116:119], a[220:223], v[52:55], a[116:119]
  v_exp_f32 v141, v141
  v_mfma_f32_16x16x32_bf16 a[120:123], a[220:223], v[56:59], a[120:123]
  v_exp_f32 v142, v142
  v_mfma_f32_16x16x32_bf16 a[124:127], a[220:223], v[60:63], a[124:127]
  v_add_f32 v83, v83, v141
  v_add_f32 v83, v83, v142
  s_waitcnt lgkmcnt(5)
  v_mfma_f32_16x16x32_bf16 a[128:131], a[224:227], v[48:51], a[128:131]
  ds_read_b128 a[196:199], v18 offset:0
  v_mfma_f32_16x16x32_bf16 a[132:135], a[224:227], v[52:55], a[132:135]
  v_exp_f32 v143, v143
  v_mfma_f32_16x16x32_bf16 a[136:139], a[224:227], v[56:59], a[136:139]
  v_exp_f32 v144, v144
  v_mfma_f32_16x16x32_bf16 a[140:143], a[224:227], v[60:63], a[140:143]
  v_add_f32 v83, v83, v143
  v_add_f32 v80, v80, v144
  v_mfma_f32_16x16x32_bf16 a[144:147], a[228:231], v[48:51], a[144:147]
  ds_read_b128 a[200:203], v17 offset:128
  v_mfma_f32_16x16x32_bf16 a[148:151], a[228:231], v[52:55], a[148:151]
  v_exp_f32 v145, v145
  v_mfma_f32_16x16x32_bf16 a[152:155], a[228:231], v[56:59], a[152:155]
  v_exp_f32 v146, v146
  v_mfma_f32_16x16x32_bf16 a[156:159], a[228:231], v[60:63], a[156:159]
  v_add_f32 v80, v80, v145
  v_add_f32 v80, v80, v146
  s_waitcnt lgkmcnt(3)
  v_mfma_f32_16x16x32_bf16 a[160:163], a[232:235], v[48:51], a[160:163]
  ds_read_b128 a[204:207], v18 offset:128
  v_mfma_f32_16x16x32_bf16 a[164:167], a[232:235], v[52:55], a[164:167]
  v_exp_f32 v147, v147
  v_mfma_f32_16x16x32_bf16 a[168:171], a[232:235], v[56:59], a[168:171]
  v_add_f32 v80, v80, v147
  v_mfma_f32_16x16x32_bf16 a[172:175], a[232:235], v[60:63], a[172:175]
  v_mfma_f32_16x16x32_bf16 a[176:179], a[236:239], v[48:51], a[176:179]
  ds_read_b128 a[208:211], v17 offset:256
  v_mfma_f32_16x16x32_bf16 a[180:183], a[236:239], v[52:55], a[180:183]
  v_mfma_f32_16x16x32_bf16 a[184:187], a[236:239], v[56:59], a[184:187]
  v_mfma_f32_16x16x32_bf16 a[188:191], a[236:239], v[60:63], a[188:191]
  s_mov_b32 s68, s62
  s_mov_b32 s62, s63
  s_mov_b32 s63, s64
  s_mov_b32 s64, s68
  s_sub_u32 s65, s65, 1
  s_cmp_lg_u32 s65, 0
  s_cbranch_scc1 K1_LOOP
  s_waitcnt lgkmcnt(3)
  v_mfma_f32_16x16x32_bf16 v[96:99], a[192:195], v[160:163], v[64:67]
  ds_read_b128 a[212:215], v18 offset:256
  s_add_u32 m0, s62, 24576
  v_cvt_pk_bf16_f32 v48, v128, v129
  v_mfma_f32_16x16x32_bf16 v[100:103], a[192:195], v[184:187], v[68:71]
  buffer_load_dwordx4 v25, s[16:19], s60 offen offset:0 nt lds
  v_mfma_f32_16x16x32_bf16 v[104:107], a[192:195], v[208:211], v[72:75]
  v_exp_f32 v148, v148
  v_mfma_f32_16x16x32_bf16 v[108:111], a[192:195], v[232:235], v[76:79]
  v_exp_f32 v149, v149
  v_mfma_f32_16x16x32_bf16 v[96:99], a[196:199], v[164:167], v[96:99]
  ds_read_b128 a[216:219], v17 offset:6144
  v_cvt_pk_bf16_f32 v49, v130, v131
  v_mfma_f32_16x16x32_bf16 v[100:103], a[196:199], v[188:191], v[100:103]
  v_add_f32 v81, v81, v148
  v_cvt_pk_bf16_f32 v52, v132, v133
  v_mfma_f32_16x16x32_bf16 v[104:107], a[196:199], v[212:215], v[104:107]
  v_exp_f32 v150, v150
  v_mfma_f32_16x16x32_bf16 v[108:111], a[196:199], v[236:239], v[108:111]
  buffer_load_dwordx4 v26, s[16:19], s60 offen offset:1024 nt lds
  s_waitcnt lgkmcnt(3)
  v_mfma_f32_16x16x32_bf16 v[96:99], a[200:203], v[168:171], v[96:99]
  ds_read_b128 a[220:223], v18 offset:6144
  v_cvt_pk_bf16_f32 v53, v134, v135
  v_mfma_f32_16x16x32_bf16 v[100:103], a[200:203], v[192:195], v[100:103]
  v_add_f32 v81, v81, v149
  v_cvt_pk_bf16_f32 v56, v136, v137
  v_mfma_f32_16x16x32_bf16 v[104:107], a[200:203], v[216:219], v[104:107]
  v_exp_f32 v151, v151
  v_mfma_f32_16x16x32_bf16 v[108:111], a[200:203], v[240:243], v[108:111]
  v_cvt_pk_bf16_f32 v57, v138, v139
  v_add_f32 v81, v81, v150
  v_mfma_f32_16x16x32_bf16 v[96:99], a[204:207], v[172:175], v[96:99]
  ds_read_b128 a[224:227], v17 offset:6272
  v_cvt_pk_bf16_f32 v60, v140, v141
  v_mfma_f32_16x16x32_bf16 v[100:103], a[204:207], v[196:199], v[100:103]
  buffer_load_dwordx4 v27, s[16:19], s60 offen offset:2048 nt lds
  v_mfma_f32_16x16x32_bf16 v[104:107], a[204:207], v[220:223], v[104:107]
  s_add_u32 s60, s60, 12288
  s_add_u32 m0, s64, 36864
  v_exp_f32 v152, v152
  v_mfma_f32_16x16x32_bf16 v[108:111], a[204:207], v[244:247], v[108:111]
  v_cvt_pk_bf16_f32 v61, v142, v143
  v_add_f32 v81, v81, v151
  s_waitcnt lgkmcnt(3)
  v_mfma_f32_16x16x32_bf16 v[96:99], a[208:211], v[176:179], v[96:99]
  ds_read_b128 a[228:231], v18 offset:6272
  v_add_f32 v82, v82, v152
  v_mfma_f32_16x16x32_bf16 v[100:103], a[208:211], v[200:203], v[100:103]
  v_exp_f32 v153, v153
  v_mfma_f32_16x16x32_bf16 v[104:107], a[208:211], v[224:227], v[104:107]
  v_exp_f32 v154, v154
  v_mfma_f32_16x16x32_bf16 v[108:111], a[208:211], v[248:251], v[108:111]
  buffer_load_dwordx4 v25, s[20:23], s61 offen offset:0 nt lds
  v_mfma_f32_16x16x32_bf16 v[96:99], a[212:215], v[180:183], v[96:99]
  ds_read_b128 a[232:235], v17 offset:6400
  v_add_f32 v82, v82, v153
  v_mfma_f32_16x16x32_bf16 v[100:103], a[212:215], v[204:207], v[100:103]
  v_exp_f32 v155, v155
  v_mfma_f32_16x16x32_bf16 v[104:107], a[212:215], v[228:231], v[104:107]
  v_add_f32 v82, v82, v154
  v_add_f32 v82, v82, v155
  v_mfma_f32_16x16x32_bf16 v[108:111], a[212:215], v[252:255], v[108:111]
  v_exp_f32 v156, v156
  s_waitcnt lgkmcnt(3)
  v_mfma_f32_16x16x32_bf16 v[112:115], a[216:219], v[160:163], v[64:67]
  ds_read_b128 a[236:239], v18 offset:6400
  v_add_f32 v83, v83, v156
  v_mfma_f32_16x16x32_bf16 v[116:119], a[216:219], v[184:187], v[68:71]
  buffer_load_dwordx4 v26, s[20:23], s61 offen offset:1024 nt lds
  v_mfma_f32_16x16x32_bf16 v[120:123], a[216:219], v[208:211], v[72:75]
  v_exp_f32 v157, v157
  v_mfma_f32_16x16x32_bf16 v[124:127], a[216:219], v[232:235], v[76:79]
  v_exp_f32 v158, v158
  v_mfma_f32_16x16x32_bf16 v[112:115], a[220:223], v[164:167], v[112:115]
  ds_read_b64_tr_b16 a[192:193], v21 offset:36864
  v_add_f32 v83, v83, v157
  v_mfma_f32_16x16x32_bf16 v[116:119], a[220:223], v[188:191], v[116:119]
  v_exp_f32 v159, v159
  v_mfma_f32_16x16x32_bf16 v[120:123], a[220:223], v[212:215], v[120:123]
  ds_read_b64_tr_b16 a[194:195], v21 offset:43008
  v_add_f32 v83, v83, v158
  v_mfma_f32_16x16x32_bf16 v[124:127], a[220:223], v[236:239], v[124:127]
  buffer_load_dwordx4 v27, s[20:23], s61 offen offset:2048 nt lds
  s_waitcnt lgkmcnt(4)
  v_mfma_f32_16x16x32_bf16 v[112:115], a[224:227], v[168:171], v[112:115]
  ds_read_b64_tr_b16 a[196:197], v22 offset:36864
  s_add_u32 s61, s61, 12288
  s_cmp_eq_u32 s56, 0
  s_mov_b32 s8, s38
  s_mov_b32 s9, s39
  s_cselect_b32 s10, 2621440, 0
  s_mov_b32 s12, s44
  s_mov_b32 s13, s45
  s_cselect_b32 s14, 7864320, 0
  v_add_f32 v83, v83, v159
  v_mfma_f32_16x16x32_bf16 v[116:119], a[224:227], v[192:195], v[116:119]
  v_cvt_pk_bf16_f32 v50, v144, v145
  v_cvt_pk_bf16_f32 v51, v146, v147
  v_mfma_f32_16x16x32_bf16 v[120:123], a[224:227], v[216:219], v[120:123]
  ds_read_b64_tr_b16 a[198:199], v22 offset:43008
  v_cvt_pk_bf16_f32 v54, v148, v149
  v_mfma_f32_16x16x32_bf16 v[124:127], a[224:227], v[240:243], v[124:127]
  v_cvt_pk_bf16_f32 v55, v150, v151
  v_cvt_pk_bf16_f32 v58, v152, v153
  v_mfma_f32_16x16x32_bf16 v[112:115], a[228:231], v[172:175], v[112:115]
  ds_read_b64_tr_b16 a[200:201], v23 offset:36864
  v_cvt_pk_bf16_f32 v59, v154, v155
  v_mfma_f32_16x16x32_bf16 v[116:119], a[228:231], v[196:199], v[116:119]
  v_cvt_pk_bf16_f32 v62, v156, v157
  v_cvt_pk_bf16_f32 v63, v158, v159
  v_mfma_f32_16x16x32_bf16 v[120:123], a[228:231], v[220:223], v[120:123]
  ds_read_b64_tr_b16 a[202:203], v23 offset:43008
  v_mfma_f32_16x16x32_bf16 v[124:127], a[228:231], v[244:247], v[124:127]
  s_waitcnt lgkmcnt(6)
  v_mfma_f32_16x16x32_bf16 v[112:115], a[232:235], v[176:179], v[112:115]
  ds_read_b64_tr_b16 a[204:205], v24 offset:36864
  v_mfma_f32_16x16x32_bf16 v[116:119], a[232:235], v[200:203], v[116:119]
  v_mfma_f32_16x16x32_bf16 v[120:123], a[232:235], v[224:227], v[120:123]
  ds_read_b64_tr_b16 a[206:207], v24 offset:43008
  v_mfma_f32_16x16x32_bf16 v[124:127], a[232:235], v[248:251], v[124:127]
  v_mfma_f32_16x16x32_bf16 v[112:115], a[236:239], v[180:183], v[112:115]
  ds_read_b64_tr_b16 a[208:209], v21 offset:36992
  v_mfma_f32_16x16x32_bf16 v[116:119], a[236:239], v[204:207], v[116:119]
  v_mfma_f32_16x16x32_bf16 v[120:123], a[236:239], v[228:231], v[120:123]
  ds_read_b64_tr_b16 a[210:211], v21 offset:43136
  v_mfma_f32_16x16x32_bf16 v[124:127], a[236:239], v[252:255], v[124:127]
  s_waitcnt lgkmcnt(6)
  v_mfma_f32_16x16x32_bf16 a[0:3], a[192:195], v[48:51], a[0:3]
  ds_read_b64_tr_b16 a[212:213], v22 offset:36992
  v_mfma_f32_16x16x32_bf16 a[4:7], a[192:195], v[52:55], a[4:7]
  v_exp_f32 v96, v96
  v_mfma_f32_16x16x32_bf16 a[8:11], a[192:195], v[56:59], a[8:11]
  ds_read_b64_tr_b16 a[214:215], v22 offset:43136
  v_add_f32 v80, v80, v96
  v_mfma_f32_16x16x32_bf16 a[12:15], a[192:195], v[60:63], a[12:15]
  v_exp_f32 v97, v97
  v_mfma_f32_16x16x32_bf16 a[16:19], a[196:199], v[48:51], a[16:19]
  ds_read_b64_tr_b16 a[216:217], v23 offset:36992
  v_add_f32 v80, v80, v97
  v_mfma_f32_16x16x32_bf16 a[20:23], a[196:199], v[52:55], a[20:23]
  v_exp_f32 v98, v98
  v_mfma_f32_16x16x32_bf16 a[24:27], a[196:199], v[56:59], a[24:27]
  ds_read_b64_tr_b16 a[218:219], v23 offset:43136
  v_add_f32 v80, v80, v98
  v_mfma_f32_16x16x32_bf16 a[28:31], a[196:199], v[60:63], a[28:31]
  v_exp_f32 v99, v99
  s_waitcnt lgkmcnt(6)
  v_mfma_f32_16x16x32_bf16 a[32:35], a[200:203], v[48:51], a[32:35]
  ds_read_b64_tr_b16 a[220:221], v24 offset:36992
  v_add_f32 v80, v80, v99
  v_mfma_f32_16x16x32_bf16 a[36:39], a[200:203], v[52:55], a[36:39]
  v_exp_f32 v100, v100
  v_mfma_f32_16x16x32_bf16 a[40:43], a[200:203], v[56:59], a[40:43]
  ds_read_b64_tr_b16 a[222:223], v24 offset:43136
  v_add_f32 v81, v81, v100
  v_mfma_f32_16x16x32_bf16 a[44:47], a[200:203], v[60:63], a[44:47]
  v_exp_f32 v101, v101
  v_mfma_f32_16x16x32_bf16 a[48:51], a[204:207], v[48:51], a[48:51]
  ds_read_b64_tr_b16 a[224:225], v21 offset:37120
  v_add_f32 v81, v81, v101
  v_mfma_f32_16x16x32_bf16 a[52:55], a[204:207], v[52:55], a[52:55]
  v_exp_f32 v102, v102
  v_mfma_f32_16x16x32_bf16 a[56:59], a[204:207], v[56:59], a[56:59]
  ds_read_b64_tr_b16 a[226:227], v21 offset:43264
  v_add_f32 v81, v81, v102
  v_mfma_f32_16x16x32_bf16 a[60:63], a[204:207], v[60:63], a[60:63]
  v_exp_f32 v103, v103
  s_waitcnt lgkmcnt(6)
  v_mfma_f32_16x16x32_bf16 a[64:67], a[208:211], v[48:51], a[64:67]
  ds_read_b64_tr_b16 a[228:229], v22 offset:37120
  v_add_f32 v81, v81, v103
  v_mfma_f32_16x16x32_bf16 a[68:71], a[208:211], v[52:55], a[68:71]
  v_exp_f32 v104, v104
  v_mfma_f32_16x16x32_bf16 a[72:75], a[208:211], v[56:59], a[72:75]
  ds_read_b64_tr_b16 a[230:231], v22 offset:43264
  v_add_f32 v82, v82, v104
  v_mfma_f32_16x16x32_bf16 a[76:79], a[208:211], v[60:63], a[76:79]
  v_exp_f32 v105, v105
  v_mfma_f32_16x16x32_bf16 a[80:83], a[212:215], v[48:51], a[80:83]
  ds_read_b64_tr_b16 a[232:233], v23 offset:37120
  s_waitcnt vmcnt(18)
  s_barrier
  v_add_f32 v82, v82, v105
  v_mfma_f32_16x16x32_bf16 a[84:87], a[212:215], v[52:55], a[84:87]
  v_exp_f32 v106, v106
  v_mfma_f32_16x16x32_bf16 a[88:91], a[212:215], v[56:59], a[88:91]
  ds_read_b64_tr_b16 a[234:235], v23 offset:43264
  v_add_f32 v82, v82, v106
  v_mfma_f32_16x16x32_bf16 a[92:95], a[212:215], v[60:63], a[92:95]
  v_exp_f32 v107, v107
  s_waitcnt lgkmcnt(6)
  v_mfma_f32_16x16x32_bf16 a[96:99], a[216:219], v[48:51], a[96:99]
  ds_read_b64_tr_b16 a[236:237], v24 offset:37120
  v_add_f32 v82, v82, v107
  v_mfma_f32_16x16x32_bf16 a[100:103], a[216:219], v[52:55], a[100:103]
  v_exp_f32 v108, v108
  v_mfma_f32_16x16x32_bf16 a[104:107], a[216:219], v[56:59], a[104:107]
  ds_read_b64_tr_b16 a[238:239], v24 offset:43264
  v_add_f32 v83, v83, v108
  v_mfma_f32_16x16x32_bf16 a[108:111], a[216:219], v[60:63], a[108:111]
  v_exp_f32 v109, v109
  v_mfma_f32_16x16x32_bf16 a[112:115], a[220:223], v[48:51], a[112:115]
  ds_read_b128 a[192:195], v17 offset:24576
  v_add_f32 v83, v83, v109
  v_mfma_f32_16x16x32_bf16 a[116:119], a[220:223], v[52:55], a[116:119]
  v_exp_f32 v110, v110
  v_mfma_f32_16x16x32_bf16 a[120:123], a[220:223], v[56:59], a[120:123]
  v_exp_f32 v111, v111
  v_mfma_f32_16x16x32_bf16 a[124:127], a[220:223], v[60:63], a[124:127]
  v_add_f32 v83, v83, v110
  v_add_f32 v83, v83, v111
  s_waitcnt lgkmcnt(5)
  v_mfma_f32_16x16x32_bf16 a[128:131], a[224:227], v[48:51], a[128:131]
  ds_read_b128 a[196:199], v18 offset:24576
  v_mfma_f32_16x16x32_bf16 a[132:135], a[224:227], v[52:55], a[132:135]
  v_exp_f32 v112, v112
  v_mfma_f32_16x16x32_bf16 a[136:139], a[224:227], v[56:59], a[136:139]
  v_exp_f32 v113, v113
  v_mfma_f32_16x16x32_bf16 a[140:143], a[224:227], v[60:63], a[140:143]
  v_add_f32 v80, v80, v112
  v_add_f32 v80, v80, v113
  v_mfma_f32_16x16x32_bf16 a[144:147], a[228:231], v[48:51], a[144:147]
  ds_read_b128 a[200:203], v17 offset:24704
  v_mfma_f32_16x16x32_bf16 a[148:151], a[228:231], v[52:55], a[148:151]
  v_exp_f32 v114, v114
  v_mfma_f32_16x16x32_bf16 a[152:155], a[228:231], v[56:59], a[152:155]
  v_exp_f32 v115, v115
  v_mfma_f32_16x16x32_bf16 a[156:159], a[228:231], v[60:63], a[156:159]
  v_add_f32 v80, v80, v114
  v_add_f32 v80, v80, v115
  s_waitcnt lgkmcnt(3)
  v_mfma_f32_16x16x32_bf16 a[160:163], a[232:235], v[48:51], a[160:163]
  ds_read_b128 a[204:207], v18 offset:24704
  v_mfma_f32_16x16x32_bf16 a[164:167], a[232:235], v[52:55], a[164:167]
  v_mfma_f32_16x16x32_bf16 a[168:171], a[232:235], v[56:59], a[168:171]
  v_mfma_f32_16x16x32_bf16 a[172:175], a[232:235], v[60:63], a[172:175]
  v_mfma_f32_16x16x32_bf16 a[176:179], a[236:239], v[48:51], a[176:179]
  ds_read_b128 a[208:211], v17 offset:24832
  v_mfma_f32_16x16x32_bf16 a[180:183], a[236:239], v[52:55], a[180:183]
  v_mfma_f32_16x16x32_bf16 a[184:187], a[236:239], v[56:59], a[184:187]
  v_mfma_f32_16x16x32_bf16 a[188:191], a[236:239], v[60:63], a[188:191]
  s_waitcnt lgkmcnt(3)
  v_mfma_f32_16x16x32_bf16 v[128:131], a[192:195], v[160:163], v[64:67]
  ds_read_b128 a[212:215], v18 offset:24832
  s_sub_u32 s3, s63, s62
  v_add_u32 v21, s3, v21
  s_add_u32 m0, s62, 12288
  v_mfma_f32_16x16x32_bf16 v[132:135], a[192:195], v[184:187], v[68:71]
  v_add_u32 v22, s3, v22
  v_add_u32 v23, s3, v23
  v_mfma_f32_16x16x32_bf16 v[136:139], a[192:195], v[208:211], v[72:75]
  v_add_u32 v24, s3, v24
  v_cvt_pk_bf16_f32 v48, v96, v97
  v_mfma_f32_16x16x32_bf16 v[140:143], a[192:195], v[232:235], v[76:79]
  buffer_load_dwordx4 v25, s[20:23], s61 offen offset:0 nt lds
  v_mfma_f32_16x16x32_bf16 v[128:131], a[196:199], v[164:167], v[128:131]
  ds_read_b128 a[216:219], v17 offset:30720
  v_cvt_pk_bf16_f32 v49, v98, v99
  v_mfma_f32_16x16x32_bf16 v[132:135], a[196:199], v[188:191], v[132:135]
  v_exp_f32 v116, v116
  v_mfma_f32_16x16x32_bf16 v[136:139], a[196:199], v[212:215], v[136:139]
  v_exp_f32 v117, v117
  v_mfma_f32_16x16x32_bf16 v[140:143], a[196:199], v[236:239], v[140:143]
  v_add_f32 v81, v81, v116
  v_cvt_pk_bf16_f32 v52, v100, v101
  s_waitcnt lgkmcnt(3)
  v_mfma_f32_16x16x32_bf16 v[128:131], a[200:203], v[168:171], v[128:131]
  ds_read_b128 a[220:223], v18 offset:30720
  v_cvt_pk_bf16_f32 v53, v102, v103
  v_mfma_f32_16x16x32_bf16 v[132:135], a[200:203], v[192:195], v[132:135]
  buffer_load_dwordx4 v26, s[20:23], s61 offen offset:1024 nt lds
  v_mfma_f32_16x16x32_bf16 v[136:139], a[200:203], v[216:219], v[136:139]
  v_exp_f32 v118, v118
  v_mfma_f32_16x16x32_bf16 v[140:143], a[200:203], v[240:243], v[140:143]
  v_add_f32 v81, v81, v117
  v_cvt_pk_bf16_f32 v56, v104, v105
  v_mfma_f32_16x16x32_bf16 v[128:131], a[204:207], v[172:175], v[128:131]
  ds_read_b128 a[224:227], v17 offset:30848
  v_cvt_pk_bf16_f32 v57, v106, v107
  v_mfma_f32_16x16x32_bf16 v[132:135], a[204:207], v[196:199], v[132:135]
  v_exp_f32 v119, v119
  v_mfma_f32_16x16x32_bf16 v[136:139], a[204:207], v[220:223], v[136:139]
  v_add_f32 v81, v81, v118
  v_cvt_pk_bf16_f32 v60, v108, v109
  v_mfma_f32_16x16x32_bf16 v[140:143], a[204:207], v[244:247], v[140:143]
  buffer_load_dwordx4 v27, s[20:23], s61 offen offset:2048 nt lds
  s_waitcnt lgkmcnt(3)
  v_mfma_f32_16x16x32_bf16 v[128:131], a[208:211], v[176:179], v[128:131]
  ds_read_b128 a[228:231], v18 offset:30848
  s_add_u32 s61, s61, 12288
  s_add_u32 m0, s55, 49152
  v_cvt_pk_bf16_f32 v61, v110, v111
  v_mfma_f32_16x16x32_bf16 v[132:135], a[208:211], v[200:203], v[132:135]
  s_add_u32 s73, s71, 0
  v_exp_f32 v120, v120
  v_mfma_f32_16x16x32_bf16 v[136:139], a[208:211], v[224:227], v[136:139]
  v_add_f32 v81, v81, v119
  v_add_f32 v82, v82, v120
  v_mfma_f32_16x16x32_bf16 v[140:143], a[208:211], v[248:251], v[140:143]
  v_exp_f32 v121, v121
  v_mfma_f32_16x16x32_bf16 v[128:131], a[212:215], v[180:183], v[128:131]
  ds_read_b128 a[232:235], v17 offset:30976
  v_add_f32 v82, v82, v121
  v_mfma_f32_16x16x32_bf16 v[132:135], a[212:215], v[204:207], v[132:135]
  buffer_load_dwordx4 v41, s[12:15], s73 offen offset:0 lds
  v_mfma_f32_16x16x32_bf16 v[136:139], a[212:215], v[228:231], v[136:139]
  v_exp_f32 v122, v122
  v_mfma_f32_16x16x32_bf16 v[140:143], a[212:215], v[252:255], v[140:143]
  v_exp_f32 v123, v123
  s_waitcnt lgkmcnt(3)
  v_mfma_f32_16x16x32_bf16 v[144:147], a[216:219], v[160:163], v[64:67]
  ds_read_b128 a[236:239], v18 offset:30976
  v_add_f32 v82, v82, v122
  v_mfma_f32_16x16x32_bf16 v[148:151], a[216:219], v[184:187], v[68:71]
  v_exp_f32 v124, v124
  v_mfma_f32_16x16x32_bf16 v[152:155], a[216:219], v[208:211], v[72:75]
  v_add_f32 v82, v82, v123
  v_add_f32 v83, v83, v124
  v_mfma_f32_16x16x32_bf16 v[156:159], a[216:219], v[232:235], v[76:79]
  buffer_load_dwordx4 v42, s[12:15], s73 offen offset:1024 lds
  v_mfma_f32_16x16x32_bf16 v[144:147], a[220:223], v[164:167], v[144:147]
  ds_read_b64_tr_b16 a[192:193], v21 offset:12288
  v_cvt_pk_bf16_f32 v50, v112, v113
  v_mfma_f32_16x16x32_bf16 v[148:151], a[220:223], v[188:191], v[148:151]
  v_exp_f32 v125, v125
  v_mfma_f32_16x16x32_bf16 v[152:155], a[220:223], v[212:215], v[152:155]
  ds_read_b64_tr_b16 a[194:195], v21 offset:18432
  v_add_f32 v83, v83, v125
  v_mfma_f32_16x16x32_bf16 v[156:159], a[220:223], v[236:239], v[156:159]
  v_exp_f32 v126, v126
  s_waitcnt lgkmcnt(4)
  v_mfma_f32_16x16x32_bf16 v[144:147], a[224:227], v[168:171], v[144:147]
  ds_read_b64_tr_b16 a[196:197], v22 offset:12288
  v_add_f32 v83, v83, v126
  v_mfma_f32_16x16x32_bf16 v[148:151], a[224:227], v[192:195], v[148:151]
  buffer_load_dwordx4 v43, s[12:15], s73 offen offset:2048 lds
  v_mfma_f32_16x16x32_bf16 v[152:155], a[224:227], v[216:219], v[152:155]
  ds_read_b64_tr_b16 a[198:199], v22 offset:18432
  v_cvt_pk_bf16_f32 v51, v114, v115
  v_mfma_f32_16x16x32_bf16 v[156:159], a[224:227], v[240:243], v[156:159]
  v_exp_f32 v127, v127
  v_mfma_f32_16x16x32_bf16 v[144:147], a[228:231], v[172:175], v[144:147]
  ds_read_b64_tr_b16 a[200:201], v23 offset:12288
  v_add_f32 v83, v83, v127
  v_mfma_f32_16x16x32_bf16 v[148:151], a[228:231], v[196:199], v[148:151]
  v_cvt_pk_bf16_f32 v54, v116, v117
  v_cvt_pk_bf16_f32 v55, v118, v119
  v_mfma_f32_16x16x32_bf16 v[152:155], a[228:231], v[220:223], v[152:155]
  ds_read_b64_tr_b16 a[202:203], v23 offset:18432
  v_cvt_pk_bf16_f32 v58, v120, v121
  v_mfma_f32_16x16x32_bf16 v[156:159], a[228:231], v[244:247], v[156:159]
  v_cvt_pk_bf16_f32 v59, v122, v123
  v_cvt_pk_bf16_f32 v62, v124, v125
  s_waitcnt lgkmcnt(6)
  v_mfma_f32_16x16x32_bf16 v[144:147], a[232:235], v[176:179], v[144:147]
  ds_read_b64_tr_b16 a[204:205], v24 offset:12288
  v_cvt_pk_bf16_f32 v63, v126, v127
  v_mfma_f32_16x16x32_bf16 v[148:151], a[232:235], v[200:203], v[148:151]
  v_mfma_f32_16x16x32_bf16 v[152:155], a[232:235], v[224:227], v[152:155]
  ds_read_b64_tr_b16 a[206:207], v24 offset:18432
  v_mfma_f32_16x16x32_bf16 v[156:159], a[232:235], v[248:251], v[156:159]
  v_mfma_f32_16x16x32_bf16 v[144:147], a[236:239], v[180:183], v[144:147]
  ds_read_b64_tr_b16 a[208:209], v21 offset:12416
  v_mfma_f32_16x16x32_bf16 v[148:151], a[236:239], v[204:207], v[148:151]
  v_mfma_f32_16x16x32_bf16 v[152:155], a[236:239], v[228:231], v[152:155]
  ds_read_b64_tr_b16 a[210:211], v21 offset:18560
  v_mfma_f32_16x16x32_bf16 v[156:159], a[236:239], v[252:255], v[156:159]
  s_waitcnt lgkmcnt(6)
  v_mfma_f32_16x16x32_bf16 a[0:3], a[192:195], v[48:51], a[0:3]
  ds_read_b64_tr_b16 a[212:213], v22 offset:12416
  s_sub_u32 s79, s64, s63
  v_add_u32 v17, s79, v17
  v_mfma_f32_16x16x32_bf16 a[4:7], a[192:195], v[52:55], a[4:7]
  v_add_u32 v18, s79, v18
  v_mfma_f32_16x16x32_bf16 a[8:11], a[192:195], v[56:59], a[8:11]
  ds_read_b64_tr_b16 a[214:215], v22 offset:18560
  v_mfma_f32_16x16x32_bf16 a[12:15], a[192:195], v[60:63], a[12:15]
  v_exp_f32 v128, v128
  v_mfma_f32_16x16x32_bf16 a[16:19], a[196:199], v[48:51], a[16:19]
  ds_read_b64_tr_b16 a[216:217], v23 offset:12416
  v_add_f32 v80, v80, v128
  v_mfma_f32_16x16x32_bf16 a[20:23], a[196:199], v[52:55], a[20:23]
  v_exp_f32 v129, v129
  v_mfma_f32_16x16x32_bf16 a[24:27], a[196:199], v[56:59], a[24:27]
  ds_read_b64_tr_b16 a[218:219], v23 offset:18560
  v_add_f32 v80, v80, v129
  v_mfma_f32_16x16x32_bf16 a[28:31], a[196:199], v[60:63], a[28:31]
  v_exp_f32 v130, v130
  s_waitcnt lgkmcnt(6)
  v_mfma_f32_16x16x32_bf16 a[32:35], a[200:203], v[48:51], a[32:35]
  ds_read_b64_tr_b16 a[220:221], v24 offset:12416
  v_add_f32 v80, v80, v130
  v_mfma_f32_16x16x32_bf16 a[36:39], a[200:203], v[52:55], a[36:39]
  v_exp_f32 v131, v131
  v_mfma_f32_16x16x32_bf16 a[40:43], a[200:203], v[56:59], a[40:43]
  ds_read_b64_tr_b16 a[222:223], v24 offset:18560
  v_add_f32 v80, v80, v131
  v_mfma_f32_16x16x32_bf16 a[44:47], a[200:203], v[60:63], a[44:47]
  v_exp_f32 v132, v132
  v_mfma_f32_16x16x32_bf16 a[48:51], a[204:207], v[48:51], a[48:51]
  ds_read_b64_tr_b16 a[224:225], v21 offset:12544
  v_add_f32 v81, v81, v132
  v_mfma_f32_16x16x32_bf16 a[52:55], a[204:207], v[52:55], a[52:55]
  v_exp_f32 v133, v133
  v_mfma_f32_16x16x32_bf16 a[56:59], a[204:207], v[56:59], a[56:59]
  ds_read_b64_tr_b16 a[226:227], v21 offset:18688
  v_add_f32 v81, v81, v133
  v_mfma_f32_16x16x32_bf16 a[60:63], a[204:207], v[60:63], a[60:63]
  v_exp_f32 v134, v134
  s_waitcnt lgkmcnt(6)
  v_mfma_f32_16x16x32_bf16 a[64:67], a[208:211], v[48:51], a[64:67]
  ds_read_b64_tr_b16 a[228:229], v22 offset:12544
  v_add_f32 v81, v81, v134
  v_mfma_f32_16x16x32_bf16 a[68:71], a[208:211], v[52:55], a[68:71]
  v_exp_f32 v135, v135
  v_mfma_f32_16x16x32_bf16 a[72:75], a[208:211], v[56:59], a[72:75]
  ds_read_b64_tr_b16 a[230:231], v22 offset:18688
  v_add_f32 v81, v81, v135
  v_mfma_f32_16x16x32_bf16 a[76:79], a[208:211], v[60:63], a[76:79]
  v_exp_f32 v136, v136
  v_mfma_f32_16x16x32_bf16 a[80:83], a[212:215], v[48:51], a[80:83]
  ds_read_b64_tr_b16 a[232:233], v23 offset:12544
  s_waitcnt vmcnt(18)
  s_barrier
  v_add_f32 v82, v82, v136
  v_mfma_f32_16x16x32_bf16 a[84:87], a[212:215], v[52:55], a[84:87]
  v_exp_f32 v137, v137
  v_mfma_f32_16x16x32_bf16 a[88:91], a[212:215], v[56:59], a[88:91]
  ds_read_b64_tr_b16 a[234:235], v23 offset:18688
  v_add_f32 v82, v82, v137
  v_mfma_f32_16x16x32_bf16 a[92:95], a[212:215], v[60:63], a[92:95]
  v_exp_f32 v138, v138
  s_waitcnt lgkmcnt(6)
  v_mfma_f32_16x16x32_bf16 a[96:99], a[216:219], v[48:51], a[96:99]
  ds_read_b64_tr_b16 a[236:237], v24 offset:12544
  v_add_f32 v82, v82, v138
  v_mfma_f32_16x16x32_bf16 a[100:103], a[216:219], v[52:55], a[100:103]
  v_exp_f32 v139, v139
  v_mfma_f32_16x16x32_bf16 a[104:107], a[216:219], v[56:59], a[104:107]
  ds_read_b64_tr_b16 a[238:239], v24 offset:18688
  v_add_f32 v82, v82, v139
  v_mfma_f32_16x16x32_bf16 a[108:111], a[216:219], v[60:63], a[108:111]
  v_exp_f32 v140, v140
  v_mfma_f32_16x16x32_bf16 a[112:115], a[220:223], v[48:51], a[112:115]
  ds_read_b128 a[192:195], v17 offset:0
  v_add_f32 v83, v83, v140
  v_mfma_f32_16x16x32_bf16 a[116:119], a[220:223], v[52:55], a[116:119]
  v_exp_f32 v141, v141
  v_mfma_f32_16x16x32_bf16 a[120:123], a[220:223], v[56:59], a[120:123]
  v_exp_f32 v142, v142
  v_mfma_f32_16x16x32_bf16 a[124:127], a[220:223], v[60:63], a[124:127]
  v_add_f32 v83, v83, v141
  v_add_f32 v83, v83, v142
  s_waitcnt lgkmcnt(5)
  v_mfma_f32_16x16x32_bf16 a[128:131], a[224:227], v[48:51], a[128:131]
  ds_read_b128 a[196:199], v18 offset:0
  v_mfma_f32_16x16x32_bf16 a[132:135], a[224:227], v[52:55], a[132:135]
  v_exp_f32 v143, v143
  v_mfma_f32_16x16x32_bf16 a[136:139], a[224:227], v[56:59], a[136:139]
  v_exp_f32 v144, v144
  v_mfma_f32_16x16x32_bf16 a[140:143], a[224:227], v[60:63], a[140:143]
  v_add_f32 v83, v83, v143
  v_add_f32 v80, v80, v144
  v_mfma_f32_16x16x32_bf16 a[144:147], a[228:231], v[48:51], a[144:147]
  ds_read_b128 a[200:203], v17 offset:128
  v_mfma_f32_16x16x32_bf16 a[148:151], a[228:231], v[52:55], a[148:151]
  v_exp_f32 v145, v145
  v_mfma_f32_16x16x32_bf16 a[152:155], a[228:231], v[56:59], a[152:155]
  v_exp_f32 v146, v146
  v_mfma_f32_16x16x32_bf16 a[156:159], a[228:231], v[60:63], a[156:159]
  v_add_f32 v80, v80, v145
  v_add_f32 v80, v80, v146
  s_waitcnt lgkmcnt(3)
  v_mfma_f32_16x16x32_bf16 a[160:163], a[232:235], v[48:51], a[160:163]
  ds_read_b128 a[204:207], v18 offset:128
  v_mfma_f32_16x16x32_bf16 a[164:167], a[232:235], v[52:55], a[164:167]
  v_exp_f32 v147, v147
  v_mfma_f32_16x16x32_bf16 a[168:171], a[232:235], v[56:59], a[168:171]
  v_add_f32 v80, v80, v147
  v_mfma_f32_16x16x32_bf16 a[172:175], a[232:235], v[60:63], a[172:175]
  v_mfma_f32_16x16x32_bf16 a[176:179], a[236:239], v[48:51], a[176:179]
  ds_read_b128 a[208:211], v17 offset:256
  v_mfma_f32_16x16x32_bf16 a[180:183], a[236:239], v[52:55], a[180:183]
  v_mfma_f32_16x16x32_bf16 a[184:187], a[236:239], v[56:59], a[184:187]
  v_mfma_f32_16x16x32_bf16 a[188:191], a[236:239], v[60:63], a[188:191]
  s_mov_b32 s68, s62
  s_mov_b32 s62, s63
  s_mov_b32 s63, s64
  s_mov_b32 s64, s68
  s_waitcnt lgkmcnt(3)
  v_mfma_f32_16x16x32_bf16 v[96:99], a[192:195], v[160:163], v[64:67]
  ds_read_b128 a[212:215], v18 offset:256
  s_add_u32 m0, s64, 36864
  v_cvt_pk_bf16_f32 v48, v128, v129
  v_mfma_f32_16x16x32_bf16 v[100:103], a[192:195], v[184:187], v[68:71]
  buffer_load_dwordx4 v25, s[20:23], s61 offen offset:0 nt lds
  v_mfma_f32_16x16x32_bf16 v[104:107], a[192:195], v[208:211], v[72:75]
  v_exp_f32 v148, v148
  v_mfma_f32_16x16x32_bf16 v[108:111], a[192:195], v[232:235], v[76:79]
  v_exp_f32 v149, v149
  v_mfma_f32_16x16x32_bf16 v[96:99], a[196:199], v[164:167], v[96:99]
  ds_read_b128 a[216:219], v17 offset:6144
  v_cvt_pk_bf16_f32 v49, v130, v131
  v_mfma_f32_16x16x32_bf16 v[100:103], a[196:199], v[188:191], v[100:103]
  v_add_f32 v81, v81, v148
  v_cvt_pk_bf16_f32 v52, v132, v133
  v_mfma_f32_16x16x32_bf16 v[104:107], a[196:199], v[212:215], v[104:107]
  v_exp_f32 v150, v150
  v_mfma_f32_16x16x32_bf16 v[108:111], a[196:199], v[236:239], v[108:111]
  buffer_load_dwordx4 v26, s[20:23], s61 offen offset:1024 nt lds
  s_waitcnt lgkmcnt(3)
  v_mfma_f32_16x16x32_bf16 v[96:99], a[200:203], v[168:171], v[96:99]
  ds_read_b128 a[220:223], v18 offset:6144
  v_cvt_pk_bf16_f32 v53, v134, v135
  v_mfma_f32_16x16x32_bf16 v[100:103], a[200:203], v[192:195], v[100:103]
  v_add_f32 v81, v81, v149
  v_cvt_pk_bf16_f32 v56, v136, v137
  v_mfma_f32_16x16x32_bf16 v[104:107], a[200:203], v[216:219], v[104:107]
  v_exp_f32 v151, v151
  v_mfma_f32_16x16x32_bf16 v[108:111], a[200:203], v[240:243], v[108:111]
  v_cvt_pk_bf16_f32 v57, v138, v139
  v_add_f32 v81, v81, v150
  v_mfma_f32_16x16x32_bf16 v[96:99], a[204:207], v[172:175], v[96:99]
  ds_read_b128 a[224:227], v17 offset:6272
  v_cvt_pk_bf16_f32 v60, v140, v141
  v_mfma_f32_16x16x32_bf16 v[100:103], a[204:207], v[196:199], v[100:103]
  buffer_load_dwordx4 v27, s[20:23], s61 offen offset:2048 nt lds
  v_mfma_f32_16x16x32_bf16 v[104:107], a[204:207], v[220:223], v[104:107]
  s_add_u32 s61, s61, 12288
  s_add_u32 m0, s55, 73728
  v_exp_f32 v152, v152
  v_mfma_f32_16x16x32_bf16 v[108:111], a[204:207], v[244:247], v[108:111]
  s_add_u32 s73, s71, 393216
  v_cvt_pk_bf16_f32 v61, v142, v143
  v_add_f32 v81, v81, v151
  s_waitcnt lgkmcnt(3)
  v_mfma_f32_16x16x32_bf16 v[96:99], a[208:211], v[176:179], v[96:99]
  ds_read_b128 a[228:231], v18 offset:6272
  v_add_f32 v82, v82, v152
  v_mfma_f32_16x16x32_bf16 v[100:103], a[208:211], v[200:203], v[100:103]
  v_exp_f32 v153, v153
  v_mfma_f32_16x16x32_bf16 v[104:107], a[208:211], v[224:227], v[104:107]
  v_exp_f32 v154, v154
  v_mfma_f32_16x16x32_bf16 v[108:111], a[208:211], v[248:251], v[108:111]
  buffer_load_dwordx4 v41, s[12:15], s73 offen offset:0 lds
  v_mfma_f32_16x16x32_bf16 v[96:99], a[212:215], v[180:183], v[96:99]
  ds_read_b128 a[232:235], v17 offset:6400
  v_add_f32 v82, v82, v153
  v_mfma_f32_16x16x32_bf16 v[100:103], a[212:215], v[204:207], v[100:103]
  v_exp_f32 v155, v155
  v_mfma_f32_16x16x32_bf16 v[104:107], a[212:215], v[228:231], v[104:107]
  v_add_f32 v82, v82, v154
  v_add_f32 v82, v82, v155
  v_mfma_f32_16x16x32_bf16 v[108:111], a[212:215], v[252:255], v[108:111]
  v_exp_f32 v156, v156
  s_waitcnt lgkmcnt(3)
  v_mfma_f32_16x16x32_bf16 v[112:115], a[216:219], v[160:163], v[64:67]
  ds_read_b128 a[236:239], v18 offset:6400
  v_add_f32 v83, v83, v156
  v_mfma_f32_16x16x32_bf16 v[116:119], a[216:219], v[184:187], v[68:71]
  buffer_load_dwordx4 v42, s[12:15], s73 offen offset:1024 lds
  v_mfma_f32_16x16x32_bf16 v[120:123], a[216:219], v[208:211], v[72:75]
  v_exp_f32 v157, v157
  v_mfma_f32_16x16x32_bf16 v[124:127], a[216:219], v[232:235], v[76:79]
  v_exp_f32 v158, v158
  v_mfma_f32_16x16x32_bf16 v[112:115], a[220:223], v[164:167], v[112:115]
  ds_read_b64_tr_b16 a[192:193], v21 offset:36864
  v_add_f32 v83, v83, v157
  v_mfma_f32_16x16x32_bf16 v[116:119], a[220:223], v[188:191], v[116:119]
  v_exp_f32 v159, v159
  v_mfma_f32_16x16x32_bf16 v[120:123], a[220:223], v[212:215], v[120:123]
  ds_read_b64_tr_b16 a[194:195], v21 offset:43008
  v_add_f32 v83, v83, v158
  v_mfma_f32_16x16x32_bf16 v[124:127], a[220:223], v[236:239], v[124:127]
  buffer_load_dwordx4 v43, s[12:15], s73 offen offset:2048 lds
  s_waitcnt lgkmcnt(4)
  v_mfma_f32_16x16x32_bf16 v[112:115], a[224:227], v[168:171], v[112:115]
  ds_read_b64_tr_b16 a[196:197], v22 offset:36864
  v_add_f32 v83, v83, v159
  v_mfma_f32_16x16x32_bf16 v[116:119], a[224:227], v[192:195], v[116:119]
  v_cvt_pk_bf16_f32 v50, v144, v145
  v_cvt_pk_bf16_f32 v51, v146, v147
  v_mfma_f32_16x16x32_bf16 v[120:123], a[224:227], v[216:219], v[120:123]
  ds_read_b64_tr_b16 a[198:199], v22 offset:43008
  v_cvt_pk_bf16_f32 v54, v148, v149
  v_mfma_f32_16x16x32_bf16 v[124:127], a[224:227], v[240:243], v[124:127]
  v_cvt_pk_bf16_f32 v55, v150, v151
  v_cvt_pk_bf16_f32 v58, v152, v153
  v_mfma_f32_16x16x32_bf16 v[112:115], a[228:231], v[172:175], v[112:115]
  ds_read_b64_tr_b16 a[200:201], v23 offset:36864
  v_cvt_pk_bf16_f32 v59, v154, v155
  v_mfma_f32_16x16x32_bf16 v[116:119], a[228:231], v[196:199], v[116:119]
  v_cvt_pk_bf16_f32 v62, v156, v157
  v_cvt_pk_bf16_f32 v63, v158, v159
  v_mfma_f32_16x16x32_bf16 v[120:123], a[228:231], v[220:223], v[120:123]
  ds_read_b64_tr_b16 a[202:203], v23 offset:43008
  v_mfma_f32_16x16x32_bf16 v[124:127], a[228:231], v[244:247], v[124:127]
  s_waitcnt lgkmcnt(6)
  v_mfma_f32_16x16x32_bf16 v[112:115], a[232:235], v[176:179], v[112:115]
  ds_read_b64_tr_b16 a[204:205], v24 offset:36864
  v_mfma_f32_16x16x32_bf16 v[116:119], a[232:235], v[200:203], v[116:119]
  v_mfma_f32_16x16x32_bf16 v[120:123], a[232:235], v[224:227], v[120:123]
  ds_read_b64_tr_b16 a[206:207], v24 offset:43008
  v_mfma_f32_16x16x32_bf16 v[124:127], a[232:235], v[248:251], v[124:127]
  v_mfma_f32_16x16x32_bf16 v[112:115], a[236:239], v[180:183], v[112:115]
  ds_read_b64_tr_b16 a[208:209], v21 offset:36992
  v_mfma_f32_16x16x32_bf16 v[116:119], a[236:239], v[204:207], v[116:119]
  v_mfma_f32_16x16x32_bf16 v[120:123], a[236:239], v[228:231], v[120:123]
  ds_read_b64_tr_b16 a[210:211], v21 offset:43136
  v_mfma_f32_16x16x32_bf16 v[124:127], a[236:239], v[252:255], v[124:127]
  s_waitcnt lgkmcnt(6)
  v_mfma_f32_16x16x32_bf16 a[0:3], a[192:195], v[48:51], a[0:3]
  ds_read_b64_tr_b16 a[212:213], v22 offset:36992
  v_mfma_f32_16x16x32_bf16 a[4:7], a[192:195], v[52:55], a[4:7]
  v_exp_f32 v96, v96
  v_mfma_f32_16x16x32_bf16 a[8:11], a[192:195], v[56:59], a[8:11]
  ds_read_b64_tr_b16 a[214:215], v22 offset:43136
  v_add_f32 v80, v80, v96
  v_mfma_f32_16x16x32_bf16 a[12:15], a[192:195], v[60:63], a[12:15]
  v_exp_f32 v97, v97
  v_mfma_f32_16x16x32_bf16 a[16:19], a[196:199], v[48:51], a[16:19]
  ds_read_b64_tr_b16 a[216:217], v23 offset:36992
  v_add_f32 v80, v80, v97
  v_mfma_f32_16x16x32_bf16 a[20:23], a[196:199], v[52:55], a[20:23]
  v_exp_f32 v98, v98
  v_mfma_f32_16x16x32_bf16 a[24:27], a[196:199], v[56:59], a[24:27]
  ds_read_b64_tr_b16 a[218:219], v23 offset:43136
  v_add_f32 v80, v80, v98
  v_mfma_f32_16x16x32_bf16 a[28:31], a[196:199], v[60:63], a[28:31]
  v_exp_f32 v99, v99
  s_waitcnt lgkmcnt(6)
  v_mfma_f32_16x16x32_bf16 a[32:35], a[200:203], v[48:51], a[32:35]
  ds_read_b64_tr_b16 a[220:221], v24 offset:36992
  v_add_f32 v80, v80, v99
  v_mfma_f32_16x16x32_bf16 a[36:39], a[200:203], v[52:55], a[36:39]
  v_exp_f32 v100, v100
  v_mfma_f32_16x16x32_bf16 a[40:43], a[200:203], v[56:59], a[40:43]
  ds_read_b64_tr_b16 a[222:223], v24 offset:43136
  v_add_f32 v81, v81, v100
  v_mfma_f32_16x16x32_bf16 a[44:47], a[200:203], v[60:63], a[44:47]
  v_exp_f32 v101, v101
  v_mfma_f32_16x16x32_bf16 a[48:51], a[204:207], v[48:51], a[48:51]
  ds_read_b64_tr_b16 a[224:225], v21 offset:37120
  v_add_f32 v81, v81, v101
  v_mfma_f32_16x16x32_bf16 a[52:55], a[204:207], v[52:55], a[52:55]
  v_exp_f32 v102, v102
  v_mfma_f32_16x16x32_bf16 a[56:59], a[204:207], v[56:59], a[56:59]
  ds_read_b64_tr_b16 a[226:227], v21 offset:43264
  v_add_f32 v81, v81, v102
  v_mfma_f32_16x16x32_bf16 a[60:63], a[204:207], v[60:63], a[60:63]
  v_exp_f32 v103, v103
  s_waitcnt lgkmcnt(6)
  v_mfma_f32_16x16x32_bf16 a[64:67], a[208:211], v[48:51], a[64:67]
  ds_read_b64_tr_b16 a[228:229], v22 offset:37120
  v_add_f32 v81, v81, v103
  v_mfma_f32_16x16x32_bf16 a[68:71], a[208:211], v[52:55], a[68:71]
  v_exp_f32 v104, v104
  v_mfma_f32_16x16x32_bf16 a[72:75], a[208:211], v[56:59], a[72:75]
  ds_read_b64_tr_b16 a[230:231], v22 offset:43264
  v_add_f32 v82, v82, v104
  v_mfma_f32_16x16x32_bf16 a[76:79], a[208:211], v[60:63], a[76:79]
  v_exp_f32 v105, v105
  v_mfma_f32_16x16x32_bf16 a[80:83], a[212:215], v[48:51], a[80:83]
  ds_read_b64_tr_b16 a[232:233], v23 offset:37120
  s_waitcnt vmcnt(18)
  s_barrier
  v_add_f32 v82, v82, v105
  v_mfma_f32_16x16x32_bf16 a[84:87], a[212:215], v[52:55], a[84:87]
  v_exp_f32 v106, v106
  v_mfma_f32_16x16x32_bf16 a[88:91], a[212:215], v[56:59], a[88:91]
  ds_read_b64_tr_b16 a[234:235], v23 offset:43264
  v_add_f32 v82, v82, v106
  v_mfma_f32_16x16x32_bf16 a[92:95], a[212:215], v[60:63], a[92:95]
  v_exp_f32 v107, v107
  s_waitcnt lgkmcnt(6)
  v_mfma_f32_16x16x32_bf16 a[96:99], a[216:219], v[48:51], a[96:99]
  ds_read_b64_tr_b16 a[236:237], v24 offset:37120
  v_add_f32 v82, v82, v107
  v_mfma_f32_16x16x32_bf16 a[100:103], a[216:219], v[52:55], a[100:103]
  v_exp_f32 v108, v108
  v_mfma_f32_16x16x32_bf16 a[104:107], a[216:219], v[56:59], a[104:107]
  ds_read_b64_tr_b16 a[238:239], v24 offset:43264
  v_add_f32 v83, v83, v108
  v_mfma_f32_16x16x32_bf16 a[108:111], a[216:219], v[60:63], a[108:111]
  v_exp_f32 v109, v109
  v_mfma_f32_16x16x32_bf16 a[112:115], a[220:223], v[48:51], a[112:115]
  ds_read_b128 a[192:195], v17 offset:24576
  v_add_f32 v83, v83, v109
  v_mfma_f32_16x16x32_bf16 a[116:119], a[220:223], v[52:55], a[116:119]
  v_exp_f32 v110, v110
  v_mfma_f32_16x16x32_bf16 a[120:123], a[220:223], v[56:59], a[120:123]
  v_exp_f32 v111, v111
  v_mfma_f32_16x16x32_bf16 a[124:127], a[220:223], v[60:63], a[124:127]
  v_add_f32 v83, v83, v110
  v_add_f32 v83, v83, v111
  s_waitcnt lgkmcnt(5)
  v_mfma_f32_16x16x32_bf16 a[128:131], a[224:227], v[48:51], a[128:131]
  ds_read_b128 a[196:199], v18 offset:24576
  v_mfma_f32_16x16x32_bf16 a[132:135], a[224:227], v[52:55], a[132:135]
  v_exp_f32 v112, v112
  v_mfma_f32_16x16x32_bf16 a[136:139], a[224:227], v[56:59], a[136:139]
  v_exp_f32 v113, v113
  v_mfma_f32_16x16x32_bf16 a[140:143], a[224:227], v[60:63], a[140:143]
  v_add_f32 v80, v80, v112
  v_add_f32 v80, v80, v113
  v_mfma_f32_16x16x32_bf16 a[144:147], a[228:231], v[48:51], a[144:147]
  ds_read_b128 a[200:203], v17 offset:24704
  v_mfma_f32_16x16x32_bf16 a[148:151], a[228:231], v[52:55], a[148:151]
  v_exp_f32 v114, v114
  v_mfma_f32_16x16x32_bf16 a[152:155], a[228:231], v[56:59], a[152:155]
  v_exp_f32 v115, v115
  v_mfma_f32_16x16x32_bf16 a[156:159], a[228:231], v[60:63], a[156:159]
  v_add_f32 v80, v80, v114
  v_add_f32 v80, v80, v115
  s_waitcnt lgkmcnt(3)
  v_mfma_f32_16x16x32_bf16 a[160:163], a[232:235], v[48:51], a[160:163]
  ds_read_b128 a[204:207], v18 offset:24704
  v_mfma_f32_16x16x32_bf16 a[164:167], a[232:235], v[52:55], a[164:167]
  v_mfma_f32_16x16x32_bf16 a[168:171], a[232:235], v[56:59], a[168:171]
  v_mfma_f32_16x16x32_bf16 a[172:175], a[232:235], v[60:63], a[172:175]
  v_mfma_f32_16x16x32_bf16 a[176:179], a[236:239], v[48:51], a[176:179]
  ds_read_b128 a[208:211], v17 offset:24832
  v_mfma_f32_16x16x32_bf16 a[180:183], a[236:239], v[52:55], a[180:183]
  v_mfma_f32_16x16x32_bf16 a[184:187], a[236:239], v[56:59], a[184:187]
  v_mfma_f32_16x16x32_bf16 a[188:191], a[236:239], v[60:63], a[188:191]
  s_waitcnt lgkmcnt(3)
  v_mfma_f32_16x16x32_bf16 v[128:131], a[192:195], v[160:163], v[64:67]
  ds_read_b128 a[212:215], v18 offset:24832
  s_sub_u32 s3, s63, s62
  v_add_u32 v21, s3, v21
  s_add_u32 m0, s55, 61440
  v_mfma_f32_16x16x32_bf16 v[132:135], a[192:195], v[184:187], v[68:71]
  v_add_u32 v22, s3, v22
  v_add_u32 v23, s3, v23
  s_add_u32 s73, s71, 786432
  v_mfma_f32_16x16x32_bf16 v[136:139], a[192:195], v[208:211], v[72:75]
  v_add_u32 v24, s3, v24
  v_cvt_pk_bf16_f32 v48, v96, v97
  v_mfma_f32_16x16x32_bf16 v[140:143], a[192:195], v[232:235], v[76:79]
  buffer_load_dwordx4 v41, s[12:15], s73 offen offset:0 lds
  v_mfma_f32_16x16x32_bf16 v[128:131], a[196:199], v[164:167], v[128:131]
  ds_read_b128 a[216:219], v17 offset:30720
  v_cvt_pk_bf16_f32 v49, v98, v99
  v_mfma_f32_16x16x32_bf16 v[132:135], a[196:199], v[188:191], v[132:135]
  v_exp_f32 v116, v116
  v_mfma_f32_16x16x32_bf16 v[136:139], a[196:199], v[212:215], v[136:139]
  v_exp_f32 v117, v117
  v_mfma_f32_16x16x32_bf16 v[140:143], a[196:199], v[236:239], v[140:143]
  v_add_f32 v81, v81, v116
  v_cvt_pk_bf16_f32 v52, v100, v101
  s_waitcnt lgkmcnt(3)
  v_mfma_f32_16x16x32_bf16 v[128:131], a[200:203], v[168:171], v[128:131]
  ds_read_b128 a[220:223], v18 offset:30720
  v_cvt_pk_bf16_f32 v53, v102, v103
  v_mfma_f32_16x16x32_bf16 v[132:135], a[200:203], v[192:195], v[132:135]
  buffer_load_dwordx4 v42, s[12:15], s73 offen offset:1024 lds
  v_mfma_f32_16x16x32_bf16 v[136:139], a[200:203], v[216:219], v[136:139]
  v_exp_f32 v118, v118
  v_mfma_f32_16x16x32_bf16 v[140:143], a[200:203], v[240:243], v[140:143]
  v_add_f32 v81, v81, v117
  v_cvt_pk_bf16_f32 v56, v104, v105
  v_mfma_f32_16x16x32_bf16 v[128:131], a[204:207], v[172:175], v[128:131]
  ds_read_b128 a[224:227], v17 offset:30848
  v_cvt_pk_bf16_f32 v57, v106, v107
  v_mfma_f32_16x16x32_bf16 v[132:135], a[204:207], v[196:199], v[132:135]
  v_exp_f32 v119, v119
  v_mfma_f32_16x16x32_bf16 v[136:139], a[204:207], v[220:223], v[136:139]
  v_add_f32 v81, v81, v118
  v_cvt_pk_bf16_f32 v60, v108, v109
  v_mfma_f32_16x16x32_bf16 v[140:143], a[204:207], v[244:247], v[140:143]
  buffer_load_dwordx4 v43, s[12:15], s73 offen offset:2048 lds
  s_waitcnt lgkmcnt(3)
  v_mfma_f32_16x16x32_bf16 v[128:131], a[208:211], v[176:179], v[128:131]
  ds_read_b128 a[228:231], v18 offset:30848
  s_cmp_eq_u32 s56, 0
  s_cselect_b32 s18, 393216, 0
  s_add_u32 s16, s40, s78
  s_addc_u32 s17, s41, 0
  s_mov_b32 s6, 0
  s_lshr_b32 s68, s2, 3
  s_lshl_b32 s68, s68, 2
  s_add_u32 s68, s68, s54
  s_and_b32 s69, s2, 1
  s_mul_i32 s69, s69, 1310720
  s_mul_i32 s68, s68, 10240
  s_add_u32 s69, s69, s68
  v_cvt_pk_bf16_f32 v61, v110, v111
  v_mfma_f32_16x16x32_bf16 v[132:135], a[208:211], v[200:203], v[132:135]
  v_exp_f32 v120, v120
  v_mfma_f32_16x16x32_bf16 v[136:139], a[208:211], v[224:227], v[136:139]
  v_add_f32 v81, v81, v119
  v_add_f32 v82, v82, v120
  v_mfma_f32_16x16x32_bf16 v[140:143], a[208:211], v[248:251], v[140:143]
  v_exp_f32 v121, v121
  v_mfma_f32_16x16x32_bf16 v[128:131], a[212:215], v[180:183], v[128:131]
  ds_read_b128 a[232:235], v17 offset:30976
  v_add_f32 v82, v82, v121
  v_mfma_f32_16x16x32_bf16 v[132:135], a[212:215], v[204:207], v[132:135]
  buffer_load_dword v47, v45, s[8:11], s69 offen
  v_mfma_f32_16x16x32_bf16 v[136:139], a[212:215], v[228:231], v[136:139]
  v_min_u32 v4, 1920, v45
  s_add_u32 s69, s69, 8192
  v_cvt_pk_bf16_f32 v50, v112, v113
  v_mfma_f32_16x16x32_bf16 v[140:143], a[212:215], v[252:255], v[140:143]
  v_exp_f32 v122, v122
  s_waitcnt lgkmcnt(3)
  v_mfma_f32_16x16x32_bf16 v[144:147], a[216:219], v[160:163], v[64:67]
  ds_read_b128 a[236:239], v18 offset:30976
  v_add_f32 v82, v82, v122
  v_mfma_f32_16x16x32_bf16 v[148:151], a[216:219], v[184:187], v[68:71]
  v_exp_f32 v123, v123
  v_mfma_f32_16x16x32_bf16 v[152:155], a[216:219], v[208:211], v[72:75]
  v_exp_f32 v124, v124
  v_mfma_f32_16x16x32_bf16 v[156:159], a[216:219], v[232:235], v[76:79]
  buffer_load_dword v47, v4, s[8:11], s69 offen
  v_mfma_f32_16x16x32_bf16 v[144:147], a[220:223], v[164:167], v[144:147]
  ds_read_b64_tr_b16 a[192:193], v21 offset:12288
  v_add_f32 v82, v82, v123
  v_mfma_f32_16x16x32_bf16 v[148:151], a[220:223], v[188:191], v[148:151]
  v_exp_f32 v125, v125
  v_mfma_f32_16x16x32_bf16 v[152:155], a[220:223], v[212:215], v[152:155]
  ds_read_b64_tr_b16 a[194:195], v21 offset:18432
  v_add_f32 v83, v83, v124
  v_mfma_f32_16x16x32_bf16 v[156:159], a[220:223], v[236:239], v[156:159]
  v_exp_f32 v126, v126
  s_waitcnt lgkmcnt(4)
  v_mfma_f32_16x16x32_bf16 v[144:147], a[224:227], v[168:171], v[144:147]
  ds_read_b64_tr_b16 a[196:197], v22 offset:12288
  v_add_f32 v83, v83, v125
  v_mfma_f32_16x16x32_bf16 v[148:151], a[224:227], v[192:195], v[148:151]
  v_exp_f32 v127, v127
  v_mfma_f32_16x16x32_bf16 v[152:155], a[224:227], v[216:219], v[152:155]
  ds_read_b64_tr_b16 a[198:199], v22 offset:18432
  v_add_f32 v83, v83, v126
  v_mfma_f32_16x16x32_bf16 v[156:159], a[224:227], v[240:243], v[156:159]
  v_add_f32 v83, v83, v127
  v_cvt_pk_bf16_f32 v51, v114, v115
  v_mfma_f32_16x16x32_bf16 v[144:147], a[228:231], v[172:175], v[144:147]
  ds_read_b64_tr_b16 a[200:201], v23 offset:12288
  v_cvt_pk_bf16_f32 v54, v116, v117
  v_mfma_f32_16x16x32_bf16 v[148:151], a[228:231], v[196:199], v[148:151]
  v_cvt_pk_bf16_f32 v55, v118, v119
  v_cvt_pk_bf16_f32 v58, v120, v121
  v_mfma_f32_16x16x32_bf16 v[152:155], a[228:231], v[220:223], v[152:155]
  ds_read_b64_tr_b16 a[202:203], v23 offset:18432
  v_cvt_pk_bf16_f32 v59, v122, v123
  v_mfma_f32_16x16x32_bf16 v[156:159], a[228:231], v[244:247], v[156:159]
  v_cvt_pk_bf16_f32 v62, v124, v125
  v_cvt_pk_bf16_f32 v63, v126, v127
  s_waitcnt lgkmcnt(6)
  v_mfma_f32_16x16x32_bf16 v[144:147], a[232:235], v[176:179], v[144:147]
  ds_read_b64_tr_b16 a[204:205], v24 offset:12288
  v_mfma_f32_16x16x32_bf16 v[148:151], a[232:235], v[200:203], v[148:151]
  v_mfma_f32_16x16x32_bf16 v[152:155], a[232:235], v[224:227], v[152:155]
  ds_read_b64_tr_b16 a[206:207], v24 offset:18432
  v_mfma_f32_16x16x32_bf16 v[156:159], a[232:235], v[248:251], v[156:159]
  v_mfma_f32_16x16x32_bf16 v[144:147], a[236:239], v[180:183], v[144:147]
  ds_read_b64_tr_b16 a[208:209], v21 offset:12416
  v_mfma_f32_16x16x32_bf16 v[148:151], a[236:239], v[204:207], v[148:151]
  v_mfma_f32_16x16x32_bf16 v[152:155], a[236:239], v[228:231], v[152:155]
  ds_read_b64_tr_b16 a[210:211], v21 offset:18560
  v_mfma_f32_16x16x32_bf16 v[156:159], a[236:239], v[252:255], v[156:159]
  s_waitcnt lgkmcnt(6)
  v_mfma_f32_16x16x32_bf16 a[0:3], a[192:195], v[48:51], a[0:3]
  ds_read_b64_tr_b16 a[212:213], v22 offset:12416
  s_sub_u32 s79, s64, s63
  v_add_u32 v17, s79, v17
  v_mfma_f32_16x16x32_bf16 a[4:7], a[192:195], v[52:55], a[4:7]
  v_add_u32 v18, s79, v18
  v_mfma_f32_16x16x32_bf16 a[8:11], a[192:195], v[56:59], a[8:11]
  ds_read_b64_tr_b16 a[214:215], v22 offset:18560
  v_mfma_f32_16x16x32_bf16 a[12:15], a[192:195], v[60:63], a[12:15]
  v_exp_f32 v128, v128
  v_mfma_f32_16x16x32_bf16 a[16:19], a[196:199], v[48:51], a[16:19]
  ds_read_b64_tr_b16 a[216:217], v23 offset:12416
  v_add_f32 v80, v80, v128
  v_mfma_f32_16x16x32_bf16 a[20:23], a[196:199], v[52:55], a[20:23]
  v_exp_f32 v129, v129
  v_mfma_f32_16x16x32_bf16 a[24:27], a[196:199], v[56:59], a[24:27]
  ds_read_b64_tr_b16 a[218:219], v23 offset:18560
  v_add_f32 v80, v80, v129
  v_mfma_f32_16x16x32_bf16 a[28:31], a[196:199], v[60:63], a[28:31]
  v_exp_f32 v130, v130
  s_waitcnt lgkmcnt(6)
  v_mfma_f32_16x16x32_bf16 a[32:35], a[200:203], v[48:51], a[32:35]
  ds_read_b64_tr_b16 a[220:221], v24 offset:12416
  v_add_f32 v80, v80, v130
  v_mfma_f32_16x16x32_bf16 a[36:39], a[200:203], v[52:55], a[36:39]
  v_exp_f32 v131, v131
  v_mfma_f32_16x16x32_bf16 a[40:43], a[200:203], v[56:59], a[40:43]
  ds_read_b64_tr_b16 a[222:223], v24 offset:18560
  v_add_f32 v80, v80, v131
  v_mfma_f32_16x16x32_bf16 a[44:47], a[200:203], v[60:63], a[44:47]
  v_exp_f32 v132, v132
  v_mfma_f32_16x16x32_bf16 a[48:51], a[204:207], v[48:51], a[48:51]
  ds_read_b64_tr_b16 a[224:225], v21 offset:12544
  v_add_f32 v81, v81, v132
  v_mfma_f32_16x16x32_bf16 a[52:55], a[204:207], v[52:55], a[52:55]
  v_exp_f32 v133, v133
  v_mfma_f32_16x16x32_bf16 a[56:59], a[204:207], v[56:59], a[56:59]
  ds_read_b64_tr_b16 a[226:227], v21 offset:18688
  v_add_f32 v81, v81, v133
  v_mfma_f32_16x16x32_bf16 a[60:63], a[204:207], v[60:63], a[60:63]
  v_exp_f32 v134, v134
  s_waitcnt lgkmcnt(6)
  v_mfma_f32_16x16x32_bf16 a[64:67], a[208:211], v[48:51], a[64:67]
  ds_read_b64_tr_b16 a[228:229], v22 offset:12544
  v_add_f32 v81, v81, v134
  v_mfma_f32_16x16x32_bf16 a[68:71], a[208:211], v[52:55], a[68:71]
  v_exp_f32 v135, v135
  v_mfma_f32_16x16x32_bf16 a[72:75], a[208:211], v[56:59], a[72:75]
  ds_read_b64_tr_b16 a[230:231], v22 offset:18688
  v_add_f32 v81, v81, v135
  v_mfma_f32_16x16x32_bf16 a[76:79], a[208:211], v[60:63], a[76:79]
  v_exp_f32 v136, v136
  v_mfma_f32_16x16x32_bf16 a[80:83], a[212:215], v[48:51], a[80:83]
  ds_read_b64_tr_b16 a[232:233], v23 offset:12544
  s_waitcnt vmcnt(17)
  s_barrier
  v_add_f32 v82, v82, v136
  v_mfma_f32_16x16x32_bf16 a[84:87], a[212:215], v[52:55], a[84:87]
  v_exp_f32 v137, v137
  v_mfma_f32_16x16x32_bf16 a[88:91], a[212:215], v[56:59], a[88:91]
  ds_read_b64_tr_b16 a[234:235], v23 offset:18688
  v_add_f32 v82, v82, v137
  v_mfma_f32_16x16x32_bf16 a[92:95], a[212:215], v[60:63], a[92:95]
  v_exp_f32 v138, v138
  s_waitcnt lgkmcnt(6)
  v_mfma_f32_16x16x32_bf16 a[96:99], a[216:219], v[48:51], a[96:99]
  ds_read_b64_tr_b16 a[236:237], v24 offset:12544
  v_add_f32 v82, v82, v138
  v_mfma_f32_16x16x32_bf16 a[100:103], a[216:219], v[52:55], a[100:103]
  v_exp_f32 v139, v139
  v_mfma_f32_16x16x32_bf16 a[104:107], a[216:219], v[56:59], a[104:107]
  ds_read_b64_tr_b16 a[238:239], v24 offset:18688
  v_add_f32 v82, v82, v139
  v_mfma_f32_16x16x32_bf16 a[108:111], a[216:219], v[60:63], a[108:111]
  v_exp_f32 v140, v140
  v_mfma_f32_16x16x32_bf16 a[112:115], a[220:223], v[48:51], a[112:115]
  ds_read_b128 a[192:195], v17 offset:0
  v_add_f32 v83, v83, v140
  v_mfma_f32_16x16x32_bf16 a[116:119], a[220:223], v[52:55], a[116:119]
  v_exp_f32 v141, v141
  v_mfma_f32_16x16x32_bf16 a[120:123], a[220:223], v[56:59], a[120:123]
  v_exp_f32 v142, v142
  v_mfma_f32_16x16x32_bf16 a[124:127], a[220:223], v[60:63], a[124:127]
  v_add_f32 v83, v83, v141
  v_add_f32 v83, v83, v142
  s_waitcnt lgkmcnt(5)
  v_mfma_f32_16x16x32_bf16 a[128:131], a[224:227], v[48:51], a[128:131]
  ds_read_b128 a[196:199], v18 offset:0
  v_mfma_f32_16x16x32_bf16 a[132:135], a[224:227], v[52:55], a[132:135]
  v_exp_f32 v143, v143
  v_mfma_f32_16x16x32_bf16 a[136:139], a[224:227], v[56:59], a[136:139]
  v_exp_f32 v144, v144
  v_mfma_f32_16x16x32_bf16 a[140:143], a[224:227], v[60:63], a[140:143]
  v_add_f32 v83, v83, v143
  v_add_f32 v80, v80, v144
  v_mfma_f32_16x16x32_bf16 a[144:147], a[228:231], v[48:51], a[144:147]
  ds_read_b128 a[200:203], v17 offset:128
  v_mfma_f32_16x16x32_bf16 a[148:151], a[228:231], v[52:55], a[148:151]
  v_exp_f32 v145, v145
  v_mfma_f32_16x16x32_bf16 a[152:155], a[228:231], v[56:59], a[152:155]
  v_exp_f32 v146, v146
  v_mfma_f32_16x16x32_bf16 a[156:159], a[228:231], v[60:63], a[156:159]
  v_add_f32 v80, v80, v145
  v_add_f32 v80, v80, v146
  s_waitcnt lgkmcnt(3)
  v_mfma_f32_16x16x32_bf16 a[160:163], a[232:235], v[48:51], a[160:163]
  ds_read_b128 a[204:207], v18 offset:128
  v_mfma_f32_16x16x32_bf16 a[164:167], a[232:235], v[52:55], a[164:167]
  v_exp_f32 v147, v147
  v_mfma_f32_16x16x32_bf16 a[168:171], a[232:235], v[56:59], a[168:171]
  v_add_f32 v80, v80, v147
  v_mfma_f32_16x16x32_bf16 a[172:175], a[232:235], v[60:63], a[172:175]
  v_mfma_f32_16x16x32_bf16 a[176:179], a[236:239], v[48:51], a[176:179]
  ds_read_b128 a[208:211], v17 offset:256
  v_mfma_f32_16x16x32_bf16 a[180:183], a[236:239], v[52:55], a[180:183]
  v_mfma_f32_16x16x32_bf16 a[184:187], a[236:239], v[56:59], a[184:187]
  v_mfma_f32_16x16x32_bf16 a[188:191], a[236:239], v[60:63], a[188:191]
  s_mov_b32 s68, s62
  s_mov_b32 s62, s63
  s_mov_b32 s63, s64
  s_mov_b32 s64, s68
  s_waitcnt lgkmcnt(3)
  v_mfma_f32_16x16x32_bf16 v[96:99], a[192:195], v[160:163], v[64:67]
  ds_read_b128 a[212:215], v18 offset:256
  s_add_u32 m0, s55, 86016
  v_cvt_pk_bf16_f32 v48, v128, v129
  v_mfma_f32_16x16x32_bf16 v[100:103], a[192:195], v[184:187], v[68:71]
  s_add_u32 s73, s71, 1179648
  buffer_load_dwordx4 v41, s[12:15], s73 offen offset:0 lds
  v_mfma_f32_16x16x32_bf16 v[104:107], a[192:195], v[208:211], v[72:75]
  v_exp_f32 v148, v148
  v_mfma_f32_16x16x32_bf16 v[108:111], a[192:195], v[232:235], v[76:79]
  v_exp_f32 v149, v149
  v_mfma_f32_16x16x32_bf16 v[96:99], a[196:199], v[164:167], v[96:99]
  ds_read_b128 a[216:219], v17 offset:6144
  v_cvt_pk_bf16_f32 v49, v130, v131
  v_mfma_f32_16x16x32_bf16 v[100:103], a[196:199], v[188:191], v[100:103]
  v_add_f32 v81, v81, v148
  v_cvt_pk_bf16_f32 v52, v132, v133
  v_mfma_f32_16x16x32_bf16 v[104:107], a[196:199], v[212:215], v[104:107]
  v_exp_f32 v150, v150
  v_mfma_f32_16x16x32_bf16 v[108:111], a[196:199], v[236:239], v[108:111]
  buffer_load_dwordx4 v42, s[12:15], s73 offen offset:1024 lds
  s_waitcnt lgkmcnt(3)
  v_mfma_f32_16x16x32_bf16 v[96:99], a[200:203], v[168:171], v[96:99]
  ds_read_b128 a[220:223], v18 offset:6144
  v_cvt_pk_bf16_f32 v53, v134, v135
  v_mfma_f32_16x16x32_bf16 v[100:103], a[200:203], v[192:195], v[100:103]
  v_add_f32 v81, v81, v149
  v_cvt_pk_bf16_f32 v56, v136, v137
  v_mfma_f32_16x16x32_bf16 v[104:107], a[200:203], v[216:219], v[104:107]
  v_exp_f32 v151, v151
  v_mfma_f32_16x16x32_bf16 v[108:111], a[200:203], v[240:243], v[108:111]
  v_cvt_pk_bf16_f32 v57, v138, v139
  v_add_f32 v81, v81, v150
  v_mfma_f32_16x16x32_bf16 v[96:99], a[204:207], v[172:175], v[96:99]
  ds_read_b128 a[224:227], v17 offset:6272
  v_cvt_pk_bf16_f32 v60, v140, v141
  v_mfma_f32_16x16x32_bf16 v[100:103], a[204:207], v[196:199], v[100:103]
  buffer_load_dwordx4 v43, s[12:15], s73 offen offset:2048 lds
  v_mfma_f32_16x16x32_bf16 v[104:107], a[204:207], v[220:223], v[104:107]
  s_lshr_b32 s68, s2, 3
  s_lshl_b32 s68, s68, 2
  s_add_u32 s68, s68, s54
  s_bfe_u32 s69, s2, 0x20001
  s_mul_i32 s69, s69, 3072
  s_mul_i32 s68, s68, 61440
  s_add_u32 s69, s69, s68
  v_exp_f32 v152, v152
  v_mfma_f32_16x16x32_bf16 v[108:111], a[204:207], v[244:247], v[108:111]
  v_cvt_pk_bf16_f32 v61, v142, v143
  v_add_f32 v81, v81, v151
  s_waitcnt lgkmcnt(3)
  v_mfma_f32_16x16x32_bf16 v[96:99], a[208:211], v[176:179], v[96:99]
  ds_read_b128 a[228:231], v18 offset:6272
  v_add_f32 v82, v82, v152
  v_mfma_f32_16x16x32_bf16 v[100:103], a[208:211], v[200:203], v[100:103]
  v_exp_f32 v153, v153
  v_mfma_f32_16x16x32_bf16 v[104:107], a[208:211], v[224:227], v[104:107]
  v_exp_f32 v154, v154
  v_mfma_f32_16x16x32_bf16 v[108:111], a[208:211], v[248:251], v[108:111]
  buffer_load_dword v47, v46, s[12:15], s69 offen
  v_mfma_f32_16x16x32_bf16 v[96:99], a[212:215], v[180:183], v[96:99]
  ds_read_b128 a[232:235], v17 offset:6400
  s_add_u32 s69, s69, 24576
  v_add_f32 v82, v82, v153
  v_mfma_f32_16x16x32_bf16 v[100:103], a[212:215], v[204:207], v[100:103]
  v_exp_f32 v155, v155
  v_mfma_f32_16x16x32_bf16 v[104:107], a[212:215], v[228:231], v[104:107]
  v_add_f32 v82, v82, v154
  v_add_f32 v82, v82, v155
  v_mfma_f32_16x16x32_bf16 v[108:111], a[212:215], v[252:255], v[108:111]
  v_exp_f32 v156, v156
  s_waitcnt lgkmcnt(3)
  v_mfma_f32_16x16x32_bf16 v[112:115], a[216:219], v[160:163], v[64:67]
  ds_read_b128 a[236:239], v18 offset:6400
  v_add_f32 v83, v83, v156
  v_mfma_f32_16x16x32_bf16 v[116:119], a[216:219], v[184:187], v[68:71]
  buffer_load_dword v47, v46, s[12:15], s69 offen
  v_mfma_f32_16x16x32_bf16 v[120:123], a[216:219], v[208:211], v[72:75]
  v_min_u32 v4, 2944, v45
  s_add_u32 s69, s69, 24576
  v_cvt_pk_bf16_f32 v50, v144, v145
  v_mfma_f32_16x16x32_bf16 v[124:127], a[216:219], v[232:235], v[76:79]
  v_exp_f32 v157, v157
  v_mfma_f32_16x16x32_bf16 v[112:115], a[220:223], v[164:167], v[112:115]
  ds_read_b64_tr_b16 a[192:193], v21 offset:36864
  v_add_f32 v83, v83, v157
  v_mfma_f32_16x16x32_bf16 v[116:119], a[220:223], v[188:191], v[116:119]
  v_exp_f32 v158, v158
  v_mfma_f32_16x16x32_bf16 v[120:123], a[220:223], v[212:215], v[120:123]
  ds_read_b64_tr_b16 a[194:195], v21 offset:43008
  v_add_f32 v83, v83, v158
  v_mfma_f32_16x16x32_bf16 v[124:127], a[220:223], v[236:239], v[124:127]
  buffer_load_dword v47, v4, s[12:15], s69 offen
  s_waitcnt lgkmcnt(4)
  v_mfma_f32_16x16x32_bf16 v[112:115], a[224:227], v[168:171], v[112:115]
  ds_read_b64_tr_b16 a[196:197], v22 offset:36864
  s_cmp_lt_u32 s2, 128
  s_cselect_b32 s4, s36, s46
  s_cselect_b32 s5, s37, s47
  s_cmp_eq_u32 s56, 0
  s_cselect_b32 s6, 0, 7864320
  s_and_b32 s68, s2, 127
  s_lshl_b32 s68, s68, 2
  s_add_u32 s68, s68, s54
  s_mul_i32 s69, s68, 15360
  v_cvt_pk_bf16_f32 v51, v146, v147
  v_mfma_f32_16x16x32_bf16 v[116:119], a[224:227], v[192:195], v[116:119]
  v_exp_f32 v159, v159
  v_mfma_f32_16x16x32_bf16 v[120:123], a[224:227], v[216:219], v[120:123]
  ds_read_b64_tr_b16 a[198:199], v22 offset:43008
  v_add_f32 v83, v83, v159
  v_mfma_f32_16x16x32_bf16 v[124:127], a[224:227], v[240:243], v[124:127]
  v_cvt_pk_bf16_f32 v54, v148, v149
  v_cvt_pk_bf16_f32 v55, v150, v151
  v_mfma_f32_16x16x32_bf16 v[112:115], a[228:231], v[172:175], v[112:115]
  ds_read_b64_tr_b16 a[200:201], v23 offset:36864
  v_cvt_pk_bf16_f32 v58, v152, v153
  v_mfma_f32_16x16x32_bf16 v[116:119], a[228:231], v[196:199], v[116:119]
  buffer_load_dword v47, v45, s[4:7], s69 offen
  v_mfma_f32_16x16x32_bf16 v[120:123], a[228:231], v[220:223], v[120:123]
  ds_read_b64_tr_b16 a[202:203], v23 offset:43008
  v_min_u32 v4, 7040, v45
  s_add_u32 s69, s69, 8192
  v_mfma_f32_16x16x32_bf16 v[124:127], a[228:231], v[244:247], v[124:127]
  v_cvt_pk_bf16_f32 v59, v154, v155
  v_cvt_pk_bf16_f32 v62, v156, v157
  s_waitcnt lgkmcnt(6)
  v_mfma_f32_16x16x32_bf16 v[112:115], a[232:235], v[176:179], v[112:115]
  ds_read_b64_tr_b16 a[204:205], v24 offset:36864
  v_cvt_pk_bf16_f32 v63, v158, v159
  v_mfma_f32_16x16x32_bf16 v[116:119], a[232:235], v[200:203], v[116:119]
  v_mfma_f32_16x16x32_bf16 v[120:123], a[232:235], v[224:227], v[120:123]
  ds_read_b64_tr_b16 a[206:207], v24 offset:43008
  v_mfma_f32_16x16x32_bf16 v[124:127], a[232:235], v[248:251], v[124:127]
  buffer_load_dword v47, v4, s[4:7], s69 offen
  v_mfma_f32_16x16x32_bf16 v[112:115], a[236:239], v[180:183], v[112:115]
  ds_read_b64_tr_b16 a[208:209], v21 offset:36992
  v_mfma_f32_16x16x32_bf16 v[116:119], a[236:239], v[204:207], v[116:119]
  v_mfma_f32_16x16x32_bf16 v[120:123], a[236:239], v[228:231], v[120:123]
  ds_read_b64_tr_b16 a[210:211], v21 offset:43136
  v_mfma_f32_16x16x32_bf16 v[124:127], a[236:239], v[252:255], v[124:127]
  s_waitcnt lgkmcnt(6)
  v_mfma_f32_16x16x32_bf16 a[0:3], a[192:195], v[48:51], a[0:3]
  ds_read_b64_tr_b16 a[212:213], v22 offset:36992
  v_mfma_f32_16x16x32_bf16 a[4:7], a[192:195], v[52:55], a[4:7]
  v_exp_f32 v96, v96
  v_mfma_f32_16x16x32_bf16 a[8:11], a[192:195], v[56:59], a[8:11]
  ds_read_b64_tr_b16 a[214:215], v22 offset:43136
  v_add_f32 v80, v80, v96
  v_mfma_f32_16x16x32_bf16 a[12:15], a[192:195], v[60:63], a[12:15]
  v_exp_f32 v97, v97
  v_mfma_f32_16x16x32_bf16 a[16:19], a[196:199], v[48:51], a[16:19]
  ds_read_b64_tr_b16 a[216:217], v23 offset:36992
  v_add_f32 v80, v80, v97
  v_mfma_f32_16x16x32_bf16 a[20:23], a[196:199], v[52:55], a[20:23]
  v_exp_f32 v98, v98
  v_mfma_f32_16x16x32_bf16 a[24:27], a[196:199], v[56:59], a[24:27]
  ds_read_b64_tr_b16 a[218:219], v23 offset:43136
  v_add_f32 v80, v80, v98
  v_mfma_f32_16x16x32_bf16 a[28:31], a[196:199], v[60:63], a[28:31]
  v_exp_f32 v99, v99
  s_waitcnt lgkmcnt(6)
  v_mfma_f32_16x16x32_bf16 a[32:35], a[200:203], v[48:51], a[32:35]
  ds_read_b64_tr_b16 a[220:221], v24 offset:36992
  v_add_f32 v80, v80, v99
  v_mfma_f32_16x16x32_bf16 a[36:39], a[200:203], v[52:55], a[36:39]
  v_exp_f32 v100, v100
  v_mfma_f32_16x16x32_bf16 a[40:43], a[200:203], v[56:59], a[40:43]
  ds_read_b64_tr_b16 a[222:223], v24 offset:43136
  v_add_f32 v81, v81, v100
  v_mfma_f32_16x16x32_bf16 a[44:47], a[200:203], v[60:63], a[44:47]
  v_exp_f32 v101, v101
  v_mfma_f32_16x16x32_bf16 a[48:51], a[204:207], v[48:51], a[48:51]
  ds_read_b64_tr_b16 a[224:225], v21 offset:37120
  v_add_f32 v81, v81, v101
  v_mfma_f32_16x16x32_bf16 a[52:55], a[204:207], v[52:55], a[52:55]
  v_exp_f32 v102, v102
  v_mfma_f32_16x16x32_bf16 a[56:59], a[204:207], v[56:59], a[56:59]
  ds_read_b64_tr_b16 a[226:227], v21 offset:43264
  v_add_f32 v81, v81, v102
  v_mfma_f32_16x16x32_bf16 a[60:63], a[204:207], v[60:63], a[60:63]
  v_exp_f32 v103, v103
  s_waitcnt lgkmcnt(6)
  v_mfma_f32_16x16x32_bf16 a[64:67], a[208:211], v[48:51], a[64:67]
  ds_read_b64_tr_b16 a[228:229], v22 offset:37120
  v_add_f32 v81, v81, v103
  v_mfma_f32_16x16x32_bf16 a[68:71], a[208:211], v[52:55], a[68:71]
  v_exp_f32 v104, v104
  v_mfma_f32_16x16x32_bf16 a[72:75], a[208:211], v[56:59], a[72:75]
  ds_read_b64_tr_b16 a[230:231], v22 offset:43264
  v_add_f32 v82, v82, v104
  v_mfma_f32_16x16x32_bf16 a[76:79], a[208:211], v[60:63], a[76:79]
  v_exp_f32 v105, v105
  v_mfma_f32_16x16x32_bf16 a[80:83], a[212:215], v[48:51], a[80:83]
  ds_read_b64_tr_b16 a[232:233], v23 offset:37120
  s_waitcnt vmcnt(22)
  s_barrier
  v_add_f32 v82, v82, v105
  v_mfma_f32_16x16x32_bf16 a[84:87], a[212:215], v[52:55], a[84:87]
  v_exp_f32 v106, v106
  v_mfma_f32_16x16x32_bf16 a[88:91], a[212:215], v[56:59], a[88:91]
  ds_read_b64_tr_b16 a[234:235], v23 offset:43264
  v_add_f32 v82, v82, v106
  v_mfma_f32_16x16x32_bf16 a[92:95], a[212:215], v[60:63], a[92:95]
  v_exp_f32 v107, v107
  s_waitcnt lgkmcnt(6)
  v_mfma_f32_16x16x32_bf16 a[96:99], a[216:219], v[48:51], a[96:99]
  ds_read_b64_tr_b16 a[236:237], v24 offset:37120
  v_add_f32 v82, v82, v107
  v_mfma_f32_16x16x32_bf16 a[100:103], a[216:219], v[52:55], a[100:103]
  v_exp_f32 v108, v108
  v_mfma_f32_16x16x32_bf16 a[104:107], a[216:219], v[56:59], a[104:107]
  ds_read_b64_tr_b16 a[238:239], v24 offset:43264
  v_add_f32 v83, v83, v108
  v_mfma_f32_16x16x32_bf16 a[108:111], a[216:219], v[60:63], a[108:111]
  v_exp_f32 v109, v109
  v_mfma_f32_16x16x32_bf16 a[112:115], a[220:223], v[48:51], a[112:115]
  ds_read_b128 a[192:195], v17 offset:24576
  v_add_f32 v83, v83, v109
  v_mfma_f32_16x16x32_bf16 a[116:119], a[220:223], v[52:55], a[116:119]
  v_exp_f32 v110, v110
  v_mfma_f32_16x16x32_bf16 a[120:123], a[220:223], v[56:59], a[120:123]
  v_exp_f32 v111, v111
  v_mfma_f32_16x16x32_bf16 a[124:127], a[220:223], v[60:63], a[124:127]
  v_add_f32 v83, v83, v110
  v_add_f32 v83, v83, v111
  s_waitcnt lgkmcnt(5)
  v_mfma_f32_16x16x32_bf16 a[128:131], a[224:227], v[48:51], a[128:131]
  ds_read_b128 a[196:199], v18 offset:24576
  v_mfma_f32_16x16x32_bf16 a[132:135], a[224:227], v[52:55], a[132:135]
  v_exp_f32 v112, v112
  v_mfma_f32_16x16x32_bf16 a[136:139], a[224:227], v[56:59], a[136:139]
  v_exp_f32 v113, v113
  v_mfma_f32_16x16x32_bf16 a[140:143], a[224:227], v[60:63], a[140:143]
  v_add_f32 v80, v80, v112
  v_add_f32 v80, v80, v113
  v_mfma_f32_16x16x32_bf16 a[144:147], a[228:231], v[48:51], a[144:147]
  ds_read_b128 a[200:203], v17 offset:24704
  v_mfma_f32_16x16x32_bf16 a[148:151], a[228:231], v[52:55], a[148:151]
  v_exp_f32 v114, v114
  v_mfma_f32_16x16x32_bf16 a[152:155], a[228:231], v[56:59], a[152:155]
  v_exp_f32 v115, v115
  v_mfma_f32_16x16x32_bf16 a[156:159], a[228:231], v[60:63], a[156:159]
  v_add_f32 v80, v80, v114
  v_add_f32 v80, v80, v115
  s_waitcnt lgkmcnt(3)
  v_mfma_f32_16x16x32_bf16 a[160:163], a[232:235], v[48:51], a[160:163]
  ds_read_b128 a[204:207], v18 offset:24704
  v_mfma_f32_16x16x32_bf16 a[164:167], a[232:235], v[52:55], a[164:167]
  v_mfma_f32_16x16x32_bf16 a[168:171], a[232:235], v[56:59], a[168:171]
  v_mfma_f32_16x16x32_bf16 a[172:175], a[232:235], v[60:63], a[172:175]
  v_mfma_f32_16x16x32_bf16 a[176:179], a[236:239], v[48:51], a[176:179]
  ds_read_b128 a[208:211], v17 offset:24832
  v_mfma_f32_16x16x32_bf16 a[180:183], a[236:239], v[52:55], a[180:183]
  v_mfma_f32_16x16x32_bf16 a[184:187], a[236:239], v[56:59], a[184:187]
  v_mfma_f32_16x16x32_bf16 a[188:191], a[236:239], v[60:63], a[188:191]
  v_mov_b32 v1, s56
  v_sub_u32 v2, 1, v1
  v_mov_b32 v3, 0
  s_cmp_eq_u32 s54, 0
  s_cselect_b32 s68, s52, -16
  s_cselect_b32 s69, 16, 4096
  s_mov_b64 exec, 1
  buffer_store_dword v1, v3, s[24:27], s68 offen sc0 sc1
  buffer_atomic_add v2, v3, s[48:51], s69 offen sc1
  s_mov_b64 exec, -1
  s_waitcnt lgkmcnt(3)
  v_mfma_f32_16x16x32_bf16 v[128:131], a[192:195], v[160:163], v[64:67]
  ds_read_b128 a[212:215], v18 offset:24832
  s_sub_u32 s3, s63, s62
  v_add_u32 v21, s3, v21
  s_add_u32 m0, s75, 0
  v_mfma_f32_16x16x32_bf16 v[132:135], a[192:195], v[184:187], v[68:71]
  v_add_u32 v22, s3, v22
  v_add_u32 v23, s3, v23
  s_add_u32 s74, s70, 0
  v_mfma_f32_16x16x32_bf16 v[136:139], a[192:195], v[208:211], v[72:75]
  v_add_u32 v24, s3, v24
  v_cvt_pk_bf16_f32 v48, v96, v97
  v_mfma_f32_16x16x32_bf16 v[140:143], a[192:195], v[232:235], v[76:79]
  buffer_load_dwordx4 v9, s[8:11], s74 offen offset:0 lds
  v_mfma_f32_16x16x32_bf16 v[128:131], a[196:199], v[164:167], v[128:131]
  ds_read_b128 a[216:219], v17 offset:30720
  v_cvt_pk_bf16_f32 v49, v98, v99
  v_mfma_f32_16x16x32_bf16 v[132:135], a[196:199], v[188:191], v[132:135]
  v_exp_f32 v116, v116
  v_mfma_f32_16x16x32_bf16 v[136:139], a[196:199], v[212:215], v[136:139]
  v_exp_f32 v117, v117
  v_mfma_f32_16x16x32_bf16 v[140:143], a[196:199], v[236:239], v[140:143]
  v_add_f32 v81, v81, v116
  v_cvt_pk_bf16_f32 v52, v100, v101
  s_waitcnt lgkmcnt(3)
  v_mfma_f32_16x16x32_bf16 v[128:131], a[200:203], v[168:171], v[128:131]
  ds_read_b128 a[220:223], v18 offset:30720
  v_cvt_pk_bf16_f32 v53, v102, v103
  v_mfma_f32_16x16x32_bf16 v[132:135], a[200:203], v[192:195], v[132:135]
  buffer_load_dwordx4 v10, s[8:11], s74 offen offset:1024 lds
  v_mfma_f32_16x16x32_bf16 v[136:139], a[200:203], v[216:219], v[136:139]
  v_exp_f32 v118, v118
  v_mfma_f32_16x16x32_bf16 v[140:143], a[200:203], v[240:243], v[140:143]
  v_add_f32 v81, v81, v117
  v_cvt_pk_bf16_f32 v56, v104, v105
  v_mfma_f32_16x16x32_bf16 v[128:131], a[204:207], v[172:175], v[128:131]
  ds_read_b128 a[224:227], v17 offset:30848
  v_cvt_pk_bf16_f32 v57, v106, v107
  v_mfma_f32_16x16x32_bf16 v[132:135], a[204:207], v[196:199], v[132:135]
  v_exp_f32 v119, v119
  v_mfma_f32_16x16x32_bf16 v[136:139], a[204:207], v[220:223], v[136:139]
  v_add_f32 v81, v81, v118
  v_cvt_pk_bf16_f32 v60, v108, v109
  v_mfma_f32_16x16x32_bf16 v[140:143], a[204:207], v[244:247], v[140:143]
  buffer_load_dwordx4 v11, s[8:11], s74 offen offset:2048 lds
  s_waitcnt lgkmcnt(3)
  v_mfma_f32_16x16x32_bf16 v[128:131], a[208:211], v[176:179], v[128:131]
  ds_read_b128 a[228:231], v18 offset:30848
  v_cvt_pk_bf16_f32 v61, v110, v111
  v_mfma_f32_16x16x32_bf16 v[132:135], a[208:211], v[200:203], v[132:135]
  v_exp_f32 v120, v120
  v_mfma_f32_16x16x32_bf16 v[136:139], a[208:211], v[224:227], v[136:139]
  v_add_f32 v81, v81, v119
  v_add_f32 v82, v82, v120
  v_mfma_f32_16x16x32_bf16 v[140:143], a[208:211], v[248:251], v[140:143]
  v_exp_f32 v121, v121
  v_mfma_f32_16x16x32_bf16 v[128:131], a[212:215], v[180:183], v[128:131]
  ds_read_b128 a[232:235], v17 offset:30976
  v_add_f32 v82, v82, v121
  v_mfma_f32_16x16x32_bf16 v[132:135], a[212:215], v[204:207], v[132:135]
  buffer_load_dwordx4 v12, s[8:11], s74 offen offset:3072 lds
  v_mfma_f32_16x16x32_bf16 v[136:139], a[212:215], v[228:231], v[136:139]
  s_add_u32 m0, s75, 4096
  v_exp_f32 v122, v122
  v_mfma_f32_16x16x32_bf16 v[140:143], a[212:215], v[252:255], v[140:143]
  s_add_u32 s74, s70, 0
  v_exp_f32 v123, v123
  s_waitcnt lgkmcnt(3)
  v_mfma_f32_16x16x32_bf16 v[144:147], a[216:219], v[160:163], v[64:67]
  ds_read_b128 a[236:239], v18 offset:30976
  v_add_f32 v82, v82, v122
  v_mfma_f32_16x16x32_bf16 v[148:151], a[216:219], v[184:187], v[68:71]
  v_exp_f32 v124, v124
  v_mfma_f32_16x16x32_bf16 v[152:155], a[216:219], v[208:211], v[72:75]
  v_add_f32 v82, v82, v123
  v_add_f32 v83, v83, v124
  v_mfma_f32_16x16x32_bf16 v[156:159], a[216:219], v[232:235], v[76:79]
  buffer_load_dwordx4 v13, s[8:11], s74 offen offset:0 lds
  v_mfma_f32_16x16x32_bf16 v[144:147], a[220:223], v[164:167], v[144:147]
  ds_read_b64_tr_b16 a[192:193], v21 offset:12288
  v_cvt_pk_bf16_f32 v50, v112, v113
  v_mfma_f32_16x16x32_bf16 v[148:151], a[220:223], v[188:191], v[148:151]
  v_exp_f32 v125, v125
  v_mfma_f32_16x16x32_bf16 v[152:155], a[220:223], v[212:215], v[152:155]
  ds_read_b64_tr_b16 a[194:195], v21 offset:18432
  v_add_f32 v83, v83, v125
  v_mfma_f32_16x16x32_bf16 v[156:159], a[220:223], v[236:239], v[156:159]
  v_exp_f32 v126, v126
  s_waitcnt lgkmcnt(4)
  v_mfma_f32_16x16x32_bf16 v[144:147], a[224:227], v[168:171], v[144:147]
  ds_read_b64_tr_b16 a[196:197], v22 offset:12288
  v_add_f32 v83, v83, v126
  v_mfma_f32_16x16x32_bf16 v[148:151], a[224:227], v[192:195], v[148:151]
  buffer_load_dwordx4 v14, s[8:11], s74 offen offset:1024 lds
  v_mfma_f32_16x16x32_bf16 v[152:155], a[224:227], v[216:219], v[152:155]
  ds_read_b64_tr_b16 a[198:199], v22 offset:18432
  v_cvt_pk_bf16_f32 v51, v114, v115
  v_mfma_f32_16x16x32_bf16 v[156:159], a[224:227], v[240:243], v[156:159]
  v_exp_f32 v127, v127
  v_mfma_f32_16x16x32_bf16 v[144:147], a[228:231], v[172:175], v[144:147]
  ds_read_b64_tr_b16 a[200:201], v23 offset:12288
  v_add_f32 v83, v83, v127
  v_mfma_f32_16x16x32_bf16 v[148:151], a[228:231], v[196:199], v[148:151]
  v_cvt_pk_bf16_f32 v54, v116, v117
  v_cvt_pk_bf16_f32 v55, v118, v119
  v_mfma_f32_16x16x32_bf16 v[152:155], a[228:231], v[220:223], v[152:155]
  ds_read_b64_tr_b16 a[202:203], v23 offset:18432
  v_cvt_pk_bf16_f32 v58, v120, v121
  v_mfma_f32_16x16x32_bf16 v[156:159], a[228:231], v[244:247], v[156:159]
  buffer_load_dwordx4 v15, s[8:11], s74 offen offset:2048 lds
  s_waitcnt lgkmcnt(6)
  v_mfma_f32_16x16x32_bf16 v[144:147], a[232:235], v[176:179], v[144:147]
  ds_read_b64_tr_b16 a[204:205], v24 offset:12288
  v_cvt_pk_bf16_f32 v59, v122, v123
  v_mfma_f32_16x16x32_bf16 v[148:151], a[232:235], v[200:203], v[148:151]
  v_cvt_pk_bf16_f32 v62, v124, v125
  v_cvt_pk_bf16_f32 v63, v126, v127
  v_mfma_f32_16x16x32_bf16 v[152:155], a[232:235], v[224:227], v[152:155]
  ds_read_b64_tr_b16 a[206:207], v24 offset:18432
  v_mfma_f32_16x16x32_bf16 v[156:159], a[232:235], v[248:251], v[156:159]
  v_mfma_f32_16x16x32_bf16 v[144:147], a[236:239], v[180:183], v[144:147]
  ds_read_b64_tr_b16 a[208:209], v21 offset:12416
  v_mfma_f32_16x16x32_bf16 v[148:151], a[236:239], v[204:207], v[148:151]
  buffer_load_dwordx4 v16, s[8:11], s74 offen offset:3072 lds
  v_mfma_f32_16x16x32_bf16 v[152:155], a[236:239], v[228:231], v[152:155]
  ds_read_b64_tr_b16 a[210:211], v21 offset:18560
  v_mfma_f32_16x16x32_bf16 v[156:159], a[236:239], v[252:255], v[156:159]
  s_waitcnt lgkmcnt(6)
  v_mfma_f32_16x16x32_bf16 a[0:3], a[192:195], v[48:51], a[0:3]
  ds_read_b64_tr_b16 a[212:213], v22 offset:12416
  s_sub_u32 s79, s64, s63
  v_add_u32 v17, s79, v17
  v_mfma_f32_16x16x32_bf16 a[4:7], a[192:195], v[52:55], a[4:7]
  v_add_u32 v18, s79, v18
  v_mfma_f32_16x16x32_bf16 a[8:11], a[192:195], v[56:59], a[8:11]
  ds_read_b64_tr_b16 a[214:215], v22 offset:18560
  v_mfma_f32_16x16x32_bf16 a[12:15], a[192:195], v[60:63], a[12:15]
  v_exp_f32 v128, v128
  v_mfma_f32_16x16x32_bf16 a[16:19], a[196:199], v[48:51], a[16:19]
  ds_read_b64_tr_b16 a[216:217], v23 offset:12416
  v_add_f32 v80, v80, v128
  v_mfma_f32_16x16x32_bf16 a[20:23], a[196:199], v[52:55], a[20:23]
  v_exp_f32 v129, v129
  v_mfma_f32_16x16x32_bf16 a[24:27], a[196:199], v[56:59], a[24:27]
  ds_read_b64_tr_b16 a[218:219], v23 offset:18560
  v_add_f32 v80, v80, v129
  v_mfma_f32_16x16x32_bf16 a[28:31], a[196:199], v[60:63], a[28:31]
  v_exp_f32 v130, v130
  s_waitcnt lgkmcnt(6)
  v_mfma_f32_16x16x32_bf16 a[32:35], a[200:203], v[48:51], a[32:35]
  ds_read_b64_tr_b16 a[220:221], v24 offset:12416
  v_add_f32 v80, v80, v130
  v_mfma_f32_16x16x32_bf16 a[36:39], a[200:203], v[52:55], a[36:39]
  v_exp_f32 v131, v131
  v_mfma_f32_16x16x32_bf16 a[40:43], a[200:203], v[56:59], a[40:43]
  ds_read_b64_tr_b16 a[222:223], v24 offset:18560
  v_add_f32 v80, v80, v131
  v_mfma_f32_16x16x32_bf16 a[44:47], a[200:203], v[60:63], a[44:47]
  v_exp_f32 v132, v132
  v_mfma_f32_16x16x32_bf16 a[48:51], a[204:207], v[48:51], a[48:51]
  ds_read_b64_tr_b16 a[224:225], v21 offset:12544
  v_add_f32 v81, v81, v132
  v_mfma_f32_16x16x32_bf16 a[52:55], a[204:207], v[52:55], a[52:55]
  v_exp_f32 v133, v133
  v_mfma_f32_16x16x32_bf16 a[56:59], a[204:207], v[56:59], a[56:59]
  ds_read_b64_tr_b16 a[226:227], v21 offset:18688
  v_add_f32 v81, v81, v133
  v_mfma_f32_16x16x32_bf16 a[60:63], a[204:207], v[60:63], a[60:63]
  v_exp_f32 v134, v134
  s_waitcnt lgkmcnt(6)
  v_mfma_f32_16x16x32_bf16 a[64:67], a[208:211], v[48:51], a[64:67]
  ds_read_b64_tr_b16 a[228:229], v22 offset:12544
  v_add_f32 v81, v81, v134
  v_mfma_f32_16x16x32_bf16 a[68:71], a[208:211], v[52:55], a[68:71]
  v_exp_f32 v135, v135
  v_mfma_f32_16x16x32_bf16 a[72:75], a[208:211], v[56:59], a[72:75]
  ds_read_b64_tr_b16 a[230:231], v22 offset:18688
  v_add_f32 v81, v81, v135
  v_mfma_f32_16x16x32_bf16 a[76:79], a[208:211], v[60:63], a[76:79]
  v_exp_f32 v136, v136
  v_mfma_f32_16x16x32_bf16 a[80:83], a[212:215], v[48:51], a[80:83]
  ds_read_b64_tr_b16 a[232:233], v23 offset:12544
  s_waitcnt vmcnt(26)
  s_barrier
  v_add_f32 v82, v82, v136
  v_mfma_f32_16x16x32_bf16 a[84:87], a[212:215], v[52:55], a[84:87]
  v_exp_f32 v137, v137
  v_mfma_f32_16x16x32_bf16 a[88:91], a[212:215], v[56:59], a[88:91]
  ds_read_b64_tr_b16 a[234:235], v23 offset:18688
  v_add_f32 v82, v82, v137
  v_mfma_f32_16x16x32_bf16 a[92:95], a[212:215], v[60:63], a[92:95]
  v_exp_f32 v138, v138
  s_waitcnt lgkmcnt(6)
  v_mfma_f32_16x16x32_bf16 a[96:99], a[216:219], v[48:51], a[96:99]
  ds_read_b64_tr_b16 a[236:237], v24 offset:12544
  v_add_f32 v82, v82, v138
  v_mfma_f32_16x16x32_bf16 a[100:103], a[216:219], v[52:55], a[100:103]
  v_exp_f32 v139, v139
  v_mfma_f32_16x16x32_bf16 a[104:107], a[216:219], v[56:59], a[104:107]
  ds_read_b64_tr_b16 a[238:239], v24 offset:18688
  v_add_f32 v82, v82, v139
  v_mfma_f32_16x16x32_bf16 a[108:111], a[216:219], v[60:63], a[108:111]
  v_exp_f32 v140, v140
  v_mfma_f32_16x16x32_bf16 a[112:115], a[220:223], v[48:51], a[112:115]
  v_exp_f32 v141, v141
  v_mfma_f32_16x16x32_bf16 a[116:119], a[220:223], v[52:55], a[116:119]
  v_add_f32 v83, v83, v140
  v_add_f32 v83, v83, v141
  v_mfma_f32_16x16x32_bf16 a[120:123], a[220:223], v[56:59], a[120:123]
  v_exp_f32 v142, v142
  v_mfma_f32_16x16x32_bf16 a[124:127], a[220:223], v[60:63], a[124:127]
  v_exp_f32 v143, v143
  s_waitcnt lgkmcnt(4)
  v_mfma_f32_16x16x32_bf16 a[128:131], a[224:227], v[48:51], a[128:131]
  v_add_f32 v83, v83, v142
  v_add_f32 v83, v83, v143
  v_mfma_f32_16x16x32_bf16 a[132:135], a[224:227], v[52:55], a[132:135]
  v_exp_f32 v144, v144
  v_mfma_f32_16x16x32_bf16 a[136:139], a[224:227], v[56:59], a[136:139]
  v_exp_f32 v145, v145
  v_mfma_f32_16x16x32_bf16 a[140:143], a[224:227], v[60:63], a[140:143]
  v_add_f32 v80, v80, v144
  v_add_f32 v80, v80, v145
  v_mfma_f32_16x16x32_bf16 a[144:147], a[228:231], v[48:51], a[144:147]
  v_exp_f32 v146, v146
  v_mfma_f32_16x16x32_bf16 a[148:151], a[228:231], v[52:55], a[148:151]
  v_exp_f32 v147, v147
  v_mfma_f32_16x16x32_bf16 a[152:155], a[228:231], v[56:59], a[152:155]
  v_add_f32 v80, v80, v146
  v_add_f32 v80, v80, v147
  v_mfma_f32_16x16x32_bf16 a[156:159], a[228:231], v[60:63], a[156:159]
  s_waitcnt lgkmcnt(0)
  v_mfma_f32_16x16x32_bf16 a[160:163], a[232:235], v[48:51], a[160:163]
  v_mfma_f32_16x16x32_bf16 a[164:167], a[232:235], v[52:55], a[164:167]
  v_mfma_f32_16x16x32_bf16 a[168:171], a[232:235], v[56:59], a[168:171]
  v_mfma_f32_16x16x32_bf16 a[172:175], a[232:235], v[60:63], a[172:175]
  v_mfma_f32_16x16x32_bf16 a[176:179], a[236:239], v[48:51], a[176:179]
  v_mfma_f32_16x16x32_bf16 a[180:183], a[236:239], v[52:55], a[180:183]
  v_mfma_f32_16x16x32_bf16 a[184:187], a[236:239], v[56:59], a[184:187]
  v_mfma_f32_16x16x32_bf16 a[188:191], a[236:239], v[60:63], a[188:191]
  s_mov_b32 s68, s62
  s_mov_b32 s62, s63
  s_mov_b32 s63, s64
  s_mov_b32 s64, s68
  v_mov_b32 v33, 0x47800000
  ds_read_b64_tr_b16 a[192:193], v21 offset:36864
  ds_read_b64_tr_b16 a[194:195], v21 offset:43008
  ds_read_b64_tr_b16 a[196:197], v22 offset:36864
  ds_read_b64_tr_b16 a[198:199], v22 offset:43008
  ds_read_b64_tr_b16 a[200:201], v23 offset:36864
  ds_read_b64_tr_b16 a[202:203], v23 offset:43008
  ds_read_b64_tr_b16 a[204:205], v24 offset:36864
  ds_read_b64_tr_b16 a[206:207], v24 offset:43008
  ds_read_b64_tr_b16 a[208:209], v21 offset:36992
  ds_read_b64_tr_b16 a[210:211], v21 offset:43136
  v_exp_f32 v148, v148
  v_cvt_pk_bf16_f32 v48, v128, v129
  v_exp_f32 v149, v149
  s_add_u32 m0, s75, 32768
  v_cvt_pk_bf16_f32 v49, v130, v131
  v_add_f32 v81, v81, v148
  v_cvt_pk_bf16_f32 v52, v132, v133
  s_add_u32 s74, s70, 128
  v_exp_f32 v150, v150
  v_cvt_pk_bf16_f32 v53, v134, v135
  v_add_f32 v81, v81, v149
  buffer_load_dwordx4 v9, s[8:11], s74 offen offset:0 lds
  v_cvt_pk_bf16_f32 v56, v136, v137
  v_exp_f32 v151, v151
  v_cvt_pk_bf16_f32 v57, v138, v139
  buffer_load_dwordx4 v10, s[8:11], s74 offen offset:1024 lds
  v_add_f32 v81, v81, v150
  v_cvt_pk_bf16_f32 v60, v140, v141
  v_exp_f32 v152, v152
  buffer_load_dwordx4 v11, s[8:11], s74 offen offset:2048 lds
  v_cvt_pk_bf16_f32 v61, v142, v143
  v_add_f32 v81, v81, v151
  v_exp_f32 v153, v153
  buffer_load_dwordx4 v12, s[8:11], s74 offen offset:3072 lds
  v_add_f32 v82, v82, v152
  v_exp_f32 v154, v154
  v_add_f32 v82, v82, v153
  s_add_u32 m0, s75, 36864
  v_exp_f32 v155, v155
  v_add_f32 v82, v82, v154
  v_exp_f32 v156, v156
  s_add_u32 s74, s70, 128
  v_add_f32 v82, v82, v155
  v_exp_f32 v157, v157
  v_add_f32 v83, v83, v156
  buffer_load_dwordx4 v13, s[8:11], s74 offen offset:0 lds
  v_exp_f32 v158, v158
  v_add_f32 v83, v83, v157
  v_exp_f32 v159, v159
  buffer_load_dwordx4 v14, s[8:11], s74 offen offset:1024 lds
  v_add_f32 v83, v83, v158
  v_add_f32 v83, v83, v159
  v_cvt_pk_bf16_f32 v50, v144, v145
  buffer_load_dwordx4 v15, s[8:11], s74 offen offset:2048 lds
  v_cvt_pk_bf16_f32 v51, v146, v147
  v_cvt_pk_bf16_f32 v54, v148, v149
  v_cvt_pk_bf16_f32 v55, v150, v151
  buffer_load_dwordx4 v16, s[8:11], s74 offen offset:3072 lds
  v_cvt_pk_bf16_f32 v58, v152, v153
  v_cvt_pk_bf16_f32 v59, v154, v155
  v_cvt_pk_bf16_f32 v62, v156, v157
  s_add_u32 m0, s55, 0
  v_cvt_pk_bf16_f32 v63, v158, v159
  s_nop 1
  s_waitcnt lgkmcnt(6)
  v_mfma_f32_16x16x32_bf16 a[0:3], a[192:195], v[48:51], a[0:3]
  ds_read_b64_tr_b16 a[212:213], v22 offset:36992
  v_add_f32 v1, v80, v81
  s_mov_b32 s73, 0
  v_mfma_f32_16x16x32_bf16 a[4:7], a[192:195], v[52:55], a[4:7]
  v_add_f32 v1, v1, v82
  v_add_f32 v1, v1, v83
  v_mfma_f32_16x16x32_bf16 a[8:11], a[192:195], v[56:59], a[8:11]
  ds_read_b64_tr_b16 a[214:215], v22 offset:43136
  v_cmp_nlt_f32 vcc, v1, v33
  s_cmp_lg_u64 vcc, 0
  s_cselect_b32 s68, 1, 0
  v_mfma_f32_16x16x32_bf16 a[12:15], a[192:195], v[60:63], a[12:15]
  v_mov_b32 v8, s68
  ds_write_b32 v44, v8
  v_mfma_f32_16x16x32_bf16 a[16:19], a[196:199], v[48:51], a[16:19]
  ds_read_b64_tr_b16 a[216:217], v23 offset:36992
  v_mfma_f32_16x16x32_bf16 a[20:23], a[196:199], v[52:55], a[20:23]
  buffer_load_dwordx4 v25, s[16:19], s73 offen offset:0 nt lds
  v_mfma_f32_16x16x32_bf16 a[24:27], a[196:199], v[56:59], a[24:27]
  ds_read_b64_tr_b16 a[218:219], v23 offset:43136
  v_mfma_f32_16x16x32_bf16 a[28:31], a[196:199], v[60:63], a[28:31]
  s_waitcnt lgkmcnt(7)
  v_mfma_f32_16x16x32_bf16 a[32:35], a[200:203], v[48:51], a[32:35]
  ds_read_b64_tr_b16 a[220:221], v24 offset:36992
  v_mfma_f32_16x16x32_bf16 a[36:39], a[200:203], v[52:55], a[36:39]
  v_mfma_f32_16x16x32_bf16 a[40:43], a[200:203], v[56:59], a[40:43]
  ds_read_b64_tr_b16 a[222:223], v24 offset:43136
  v_mfma_f32_16x16x32_bf16 a[44:47], a[200:203], v[60:63], a[44:47]
  buffer_load_dwordx4 v26, s[16:19], s73 offen offset:1024 nt lds
  v_mfma_f32_16x16x32_bf16 a[48:51], a[204:207], v[48:51], a[48:51]
  ds_read_b64_tr_b16 a[224:225], v21 offset:37120
  v_mfma_f32_16x16x32_bf16 a[52:55], a[204:207], v[52:55], a[52:55]
  v_mfma_f32_16x16x32_bf16 a[56:59], a[204:207], v[56:59], a[56:59]
  ds_read_b64_tr_b16 a[226:227], v21 offset:43264
  v_mfma_f32_16x16x32_bf16 a[60:63], a[204:207], v[60:63], a[60:63]
  s_waitcnt lgkmcnt(7)
  v_mfma_f32_16x16x32_bf16 a[64:67], a[208:211], v[48:51], a[64:67]
  ds_read_b64_tr_b16 a[228:229], v22 offset:37120
  v_mfma_f32_16x16x32_bf16 a[68:71], a[208:211], v[52:55], a[68:71]
  buffer_load_dwordx4 v27, s[16:19], s73 offen offset:2048 nt lds
  v_mfma_f32_16x16x32_bf16 a[72:75], a[208:211], v[56:59], a[72:75]
  ds_read_b64_tr_b16 a[230:231], v22 offset:43264
  v_mfma_f32_16x16x32_bf16 a[76:79], a[208:211], v[60:63], a[76:79]
  v_mfma_f32_16x16x32_bf16 a[80:83], a[212:215], v[48:51], a[80:83]
  ds_read_b64_tr_b16 a[232:233], v23 offset:37120
  s_waitcnt lgkmcnt(9)
  s_barrier
  v_mov_b32 v7, 12288
  v_mfma_f32_16x16x32_bf16 a[84:87], a[212:215], v[52:55], a[84:87]
  ds_read_b128 v[2:5], v7
  v_mfma_f32_16x16x32_bf16 a[88:91], a[212:215], v[56:59], a[88:91]
  ds_read_b64_tr_b16 a[234:235], v23 offset:43264
  v_mfma_f32_16x16x32_bf16 a[92:95], a[212:215], v[60:63], a[92:95]
  s_waitcnt lgkmcnt(7)
  v_mfma_f32_16x16x32_bf16 a[96:99], a[216:219], v[48:51], a[96:99]
  ds_read_b64_tr_b16 a[236:237], v24 offset:37120
  v_mfma_f32_16x16x32_bf16 a[100:103], a[216:219], v[52:55], a[100:103]
  v_mfma_f32_16x16x32_bf16 a[104:107], a[216:219], v[56:59], a[104:107]
  ds_read_b64_tr_b16 a[238:239], v24 offset:43264
  v_mfma_f32_16x16x32_bf16 a[108:111], a[216:219], v[60:63], a[108:111]
  v_mfma_f32_16x16x32_bf16 a[112:115], a[220:223], v[48:51], a[112:115]
  v_mfma_f32_16x16x32_bf16 a[116:119], a[220:223], v[52:55], a[116:119]
  v_mfma_f32_16x16x32_bf16 a[120:123], a[220:223], v[56:59], a[120:123]
  v_mfma_f32_16x16x32_bf16 a[124:127], a[220:223], v[60:63], a[124:127]
  s_waitcnt lgkmcnt(5)
  v_mfma_f32_16x16x32_bf16 a[128:131], a[224:227], v[48:51], a[128:131]
  v_mfma_f32_16x16x32_bf16 a[132:135], a[224:227], v[52:55], a[132:135]
  v_mfma_f32_16x16x32_bf16 a[136:139], a[224:227], v[56:59], a[136:139]
  v_mfma_f32_16x16x32_bf16 a[140:143], a[224:227], v[60:63], a[140:143]
  v_mfma_f32_16x16x32_bf16 a[144:147], a[228:231], v[48:51], a[144:147]
  v_mfma_f32_16x16x32_bf16 a[148:151], a[228:231], v[52:55], a[148:151]
  v_mfma_f32_16x16x32_bf16 a[152:155], a[228:231], v[56:59], a[152:155]
  v_mfma_f32_16x16x32_bf16 a[156:159], a[228:231], v[60:63], a[156:159]
  s_waitcnt lgkmcnt(0)
  v_mfma_f32_16x16x32_bf16 a[160:163], a[232:235], v[48:51], a[160:163]
  v_mfma_f32_16x16x32_bf16 a[164:167], a[232:235], v[52:55], a[164:167]
  v_mfma_f32_16x16x32_bf16 a[168:171], a[232:235], v[56:59], a[168:171]
  v_mfma_f32_16x16x32_bf16 a[172:175], a[232:235], v[60:63], a[172:175]
  v_mfma_f32_16x16x32_bf16 a[176:179], a[236:239], v[48:51], a[176:179]
  v_mfma_f32_16x16x32_bf16 a[180:183], a[236:239], v[52:55], a[180:183]
  v_mfma_f32_16x16x32_bf16 a[184:187], a[236:239], v[56:59], a[184:187]
  v_mfma_f32_16x16x32_bf16 a[188:191], a[236:239], v[60:63], a[188:191]
  v_or3_b32 v1, v2, v3, v4
  v_or_b32 v1, v1, v5
  s_nop 0
  v_readfirstlane_b32 s68, v1
  s_nop 3
  s_lshr_b32 s88, s68, 1
  s_and_b32 s68, s68, 1
  s_cmp_lg_u32 s68, 0
  s_cbranch_scc1 K1_SAFE
  s_nop 3
  v_subrev_u32 v17, 49152, v17
  v_subrev_u32 v18, 49152, v18
  v_mov_b32 v1, v80
  v_mov_b32 v2, v81
  v_mov_b32 v3, v82
  v_mov_b32 v4, v83
  s_nop 0
  v_permlane32_swap_b32 v80, v1
  v_permlane32_swap_b32 v81, v2
  v_permlane32_swap_b32 v82, v3
  v_permlane32_swap_b32 v83, v4
  v_add_f32 v80, v80, v1
  v_add_f32 v81, v81, v2
  v_add_f32 v82, v82, v3
  v_add_f32 v83, v83, v4
  v_mov_b32 v1, v80
  v_mov_b32 v2, v81
  v_mov_b32 v3, v82
  v_mov_b32 v4, v83
  s_nop 0
  v_permlane16_swap_b32 v80, v1
  v_permlane16_swap_b32 v81, v2
  v_permlane16_swap_b32 v82, v3
  v_permlane16_swap_b32 v83, v4
  v_add_f32 v80, v80, v1
  v_add_f32 v81, v81, v2
  v_add_f32 v82, v82, v3
  v_add_f32 v83, v83, v4
  v_rcp_f32 v37, v80
  v_rcp_f32 v38, v81
  v_rcp_f32 v39, v82
  v_rcp_f32 v40, v83
  s_nop 3
  s_mov_b32 s82, 439353344
  s_add_u32 s56, s56, 1
  s_cmp_lt_u32 s56, 2
  s_cbranch_scc1 K1_ITEM
  v_accvgpr_read_b32 v48, a0
  v_accvgpr_read_b32 v49, a1
  v_accvgpr_read_b32 v50, a2
  v_accvgpr_read_b32 v51, a3
  v_accvgpr_read_b32 v52, a16
  v_accvgpr_read_b32 v53, a17
  v_accvgpr_read_b32 v54, a18
  v_accvgpr_read_b32 v55, a19
  v_mul_f32 v48, v48, v37
  v_mul_f32 v49, v49, v37
  v_mul_f32 v50, v50, v37
  v_mul_f32 v51, v51, v37
  v_mul_f32 v52, v52, v37
  v_mul_f32 v53, v53, v37
  v_mul_f32 v54, v54, v37
  v_mul_f32 v55, v55, v37
  v_cvt_pk_bf16_f32 v56, v48, v49
  v_cvt_pk_bf16_f32 v57, v50, v51
  v_cvt_pk_bf16_f32 v58, v52, v53
  v_cvt_pk_bf16_f32 v59, v54, v55
  s_add_u32 s53, s72, 25165824
  buffer_store_dwordx4 v[56:59], v28, s[24:27], s53 offen sc0 sc1
  v_accvgpr_read_b32 v48, a4
  v_accvgpr_read_b32 v49, a5
  v_accvgpr_read_b32 v50, a6
  v_accvgpr_read_b32 v51, a7
  v_accvgpr_read_b32 v52, a20
  v_accvgpr_read_b32 v53, a21
  v_accvgpr_read_b32 v54, a22
  v_accvgpr_read_b32 v55, a23
  v_mul_f32 v48, v48, v38
  v_mul_f32 v49, v49, v38
  v_mul_f32 v50, v50, v38
  v_mul_f32 v51, v51, v38
  v_mul_f32 v52, v52, v38
  v_mul_f32 v53, v53, v38
  v_mul_f32 v54, v54, v38
  v_mul_f32 v55, v55, v38
  v_cvt_pk_bf16_f32 v60, v48, v49
  v_cvt_pk_bf16_f32 v61, v50, v51
  v_cvt_pk_bf16_f32 v62, v52, v53
  v_cvt_pk_bf16_f32 v63, v54, v55
  s_add_u32 s53, s72, 25362432
  buffer_store_dwordx4 v[60:63], v28, s[24:27], s53 offen sc0 sc1
  v_accvgpr_read_b32 v48, a8
  v_accvgpr_read_b32 v49, a9
  v_accvgpr_read_b32 v50, a10
  v_accvgpr_read_b32 v51, a11
  v_accvgpr_read_b32 v52, a24
  v_accvgpr_read_b32 v53, a25
  v_accvgpr_read_b32 v54, a26
  v_accvgpr_read_b32 v55, a27
  v_mul_f32 v48, v48, v39
  v_mul_f32 v49, v49, v39
  v_mul_f32 v50, v50, v39
  v_mul_f32 v51, v51, v39
  v_mul_f32 v52, v52, v39
  v_mul_f32 v53, v53, v39
  v_mul_f32 v54, v54, v39
  v_mul_f32 v55, v55, v39
  v_cvt_pk_bf16_f32 v56, v48, v49
  v_cvt_pk_bf16_f32 v57, v50, v51
  v_cvt_pk_bf16_f32 v58, v52, v53
  v_cvt_pk_bf16_f32 v59, v54, v55
  s_add_u32 s53, s72, 25559040
  buffer_store_dwordx4 v[56:59], v28, s[24:27], s53 offen sc0 sc1
  v_accvgpr_read_b32 v48, a12
  v_accvgpr_read_b32 v49, a13
  v_accvgpr_read_b32 v50, a14
  v_accvgpr_read_b32 v51, a15
  v_accvgpr_read_b32 v52, a28
  v_accvgpr_read_b32 v53, a29
  v_accvgpr_read_b32 v54, a30
  v_accvgpr_read_b32 v55, a31
  v_mul_f32 v48, v48, v40
  v_mul_f32 v49, v49, v40
  v_mul_f32 v50, v50, v40
  v_mul_f32 v51, v51, v40
  v_mul_f32 v52, v52, v40
  v_mul_f32 v53, v53, v40
  v_mul_f32 v54, v54, v40
  v_mul_f32 v55, v55, v40
  v_cvt_pk_bf16_f32 v60, v48, v49
  v_cvt_pk_bf16_f32 v61, v50, v51
  v_cvt_pk_bf16_f32 v62, v52, v53
  v_cvt_pk_bf16_f32 v63, v54, v55
  s_add_u32 s53, s72, 25755648
  buffer_store_dwordx4 v[60:63], v28, s[24:27], s53 offen sc0 sc1
  v_accvgpr_read_b32 v48, a32
  v_accvgpr_read_b32 v49, a33
  v_accvgpr_read_b32 v50, a34
  v_accvgpr_read_b32 v51, a35
  v_accvgpr_read_b32 v52, a48
  v_accvgpr_read_b32 v53, a49
  v_accvgpr_read_b32 v54, a50
  v_accvgpr_read_b32 v55, a51
  v_mul_f32 v48, v48, v37
  v_mul_f32 v49, v49, v37
  v_mul_f32 v50, v50, v37
  v_mul_f32 v51, v51, v37
  v_mul_f32 v52, v52, v37
  v_mul_f32 v53, v53, v37
  v_mul_f32 v54, v54, v37
  v_mul_f32 v55, v55, v37
  v_cvt_pk_bf16_f32 v56, v48, v49
  v_cvt_pk_bf16_f32 v57, v50, v51
  v_cvt_pk_bf16_f32 v58, v52, v53
  v_cvt_pk_bf16_f32 v59, v54, v55
  s_add_u32 s53, s72, 25166848
  buffer_store_dwordx4 v[56:59], v28, s[24:27], s53 offen sc0 sc1
  v_accvgpr_read_b32 v48, a36
  v_accvgpr_read_b32 v49, a37
  v_accvgpr_read_b32 v50, a38
  v_accvgpr_read_b32 v51, a39
  v_accvgpr_read_b32 v52, a52
  v_accvgpr_read_b32 v53, a53
  v_accvgpr_read_b32 v54, a54
  v_accvgpr_read_b32 v55, a55
  v_mul_f32 v48, v48, v38
  v_mul_f32 v49, v49, v38
  v_mul_f32 v50, v50, v38
  v_mul_f32 v51, v51, v38
  v_mul_f32 v52, v52, v38
  v_mul_f32 v53, v53, v38
  v_mul_f32 v54, v54, v38
  v_mul_f32 v55, v55, v38
  v_cvt_pk_bf16_f32 v60, v48, v49
  v_cvt_pk_bf16_f32 v61, v50, v51
  v_cvt_pk_bf16_f32 v62, v52, v53
  v_cvt_pk_bf16_f32 v63, v54, v55
  s_add_u32 s53, s72, 25363456
  buffer_store_dwordx4 v[60:63], v28, s[24:27], s53 offen sc0 sc1
  v_accvgpr_read_b32 v48, a40
  v_accvgpr_read_b32 v49, a41
  v_accvgpr_read_b32 v50, a42
  v_accvgpr_read_b32 v51, a43
  v_accvgpr_read_b32 v52, a56
  v_accvgpr_read_b32 v53, a57
  v_accvgpr_read_b32 v54, a58
  v_accvgpr_read_b32 v55, a59
  v_mul_f32 v48, v48, v39
  v_mul_f32 v49, v49, v39
  v_mul_f32 v50, v50, v39
  v_mul_f32 v51, v51, v39
  v_mul_f32 v52, v52, v39
  v_mul_f32 v53, v53, v39
  v_mul_f32 v54, v54, v39
  v_mul_f32 v55, v55, v39
  v_cvt_pk_bf16_f32 v56, v48, v49
  v_cvt_pk_bf16_f32 v57, v50, v51
  v_cvt_pk_bf16_f32 v58, v52, v53
  v_cvt_pk_bf16_f32 v59, v54, v55
  s_add_u32 s53, s72, 25560064
  buffer_store_dwordx4 v[56:59], v28, s[24:27], s53 offen sc0 sc1
  v_accvgpr_read_b32 v48, a44
  v_accvgpr_read_b32 v49, a45
  v_accvgpr_read_b32 v50, a46
  v_accvgpr_read_b32 v51, a47
  v_accvgpr_read_b32 v52, a60
  v_accvgpr_read_b32 v53, a61
  v_accvgpr_read_b32 v54, a62
  v_accvgpr_read_b32 v55, a63
  v_mul_f32 v48, v48, v40
  v_mul_f32 v49, v49, v40
  v_mul_f32 v50, v50, v40
  v_mul_f32 v51, v51, v40
  v_mul_f32 v52, v52, v40
  v_mul_f32 v53, v53, v40
  v_mul_f32 v54, v54, v40
  v_mul_f32 v55, v55, v40
  v_cvt_pk_bf16_f32 v60, v48, v49
  v_cvt_pk_bf16_f32 v61, v50, v51
  v_cvt_pk_bf16_f32 v62, v52, v53
  v_cvt_pk_bf16_f32 v63, v54, v55
  s_add_u32 s53, s72, 25756672
  buffer_store_dwordx4 v[60:63], v28, s[24:27], s53 offen sc0 sc1
  v_accvgpr_read_b32 v48, a64
  v_accvgpr_read_b32 v49, a65
  v_accvgpr_read_b32 v50, a66
  v_accvgpr_read_b32 v51, a67
  v_accvgpr_read_b32 v52, a80
  v_accvgpr_read_b32 v53, a81
  v_accvgpr_read_b32 v54, a82
  v_accvgpr_read_b32 v55, a83
  v_mul_f32 v48, v48, v37
  v_mul_f32 v49, v49, v37
  v_mul_f32 v50, v50, v37
  v_mul_f32 v51, v51, v37
  v_mul_f32 v52, v52, v37
  v_mul_f32 v53, v53, v37
  v_mul_f32 v54, v54, v37
  v_mul_f32 v55, v55, v37
  v_cvt_pk_bf16_f32 v56, v48, v49
  v_cvt_pk_bf16_f32 v57, v50, v51
  v_cvt_pk_bf16_f32 v58, v52, v53
  v_cvt_pk_bf16_f32 v59, v54, v55
  s_add_u32 s53, s72, 25167872
  buffer_store_dwordx4 v[56:59], v28, s[24:27], s53 offen sc0 sc1
  v_accvgpr_read_b32 v48, a68
  v_accvgpr_read_b32 v49, a69
  v_accvgpr_read_b32 v50, a70
  v_accvgpr_read_b32 v51, a71
  v_accvgpr_read_b32 v52, a84
  v_accvgpr_read_b32 v53, a85
  v_accvgpr_read_b32 v54, a86
  v_accvgpr_read_b32 v55, a87
  v_mul_f32 v48, v48, v38
  v_mul_f32 v49, v49, v38
  v_mul_f32 v50, v50, v38
  v_mul_f32 v51, v51, v38
  v_mul_f32 v52, v52, v38
  v_mul_f32 v53, v53, v38
  v_mul_f32 v54, v54, v38
  v_mul_f32 v55, v55, v38
  v_cvt_pk_bf16_f32 v60, v48, v49
  v_cvt_pk_bf16_f32 v61, v50, v51
  v_cvt_pk_bf16_f32 v62, v52, v53
  v_cvt_pk_bf16_f32 v63, v54, v55
  s_add_u32 s53, s72, 25364480
  buffer_store_dwordx4 v[60:63], v28, s[24:27], s53 offen sc0 sc1
  v_accvgpr_read_b32 v48, a72
  v_accvgpr_read_b32 v49, a73
  v_accvgpr_read_b32 v50, a74
  v_accvgpr_read_b32 v51, a75
  v_accvgpr_read_b32 v52, a88
  v_accvgpr_read_b32 v53, a89
  v_accvgpr_read_b32 v54, a90
  v_accvgpr_read_b32 v55, a91
  v_mul_f32 v48, v48, v39
  v_mul_f32 v49, v49, v39
  v_mul_f32 v50, v50, v39
  v_mul_f32 v51, v51, v39
  v_mul_f32 v52, v52, v39
  v_mul_f32 v53, v53, v39
  v_mul_f32 v54, v54, v39
  v_mul_f32 v55, v55, v39
  v_cvt_pk_bf16_f32 v56, v48, v49
  v_cvt_pk_bf16_f32 v57, v50, v51
  v_cvt_pk_bf16_f32 v58, v52, v53
  v_cvt_pk_bf16_f32 v59, v54, v55
  s_add_u32 s53, s72, 25561088
  buffer_store_dwordx4 v[56:59], v28, s[24:27], s53 offen sc0 sc1
  v_accvgpr_read_b32 v48, a76
  v_accvgpr_read_b32 v49, a77
  v_accvgpr_read_b32 v50, a78
  v_accvgpr_read_b32 v51, a79
  v_accvgpr_read_b32 v52, a92
  v_accvgpr_read_b32 v53, a93
  v_accvgpr_read_b32 v54, a94
  v_accvgpr_read_b32 v55, a95
  v_mul_f32 v48, v48, v40
  v_mul_f32 v49, v49, v40
  v_mul_f32 v50, v50, v40
  v_mul_f32 v51, v51, v40
  v_mul_f32 v52, v52, v40
  v_mul_f32 v53, v53, v40
  v_mul_f32 v54, v54, v40
  v_mul_f32 v55, v55, v40
  v_cvt_pk_bf16_f32 v60, v48, v49
  v_cvt_pk_bf16_f32 v61, v50, v51
  v_cvt_pk_bf16_f32 v62, v52, v53
  v_cvt_pk_bf16_f32 v63, v54, v55
  s_add_u32 s53, s72, 25757696
  buffer_store_dwordx4 v[60:63], v28, s[24:27], s53 offen sc0 sc1
  v_accvgpr_read_b32 v48, a96
  v_accvgpr_read_b32 v49, a97
  v_accvgpr_read_b32 v50, a98
  v_accvgpr_read_b32 v51, a99
  v_accvgpr_read_b32 v52, a112
  v_accvgpr_read_b32 v53, a113
  v_accvgpr_read_b32 v54, a114
  v_accvgpr_read_b32 v55, a115
  v_mul_f32 v48, v48, v37
  v_mul_f32 v49, v49, v37
  v_mul_f32 v50, v50, v37
  v_mul_f32 v51, v51, v37
  v_mul_f32 v52, v52, v37
  v_mul_f32 v53, v53, v37
  v_mul_f32 v54, v54, v37
  v_mul_f32 v55, v55, v37
  v_cvt_pk_bf16_f32 v56, v48, v49
  v_cvt_pk_bf16_f32 v57, v50, v51
  v_cvt_pk_bf16_f32 v58, v52, v53
  v_cvt_pk_bf16_f32 v59, v54, v55
  s_add_u32 s53, s72, 25168896
  buffer_store_dwordx4 v[56:59], v28, s[24:27], s53 offen sc0 sc1
  v_accvgpr_read_b32 v48, a100
  v_accvgpr_read_b32 v49, a101
  v_accvgpr_read_b32 v50, a102
  v_accvgpr_read_b32 v51, a103
  v_accvgpr_read_b32 v52, a116
  v_accvgpr_read_b32 v53, a117
  v_accvgpr_read_b32 v54, a118
  v_accvgpr_read_b32 v55, a119
  v_mul_f32 v48, v48, v38
  v_mul_f32 v49, v49, v38
  v_mul_f32 v50, v50, v38
  v_mul_f32 v51, v51, v38
  v_mul_f32 v52, v52, v38
  v_mul_f32 v53, v53, v38
  v_mul_f32 v54, v54, v38
  v_mul_f32 v55, v55, v38
  v_cvt_pk_bf16_f32 v60, v48, v49
  v_cvt_pk_bf16_f32 v61, v50, v51
  v_cvt_pk_bf16_f32 v62, v52, v53
  v_cvt_pk_bf16_f32 v63, v54, v55
  s_add_u32 s53, s72, 25365504
  buffer_store_dwordx4 v[60:63], v28, s[24:27], s53 offen sc0 sc1
  v_accvgpr_read_b32 v48, a104
  v_accvgpr_read_b32 v49, a105
  v_accvgpr_read_b32 v50, a106
  v_accvgpr_read_b32 v51, a107
  v_accvgpr_read_b32 v52, a120
  v_accvgpr_read_b32 v53, a121
  v_accvgpr_read_b32 v54, a122
  v_accvgpr_read_b32 v55, a123
  v_mul_f32 v48, v48, v39
  v_mul_f32 v49, v49, v39
  v_mul_f32 v50, v50, v39
  v_mul_f32 v51, v51, v39
  v_mul_f32 v52, v52, v39
  v_mul_f32 v53, v53, v39
  v_mul_f32 v54, v54, v39
  v_mul_f32 v55, v55, v39
  v_cvt_pk_bf16_f32 v56, v48, v49
  v_cvt_pk_bf16_f32 v57, v50, v51
  v_cvt_pk_bf16_f32 v58, v52, v53
  v_cvt_pk_bf16_f32 v59, v54, v55
  s_add_u32 s53, s72, 25562112
  buffer_store_dwordx4 v[56:59], v28, s[24:27], s53 offen sc0 sc1
  v_accvgpr_read_b32 v48, a108
  v_accvgpr_read_b32 v49, a109
  v_accvgpr_read_b32 v50, a110
  v_accvgpr_read_b32 v51, a111
  v_accvgpr_read_b32 v52, a124
  v_accvgpr_read_b32 v53, a125
  v_accvgpr_read_b32 v54, a126
  v_accvgpr_read_b32 v55, a127
  v_mul_f32 v48, v48, v40
  v_mul_f32 v49, v49, v40
  v_mul_f32 v50, v50, v40
  v_mul_f32 v51, v51, v40
  v_mul_f32 v52, v52, v40
  v_mul_f32 v53, v53, v40
  v_mul_f32 v54, v54, v40
  v_mul_f32 v55, v55, v40
  v_cvt_pk_bf16_f32 v60, v48, v49
  v_cvt_pk_bf16_f32 v61, v50, v51
  v_cvt_pk_bf16_f32 v62, v52, v53
  v_cvt_pk_bf16_f32 v63, v54, v55
  s_add_u32 s53, s72, 25758720
  buffer_store_dwordx4 v[60:63], v28, s[24:27], s53 offen sc0 sc1
  v_accvgpr_read_b32 v48, a128
  v_accvgpr_read_b32 v49, a129
  v_accvgpr_read_b32 v50, a130
  v_accvgpr_read_b32 v51, a131
  v_accvgpr_read_b32 v52, a144
  v_accvgpr_read_b32 v53, a145
  v_accvgpr_read_b32 v54, a146
  v_accvgpr_read_b32 v55, a147
  v_mul_f32 v48, v48, v37
  v_mul_f32 v49, v49, v37
  v_mul_f32 v50, v50, v37
  v_mul_f32 v51, v51, v37
  v_mul_f32 v52, v52, v37
  v_mul_f32 v53, v53, v37
  v_mul_f32 v54, v54, v37
  v_mul_f32 v55, v55, v37
  v_cvt_pk_bf16_f32 v56, v48, v49
  v_cvt_pk_bf16_f32 v57, v50, v51
  v_cvt_pk_bf16_f32 v58, v52, v53
  v_cvt_pk_bf16_f32 v59, v54, v55
  s_add_u32 s53, s72, 25169920
  buffer_store_dwordx4 v[56:59], v28, s[24:27], s53 offen sc0 sc1
  v_accvgpr_read_b32 v48, a132
  v_accvgpr_read_b32 v49, a133
  v_accvgpr_read_b32 v50, a134
  v_accvgpr_read_b32 v51, a135
  v_accvgpr_read_b32 v52, a148
  v_accvgpr_read_b32 v53, a149
  v_accvgpr_read_b32 v54, a150
  v_accvgpr_read_b32 v55, a151
  v_mul_f32 v48, v48, v38
  v_mul_f32 v49, v49, v38
  v_mul_f32 v50, v50, v38
  v_mul_f32 v51, v51, v38
  v_mul_f32 v52, v52, v38
  v_mul_f32 v53, v53, v38
  v_mul_f32 v54, v54, v38
  v_mul_f32 v55, v55, v38
  v_cvt_pk_bf16_f32 v60, v48, v49
  v_cvt_pk_bf16_f32 v61, v50, v51
  v_cvt_pk_bf16_f32 v62, v52, v53
  v_cvt_pk_bf16_f32 v63, v54, v55
  s_add_u32 s53, s72, 25366528
  buffer_store_dwordx4 v[60:63], v28, s[24:27], s53 offen sc0 sc1
  v_accvgpr_read_b32 v48, a136
  v_accvgpr_read_b32 v49, a137
  v_accvgpr_read_b32 v50, a138
  v_accvgpr_read_b32 v51, a139
  v_accvgpr_read_b32 v52, a152
  v_accvgpr_read_b32 v53, a153
  v_accvgpr_read_b32 v54, a154
  v_accvgpr_read_b32 v55, a155
  v_mul_f32 v48, v48, v39
  v_mul_f32 v49, v49, v39
  v_mul_f32 v50, v50, v39
  v_mul_f32 v51, v51, v39
  v_mul_f32 v52, v52, v39
  v_mul_f32 v53, v53, v39
  v_mul_f32 v54, v54, v39
  v_mul_f32 v55, v55, v39
  v_cvt_pk_bf16_f32 v56, v48, v49
  v_cvt_pk_bf16_f32 v57, v50, v51
  v_cvt_pk_bf16_f32 v58, v52, v53
  v_cvt_pk_bf16_f32 v59, v54, v55
  s_add_u32 s53, s72, 25563136
  buffer_store_dwordx4 v[56:59], v28, s[24:27], s53 offen sc0 sc1
  v_accvgpr_read_b32 v48, a140
  v_accvgpr_read_b32 v49, a141
  v_accvgpr_read_b32 v50, a142
  v_accvgpr_read_b32 v51, a143
  v_accvgpr_read_b32 v52, a156
  v_accvgpr_read_b32 v53, a157
  v_accvgpr_read_b32 v54, a158
  v_accvgpr_read_b32 v55, a159
  v_mul_f32 v48, v48, v40
  v_mul_f32 v49, v49, v40
  v_mul_f32 v50, v50, v40
  v_mul_f32 v51, v51, v40
  v_mul_f32 v52, v52, v40
  v_mul_f32 v53, v53, v40
  v_mul_f32 v54, v54, v40
  v_mul_f32 v55, v55, v40
  v_cvt_pk_bf16_f32 v60, v48, v49
  v_cvt_pk_bf16_f32 v61, v50, v51
  v_cvt_pk_bf16_f32 v62, v52, v53
  v_cvt_pk_bf16_f32 v63, v54, v55
  s_add_u32 s53, s72, 25759744
  buffer_store_dwordx4 v[60:63], v28, s[24:27], s53 offen sc0 sc1
  v_accvgpr_read_b32 v48, a160
  v_accvgpr_read_b32 v49, a161
  v_accvgpr_read_b32 v50, a162
  v_accvgpr_read_b32 v51, a163
  v_accvgpr_read_b32 v52, a176
  v_accvgpr_read_b32 v53, a177
  v_accvgpr_read_b32 v54, a178
  v_accvgpr_read_b32 v55, a179
  v_mul_f32 v48, v48, v37
  v_mul_f32 v49, v49, v37
  v_mul_f32 v50, v50, v37
  v_mul_f32 v51, v51, v37
  v_mul_f32 v52, v52, v37
  v_mul_f32 v53, v53, v37
  v_mul_f32 v54, v54, v37
  v_mul_f32 v55, v55, v37
  v_cvt_pk_bf16_f32 v56, v48, v49
  v_cvt_pk_bf16_f32 v57, v50, v51
  v_cvt_pk_bf16_f32 v58, v52, v53
  v_cvt_pk_bf16_f32 v59, v54, v55
  s_add_u32 s53, s72, 25170944
  buffer_store_dwordx4 v[56:59], v28, s[24:27], s53 offen sc0 sc1
  v_accvgpr_read_b32 v48, a164
  v_accvgpr_read_b32 v49, a165
  v_accvgpr_read_b32 v50, a166
  v_accvgpr_read_b32 v51, a167
  v_accvgpr_read_b32 v52, a180
  v_accvgpr_read_b32 v53, a181
  v_accvgpr_read_b32 v54, a182
  v_accvgpr_read_b32 v55, a183
  v_mul_f32 v48, v48, v38
  v_mul_f32 v49, v49, v38
  v_mul_f32 v50, v50, v38
  v_mul_f32 v51, v51, v38
  v_mul_f32 v52, v52, v38
  v_mul_f32 v53, v53, v38
  v_mul_f32 v54, v54, v38
  v_mul_f32 v55, v55, v38
  v_cvt_pk_bf16_f32 v60, v48, v49
  v_cvt_pk_bf16_f32 v61, v50, v51
  v_cvt_pk_bf16_f32 v62, v52, v53
  v_cvt_pk_bf16_f32 v63, v54, v55
  s_add_u32 s53, s72, 25367552
  buffer_store_dwordx4 v[60:63], v28, s[24:27], s53 offen sc0 sc1
  v_accvgpr_read_b32 v48, a168
  v_accvgpr_read_b32 v49, a169
  v_accvgpr_read_b32 v50, a170
  v_accvgpr_read_b32 v51, a171
  v_accvgpr_read_b32 v52, a184
  v_accvgpr_read_b32 v53, a185
  v_accvgpr_read_b32 v54, a186
  v_accvgpr_read_b32 v55, a187
  v_mul_f32 v48, v48, v39
  v_mul_f32 v49, v49, v39
  v_mul_f32 v50, v50, v39
  v_mul_f32 v51, v51, v39
  v_mul_f32 v52, v52, v39
  v_mul_f32 v53, v53, v39
  v_mul_f32 v54, v54, v39
  v_mul_f32 v55, v55, v39
  v_cvt_pk_bf16_f32 v56, v48, v49
  v_cvt_pk_bf16_f32 v57, v50, v51
  v_cvt_pk_bf16_f32 v58, v52, v53
  v_cvt_pk_bf16_f32 v59, v54, v55
  s_add_u32 s53, s72, 25564160
  buffer_store_dwordx4 v[56:59], v28, s[24:27], s53 offen sc0 sc1
  v_accvgpr_read_b32 v48, a172
  v_accvgpr_read_b32 v49, a173
  v_accvgpr_read_b32 v50, a174
  v_accvgpr_read_b32 v51, a175
  v_accvgpr_read_b32 v52, a188
  v_accvgpr_read_b32 v53, a189
  v_accvgpr_read_b32 v54, a190
  v_accvgpr_read_b32 v55, a191
  v_mul_f32 v48, v48, v40
  v_mul_f32 v49, v49, v40
  v_mul_f32 v50, v50, v40
  v_mul_f32 v51, v51, v40
  v_mul_f32 v52, v52, v40
  v_mul_f32 v53, v53, v40
  v_mul_f32 v54, v54, v40
  v_mul_f32 v55, v55, v40
  v_cvt_pk_bf16_f32 v60, v48, v49
  v_cvt_pk_bf16_f32 v61, v50, v51
  v_cvt_pk_bf16_f32 v62, v52, v53
  v_cvt_pk_bf16_f32 v63, v54, v55
  s_add_u32 s53, s72, 25760768
  buffer_store_dwordx4 v[60:63], v28, s[24:27], s53 offen sc0 sc1
K1_FIN:
  s_add_u32 s3, s52, 16384
  s_mov_b32 s45, s60
  s_load_dwordx2 s[32:33], s[0:1], 32
  s_load_dwordx2 s[34:35], s[0:1], 72
  s_load_dwordx4 s[36:39], s[0:1], 80
  s_load_dwordx2 s[40:41], s[0:1], 96
  v_and_b32 v1, 63, v0
  v_lshrrev_b32 v2, 6, v0
  v_lshlrev_b32 v8, 4, v1
  v_readfirstlane_b32 s54, v2
  s_mul_i32 s59, s54, 320
  v_add_u32 v3, s59, v1
  v_mul_u32_u24 v4, 3277, v3
  v_lshrrev_b32 v4, 16, v4
  v_bfe_u32 v5, v4, 2, 1
  v_lshlrev_b32 v5, 5, v5
  v_lshlrev_b32 v6, 4, v3
  v_mul_u32_u24 v7, 320, v4
  v_sub_u32 v6, v6, v7
  v_xor_b32 v6, v6, v5
  v_mul_u32_u24 v5, 1280, v4
  v_add_u32 v5, v5, v6
  v_subrev_u32 v10, 0, v5
  v_add_u32 v3, s59, v1
  v_add_u32 v3, 64, v3
  v_mul_u32_u24 v4, 3277, v3
  v_lshrrev_b32 v4, 16, v4
  v_bfe_u32 v5, v4, 2, 1
  v_lshlrev_b32 v5, 5, v5
  v_lshlrev_b32 v6, 4, v3
  v_mul_u32_u24 v7, 320, v4
  v_sub_u32 v6, v6, v7
  v_xor_b32 v6, v6, v5
  v_mul_u32_u24 v5, 1280, v4
  v_add_u32 v5, v5, v6
  v_subrev_u32 v11, 1024, v5
  v_add_u32 v3, s59, v1
  v_add_u32 v3, 128, v3
  v_mul_u32_u24 v4, 3277, v3
  v_lshrrev_b32 v4, 16, v4
  v_bfe_u32 v5, v4, 2, 1
  v_lshlrev_b32 v5, 5, v5
  v_lshlrev_b32 v6, 4, v3
  v_mul_u32_u24 v7, 320, v4
  v_sub_u32 v6, v6, v7
  v_xor_b32 v6, v6, v5
  v_mul_u32_u24 v5, 1280, v4
  v_add_u32 v5, v5, v6
  v_subrev_u32 v12, 2048, v5
  v_add_u32 v3, s59, v1
  v_add_u32 v3, 192, v3
  v_mul_u32_u24 v4, 3277, v3
  v_lshrrev_b32 v4, 16, v4
  v_bfe_u32 v5, v4, 2, 1
  v_lshlrev_b32 v5, 5, v5
  v_lshlrev_b32 v6, 4, v3
  v_mul_u32_u24 v7, 320, v4
  v_sub_u32 v6, v6, v7
  v_xor_b32 v6, v6, v5
  v_mul_u32_u24 v5, 1280, v4
  v_add_u32 v5, v5, v6
  v_subrev_u32 v13, 3072, v5
  v_add_u32 v3, s59, v1
  v_add_u32 v3, 256, v3
  v_mul_u32_u24 v4, 3277, v3
  v_lshrrev_b32 v4, 16, v4
  v_bfe_u32 v5, v4, 2, 1
  v_lshlrev_b32 v5, 5, v5
  v_lshlrev_b32 v6, 4, v3
  v_mul_u32_u24 v7, 320, v4
  v_sub_u32 v6, v6, v7
  v_xor_b32 v6, v6, v5
  v_mul_u32_u24 v5, 1280, v4
  v_add_u32 v5, v5, v6
  v_subrev_u32 v14, 0, v5
  v_lshrrev_b32 v3, 4, v1
  v_bfe_u32 v4, v1, 2, 2
  v_lshl_add_u32 v4, v3, 2, v4
  v_mul_u32_u24 v4, 320, v4
  v_and_b32 v5, 3, v1
  v_lshl_add_u32 v4, v5, 3, v4
  v_and_b32 v5, 1, v3
  v_xor_b32 v6, 0, v5
  v_lshl_add_u32 v6, v6, 5, v4
  v_add_u32 v16, 81920, v6
  v_add_u32 v18, 102400, v6
  v_add_u32 v20, 122880, v6
  v_add_u32 v22, 143360, v6
  v_xor_b32 v6, 1, v5
  v_lshl_add_u32 v6, v6, 5, v4
  v_add_u32 v17, 81920, v6
  v_add_u32 v19, 102400, v6
  v_add_u32 v21, 122880, v6
  v_add_u32 v23, 143360, v6
  v_and_b32 v5, 15, v1
  v_mul_u32_u24 v5, 2560, v5
  v_lshl_add_u32 v24, v3, 3, v5
  s_waitcnt lgkmcnt(0)
  s_bfe_u32 s55, s2, 0x10002
  s_and_b32 s56, s2, 3
  s_lshr_b32 s57, s2, 5
  s_bfe_u32 s58, s2, 0x20003
  s_cmp_eq_u32 s55, 0
  s_cselect_b32 s8, s32, s34
  s_cselect_b32 s9, s33, s35
  s_mul_i32 s59, s56, 1966080
  s_add_u32 s8, s8, s59
  s_addc_u32 s9, s9, 0
  s_mov_b32 s10, 1966080
  s_mov_b32 s11, 0x00020000
  s_mul_i32 s59, s55, 25165824
  s_lshl_b32 s60, s57, 4
  s_lshl_b32 s61, s54, 2
  s_add_u32 s60, s60, s61
  s_mul_i32 s60, s60, 196608
  s_add_u32 s59, s59, s60
  s_mul_i32 s60, s56, 49152
  s_add_u32 s59, s59, s60
  s_add_u32 s12, s40, s59
  s_addc_u32 s13, s41, 0
  s_mov_b32 s14, 49152
  s_mov_b32 s15, 0x00020000
  s_add_u32 s59, s59, 196608
  s_add_u32 s16, s40, s59
  s_addc_u32 s17, s41, 0
  s_mov_b32 s18, 49152
  s_mov_b32 s19, 0x00020000
  s_add_u32 s59, s59, 196608
  s_add_u32 s72, s40, s59
  s_addc_u32 s73, s41, 0
  s_mov_b32 s74, 49152
  s_mov_b32 s75, 0x00020000
  s_add_u32 s59, s59, 196608
  s_add_u32 s96, s40, s59
  s_addc_u32 s97, s41, 0
  s_mov_b32 s98, 49152
  s_mov_b32 s99, 0x00020000
  s_mov_b32 s20, s40
  s_mov_b32 s21, s41
  s_mov_b32 s22, 439353344
  s_mov_b32 s23, 0x00020000
  s_mov_b32 s24, s36
  s_mov_b32 s25, s37
  s_mov_b32 s26, 5242880
  s_mov_b32 s27, 0x00020000
  s_mov_b32 s28, s38
  s_mov_b32 s29, s39
  s_mov_b32 s30, 256
  s_mov_b32 s31, 0x00020000
  s_mul_i32 s62, s58, 320
  s_mov_b32 s63, 0
  s_mul_i32 s64, s54, 5120
  s_lshl_b32 s59, s55, 5
  s_lshl_b32 s60, s57, 2
  s_add_u32 s59, s59, s60
  s_add_u32 s59, s59, s58
  s_lshl_b32 s70, s59, 8
  s_lshl_b32 s60, s54, 2
  s_add_u32 s70, s70, s60
  s_add_u32 s70, s70, 54525952
  s_mul_i32 s59, s59, 327680
  s_mul_i32 s60, s54, 5120
  s_add_u32 s59, s59, s60
  s_add_u32 s67, s59, 67108864
  s_lshl_b32 s59, s57, 2
  s_add_u32 s59, s59, s54
  s_mul_i32 s69, s59, 163840
  s_mul_i32 s59, s55, 1280
  s_add_u32 s69, s69, s59
  s_add_u32 s69, s69, s62
  s_mul_i32 s59, s56, 40960
  s_add_u32 s69, s69, s59
  s_waitcnt vmcnt(24)
  s_barrier
  s_add_u32 m0, s64, 81920
  s_nop 0
  buffer_load_dwordx4 v10, s[8:11], s62 offen offset:0 lds
  buffer_load_dwordx4 v11, s[8:11], s62 offen offset:1024 lds
  buffer_load_dwordx4 v12, s[8:11], s62 offen offset:2048 lds
  buffer_load_dwordx4 v13, s[8:11], s62 offen offset:3072 lds
  s_add_u32 m0, s64, 86016
  s_nop 0
  buffer_load_dwordx4 v14, s[8:11], s62 offen lds
  s_add_u32 s62, s62, 81920
  s_add_u32 m0, s64, 102400
  s_nop 0
  buffer_load_dwordx4 v10, s[8:11], s62 offen offset:0 lds
  buffer_load_dwordx4 v11, s[8:11], s62 offen offset:1024 lds
  buffer_load_dwordx4 v12, s[8:11], s62 offen offset:2048 lds
  buffer_load_dwordx4 v13, s[8:11], s62 offen offset:3072 lds
  s_add_u32 m0, s64, 106496
  s_nop 0
  buffer_load_dwordx4 v14, s[8:11], s62 offen lds
  s_add_u32 s62, s62, 81920
  s_add_u32 m0, s64, 122880
  s_nop 0
  buffer_load_dwordx4 v10, s[8:11], s62 offen offset:0 lds
  buffer_load_dwordx4 v11, s[8:11], s62 offen offset:1024 lds
  buffer_load_dwordx4 v12, s[8:11], s62 offen offset:2048 lds
  buffer_load_dwordx4 v13, s[8:11], s62 offen offset:3072 lds
  s_add_u32 m0, s64, 126976
  s_nop 0
  buffer_load_dwordx4 v14, s[8:11], s62 offen lds
  s_add_u32 s62, s62, 81920
  s_waitcnt vmcnt(15)
  s_barrier
  s_cmp_lg_u32 s54, 0
  s_cbranch_scc1 K2_READY
  v_mov_b32 v2, 1
  v_mov_b32 v3, 0
  s_mov_b64 exec, 1
  buffer_store_dword v2, v3, s[20:23], s3 offen sc0 sc1
  s_mov_b64 exec, 0xff
  v_lshlrev_b32 v4, 6, v1
  s_lshl_b32 s59, s55, 8
  s_lshl_b32 s60, s57, 5
  s_add_u32 s59, s59, s60
  s_lshl_b32 s60, s56, 3
  s_add_u32 s59, s59, s60
  s_lshl_b32 s59, s59, 6
  s_add_u32 s59, s59, 55574528
  s_mov_b32 s71, 0
K2_WAIT:
  buffer_load_dword v5, v4, s[20:23], s59 offen sc0 sc1
  buffer_load_dword v6, v3, s[28:31], 0 offen offset:16 sc0 sc1
  s_waitcnt vmcnt(0)
  v_xor_b32 v5, 1, v5
  v_and_b32 v6, 0xff, v6
  v_or_b32 v5, v5, v6
  v_cmp_ne_u32 vcc, 0, v5
  s_add_u32 s71, s71, 1
  s_cbranch_vccz K2_GO
  s_sleep 2
  s_cmp_lt_u32 s71, 100000
  s_cbranch_scc1 K2_WAIT
K2_GO:
  s_mov_b64 exec, -1
K2_READY:
  s_barrier
  buffer_load_dwordx4 v[64:67], v8, s[12:15], s63 offen offset:0 sc0 sc1
  buffer_load_dwordx4 v[68:71], v8, s[16:19], s63 offen offset:0 sc0 sc1
  buffer_load_dwordx4 v[72:75], v8, s[72:75], s63 offen offset:0 sc0 sc1
  buffer_load_dwordx4 v[76:79], v8, s[96:99], s63 offen offset:0 sc0 sc1
  buffer_load_dwordx4 v[80:83], v8, s[12:15], s63 offen offset:1024 sc0 sc1
  buffer_load_dwordx4 v[84:87], v8, s[16:19], s63 offen offset:1024 sc0 sc1
  buffer_load_dwordx4 v[88:91], v8, s[72:75], s63 offen offset:1024 sc0 sc1
  buffer_load_dwordx4 v[92:95], v8, s[96:99], s63 offen offset:1024 sc0 sc1
  buffer_load_dwordx4 v[96:99], v8, s[12:15], s63 offen offset:2048 sc0 sc1
  buffer_load_dwordx4 v[100:103], v8, s[16:19], s63 offen offset:2048 sc0 sc1
  buffer_load_dwordx4 v[104:107], v8, s[72:75], s63 offen offset:2048 sc0 sc1
  buffer_load_dwordx4 v[108:111], v8, s[96:99], s63 offen offset:2048 sc0 sc1
  s_waitcnt vmcnt(22)
  s_barrier
  ds_read_b64_tr_b16 a[160:161], v16 offset:0
  ds_read_b64_tr_b16 a[162:163], v16 offset:5120
  ds_read_b64_tr_b16 a[164:165], v17 offset:0
  ds_read_b64_tr_b16 a[166:167], v17 offset:5120
  ds_read_b64_tr_b16 a[168:169], v16 offset:64
  ds_read_b64_tr_b16 a[170:171], v16 offset:5184
  ds_read_b64_tr_b16 a[172:173], v17 offset:64
  ds_read_b64_tr_b16 a[174:175], v17 offset:5184
  ds_read_b64_tr_b16 a[176:177], v16 offset:128
  ds_read_b64_tr_b16 a[178:179], v16 offset:5248
  s_waitcnt vmcnt(8)
  s_waitcnt lgkmcnt(6)
  v_mfma_f32_16x16x32_bf16 a[0:3], a[160:163], v[64:67], 0
  ds_read_b64_tr_b16 a[180:181], v17 offset:128
  v_mfma_f32_16x16x32_bf16 a[40:43], a[160:163], v[68:71], 0
  v_mfma_f32_16x16x32_bf16 a[80:83], a[160:163], v[72:75], 0
  ds_read_b64_tr_b16 a[182:183], v17 offset:5248
  v_mfma_f32_16x16x32_bf16 a[120:123], a[160:163], v[76:79], 0
  v_mfma_f32_16x16x32_bf16 a[4:7], a[164:167], v[64:67], 0
  ds_read_b64_tr_b16 a[184:185], v16 offset:192
  v_mfma_f32_16x16x32_bf16 a[44:47], a[164:167], v[68:71], 0
  buffer_load_dwordx4 v[112:115], v8, s[12:15], s63 offen offset:3072 sc0 sc1
  v_mfma_f32_16x16x32_bf16 a[84:87], a[164:167], v[72:75], 0
  ds_read_b64_tr_b16 a[186:187], v16 offset:5312
  v_mfma_f32_16x16x32_bf16 a[124:127], a[164:167], v[76:79], 0
  s_waitcnt lgkmcnt(6)
  v_mfma_f32_16x16x32_bf16 a[8:11], a[168:171], v[64:67], 0
  ds_read_b64_tr_b16 a[188:189], v17 offset:192
  v_mfma_f32_16x16x32_bf16 a[48:51], a[168:171], v[68:71], 0
  v_mfma_f32_16x16x32_bf16 a[88:91], a[168:171], v[72:75], 0
  ds_read_b64_tr_b16 a[190:191], v17 offset:5312
  v_mfma_f32_16x16x32_bf16 a[128:131], a[168:171], v[76:79], 0
  v_mfma_f32_16x16x32_bf16 a[12:15], a[172:175], v[64:67], 0
  ds_read_b64_tr_b16 a[192:193], v16 offset:256
  v_mfma_f32_16x16x32_bf16 a[52:55], a[172:175], v[68:71], 0
  buffer_load_dwordx4 v[116:119], v8, s[16:19], s63 offen offset:3072 sc0 sc1
  v_mfma_f32_16x16x32_bf16 a[92:95], a[172:175], v[72:75], 0
  ds_read_b64_tr_b16 a[194:195], v16 offset:5376
  v_mfma_f32_16x16x32_bf16 a[132:135], a[172:175], v[76:79], 0
  s_waitcnt lgkmcnt(6)
  v_mfma_f32_16x16x32_bf16 a[16:19], a[176:179], v[64:67], 0
  ds_read_b64_tr_b16 a[196:197], v17 offset:256
  v_mfma_f32_16x16x32_bf16 a[56:59], a[176:179], v[68:71], 0
  v_mfma_f32_16x16x32_bf16 a[96:99], a[176:179], v[72:75], 0
  ds_read_b64_tr_b16 a[198:199], v17 offset:5376
  v_mfma_f32_16x16x32_bf16 a[136:139], a[176:179], v[76:79], 0
  v_mfma_f32_16x16x32_bf16 a[20:23], a[180:183], v[64:67], 0
  ds_read_b64_tr_b16 a[160:161], v16 offset:10240
  v_mfma_f32_16x16x32_bf16 a[60:63], a[180:183], v[68:71], 0
  buffer_load_dwordx4 v[120:123], v8, s[72:75], s63 offen offset:3072 sc0 sc1
  v_mfma_f32_16x16x32_bf16 a[100:103], a[180:183], v[72:75], 0
  ds_read_b64_tr_b16 a[162:163], v16 offset:15360
  v_mfma_f32_16x16x32_bf16 a[140:143], a[180:183], v[76:79], 0
  s_waitcnt lgkmcnt(6)
  v_mfma_f32_16x16x32_bf16 a[24:27], a[184:187], v[64:67], 0
  ds_read_b64_tr_b16 a[164:165], v17 offset:10240
  v_mfma_f32_16x16x32_bf16 a[64:67], a[184:187], v[68:71], 0
  v_mfma_f32_16x16x32_bf16 a[104:107], a[184:187], v[72:75], 0
  ds_read_b64_tr_b16 a[166:167], v17 offset:15360
  v_mfma_f32_16x16x32_bf16 a[144:147], a[184:187], v[76:79], 0
  v_mfma_f32_16x16x32_bf16 a[28:31], a[188:191], v[64:67], 0
  ds_read_b64_tr_b16 a[168:169], v16 offset:10304
  v_mfma_f32_16x16x32_bf16 a[68:71], a[188:191], v[68:71], 0
  buffer_load_dwordx4 v[124:127], v8, s[96:99], s63 offen offset:3072 sc0 sc1
  v_mfma_f32_16x16x32_bf16 a[108:111], a[188:191], v[72:75], 0
  ds_read_b64_tr_b16 a[170:171], v16 offset:15424
  v_mfma_f32_16x16x32_bf16 a[148:151], a[188:191], v[76:79], 0
  s_waitcnt lgkmcnt(6)
  v_mfma_f32_16x16x32_bf16 a[32:35], a[192:195], v[64:67], 0
  ds_read_b64_tr_b16 a[172:173], v17 offset:10304
  v_mfma_f32_16x16x32_bf16 a[72:75], a[192:195], v[68:71], 0
  v_mfma_f32_16x16x32_bf16 a[112:115], a[192:195], v[72:75], 0
  ds_read_b64_tr_b16 a[174:175], v17 offset:15424
  v_mfma_f32_16x16x32_bf16 a[152:155], a[192:195], v[76:79], 0
  v_mfma_f32_16x16x32_bf16 a[36:39], a[196:199], v[64:67], 0
  ds_read_b64_tr_b16 a[176:177], v16 offset:10368
  v_mfma_f32_16x16x32_bf16 a[76:79], a[196:199], v[68:71], 0
  v_mfma_f32_16x16x32_bf16 a[116:119], a[196:199], v[72:75], 0
  ds_read_b64_tr_b16 a[178:179], v16 offset:15488
  v_mfma_f32_16x16x32_bf16 a[156:159], a[196:199], v[76:79], 0
  s_waitcnt vmcnt(8)
  s_waitcnt lgkmcnt(6)
  v_mfma_f32_16x16x32_bf16 a[0:3], a[160:163], v[80:83], a[0:3]
  ds_read_b64_tr_b16 a[180:181], v17 offset:10368
  v_mfma_f32_16x16x32_bf16 a[40:43], a[160:163], v[84:87], a[40:43]
  v_mfma_f32_16x16x32_bf16 a[80:83], a[160:163], v[88:91], a[80:83]
  ds_read_b64_tr_b16 a[182:183], v17 offset:15488
  v_mfma_f32_16x16x32_bf16 a[120:123], a[160:163], v[92:95], a[120:123]
  v_mfma_f32_16x16x32_bf16 a[4:7], a[164:167], v[80:83], a[4:7]
  ds_read_b64_tr_b16 a[184:185], v16 offset:10432
  v_mfma_f32_16x16x32_bf16 a[44:47], a[164:167], v[84:87], a[44:47]
  s_add_u32 s63, s63, 4096
  buffer_load_dwordx4 v[64:67], v8, s[12:15], s63 offen offset:0 sc0 sc1
  v_mfma_f32_16x16x32_bf16 a[84:87], a[164:167], v[88:91], a[84:87]
  ds_read_b64_tr_b16 a[186:187], v16 offset:15552
  v_mfma_f32_16x16x32_bf16 a[124:127], a[164:167], v[92:95], a[124:127]
  s_waitcnt lgkmcnt(6)
  v_mfma_f32_16x16x32_bf16 a[8:11], a[168:171], v[80:83], a[8:11]
  ds_read_b64_tr_b16 a[188:189], v17 offset:10432
  v_mfma_f32_16x16x32_bf16 a[48:51], a[168:171], v[84:87], a[48:51]
  v_mfma_f32_16x16x32_bf16 a[88:91], a[168:171], v[88:91], a[88:91]
  ds_read_b64_tr_b16 a[190:191], v17 offset:15552
  v_mfma_f32_16x16x32_bf16 a[128:131], a[168:171], v[92:95], a[128:131]
  v_mfma_f32_16x16x32_bf16 a[12:15], a[172:175], v[80:83], a[12:15]
  ds_read_b64_tr_b16 a[192:193], v16 offset:10496
  v_mfma_f32_16x16x32_bf16 a[52:55], a[172:175], v[84:87], a[52:55]
  buffer_load_dwordx4 v[68:71], v8, s[16:19], s63 offen offset:0 sc0 sc1
  v_mfma_f32_16x16x32_bf16 a[92:95], a[172:175], v[88:91], a[92:95]
  ds_read_b64_tr_b16 a[194:195], v16 offset:15616
  v_mfma_f32_16x16x32_bf16 a[132:135], a[172:175], v[92:95], a[132:135]
  s_waitcnt lgkmcnt(6)
  v_mfma_f32_16x16x32_bf16 a[16:19], a[176:179], v[80:83], a[16:19]
  ds_read_b64_tr_b16 a[196:197], v17 offset:10496
  v_mfma_f32_16x16x32_bf16 a[56:59], a[176:179], v[84:87], a[56:59]
  v_mfma_f32_16x16x32_bf16 a[96:99], a[176:179], v[88:91], a[96:99]
  ds_read_b64_tr_b16 a[198:199], v17 offset:15616
  v_mfma_f32_16x16x32_bf16 a[136:139], a[176:179], v[92:95], a[136:139]
  s_barrier
  v_mfma_f32_16x16x32_bf16 a[20:23], a[180:183], v[80:83], a[20:23]
  ds_read_b64_tr_b16 a[160:161], v18 offset:0
  v_mfma_f32_16x16x32_bf16 a[60:63], a[180:183], v[84:87], a[60:63]
  buffer_load_dwordx4 v[72:75], v8, s[72:75], s63 offen offset:0 sc0 sc1
  v_mfma_f32_16x16x32_bf16 a[100:103], a[180:183], v[88:91], a[100:103]
  ds_read_b64_tr_b16 a[162:163], v18 offset:5120
  v_mfma_f32_16x16x32_bf16 a[140:143], a[180:183], v[92:95], a[140:143]
  s_waitcnt lgkmcnt(6)
  v_mfma_f32_16x16x32_bf16 a[24:27], a[184:187], v[80:83], a[24:27]
  ds_read_b64_tr_b16 a[164:165], v19 offset:0
  v_mfma_f32_16x16x32_bf16 a[64:67], a[184:187], v[84:87], a[64:67]
  s_add_u32 m0, s64, 143360
  s_nop 0
  buffer_load_dwordx4 v10, s[8:11], s62 offen offset:0 lds
  v_mfma_f32_16x16x32_bf16 a[104:107], a[184:187], v[88:91], a[104:107]
  ds_read_b64_tr_b16 a[166:167], v19 offset:5120
  v_mfma_f32_16x16x32_bf16 a[144:147], a[184:187], v[92:95], a[144:147]
  v_mfma_f32_16x16x32_bf16 a[28:31], a[188:191], v[80:83], a[28:31]
  ds_read_b64_tr_b16 a[168:169], v18 offset:64
  v_mfma_f32_16x16x32_bf16 a[68:71], a[188:191], v[84:87], a[68:71]
  buffer_load_dwordx4 v[76:79], v8, s[96:99], s63 offen offset:0 sc0 sc1
  v_mfma_f32_16x16x32_bf16 a[108:111], a[188:191], v[88:91], a[108:111]
  ds_read_b64_tr_b16 a[170:171], v18 offset:5184
  v_mfma_f32_16x16x32_bf16 a[148:151], a[188:191], v[92:95], a[148:151]
  s_waitcnt lgkmcnt(6)
  v_mfma_f32_16x16x32_bf16 a[32:35], a[192:195], v[80:83], a[32:35]
  ds_read_b64_tr_b16 a[172:173], v19 offset:64
  v_mfma_f32_16x16x32_bf16 a[72:75], a[192:195], v[84:87], a[72:75]
  buffer_load_dwordx4 v11, s[8:11], s62 offen offset:1024 lds
  v_mfma_f32_16x16x32_bf16 a[112:115], a[192:195], v[88:91], a[112:115]
  ds_read_b64_tr_b16 a[174:175], v19 offset:5184
  v_mfma_f32_16x16x32_bf16 a[152:155], a[192:195], v[92:95], a[152:155]
  v_mfma_f32_16x16x32_bf16 a[36:39], a[196:199], v[80:83], a[36:39]
  ds_read_b64_tr_b16 a[176:177], v18 offset:128
  v_mfma_f32_16x16x32_bf16 a[76:79], a[196:199], v[84:87], a[76:79]
  buffer_load_dwordx4 v12, s[8:11], s62 offen offset:2048 lds
  v_mfma_f32_16x16x32_bf16 a[116:119], a[196:199], v[88:91], a[116:119]
  ds_read_b64_tr_b16 a[178:179], v18 offset:5248
  v_mfma_f32_16x16x32_bf16 a[156:159], a[196:199], v[92:95], a[156:159]
  s_waitcnt vmcnt(11)
  s_waitcnt lgkmcnt(6)
  v_mfma_f32_16x16x32_bf16 a[0:3], a[160:163], v[96:99], a[0:3]
  ds_read_b64_tr_b16 a[180:181], v19 offset:128
  v_mfma_f32_16x16x32_bf16 a[40:43], a[160:163], v[100:103], a[40:43]
  buffer_load_dwordx4 v13, s[8:11], s62 offen offset:3072 lds
  v_mfma_f32_16x16x32_bf16 a[80:83], a[160:163], v[104:107], a[80:83]
  ds_read_b64_tr_b16 a[182:183], v19 offset:5248
  v_mfma_f32_16x16x32_bf16 a[120:123], a[160:163], v[108:111], a[120:123]
  v_mfma_f32_16x16x32_bf16 a[4:7], a[164:167], v[96:99], a[4:7]
  ds_read_b64_tr_b16 a[184:185], v18 offset:192
  v_mfma_f32_16x16x32_bf16 a[44:47], a[164:167], v[100:103], a[44:47]
  buffer_load_dwordx4 v[80:83], v8, s[12:15], s63 offen offset:1024 sc0 sc1
  v_mfma_f32_16x16x32_bf16 a[84:87], a[164:167], v[104:107], a[84:87]
  ds_read_b64_tr_b16 a[186:187], v18 offset:5312
  v_mfma_f32_16x16x32_bf16 a[124:127], a[164:167], v[108:111], a[124:127]
  s_waitcnt lgkmcnt(6)
  v_mfma_f32_16x16x32_bf16 a[8:11], a[168:171], v[96:99], a[8:11]
  ds_read_b64_tr_b16 a[188:189], v19 offset:192
  v_mfma_f32_16x16x32_bf16 a[48:51], a[168:171], v[100:103], a[48:51]
  s_add_u32 m0, s64, 147456
  s_nop 0
  buffer_load_dwordx4 v14, s[8:11], s62 offen lds
  v_mfma_f32_16x16x32_bf16 a[88:91], a[168:171], v[104:107], a[88:91]
  ds_read_b64_tr_b16 a[190:191], v19 offset:5312
  v_mfma_f32_16x16x32_bf16 a[128:131], a[168:171], v[108:111], a[128:131]
  v_mfma_f32_16x16x32_bf16 a[12:15], a[172:175], v[96:99], a[12:15]
  ds_read_b64_tr_b16 a[192:193], v18 offset:256
  v_mfma_f32_16x16x32_bf16 a[52:55], a[172:175], v[100:103], a[52:55]
  buffer_load_dwordx4 v[84:87], v8, s[16:19], s63 offen offset:1024 sc0 sc1
  v_mfma_f32_16x16x32_bf16 a[92:95], a[172:175], v[104:107], a[92:95]
  ds_read_b64_tr_b16 a[194:195], v18 offset:5376
  v_mfma_f32_16x16x32_bf16 a[132:135], a[172:175], v[108:111], a[132:135]
  s_waitcnt lgkmcnt(6)
  v_mfma_f32_16x16x32_bf16 a[16:19], a[176:179], v[96:99], a[16:19]
  ds_read_b64_tr_b16 a[196:197], v19 offset:256
  v_mfma_f32_16x16x32_bf16 a[56:59], a[176:179], v[100:103], a[56:59]
  s_add_u32 s62, s62, 81920
  v_mfma_f32_16x16x32_bf16 a[96:99], a[176:179], v[104:107], a[96:99]
  ds_read_b64_tr_b16 a[198:199], v19 offset:5376
  v_mfma_f32_16x16x32_bf16 a[136:139], a[176:179], v[108:111], a[136:139]
  v_mfma_f32_16x16x32_bf16 a[20:23], a[180:183], v[96:99], a[20:23]
  ds_read_b64_tr_b16 a[160:161], v18 offset:10240
  v_mfma_f32_16x16x32_bf16 a[60:63], a[180:183], v[100:103], a[60:63]
  buffer_load_dwordx4 v[88:91], v8, s[72:75], s63 offen offset:1024 sc0 sc1
  v_mfma_f32_16x16x32_bf16 a[100:103], a[180:183], v[104:107], a[100:103]
  ds_read_b64_tr_b16 a[162:163], v18 offset:15360
  v_mfma_f32_16x16x32_bf16 a[140:143], a[180:183], v[108:111], a[140:143]
  s_waitcnt lgkmcnt(6)
  v_mfma_f32_16x16x32_bf16 a[24:27], a[184:187], v[96:99], a[24:27]
  ds_read_b64_tr_b16 a[164:165], v19 offset:10240
  v_mfma_f32_16x16x32_bf16 a[64:67], a[184:187], v[100:103], a[64:67]
  v_mfma_f32_16x16x32_bf16 a[104:107], a[184:187], v[104:107], a[104:107]
  ds_read_b64_tr_b16 a[166:167], v19 offset:15360
  v_mfma_f32_16x16x32_bf16 a[144:147], a[184:187], v[108:111], a[144:147]
  v_mfma_f32_16x16x32_bf16 a[28:31], a[188:191], v[96:99], a[28:31]
  ds_read_b64_tr_b16 a[168:169], v18 offset:10304
  v_mfma_f32_16x16x32_bf16 a[68:71], a[188:191], v[100:103], a[68:71]
  buffer_load_dwordx4 v[92:95], v8, s[96:99], s63 offen offset:1024 sc0 sc1
  v_mfma_f32_16x16x32_bf16 a[108:111], a[188:191], v[104:107], a[108:111]
  ds_read_b64_tr_b16 a[170:171], v18 offset:15424
  v_mfma_f32_16x16x32_bf16 a[148:151], a[188:191], v[108:111], a[148:151]
  s_waitcnt lgkmcnt(6)
  v_mfma_f32_16x16x32_bf16 a[32:35], a[192:195], v[96:99], a[32:35]
  ds_read_b64_tr_b16 a[172:173], v19 offset:10304
  v_mfma_f32_16x16x32_bf16 a[72:75], a[192:195], v[100:103], a[72:75]
  v_mfma_f32_16x16x32_bf16 a[112:115], a[192:195], v[104:107], a[112:115]
  ds_read_b64_tr_b16 a[174:175], v19 offset:15424
  v_mfma_f32_16x16x32_bf16 a[152:155], a[192:195], v[108:111], a[152:155]
  v_mfma_f32_16x16x32_bf16 a[36:39], a[196:199], v[96:99], a[36:39]
  ds_read_b64_tr_b16 a[176:177], v18 offset:10368
  v_mfma_f32_16x16x32_bf16 a[76:79], a[196:199], v[100:103], a[76:79]
  v_mfma_f32_16x16x32_bf16 a[116:119], a[196:199], v[104:107], a[116:119]
  ds_read_b64_tr_b16 a[178:179], v18 offset:15488
  v_mfma_f32_16x16x32_bf16 a[156:159], a[196:199], v[108:111], a[156:159]
  s_waitcnt vmcnt(13)
  s_waitcnt lgkmcnt(6)
  v_mfma_f32_16x16x32_bf16 a[0:3], a[160:163], v[112:115], a[0:3]
  ds_read_b64_tr_b16 a[180:181], v19 offset:10368
  v_mfma_f32_16x16x32_bf16 a[40:43], a[160:163], v[116:119], a[40:43]
  v_mfma_f32_16x16x32_bf16 a[80:83], a[160:163], v[120:123], a[80:83]
  ds_read_b64_tr_b16 a[182:183], v19 offset:15488
  v_mfma_f32_16x16x32_bf16 a[120:123], a[160:163], v[124:127], a[120:123]
  v_mfma_f32_16x16x32_bf16 a[4:7], a[164:167], v[112:115], a[4:7]
  ds_read_b64_tr_b16 a[184:185], v18 offset:10432
  v_mfma_f32_16x16x32_bf16 a[44:47], a[164:167], v[116:119], a[44:47]
  buffer_load_dwordx4 v[96:99], v8, s[12:15], s63 offen offset:2048 sc0 sc1
  v_mfma_f32_16x16x32_bf16 a[84:87], a[164:167], v[120:123], a[84:87]
  ds_read_b64_tr_b16 a[186:187], v18 offset:15552
  v_mfma_f32_16x16x32_bf16 a[124:127], a[164:167], v[124:127], a[124:127]
  s_waitcnt lgkmcnt(6)
  v_mfma_f32_16x16x32_bf16 a[8:11], a[168:171], v[112:115], a[8:11]
  ds_read_b64_tr_b16 a[188:189], v19 offset:10432
  v_mfma_f32_16x16x32_bf16 a[48:51], a[168:171], v[116:119], a[48:51]
  v_mfma_f32_16x16x32_bf16 a[88:91], a[168:171], v[120:123], a[88:91]
  ds_read_b64_tr_b16 a[190:191], v19 offset:15552
  v_mfma_f32_16x16x32_bf16 a[128:131], a[168:171], v[124:127], a[128:131]
  v_mfma_f32_16x16x32_bf16 a[12:15], a[172:175], v[112:115], a[12:15]
  ds_read_b64_tr_b16 a[192:193], v18 offset:10496
  v_mfma_f32_16x16x32_bf16 a[52:55], a[172:175], v[116:119], a[52:55]
  buffer_load_dwordx4 v[100:103], v8, s[16:19], s63 offen offset:2048 sc0 sc1
  v_mfma_f32_16x16x32_bf16 a[92:95], a[172:175], v[120:123], a[92:95]
  ds_read_b64_tr_b16 a[194:195], v18 offset:15616
  v_mfma_f32_16x16x32_bf16 a[132:135], a[172:175], v[124:127], a[132:135]
  s_waitcnt lgkmcnt(6)
  v_mfma_f32_16x16x32_bf16 a[16:19], a[176:179], v[112:115], a[16:19]
  ds_read_b64_tr_b16 a[196:197], v19 offset:10496
  v_mfma_f32_16x16x32_bf16 a[56:59], a[176:179], v[116:119], a[56:59]
  v_mfma_f32_16x16x32_bf16 a[96:99], a[176:179], v[120:123], a[96:99]
  ds_read_b64_tr_b16 a[198:199], v19 offset:15616
  v_mfma_f32_16x16x32_bf16 a[136:139], a[176:179], v[124:127], a[136:139]
  s_barrier
  v_mfma_f32_16x16x32_bf16 a[20:23], a[180:183], v[112:115], a[20:23]
  ds_read_b64_tr_b16 a[160:161], v20 offset:0
  v_mfma_f32_16x16x32_bf16 a[60:63], a[180:183], v[116:119], a[60:63]
  buffer_load_dwordx4 v[104:107], v8, s[72:75], s63 offen offset:2048 sc0 sc1
  v_mfma_f32_16x16x32_bf16 a[100:103], a[180:183], v[120:123], a[100:103]
  ds_read_b64_tr_b16 a[162:163], v20 offset:5120
  v_mfma_f32_16x16x32_bf16 a[140:143], a[180:183], v[124:127], a[140:143]
  s_waitcnt lgkmcnt(6)
  v_mfma_f32_16x16x32_bf16 a[24:27], a[184:187], v[112:115], a[24:27]
  ds_read_b64_tr_b16 a[164:165], v21 offset:0
  v_mfma_f32_16x16x32_bf16 a[64:67], a[184:187], v[116:119], a[64:67]
  s_add_u32 m0, s64, 81920
  s_nop 0
  buffer_load_dwordx4 v10, s[8:11], s62 offen offset:0 lds
  v_mfma_f32_16x16x32_bf16 a[104:107], a[184:187], v[120:123], a[104:107]
  ds_read_b64_tr_b16 a[166:167], v21 offset:5120
  v_mfma_f32_16x16x32_bf16 a[144:147], a[184:187], v[124:127], a[144:147]
  v_mfma_f32_16x16x32_bf16 a[28:31], a[188:191], v[112:115], a[28:31]
  ds_read_b64_tr_b16 a[168:169], v20 offset:64
  v_mfma_f32_16x16x32_bf16 a[68:71], a[188:191], v[116:119], a[68:71]
  buffer_load_dwordx4 v[108:111], v8, s[96:99], s63 offen offset:2048 sc0 sc1
  v_mfma_f32_16x16x32_bf16 a[108:111], a[188:191], v[120:123], a[108:111]
  ds_read_b64_tr_b16 a[170:171], v20 offset:5184
  v_mfma_f32_16x16x32_bf16 a[148:151], a[188:191], v[124:127], a[148:151]
  s_waitcnt lgkmcnt(6)
  v_mfma_f32_16x16x32_bf16 a[32:35], a[192:195], v[112:115], a[32:35]
  ds_read_b64_tr_b16 a[172:173], v21 offset:64
  v_mfma_f32_16x16x32_bf16 a[72:75], a[192:195], v[116:119], a[72:75]
  buffer_load_dwordx4 v11, s[8:11], s62 offen offset:1024 lds
  v_mfma_f32_16x16x32_bf16 a[112:115], a[192:195], v[120:123], a[112:115]
  ds_read_b64_tr_b16 a[174:175], v21 offset:5184
  v_mfma_f32_16x16x32_bf16 a[152:155], a[192:195], v[124:127], a[152:155]
  v_mfma_f32_16x16x32_bf16 a[36:39], a[196:199], v[112:115], a[36:39]
  ds_read_b64_tr_b16 a[176:177], v20 offset:128
  v_mfma_f32_16x16x32_bf16 a[76:79], a[196:199], v[116:119], a[76:79]
  buffer_load_dwordx4 v12, s[8:11], s62 offen offset:2048 lds
  v_mfma_f32_16x16x32_bf16 a[116:119], a[196:199], v[120:123], a[116:119]
  ds_read_b64_tr_b16 a[178:179], v20 offset:5248
  v_mfma_f32_16x16x32_bf16 a[156:159], a[196:199], v[124:127], a[156:159]
  s_waitcnt vmcnt(15)
  s_waitcnt lgkmcnt(6)
  v_mfma_f32_16x16x32_bf16 a[0:3], a[160:163], v[64:67], a[0:3]
  ds_read_b64_tr_b16 a[180:181], v21 offset:128
  v_mfma_f32_16x16x32_bf16 a[40:43], a[160:163], v[68:71], a[40:43]
  buffer_load_dwordx4 v13, s[8:11], s62 offen offset:3072 lds
  v_mfma_f32_16x16x32_bf16 a[80:83], a[160:163], v[72:75], a[80:83]
  ds_read_b64_tr_b16 a[182:183], v21 offset:5248
  v_mfma_f32_16x16x32_bf16 a[120:123], a[160:163], v[76:79], a[120:123]
  v_mfma_f32_16x16x32_bf16 a[4:7], a[164:167], v[64:67], a[4:7]
  ds_read_b64_tr_b16 a[184:185], v20 offset:192
  v_mfma_f32_16x16x32_bf16 a[44:47], a[164:167], v[68:71], a[44:47]
  buffer_load_dwordx4 v[112:115], v8, s[12:15], s63 offen offset:3072 sc0 sc1
  v_mfma_f32_16x16x32_bf16 a[84:87], a[164:167], v[72:75], a[84:87]
  ds_read_b64_tr_b16 a[186:187], v20 offset:5312
  v_mfma_f32_16x16x32_bf16 a[124:127], a[164:167], v[76:79], a[124:127]
  s_waitcnt lgkmcnt(6)
  v_mfma_f32_16x16x32_bf16 a[8:11], a[168:171], v[64:67], a[8:11]
  ds_read_b64_tr_b16 a[188:189], v21 offset:192
  v_mfma_f32_16x16x32_bf16 a[48:51], a[168:171], v[68:71], a[48:51]
  s_add_u32 m0, s64, 86016
  s_nop 0
  buffer_load_dwordx4 v14, s[8:11], s62 offen lds
  v_mfma_f32_16x16x32_bf16 a[88:91], a[168:171], v[72:75], a[88:91]
  ds_read_b64_tr_b16 a[190:191], v21 offset:5312
  v_mfma_f32_16x16x32_bf16 a[128:131], a[168:171], v[76:79], a[128:131]
  v_mfma_f32_16x16x32_bf16 a[12:15], a[172:175], v[64:67], a[12:15]
  ds_read_b64_tr_b16 a[192:193], v20 offset:256
  v_mfma_f32_16x16x32_bf16 a[52:55], a[172:175], v[68:71], a[52:55]
  buffer_load_dwordx4 v[116:119], v8, s[16:19], s63 offen offset:3072 sc0 sc1
  v_mfma_f32_16x16x32_bf16 a[92:95], a[172:175], v[72:75], a[92:95]
  ds_read_b64_tr_b16 a[194:195], v20 offset:5376
  v_mfma_f32_16x16x32_bf16 a[132:135], a[172:175], v[76:79], a[132:135]
  s_waitcnt lgkmcnt(6)
  v_mfma_f32_16x16x32_bf16 a[16:19], a[176:179], v[64:67], a[16:19]
  ds_read_b64_tr_b16 a[196:197], v21 offset:256
  v_mfma_f32_16x16x32_bf16 a[56:59], a[176:179], v[68:71], a[56:59]
  s_add_u32 s62, s62, 81920
  v_mfma_f32_16x16x32_bf16 a[96:99], a[176:179], v[72:75], a[96:99]
  ds_read_b64_tr_b16 a[198:199], v21 offset:5376
  v_mfma_f32_16x16x32_bf16 a[136:139], a[176:179], v[76:79], a[136:139]
  v_mfma_f32_16x16x32_bf16 a[20:23], a[180:183], v[64:67], a[20:23]
  ds_read_b64_tr_b16 a[160:161], v20 offset:10240
  v_mfma_f32_16x16x32_bf16 a[60:63], a[180:183], v[68:71], a[60:63]
  buffer_load_dwordx4 v[120:123], v8, s[72:75], s63 offen offset:3072 sc0 sc1
  v_mfma_f32_16x16x32_bf16 a[100:103], a[180:183], v[72:75], a[100:103]
  ds_read_b64_tr_b16 a[162:163], v20 offset:15360
  v_mfma_f32_16x16x32_bf16 a[140:143], a[180:183], v[76:79], a[140:143]
  s_waitcnt lgkmcnt(6)
  v_mfma_f32_16x16x32_bf16 a[24:27], a[184:187], v[64:67], a[24:27]
  ds_read_b64_tr_b16 a[164:165], v21 offset:10240
  v_mfma_f32_16x16x32_bf16 a[64:67], a[184:187], v[68:71], a[64:67]
  v_mfma_f32_16x16x32_bf16 a[104:107], a[184:187], v[72:75], a[104:107]
  ds_read_b64_tr_b16 a[166:167], v21 offset:15360
  v_mfma_f32_16x16x32_bf16 a[144:147], a[184:187], v[76:79], a[144:147]
  v_mfma_f32_16x16x32_bf16 a[28:31], a[188:191], v[64:67], a[28:31]
  ds_read_b64_tr_b16 a[168:169], v20 offset:10304
  v_mfma_f32_16x16x32_bf16 a[68:71], a[188:191], v[68:71], a[68:71]
  buffer_load_dwordx4 v[124:127], v8, s[96:99], s63 offen offset:3072 sc0 sc1
  v_mfma_f32_16x16x32_bf16 a[108:111], a[188:191], v[72:75], a[108:111]
  ds_read_b64_tr_b16 a[170:171], v20 offset:15424
  v_mfma_f32_16x16x32_bf16 a[148:151], a[188:191], v[76:79], a[148:151]
  s_waitcnt lgkmcnt(6)
  v_mfma_f32_16x16x32_bf16 a[32:35], a[192:195], v[64:67], a[32:35]
  ds_read_b64_tr_b16 a[172:173], v21 offset:10304
  v_mfma_f32_16x16x32_bf16 a[72:75], a[192:195], v[68:71], a[72:75]
  v_mfma_f32_16x16x32_bf16 a[112:115], a[192:195], v[72:75], a[112:115]
  ds_read_b64_tr_b16 a[174:175], v21 offset:15424
  v_mfma_f32_16x16x32_bf16 a[152:155], a[192:195], v[76:79], a[152:155]
  v_mfma_f32_16x16x32_bf16 a[36:39], a[196:199], v[64:67], a[36:39]
  ds_read_b64_tr_b16 a[176:177], v20 offset:10368
  v_mfma_f32_16x16x32_bf16 a[76:79], a[196:199], v[68:71], a[76:79]
  v_mfma_f32_16x16x32_bf16 a[116:119], a[196:199], v[72:75], a[116:119]
  ds_read_b64_tr_b16 a[178:179], v20 offset:15488
  v_mfma_f32_16x16x32_bf16 a[156:159], a[196:199], v[76:79], a[156:159]
  s_waitcnt vmcnt(13)
  s_waitcnt lgkmcnt(6)
  v_mfma_f32_16x16x32_bf16 a[0:3], a[160:163], v[80:83], a[0:3]
  ds_read_b64_tr_b16 a[180:181], v21 offset:10368
  v_mfma_f32_16x16x32_bf16 a[40:43], a[160:163], v[84:87], a[40:43]
  v_mfma_f32_16x16x32_bf16 a[80:83], a[160:163], v[88:91], a[80:83]
  ds_read_b64_tr_b16 a[182:183], v21 offset:15488
  v_mfma_f32_16x16x32_bf16 a[120:123], a[160:163], v[92:95], a[120:123]
  v_mfma_f32_16x16x32_bf16 a[4:7], a[164:167], v[80:83], a[4:7]
  ds_read_b64_tr_b16 a[184:185], v20 offset:10432
  v_mfma_f32_16x16x32_bf16 a[44:47], a[164:167], v[84:87], a[44:47]
  s_add_u32 s63, s63, 4096
  buffer_load_dwordx4 v[64:67], v8, s[12:15], s63 offen offset:0 sc0 sc1
  v_mfma_f32_16x16x32_bf16 a[84:87], a[164:167], v[88:91], a[84:87]
  ds_read_b64_tr_b16 a[186:187], v20 offset:15552
  v_mfma_f32_16x16x32_bf16 a[124:127], a[164:167], v[92:95], a[124:127]
  s_waitcnt lgkmcnt(6)
  v_mfma_f32_16x16x32_bf16 a[8:11], a[168:171], v[80:83], a[8:11]
  ds_read_b64_tr_b16 a[188:189], v21 offset:10432
  v_mfma_f32_16x16x32_bf16 a[48:51], a[168:171], v[84:87], a[48:51]
  v_mfma_f32_16x16x32_bf16 a[88:91], a[168:171], v[88:91], a[88:91]
  ds_read_b64_tr_b16 a[190:191], v21 offset:15552
  v_mfma_f32_16x16x32_bf16 a[128:131], a[168:171], v[92:95], a[128:131]
  v_mfma_f32_16x16x32_bf16 a[12:15], a[172:175], v[80:83], a[12:15]
  ds_read_b64_tr_b16 a[192:193], v20 offset:10496
  v_mfma_f32_16x16x32_bf16 a[52:55], a[172:175], v[84:87], a[52:55]
  buffer_load_dwordx4 v[68:71], v8, s[16:19], s63 offen offset:0 sc0 sc1
  v_mfma_f32_16x16x32_bf16 a[92:95], a[172:175], v[88:91], a[92:95]
  ds_read_b64_tr_b16 a[194:195], v20 offset:15616
  v_mfma_f32_16x16x32_bf16 a[132:135], a[172:175], v[92:95], a[132:135]
  s_waitcnt lgkmcnt(6)
  v_mfma_f32_16x16x32_bf16 a[16:19], a[176:179], v[80:83], a[16:19]
  ds_read_b64_tr_b16 a[196:197], v21 offset:10496
  v_mfma_f32_16x16x32_bf16 a[56:59], a[176:179], v[84:87], a[56:59]
  v_mfma_f32_16x16x32_bf16 a[96:99], a[176:179], v[88:91], a[96:99]
  ds_read_b64_tr_b16 a[198:199], v21 offset:15616
  v_mfma_f32_16x16x32_bf16 a[136:139], a[176:179], v[92:95], a[136:139]
  s_barrier
  v_mfma_f32_16x16x32_bf16 a[20:23], a[180:183], v[80:83], a[20:23]
  ds_read_b64_tr_b16 a[160:161], v22 offset:0
  v_mfma_f32_16x16x32_bf16 a[60:63], a[180:183], v[84:87], a[60:63]
  buffer_load_dwordx4 v[72:75], v8, s[72:75], s63 offen offset:0 sc0 sc1
  v_mfma_f32_16x16x32_bf16 a[100:103], a[180:183], v[88:91], a[100:103]
  ds_read_b64_tr_b16 a[162:163], v22 offset:5120
  v_mfma_f32_16x16x32_bf16 a[140:143], a[180:183], v[92:95], a[140:143]
  s_waitcnt lgkmcnt(6)
  v_mfma_f32_16x16x32_bf16 a[24:27], a[184:187], v[80:83], a[24:27]
  ds_read_b64_tr_b16 a[164:165], v23 offset:0
  v_mfma_f32_16x16x32_bf16 a[64:67], a[184:187], v[84:87], a[64:67]
  s_add_u32 m0, s64, 102400
  s_nop 0
  buffer_load_dwordx4 v10, s[8:11], s62 offen offset:0 lds
  v_mfma_f32_16x16x32_bf16 a[104:107], a[184:187], v[88:91], a[104:107]
  ds_read_b64_tr_b16 a[166:167], v23 offset:5120
  v_mfma_f32_16x16x32_bf16 a[144:147], a[184:187], v[92:95], a[144:147]
  v_mfma_f32_16x16x32_bf16 a[28:31], a[188:191], v[80:83], a[28:31]
  ds_read_b64_tr_b16 a[168:169], v22 offset:64
  v_mfma_f32_16x16x32_bf16 a[68:71], a[188:191], v[84:87], a[68:71]
  buffer_load_dwordx4 v[76:79], v8, s[96:99], s63 offen offset:0 sc0 sc1
  v_mfma_f32_16x16x32_bf16 a[108:111], a[188:191], v[88:91], a[108:111]
  ds_read_b64_tr_b16 a[170:171], v22 offset:5184
  v_mfma_f32_16x16x32_bf16 a[148:151], a[188:191], v[92:95], a[148:151]
  s_waitcnt lgkmcnt(6)
  v_mfma_f32_16x16x32_bf16 a[32:35], a[192:195], v[80:83], a[32:35]
  ds_read_b64_tr_b16 a[172:173], v23 offset:64
  v_mfma_f32_16x16x32_bf16 a[72:75], a[192:195], v[84:87], a[72:75]
  buffer_load_dwordx4 v11, s[8:11], s62 offen offset:1024 lds
  v_mfma_f32_16x16x32_bf16 a[112:115], a[192:195], v[88:91], a[112:115]
  ds_read_b64_tr_b16 a[174:175], v23 offset:5184
  v_mfma_f32_16x16x32_bf16 a[152:155], a[192:195], v[92:95], a[152:155]
  v_mfma_f32_16x16x32_bf16 a[36:39], a[196:199], v[80:83], a[36:39]
  ds_read_b64_tr_b16 a[176:177], v22 offset:128
  v_mfma_f32_16x16x32_bf16 a[76:79], a[196:199], v[84:87], a[76:79]
  buffer_load_dwordx4 v12, s[8:11], s62 offen offset:2048 lds
  v_mfma_f32_16x16x32_bf16 a[116:119], a[196:199], v[88:91], a[116:119]
  ds_read_b64_tr_b16 a[178:179], v22 offset:5248
  v_mfma_f32_16x16x32_bf16 a[156:159], a[196:199], v[92:95], a[156:159]
  s_waitcnt vmcnt(15)
  s_waitcnt lgkmcnt(6)
  v_mfma_f32_16x16x32_bf16 a[0:3], a[160:163], v[96:99], a[0:3]
  ds_read_b64_tr_b16 a[180:181], v23 offset:128
  v_mfma_f32_16x16x32_bf16 a[40:43], a[160:163], v[100:103], a[40:43]
  buffer_load_dwordx4 v13, s[8:11], s62 offen offset:3072 lds
  v_mfma_f32_16x16x32_bf16 a[80:83], a[160:163], v[104:107], a[80:83]
  ds_read_b64_tr_b16 a[182:183], v23 offset:5248
  v_mfma_f32_16x16x32_bf16 a[120:123], a[160:163], v[108:111], a[120:123]
  v_mfma_f32_16x16x32_bf16 a[4:7], a[164:167], v[96:99], a[4:7]
  ds_read_b64_tr_b16 a[184:185], v22 offset:192
  v_mfma_f32_16x16x32_bf16 a[44:47], a[164:167], v[100:103], a[44:47]
  buffer_load_dwordx4 v[80:83], v8, s[12:15], s63 offen offset:1024 sc0 sc1
  v_mfma_f32_16x16x32_bf16 a[84:87], a[164:167], v[104:107], a[84:87]
  ds_read_b64_tr_b16 a[186:187], v22 offset:5312
  v_mfma_f32_16x16x32_bf16 a[124:127], a[164:167], v[108:111], a[124:127]
  s_waitcnt lgkmcnt(6)
  v_mfma_f32_16x16x32_bf16 a[8:11], a[168:171], v[96:99], a[8:11]
  ds_read_b64_tr_b16 a[188:189], v23 offset:192
  v_mfma_f32_16x16x32_bf16 a[48:51], a[168:171], v[100:103], a[48:51]
  s_add_u32 m0, s64, 106496
  s_nop 0
  buffer_load_dwordx4 v14, s[8:11], s62 offen lds
  v_mfma_f32_16x16x32_bf16 a[88:91], a[168:171], v[104:107], a[88:91]
  ds_read_b64_tr_b16 a[190:191], v23 offset:5312
  v_mfma_f32_16x16x32_bf16 a[128:131], a[168:171], v[108:111], a[128:131]
  v_mfma_f32_16x16x32_bf16 a[12:15], a[172:175], v[96:99], a[12:15]
  ds_read_b64_tr_b16 a[192:193], v22 offset:256
  v_mfma_f32_16x16x32_bf16 a[52:55], a[172:175], v[100:103], a[52:55]
  buffer_load_dwordx4 v[84:87], v8, s[16:19], s63 offen offset:1024 sc0 sc1
  v_mfma_f32_16x16x32_bf16 a[92:95], a[172:175], v[104:107], a[92:95]
  ds_read_b64_tr_b16 a[194:195], v22 offset:5376
  v_mfma_f32_16x16x32_bf16 a[132:135], a[172:175], v[108:111], a[132:135]
  s_waitcnt lgkmcnt(6)
  v_mfma_f32_16x16x32_bf16 a[16:19], a[176:179], v[96:99], a[16:19]
  ds_read_b64_tr_b16 a[196:197], v23 offset:256
  v_mfma_f32_16x16x32_bf16 a[56:59], a[176:179], v[100:103], a[56:59]
  s_add_u32 s62, s62, 81920
  v_mfma_f32_16x16x32_bf16 a[96:99], a[176:179], v[104:107], a[96:99]
  ds_read_b64_tr_b16 a[198:199], v23 offset:5376
  v_mfma_f32_16x16x32_bf16 a[136:139], a[176:179], v[108:111], a[136:139]
  v_mfma_f32_16x16x32_bf16 a[20:23], a[180:183], v[96:99], a[20:23]
  ds_read_b64_tr_b16 a[160:161], v22 offset:10240
  v_mfma_f32_16x16x32_bf16 a[60:63], a[180:183], v[100:103], a[60:63]
  buffer_load_dwordx4 v[88:91], v8, s[72:75], s63 offen offset:1024 sc0 sc1
  v_mfma_f32_16x16x32_bf16 a[100:103], a[180:183], v[104:107], a[100:103]
  ds_read_b64_tr_b16 a[162:163], v22 offset:15360
  v_mfma_f32_16x16x32_bf16 a[140:143], a[180:183], v[108:111], a[140:143]
  s_waitcnt lgkmcnt(6)
  v_mfma_f32_16x16x32_bf16 a[24:27], a[184:187], v[96:99], a[24:27]
  ds_read_b64_tr_b16 a[164:165], v23 offset:10240
  v_mfma_f32_16x16x32_bf16 a[64:67], a[184:187], v[100:103], a[64:67]
  v_mfma_f32_16x16x32_bf16 a[104:107], a[184:187], v[104:107], a[104:107]
  ds_read_b64_tr_b16 a[166:167], v23 offset:15360
  v_mfma_f32_16x16x32_bf16 a[144:147], a[184:187], v[108:111], a[144:147]
  v_mfma_f32_16x16x32_bf16 a[28:31], a[188:191], v[96:99], a[28:31]
  ds_read_b64_tr_b16 a[168:169], v22 offset:10304
  v_mfma_f32_16x16x32_bf16 a[68:71], a[188:191], v[100:103], a[68:71]
  buffer_load_dwordx4 v[92:95], v8, s[96:99], s63 offen offset:1024 sc0 sc1
  v_mfma_f32_16x16x32_bf16 a[108:111], a[188:191], v[104:107], a[108:111]
  ds_read_b64_tr_b16 a[170:171], v22 offset:15424
  v_mfma_f32_16x16x32_bf16 a[148:151], a[188:191], v[108:111], a[148:151]
  s_waitcnt lgkmcnt(6)
  v_mfma_f32_16x16x32_bf16 a[32:35], a[192:195], v[96:99], a[32:35]
  ds_read_b64_tr_b16 a[172:173], v23 offset:10304
  v_mfma_f32_16x16x32_bf16 a[72:75], a[192:195], v[100:103], a[72:75]
  v_mfma_f32_16x16x32_bf16 a[112:115], a[192:195], v[104:107], a[112:115]
  ds_read_b64_tr_b16 a[174:175], v23 offset:15424
  v_mfma_f32_16x16x32_bf16 a[152:155], a[192:195], v[108:111], a[152:155]
  v_mfma_f32_16x16x32_bf16 a[36:39], a[196:199], v[96:99], a[36:39]
  ds_read_b64_tr_b16 a[176:177], v22 offset:10368
  v_mfma_f32_16x16x32_bf16 a[76:79], a[196:199], v[100:103], a[76:79]
  v_mfma_f32_16x16x32_bf16 a[116:119], a[196:199], v[104:107], a[116:119]
  ds_read_b64_tr_b16 a[178:179], v22 offset:15488
  v_mfma_f32_16x16x32_bf16 a[156:159], a[196:199], v[108:111], a[156:159]
  s_waitcnt vmcnt(13)
  s_waitcnt lgkmcnt(6)
  v_mfma_f32_16x16x32_bf16 a[0:3], a[160:163], v[112:115], a[0:3]
  ds_read_b64_tr_b16 a[180:181], v23 offset:10368
  v_mfma_f32_16x16x32_bf16 a[40:43], a[160:163], v[116:119], a[40:43]
  v_mfma_f32_16x16x32_bf16 a[80:83], a[160:163], v[120:123], a[80:83]
  ds_read_b64_tr_b16 a[182:183], v23 offset:15488
  v_mfma_f32_16x16x32_bf16 a[120:123], a[160:163], v[124:127], a[120:123]
  v_mfma_f32_16x16x32_bf16 a[4:7], a[164:167], v[112:115], a[4:7]
  ds_read_b64_tr_b16 a[184:185], v22 offset:10432
  v_mfma_f32_16x16x32_bf16 a[44:47], a[164:167], v[116:119], a[44:47]
  buffer_load_dwordx4 v[96:99], v8, s[12:15], s63 offen offset:2048 sc0 sc1
  v_mfma_f32_16x16x32_bf16 a[84:87], a[164:167], v[120:123], a[84:87]
  ds_read_b64_tr_b16 a[186:187], v22 offset:15552
  v_mfma_f32_16x16x32_bf16 a[124:127], a[164:167], v[124:127], a[124:127]
  s_waitcnt lgkmcnt(6)
  v_mfma_f32_16x16x32_bf16 a[8:11], a[168:171], v[112:115], a[8:11]
  ds_read_b64_tr_b16 a[188:189], v23 offset:10432
  v_mfma_f32_16x16x32_bf16 a[48:51], a[168:171], v[116:119], a[48:51]
  v_mfma_f32_16x16x32_bf16 a[88:91], a[168:171], v[120:123], a[88:91]
  ds_read_b64_tr_b16 a[190:191], v23 offset:15552
  v_mfma_f32_16x16x32_bf16 a[128:131], a[168:171], v[124:127], a[128:131]
  v_mfma_f32_16x16x32_bf16 a[12:15], a[172:175], v[112:115], a[12:15]
  ds_read_b64_tr_b16 a[192:193], v22 offset:10496
  v_mfma_f32_16x16x32_bf16 a[52:55], a[172:175], v[116:119], a[52:55]
  buffer_load_dwordx4 v[100:103], v8, s[16:19], s63 offen offset:2048 sc0 sc1
  v_mfma_f32_16x16x32_bf16 a[92:95], a[172:175], v[120:123], a[92:95]
  ds_read_b64_tr_b16 a[194:195], v22 offset:15616
  v_mfma_f32_16x16x32_bf16 a[132:135], a[172:175], v[124:127], a[132:135]
  s_waitcnt lgkmcnt(6)
  v_mfma_f32_16x16x32_bf16 a[16:19], a[176:179], v[112:115], a[16:19]
  ds_read_b64_tr_b16 a[196:197], v23 offset:10496
  v_mfma_f32_16x16x32_bf16 a[56:59], a[176:179], v[116:119], a[56:59]
  v_mfma_f32_16x16x32_bf16 a[96:99], a[176:179], v[120:123], a[96:99]
  ds_read_b64_tr_b16 a[198:199], v23 offset:15616
  v_mfma_f32_16x16x32_bf16 a[136:139], a[176:179], v[124:127], a[136:139]
  s_barrier
  v_mfma_f32_16x16x32_bf16 a[20:23], a[180:183], v[112:115], a[20:23]
  ds_read_b64_tr_b16 a[160:161], v16 offset:0
  v_mfma_f32_16x16x32_bf16 a[60:63], a[180:183], v[116:119], a[60:63]
  buffer_load_dwordx4 v[104:107], v8, s[72:75], s63 offen offset:2048 sc0 sc1
  v_mfma_f32_16x16x32_bf16 a[100:103], a[180:183], v[120:123], a[100:103]
  ds_read_b64_tr_b16 a[162:163], v16 offset:5120
  v_mfma_f32_16x16x32_bf16 a[140:143], a[180:183], v[124:127], a[140:143]
  s_waitcnt lgkmcnt(6)
  v_mfma_f32_16x16x32_bf16 a[24:27], a[184:187], v[112:115], a[24:27]
  ds_read_b64_tr_b16 a[164:165], v17 offset:0
  v_mfma_f32_16x16x32_bf16 a[64:67], a[184:187], v[116:119], a[64:67]
  s_add_u32 m0, s64, 122880
  s_nop 0
  buffer_load_dwordx4 v10, s[8:11], s62 offen offset:0 lds
  v_mfma_f32_16x16x32_bf16 a[104:107], a[184:187], v[120:123], a[104:107]
  ds_read_b64_tr_b16 a[166:167], v17 offset:5120
  v_mfma_f32_16x16x32_bf16 a[144:147], a[184:187], v[124:127], a[144:147]
  v_mfma_f32_16x16x32_bf16 a[28:31], a[188:191], v[112:115], a[28:31]
  ds_read_b64_tr_b16 a[168:169], v16 offset:64
  v_mfma_f32_16x16x32_bf16 a[68:71], a[188:191], v[116:119], a[68:71]
  buffer_load_dwordx4 v[108:111], v8, s[96:99], s63 offen offset:2048 sc0 sc1
  v_mfma_f32_16x16x32_bf16 a[108:111], a[188:191], v[120:123], a[108:111]
  ds_read_b64_tr_b16 a[170:171], v16 offset:5184
  v_mfma_f32_16x16x32_bf16 a[148:151], a[188:191], v[124:127], a[148:151]
  s_waitcnt lgkmcnt(6)
  v_mfma_f32_16x16x32_bf16 a[32:35], a[192:195], v[112:115], a[32:35]
  ds_read_b64_tr_b16 a[172:173], v17 offset:64
  v_mfma_f32_16x16x32_bf16 a[72:75], a[192:195], v[116:119], a[72:75]
  buffer_load_dwordx4 v11, s[8:11], s62 offen offset:1024 lds
  v_mfma_f32_16x16x32_bf16 a[112:115], a[192:195], v[120:123], a[112:115]
  ds_read_b64_tr_b16 a[174:175], v17 offset:5184
  v_mfma_f32_16x16x32_bf16 a[152:155], a[192:195], v[124:127], a[152:155]
  v_mfma_f32_16x16x32_bf16 a[36:39], a[196:199], v[112:115], a[36:39]
  ds_read_b64_tr_b16 a[176:177], v16 offset:128
  v_mfma_f32_16x16x32_bf16 a[76:79], a[196:199], v[116:119], a[76:79]
  buffer_load_dwordx4 v12, s[8:11], s62 offen offset:2048 lds
  v_mfma_f32_16x16x32_bf16 a[116:119], a[196:199], v[120:123], a[116:119]
  ds_read_b64_tr_b16 a[178:179], v16 offset:5248
  v_mfma_f32_16x16x32_bf16 a[156:159], a[196:199], v[124:127], a[156:159]
  s_mov_b32 s66, 5
.p2align 3
K2_LOOP:
  s_waitcnt vmcnt(15)
  s_waitcnt lgkmcnt(6)
  v_mfma_f32_16x16x32_bf16 a[0:3], a[160:163], v[64:67], a[0:3]
  ds_read_b64_tr_b16 a[180:181], v17 offset:128
  v_mfma_f32_16x16x32_bf16 a[40:43], a[160:163], v[68:71], a[40:43]
  buffer_load_dwordx4 v13, s[8:11], s62 offen offset:3072 lds
  v_mfma_f32_16x16x32_bf16 a[80:83], a[160:163], v[72:75], a[80:83]
  ds_read_b64_tr_b16 a[182:183], v17 offset:5248
  v_mfma_f32_16x16x32_bf16 a[120:123], a[160:163], v[76:79], a[120:123]
  v_mfma_f32_16x16x32_bf16 a[4:7], a[164:167], v[64:67], a[4:7]
  ds_read_b64_tr_b16 a[184:185], v16 offset:192
  v_mfma_f32_16x16x32_bf16 a[44:47], a[164:167], v[68:71], a[44:47]
  buffer_load_dwordx4 v[112:115], v8, s[12:15], s63 offen offset:3072 sc0 sc1
  v_mfma_f32_16x16x32_bf16 a[84:87], a[164:167], v[72:75], a[84:87]
  ds_read_b64_tr_b16 a[186:187], v16 offset:5312
  v_mfma_f32_16x16x32_bf16 a[124:127], a[164:167], v[76:79], a[124:127]
  s_waitcnt lgkmcnt(6)
  v_mfma_f32_16x16x32_bf16 a[8:11], a[168:171], v[64:67], a[8:11]
  ds_read_b64_tr_b16 a[188:189], v17 offset:192
  v_mfma_f32_16x16x32_bf16 a[48:51], a[168:171], v[68:71], a[48:51]
  s_add_u32 m0, s64, 126976
  s_nop 0
  buffer_load_dwordx4 v14, s[8:11], s62 offen lds
  v_mfma_f32_16x16x32_bf16 a[88:91], a[168:171], v[72:75], a[88:91]
  ds_read_b64_tr_b16 a[190:191], v17 offset:5312
  v_mfma_f32_16x16x32_bf16 a[128:131], a[168:171], v[76:79], a[128:131]
  v_mfma_f32_16x16x32_bf16 a[12:15], a[172:175], v[64:67], a[12:15]
  ds_read_b64_tr_b16 a[192:193], v16 offset:256
  v_mfma_f32_16x16x32_bf16 a[52:55], a[172:175], v[68:71], a[52:55]
  buffer_load_dwordx4 v[116:119], v8, s[16:19], s63 offen offset:3072 sc0 sc1
  v_mfma_f32_16x16x32_bf16 a[92:95], a[172:175], v[72:75], a[92:95]
  ds_read_b64_tr_b16 a[194:195], v16 offset:5376
  v_mfma_f32_16x16x32_bf16 a[132:135], a[172:175], v[76:79], a[132:135]
  s_waitcnt lgkmcnt(6)
  v_mfma_f32_16x16x32_bf16 a[16:19], a[176:179], v[64:67], a[16:19]
  ds_read_b64_tr_b16 a[196:197], v17 offset:256
  v_mfma_f32_16x16x32_bf16 a[56:59], a[176:179], v[68:71], a[56:59]
  s_add_u32 s62, s62, 81920
  v_mfma_f32_16x16x32_bf16 a[96:99], a[176:179], v[72:75], a[96:99]
  ds_read_b64_tr_b16 a[198:199], v17 offset:5376
  v_mfma_f32_16x16x32_bf16 a[136:139], a[176:179], v[76:79], a[136:139]
  v_mfma_f32_16x16x32_bf16 a[20:23], a[180:183], v[64:67], a[20:23]
  ds_read_b64_tr_b16 a[160:161], v16 offset:10240
  v_mfma_f32_16x16x32_bf16 a[60:63], a[180:183], v[68:71], a[60:63]
  buffer_load_dwordx4 v[120:123], v8, s[72:75], s63 offen offset:3072 sc0 sc1
  v_mfma_f32_16x16x32_bf16 a[100:103], a[180:183], v[72:75], a[100:103]
  ds_read_b64_tr_b16 a[162:163], v16 offset:15360
  v_mfma_f32_16x16x32_bf16 a[140:143], a[180:183], v[76:79], a[140:143]
  s_waitcnt lgkmcnt(6)
  v_mfma_f32_16x16x32_bf16 a[24:27], a[184:187], v[64:67], a[24:27]
  ds_read_b64_tr_b16 a[164:165], v17 offset:10240
  v_mfma_f32_16x16x32_bf16 a[64:67], a[184:187], v[68:71], a[64:67]
  v_mfma_f32_16x16x32_bf16 a[104:107], a[184:187], v[72:75], a[104:107]
  ds_read_b64_tr_b16 a[166:167], v17 offset:15360
  v_mfma_f32_16x16x32_bf16 a[144:147], a[184:187], v[76:79], a[144:147]
  v_mfma_f32_16x16x32_bf16 a[28:31], a[188:191], v[64:67], a[28:31]
  ds_read_b64_tr_b16 a[168:169], v16 offset:10304
  v_mfma_f32_16x16x32_bf16 a[68:71], a[188:191], v[68:71], a[68:71]
  buffer_load_dwordx4 v[124:127], v8, s[96:99], s63 offen offset:3072 sc0 sc1
  v_mfma_f32_16x16x32_bf16 a[108:111], a[188:191], v[72:75], a[108:111]
  ds_read_b64_tr_b16 a[170:171], v16 offset:15424
  v_mfma_f32_16x16x32_bf16 a[148:151], a[188:191], v[76:79], a[148:151]
  s_waitcnt lgkmcnt(6)
  v_mfma_f32_16x16x32_bf16 a[32:35], a[192:195], v[64:67], a[32:35]
  ds_read_b64_tr_b16 a[172:173], v17 offset:10304
  v_mfma_f32_16x16x32_bf16 a[72:75], a[192:195], v[68:71], a[72:75]
  v_mfma_f32_16x16x32_bf16 a[112:115], a[192:195], v[72:75], a[112:115]
  ds_read_b64_tr_b16 a[174:175], v17 offset:15424
  v_mfma_f32_16x16x32_bf16 a[152:155], a[192:195], v[76:79], a[152:155]
  v_mfma_f32_16x16x32_bf16 a[36:39], a[196:199], v[64:67], a[36:39]
  ds_read_b64_tr_b16 a[176:177], v16 offset:10368
  v_mfma_f32_16x16x32_bf16 a[76:79], a[196:199], v[68:71], a[76:79]
  v_mfma_f32_16x16x32_bf16 a[116:119], a[196:199], v[72:75], a[116:119]
  ds_read_b64_tr_b16 a[178:179], v16 offset:15488
  v_mfma_f32_16x16x32_bf16 a[156:159], a[196:199], v[76:79], a[156:159]
  s_waitcnt vmcnt(13)
  s_waitcnt lgkmcnt(6)
  v_mfma_f32_16x16x32_bf16 a[0:3], a[160:163], v[80:83], a[0:3]
  ds_read_b64_tr_b16 a[180:181], v17 offset:10368
  v_mfma_f32_16x16x32_bf16 a[40:43], a[160:163], v[84:87], a[40:43]
  v_mfma_f32_16x16x32_bf16 a[80:83], a[160:163], v[88:91], a[80:83]
  ds_read_b64_tr_b16 a[182:183], v17 offset:15488
  v_mfma_f32_16x16x32_bf16 a[120:123], a[160:163], v[92:95], a[120:123]
  v_mfma_f32_16x16x32_bf16 a[4:7], a[164:167], v[80:83], a[4:7]
  ds_read_b64_tr_b16 a[184:185], v16 offset:10432
  v_mfma_f32_16x16x32_bf16 a[44:47], a[164:167], v[84:87], a[44:47]
  s_add_u32 s63, s63, 4096
  buffer_load_dwordx4 v[64:67], v8, s[12:15], s63 offen offset:0 sc0 sc1
  v_mfma_f32_16x16x32_bf16 a[84:87], a[164:167], v[88:91], a[84:87]
  ds_read_b64_tr_b16 a[186:187], v16 offset:15552
  v_mfma_f32_16x16x32_bf16 a[124:127], a[164:167], v[92:95], a[124:127]
  s_waitcnt lgkmcnt(6)
  v_mfma_f32_16x16x32_bf16 a[8:11], a[168:171], v[80:83], a[8:11]
  ds_read_b64_tr_b16 a[188:189], v17 offset:10432
  v_mfma_f32_16x16x32_bf16 a[48:51], a[168:171], v[84:87], a[48:51]
  v_mfma_f32_16x16x32_bf16 a[88:91], a[168:171], v[88:91], a[88:91]
  ds_read_b64_tr_b16 a[190:191], v17 offset:15552
  v_mfma_f32_16x16x32_bf16 a[128:131], a[168:171], v[92:95], a[128:131]
  v_mfma_f32_16x16x32_bf16 a[12:15], a[172:175], v[80:83], a[12:15]
  ds_read_b64_tr_b16 a[192:193], v16 offset:10496
  v_mfma_f32_16x16x32_bf16 a[52:55], a[172:175], v[84:87], a[52:55]
  buffer_load_dwordx4 v[68:71], v8, s[16:19], s63 offen offset:0 sc0 sc1
  v_mfma_f32_16x16x32_bf16 a[92:95], a[172:175], v[88:91], a[92:95]
  ds_read_b64_tr_b16 a[194:195], v16 offset:15616
  v_mfma_f32_16x16x32_bf16 a[132:135], a[172:175], v[92:95], a[132:135]
  s_waitcnt lgkmcnt(6)
  v_mfma_f32_16x16x32_bf16 a[16:19], a[176:179], v[80:83], a[16:19]
  ds_read_b64_tr_b16 a[196:197], v17 offset:10496
  v_mfma_f32_16x16x32_bf16 a[56:59], a[176:179], v[84:87], a[56:59]
  v_mfma_f32_16x16x32_bf16 a[96:99], a[176:179], v[88:91], a[96:99]
  ds_read_b64_tr_b16 a[198:199], v17 offset:15616
  v_mfma_f32_16x16x32_bf16 a[136:139], a[176:179], v[92:95], a[136:139]
  s_barrier
  v_mfma_f32_16x16x32_bf16 a[20:23], a[180:183], v[80:83], a[20:23]
  ds_read_b64_tr_b16 a[160:161], v18 offset:0
  v_mfma_f32_16x16x32_bf16 a[60:63], a[180:183], v[84:87], a[60:63]
  buffer_load_dwordx4 v[72:75], v8, s[72:75], s63 offen offset:0 sc0 sc1
  v_mfma_f32_16x16x32_bf16 a[100:103], a[180:183], v[88:91], a[100:103]
  ds_read_b64_tr_b16 a[162:163], v18 offset:5120
  v_mfma_f32_16x16x32_bf16 a[140:143], a[180:183], v[92:95], a[140:143]
  s_waitcnt lgkmcnt(6)
  v_mfma_f32_16x16x32_bf16 a[24:27], a[184:187], v[80:83], a[24:27]
  ds_read_b64_tr_b16 a[164:165], v19 offset:0
  v_mfma_f32_16x16x32_bf16 a[64:67], a[184:187], v[84:87], a[64:67]
  s_add_u32 m0, s64, 143360
  s_nop 0
  buffer_load_dwordx4 v10, s[8:11], s62 offen offset:0 lds
  v_mfma_f32_16x16x32_bf16 a[104:107], a[184:187], v[88:91], a[104:107]
  ds_read_b64_tr_b16 a[166:167], v19 offset:5120
  v_mfma_f32_16x16x32_bf16 a[144:147], a[184:187], v[92:95], a[144:147]
  v_mfma_f32_16x16x32_bf16 a[28:31], a[188:191], v[80:83], a[28:31]
  ds_read_b64_tr_b16 a[168:169], v18 offset:64
  v_mfma_f32_16x16x32_bf16 a[68:71], a[188:191], v[84:87], a[68:71]
  buffer_load_dwordx4 v[76:79], v8, s[96:99], s63 offen offset:0 sc0 sc1
  v_mfma_f32_16x16x32_bf16 a[108:111], a[188:191], v[88:91], a[108:111]
  ds_read_b64_tr_b16 a[170:171], v18 offset:5184
  v_mfma_f32_16x16x32_bf16 a[148:151], a[188:191], v[92:95], a[148:151]
  s_waitcnt lgkmcnt(6)
  v_mfma_f32_16x16x32_bf16 a[32:35], a[192:195], v[80:83], a[32:35]
  ds_read_b64_tr_b16 a[172:173], v19 offset:64
  v_mfma_f32_16x16x32_bf16 a[72:75], a[192:195], v[84:87], a[72:75]
  buffer_load_dwordx4 v11, s[8:11], s62 offen offset:1024 lds
  v_mfma_f32_16x16x32_bf16 a[112:115], a[192:195], v[88:91], a[112:115]
  ds_read_b64_tr_b16 a[174:175], v19 offset:5184
  v_mfma_f32_16x16x32_bf16 a[152:155], a[192:195], v[92:95], a[152:155]
  v_mfma_f32_16x16x32_bf16 a[36:39], a[196:199], v[80:83], a[36:39]
  ds_read_b64_tr_b16 a[176:177], v18 offset:128
  v_mfma_f32_16x16x32_bf16 a[76:79], a[196:199], v[84:87], a[76:79]
  buffer_load_dwordx4 v12, s[8:11], s62 offen offset:2048 lds
  v_mfma_f32_16x16x32_bf16 a[116:119], a[196:199], v[88:91], a[116:119]
  ds_read_b64_tr_b16 a[178:179], v18 offset:5248
  v_mfma_f32_16x16x32_bf16 a[156:159], a[196:199], v[92:95], a[156:159]
  s_waitcnt vmcnt(15)
  s_waitcnt lgkmcnt(6)
  v_mfma_f32_16x16x32_bf16 a[0:3], a[160:163], v[96:99], a[0:3]
  ds_read_b64_tr_b16 a[180:181], v19 offset:128
  v_mfma_f32_16x16x32_bf16 a[40:43], a[160:163], v[100:103], a[40:43]
  buffer_load_dwordx4 v13, s[8:11], s62 offen offset:3072 lds
  v_mfma_f32_16x16x32_bf16 a[80:83], a[160:163], v[104:107], a[80:83]
  ds_read_b64_tr_b16 a[182:183], v19 offset:5248
  v_mfma_f32_16x16x32_bf16 a[120:123], a[160:163], v[108:111], a[120:123]
  v_mfma_f32_16x16x32_bf16 a[4:7], a[164:167], v[96:99], a[4:7]
  ds_read_b64_tr_b16 a[184:185], v18 offset:192
  v_mfma_f32_16x16x32_bf16 a[44:47], a[164:167], v[100:103], a[44:47]
  buffer_load_dwordx4 v[80:83], v8, s[12:15], s63 offen offset:1024 sc0 sc1
  v_mfma_f32_16x16x32_bf16 a[84:87], a[164:167], v[104:107], a[84:87]
  ds_read_b64_tr_b16 a[186:187], v18 offset:5312
  v_mfma_f32_16x16x32_bf16 a[124:127], a[164:167], v[108:111], a[124:127]
  s_waitcnt lgkmcnt(6)
  v_mfma_f32_16x16x32_bf16 a[8:11], a[168:171], v[96:99], a[8:11]
  ds_read_b64_tr_b16 a[188:189], v19 offset:192
  v_mfma_f32_16x16x32_bf16 a[48:51], a[168:171], v[100:103], a[48:51]
  s_add_u32 m0, s64, 147456
  s_nop 0
  buffer_load_dwordx4 v14, s[8:11], s62 offen lds
  v_mfma_f32_16x16x32_bf16 a[88:91], a[168:171], v[104:107], a[88:91]
  ds_read_b64_tr_b16 a[190:191], v19 offset:5312
  v_mfma_f32_16x16x32_bf16 a[128:131], a[168:171], v[108:111], a[128:131]
  v_mfma_f32_16x16x32_bf16 a[12:15], a[172:175], v[96:99], a[12:15]
  ds_read_b64_tr_b16 a[192:193], v18 offset:256
  v_mfma_f32_16x16x32_bf16 a[52:55], a[172:175], v[100:103], a[52:55]
  buffer_load_dwordx4 v[84:87], v8, s[16:19], s63 offen offset:1024 sc0 sc1
  v_mfma_f32_16x16x32_bf16 a[92:95], a[172:175], v[104:107], a[92:95]
  ds_read_b64_tr_b16 a[194:195], v18 offset:5376
  v_mfma_f32_16x16x32_bf16 a[132:135], a[172:175], v[108:111], a[132:135]
  s_waitcnt lgkmcnt(6)
  v_mfma_f32_16x16x32_bf16 a[16:19], a[176:179], v[96:99], a[16:19]
  ds_read_b64_tr_b16 a[196:197], v19 offset:256
  v_mfma_f32_16x16x32_bf16 a[56:59], a[176:179], v[100:103], a[56:59]
  s_add_u32 s62, s62, 81920
  v_mfma_f32_16x16x32_bf16 a[96:99], a[176:179], v[104:107], a[96:99]
  ds_read_b64_tr_b16 a[198:199], v19 offset:5376
  v_mfma_f32_16x16x32_bf16 a[136:139], a[176:179], v[108:111], a[136:139]
  v_mfma_f32_16x16x32_bf16 a[20:23], a[180:183], v[96:99], a[20:23]
  ds_read_b64_tr_b16 a[160:161], v18 offset:10240
  v_mfma_f32_16x16x32_bf16 a[60:63], a[180:183], v[100:103], a[60:63]
  buffer_load_dwordx4 v[88:91], v8, s[72:75], s63 offen offset:1024 sc0 sc1
  v_mfma_f32_16x16x32_bf16 a[100:103], a[180:183], v[104:107], a[100:103]
  ds_read_b64_tr_b16 a[162:163], v18 offset:15360
  v_mfma_f32_16x16x32_bf16 a[140:143], a[180:183], v[108:111], a[140:143]
  s_waitcnt lgkmcnt(6)
  v_mfma_f32_16x16x32_bf16 a[24:27], a[184:187], v[96:99], a[24:27]
  ds_read_b64_tr_b16 a[164:165], v19 offset:10240
  v_mfma_f32_16x16x32_bf16 a[64:67], a[184:187], v[100:103], a[64:67]
  v_mfma_f32_16x16x32_bf16 a[104:107], a[184:187], v[104:107], a[104:107]
  ds_read_b64_tr_b16 a[166:167], v19 offset:15360
  v_mfma_f32_16x16x32_bf16 a[144:147], a[184:187], v[108:111], a[144:147]
  v_mfma_f32_16x16x32_bf16 a[28:31], a[188:191], v[96:99], a[28:31]
  ds_read_b64_tr_b16 a[168:169], v18 offset:10304
  v_mfma_f32_16x16x32_bf16 a[68:71], a[188:191], v[100:103], a[68:71]
  buffer_load_dwordx4 v[92:95], v8, s[96:99], s63 offen offset:1024 sc0 sc1
  v_mfma_f32_16x16x32_bf16 a[108:111], a[188:191], v[104:107], a[108:111]
  ds_read_b64_tr_b16 a[170:171], v18 offset:15424
  v_mfma_f32_16x16x32_bf16 a[148:151], a[188:191], v[108:111], a[148:151]
  s_waitcnt lgkmcnt(6)
  v_mfma_f32_16x16x32_bf16 a[32:35], a[192:195], v[96:99], a[32:35]
  ds_read_b64_tr_b16 a[172:173], v19 offset:10304
  v_mfma_f32_16x16x32_bf16 a[72:75], a[192:195], v[100:103], a[72:75]
  v_mfma_f32_16x16x32_bf16 a[112:115], a[192:195], v[104:107], a[112:115]
  ds_read_b64_tr_b16 a[174:175], v19 offset:15424
  v_mfma_f32_16x16x32_bf16 a[152:155], a[192:195], v[108:111], a[152:155]
  v_mfma_f32_16x16x32_bf16 a[36:39], a[196:199], v[96:99], a[36:39]
  ds_read_b64_tr_b16 a[176:177], v18 offset:10368
  v_mfma_f32_16x16x32_bf16 a[76:79], a[196:199], v[100:103], a[76:79]
  v_mfma_f32_16x16x32_bf16 a[116:119], a[196:199], v[104:107], a[116:119]
  ds_read_b64_tr_b16 a[178:179], v18 offset:15488
  v_mfma_f32_16x16x32_bf16 a[156:159], a[196:199], v[108:111], a[156:159]
  s_waitcnt vmcnt(13)
  s_waitcnt lgkmcnt(6)
  v_mfma_f32_16x16x32_bf16 a[0:3], a[160:163], v[112:115], a[0:3]
  ds_read_b64_tr_b16 a[180:181], v19 offset:10368
  v_mfma_f32_16x16x32_bf16 a[40:43], a[160:163], v[116:119], a[40:43]
  v_mfma_f32_16x16x32_bf16 a[80:83], a[160:163], v[120:123], a[80:83]
  ds_read_b64_tr_b16 a[182:183], v19 offset:15488
  v_mfma_f32_16x16x32_bf16 a[120:123], a[160:163], v[124:127], a[120:123]
  v_mfma_f32_16x16x32_bf16 a[4:7], a[164:167], v[112:115], a[4:7]
  ds_read_b64_tr_b16 a[184:185], v18 offset:10432
  v_mfma_f32_16x16x32_bf16 a[44:47], a[164:167], v[116:119], a[44:47]
  buffer_load_dwordx4 v[96:99], v8, s[12:15], s63 offen offset:2048 sc0 sc1
  v_mfma_f32_16x16x32_bf16 a[84:87], a[164:167], v[120:123], a[84:87]
  ds_read_b64_tr_b16 a[186:187], v18 offset:15552
  v_mfma_f32_16x16x32_bf16 a[124:127], a[164:167], v[124:127], a[124:127]
  s_waitcnt lgkmcnt(6)
  v_mfma_f32_16x16x32_bf16 a[8:11], a[168:171], v[112:115], a[8:11]
  ds_read_b64_tr_b16 a[188:189], v19 offset:10432
  v_mfma_f32_16x16x32_bf16 a[48:51], a[168:171], v[116:119], a[48:51]
  v_mfma_f32_16x16x32_bf16 a[88:91], a[168:171], v[120:123], a[88:91]
  ds_read_b64_tr_b16 a[190:191], v19 offset:15552
  v_mfma_f32_16x16x32_bf16 a[128:131], a[168:171], v[124:127], a[128:131]
  v_mfma_f32_16x16x32_bf16 a[12:15], a[172:175], v[112:115], a[12:15]
  ds_read_b64_tr_b16 a[192:193], v18 offset:10496
  v_mfma_f32_16x16x32_bf16 a[52:55], a[172:175], v[116:119], a[52:55]
  buffer_load_dwordx4 v[100:103], v8, s[16:19], s63 offen offset:2048 sc0 sc1
  v_mfma_f32_16x16x32_bf16 a[92:95], a[172:175], v[120:123], a[92:95]
  ds_read_b64_tr_b16 a[194:195], v18 offset:15616
  v_mfma_f32_16x16x32_bf16 a[132:135], a[172:175], v[124:127], a[132:135]
  s_waitcnt lgkmcnt(6)
  v_mfma_f32_16x16x32_bf16 a[16:19], a[176:179], v[112:115], a[16:19]
  ds_read_b64_tr_b16 a[196:197], v19 offset:10496
  v_mfma_f32_16x16x32_bf16 a[56:59], a[176:179], v[116:119], a[56:59]
  v_mfma_f32_16x16x32_bf16 a[96:99], a[176:179], v[120:123], a[96:99]
  ds_read_b64_tr_b16 a[198:199], v19 offset:15616
  v_mfma_f32_16x16x32_bf16 a[136:139], a[176:179], v[124:127], a[136:139]
  s_barrier
  v_mfma_f32_16x16x32_bf16 a[20:23], a[180:183], v[112:115], a[20:23]
  ds_read_b64_tr_b16 a[160:161], v20 offset:0
  v_mfma_f32_16x16x32_bf16 a[60:63], a[180:183], v[116:119], a[60:63]
  buffer_load_dwordx4 v[104:107], v8, s[72:75], s63 offen offset:2048 sc0 sc1
  v_mfma_f32_16x16x32_bf16 a[100:103], a[180:183], v[120:123], a[100:103]
  ds_read_b64_tr_b16 a[162:163], v20 offset:5120
  v_mfma_f32_16x16x32_bf16 a[140:143], a[180:183], v[124:127], a[140:143]
  s_waitcnt lgkmcnt(6)
  v_mfma_f32_16x16x32_bf16 a[24:27], a[184:187], v[112:115], a[24:27]
  ds_read_b64_tr_b16 a[164:165], v21 offset:0
  v_mfma_f32_16x16x32_bf16 a[64:67], a[184:187], v[116:119], a[64:67]
  s_add_u32 m0, s64, 81920
  s_nop 0
  buffer_load_dwordx4 v10, s[8:11], s62 offen offset:0 lds
  v_mfma_f32_16x16x32_bf16 a[104:107], a[184:187], v[120:123], a[104:107]
  ds_read_b64_tr_b16 a[166:167], v21 offset:5120
  v_mfma_f32_16x16x32_bf16 a[144:147], a[184:187], v[124:127], a[144:147]
  v_mfma_f32_16x16x32_bf16 a[28:31], a[188:191], v[112:115], a[28:31]
  ds_read_b64_tr_b16 a[168:169], v20 offset:64
  v_mfma_f32_16x16x32_bf16 a[68:71], a[188:191], v[116:119], a[68:71]
  buffer_load_dwordx4 v[108:111], v8, s[96:99], s63 offen offset:2048 sc0 sc1
  v_mfma_f32_16x16x32_bf16 a[108:111], a[188:191], v[120:123], a[108:111]
  ds_read_b64_tr_b16 a[170:171], v20 offset:5184
  v_mfma_f32_16x16x32_bf16 a[148:151], a[188:191], v[124:127], a[148:151]
  s_waitcnt lgkmcnt(6)
  v_mfma_f32_16x16x32_bf16 a[32:35], a[192:195], v[112:115], a[32:35]
  ds_read_b64_tr_b16 a[172:173], v21 offset:64
  v_mfma_f32_16x16x32_bf16 a[72:75], a[192:195], v[116:119], a[72:75]
  buffer_load_dwordx4 v11, s[8:11], s62 offen offset:1024 lds
  v_mfma_f32_16x16x32_bf16 a[112:115], a[192:195], v[120:123], a[112:115]
  ds_read_b64_tr_b16 a[174:175], v21 offset:5184
  v_mfma_f32_16x16x32_bf16 a[152:155], a[192:195], v[124:127], a[152:155]
  v_mfma_f32_16x16x32_bf16 a[36:39], a[196:199], v[112:115], a[36:39]
  ds_read_b64_tr_b16 a[176:177], v20 offset:128
  v_mfma_f32_16x16x32_bf16 a[76:79], a[196:199], v[116:119], a[76:79]
  buffer_load_dwordx4 v12, s[8:11], s62 offen offset:2048 lds
  v_mfma_f32_16x16x32_bf16 a[116:119], a[196:199], v[120:123], a[116:119]
  ds_read_b64_tr_b16 a[178:179], v20 offset:5248
  v_mfma_f32_16x16x32_bf16 a[156:159], a[196:199], v[124:127], a[156:159]
  s_waitcnt vmcnt(15)
  s_waitcnt lgkmcnt(6)
  v_mfma_f32_16x16x32_bf16 a[0:3], a[160:163], v[64:67], a[0:3]
  ds_read_b64_tr_b16 a[180:181], v21 offset:128
  v_mfma_f32_16x16x32_bf16 a[40:43], a[160:163], v[68:71], a[40:43]
  buffer_load_dwordx4 v13, s[8:11], s62 offen offset:3072 lds
  v_mfma_f32_16x16x32_bf16 a[80:83], a[160:163], v[72:75], a[80:83]
  ds_read_b64_tr_b16 a[182:183], v21 offset:5248
  v_mfma_f32_16x16x32_bf16 a[120:123], a[160:163], v[76:79], a[120:123]
  v_mfma_f32_16x16x32_bf16 a[4:7], a[164:167], v[64:67], a[4:7]
  ds_read_b64_tr_b16 a[184:185], v20 offset:192
  v_mfma_f32_16x16x32_bf16 a[44:47], a[164:167], v[68:71], a[44:47]
  buffer_load_dwordx4 v[112:115], v8, s[12:15], s63 offen offset:3072 sc0 sc1
  v_mfma_f32_16x16x32_bf16 a[84:87], a[164:167], v[72:75], a[84:87]
  ds_read_b64_tr_b16 a[186:187], v20 offset:5312
  v_mfma_f32_16x16x32_bf16 a[124:127], a[164:167], v[76:79], a[124:127]
  s_waitcnt lgkmcnt(6)
  v_mfma_f32_16x16x32_bf16 a[8:11], a[168:171], v[64:67], a[8:11]
  ds_read_b64_tr_b16 a[188:189], v21 offset:192
  v_mfma_f32_16x16x32_bf16 a[48:51], a[168:171], v[68:71], a[48:51]
  s_add_u32 m0, s64, 86016
  s_nop 0
  buffer_load_dwordx4 v14, s[8:11], s62 offen lds
  v_mfma_f32_16x16x32_bf16 a[88:91], a[168:171], v[72:75], a[88:91]
  ds_read_b64_tr_b16 a[190:191], v21 offset:5312
  v_mfma_f32_16x16x32_bf16 a[128:131], a[168:171], v[76:79], a[128:131]
  v_mfma_f32_16x16x32_bf16 a[12:15], a[172:175], v[64:67], a[12:15]
  ds_read_b64_tr_b16 a[192:193], v20 offset:256
  v_mfma_f32_16x16x32_bf16 a[52:55], a[172:175], v[68:71], a[52:55]
  buffer_load_dwordx4 v[116:119], v8, s[16:19], s63 offen offset:3072 sc0 sc1
  v_mfma_f32_16x16x32_bf16 a[92:95], a[172:175], v[72:75], a[92:95]
  ds_read_b64_tr_b16 a[194:195], v20 offset:5376
  v_mfma_f32_16x16x32_bf16 a[132:135], a[172:175], v[76:79], a[132:135]
  s_waitcnt lgkmcnt(6)
  v_mfma_f32_16x16x32_bf16 a[16:19], a[176:179], v[64:67], a[16:19]
  ds_read_b64_tr_b16 a[196:197], v21 offset:256
  v_mfma_f32_16x16x32_bf16 a[56:59], a[176:179], v[68:71], a[56:59]
  s_add_u32 s62, s62, 81920
  v_mfma_f32_16x16x32_bf16 a[96:99], a[176:179], v[72:75], a[96:99]
  ds_read_b64_tr_b16 a[198:199], v21 offset:5376
  v_mfma_f32_16x16x32_bf16 a[136:139], a[176:179], v[76:79], a[136:139]
  v_mfma_f32_16x16x32_bf16 a[20:23], a[180:183], v[64:67], a[20:23]
  ds_read_b64_tr_b16 a[160:161], v20 offset:10240
  v_mfma_f32_16x16x32_bf16 a[60:63], a[180:183], v[68:71], a[60:63]
  buffer_load_dwordx4 v[120:123], v8, s[72:75], s63 offen offset:3072 sc0 sc1
  v_mfma_f32_16x16x32_bf16 a[100:103], a[180:183], v[72:75], a[100:103]
  ds_read_b64_tr_b16 a[162:163], v20 offset:15360
  v_mfma_f32_16x16x32_bf16 a[140:143], a[180:183], v[76:79], a[140:143]
  s_waitcnt lgkmcnt(6)
  v_mfma_f32_16x16x32_bf16 a[24:27], a[184:187], v[64:67], a[24:27]
  ds_read_b64_tr_b16 a[164:165], v21 offset:10240
  v_mfma_f32_16x16x32_bf16 a[64:67], a[184:187], v[68:71], a[64:67]
  v_mfma_f32_16x16x32_bf16 a[104:107], a[184:187], v[72:75], a[104:107]
  ds_read_b64_tr_b16 a[166:167], v21 offset:15360
  v_mfma_f32_16x16x32_bf16 a[144:147], a[184:187], v[76:79], a[144:147]
  v_mfma_f32_16x16x32_bf16 a[28:31], a[188:191], v[64:67], a[28:31]
  ds_read_b64_tr_b16 a[168:169], v20 offset:10304
  v_mfma_f32_16x16x32_bf16 a[68:71], a[188:191], v[68:71], a[68:71]
  buffer_load_dwordx4 v[124:127], v8, s[96:99], s63 offen offset:3072 sc0 sc1
  v_mfma_f32_16x16x32_bf16 a[108:111], a[188:191], v[72:75], a[108:111]
  ds_read_b64_tr_b16 a[170:171], v20 offset:15424
  v_mfma_f32_16x16x32_bf16 a[148:151], a[188:191], v[76:79], a[148:151]
  s_waitcnt lgkmcnt(6)
  v_mfma_f32_16x16x32_bf16 a[32:35], a[192:195], v[64:67], a[32:35]
  ds_read_b64_tr_b16 a[172:173], v21 offset:10304
  v_mfma_f32_16x16x32_bf16 a[72:75], a[192:195], v[68:71], a[72:75]
  v_mfma_f32_16x16x32_bf16 a[112:115], a[192:195], v[72:75], a[112:115]
  ds_read_b64_tr_b16 a[174:175], v21 offset:15424
  v_mfma_f32_16x16x32_bf16 a[152:155], a[192:195], v[76:79], a[152:155]
  v_mfma_f32_16x16x32_bf16 a[36:39], a[196:199], v[64:67], a[36:39]
  ds_read_b64_tr_b16 a[176:177], v20 offset:10368
  v_mfma_f32_16x16x32_bf16 a[76:79], a[196:199], v[68:71], a[76:79]
  v_mfma_f32_16x16x32_bf16 a[116:119], a[196:199], v[72:75], a[116:119]
  ds_read_b64_tr_b16 a[178:179], v20 offset:15488
  v_mfma_f32_16x16x32_bf16 a[156:159], a[196:199], v[76:79], a[156:159]
  s_waitcnt vmcnt(13)
  s_waitcnt lgkmcnt(6)
  v_mfma_f32_16x16x32_bf16 a[0:3], a[160:163], v[80:83], a[0:3]
  ds_read_b64_tr_b16 a[180:181], v21 offset:10368
  v_mfma_f32_16x16x32_bf16 a[40:43], a[160:163], v[84:87], a[40:43]
  v_mfma_f32_16x16x32_bf16 a[80:83], a[160:163], v[88:91], a[80:83]
  ds_read_b64_tr_b16 a[182:183], v21 offset:15488
  v_mfma_f32_16x16x32_bf16 a[120:123], a[160:163], v[92:95], a[120:123]
  v_mfma_f32_16x16x32_bf16 a[4:7], a[164:167], v[80:83], a[4:7]
  ds_read_b64_tr_b16 a[184:185], v20 offset:10432
  v_mfma_f32_16x16x32_bf16 a[44:47], a[164:167], v[84:87], a[44:47]
  s_add_u32 s63, s63, 4096
  buffer_load_dwordx4 v[64:67], v8, s[12:15], s63 offen offset:0 sc0 sc1
  v_mfma_f32_16x16x32_bf16 a[84:87], a[164:167], v[88:91], a[84:87]
  ds_read_b64_tr_b16 a[186:187], v20 offset:15552
  v_mfma_f32_16x16x32_bf16 a[124:127], a[164:167], v[92:95], a[124:127]
  s_waitcnt lgkmcnt(6)
  v_mfma_f32_16x16x32_bf16 a[8:11], a[168:171], v[80:83], a[8:11]
  ds_read_b64_tr_b16 a[188:189], v21 offset:10432
  v_mfma_f32_16x16x32_bf16 a[48:51], a[168:171], v[84:87], a[48:51]
  v_mfma_f32_16x16x32_bf16 a[88:91], a[168:171], v[88:91], a[88:91]
  ds_read_b64_tr_b16 a[190:191], v21 offset:15552
  v_mfma_f32_16x16x32_bf16 a[128:131], a[168:171], v[92:95], a[128:131]
  v_mfma_f32_16x16x32_bf16 a[12:15], a[172:175], v[80:83], a[12:15]
  ds_read_b64_tr_b16 a[192:193], v20 offset:10496
  v_mfma_f32_16x16x32_bf16 a[52:55], a[172:175], v[84:87], a[52:55]
  buffer_load_dwordx4 v[68:71], v8, s[16:19], s63 offen offset:0 sc0 sc1
  v_mfma_f32_16x16x32_bf16 a[92:95], a[172:175], v[88:91], a[92:95]
  ds_read_b64_tr_b16 a[194:195], v20 offset:15616
  v_mfma_f32_16x16x32_bf16 a[132:135], a[172:175], v[92:95], a[132:135]
  s_waitcnt lgkmcnt(6)
  v_mfma_f32_16x16x32_bf16 a[16:19], a[176:179], v[80:83], a[16:19]
  ds_read_b64_tr_b16 a[196:197], v21 offset:10496
  v_mfma_f32_16x16x32_bf16 a[56:59], a[176:179], v[84:87], a[56:59]
  v_mfma_f32_16x16x32_bf16 a[96:99], a[176:179], v[88:91], a[96:99]
  ds_read_b64_tr_b16 a[198:199], v21 offset:15616
  v_mfma_f32_16x16x32_bf16 a[136:139], a[176:179], v[92:95], a[136:139]
  s_barrier
  v_mfma_f32_16x16x32_bf16 a[20:23], a[180:183], v[80:83], a[20:23]
  ds_read_b64_tr_b16 a[160:161], v22 offset:0
  v_mfma_f32_16x16x32_bf16 a[60:63], a[180:183], v[84:87], a[60:63]
  buffer_load_dwordx4 v[72:75], v8, s[72:75], s63 offen offset:0 sc0 sc1
  v_mfma_f32_16x16x32_bf16 a[100:103], a[180:183], v[88:91], a[100:103]
  ds_read_b64_tr_b16 a[162:163], v22 offset:5120
  v_mfma_f32_16x16x32_bf16 a[140:143], a[180:183], v[92:95], a[140:143]
  s_waitcnt lgkmcnt(6)
  v_mfma_f32_16x16x32_bf16 a[24:27], a[184:187], v[80:83], a[24:27]
  ds_read_b64_tr_b16 a[164:165], v23 offset:0
  v_mfma_f32_16x16x32_bf16 a[64:67], a[184:187], v[84:87], a[64:67]
  s_add_u32 m0, s64, 102400
  s_nop 0
  buffer_load_dwordx4 v10, s[8:11], s62 offen offset:0 lds
  v_mfma_f32_16x16x32_bf16 a[104:107], a[184:187], v[88:91], a[104:107]
  ds_read_b64_tr_b16 a[166:167], v23 offset:5120
  v_mfma_f32_16x16x32_bf16 a[144:147], a[184:187], v[92:95], a[144:147]
  v_mfma_f32_16x16x32_bf16 a[28:31], a[188:191], v[80:83], a[28:31]
  ds_read_b64_tr_b16 a[168:169], v22 offset:64
  v_mfma_f32_16x16x32_bf16 a[68:71], a[188:191], v[84:87], a[68:71]
  buffer_load_dwordx4 v[76:79], v8, s[96:99], s63 offen offset:0 sc0 sc1
  v_mfma_f32_16x16x32_bf16 a[108:111], a[188:191], v[88:91], a[108:111]
  ds_read_b64_tr_b16 a[170:171], v22 offset:5184
  v_mfma_f32_16x16x32_bf16 a[148:151], a[188:191], v[92:95], a[148:151]
  s_waitcnt lgkmcnt(6)
  v_mfma_f32_16x16x32_bf16 a[32:35], a[192:195], v[80:83], a[32:35]
  ds_read_b64_tr_b16 a[172:173], v23 offset:64
  v_mfma_f32_16x16x32_bf16 a[72:75], a[192:195], v[84:87], a[72:75]
  buffer_load_dwordx4 v11, s[8:11], s62 offen offset:1024 lds
  v_mfma_f32_16x16x32_bf16 a[112:115], a[192:195], v[88:91], a[112:115]
  ds_read_b64_tr_b16 a[174:175], v23 offset:5184
  v_mfma_f32_16x16x32_bf16 a[152:155], a[192:195], v[92:95], a[152:155]
  v_mfma_f32_16x16x32_bf16 a[36:39], a[196:199], v[80:83], a[36:39]
  ds_read_b64_tr_b16 a[176:177], v22 offset:128
  v_mfma_f32_16x16x32_bf16 a[76:79], a[196:199], v[84:87], a[76:79]
  buffer_load_dwordx4 v12, s[8:11], s62 offen offset:2048 lds
  v_mfma_f32_16x16x32_bf16 a[116:119], a[196:199], v[88:91], a[116:119]
  ds_read_b64_tr_b16 a[178:179], v22 offset:5248
  v_mfma_f32_16x16x32_bf16 a[156:159], a[196:199], v[92:95], a[156:159]
  s_waitcnt vmcnt(15)
  s_waitcnt lgkmcnt(6)
  v_mfma_f32_16x16x32_bf16 a[0:3], a[160:163], v[96:99], a[0:3]
  ds_read_b64_tr_b16 a[180:181], v23 offset:128
  v_mfma_f32_16x16x32_bf16 a[40:43], a[160:163], v[100:103], a[40:43]
  buffer_load_dwordx4 v13, s[8:11], s62 offen offset:3072 lds
  v_mfma_f32_16x16x32_bf16 a[80:83], a[160:163], v[104:107], a[80:83]
  ds_read_b64_tr_b16 a[182:183], v23 offset:5248
  v_mfma_f32_16x16x32_bf16 a[120:123], a[160:163], v[108:111], a[120:123]
  v_mfma_f32_16x16x32_bf16 a[4:7], a[164:167], v[96:99], a[4:7]
  ds_read_b64_tr_b16 a[184:185], v22 offset:192
  v_mfma_f32_16x16x32_bf16 a[44:47], a[164:167], v[100:103], a[44:47]
  buffer_load_dwordx4 v[80:83], v8, s[12:15], s63 offen offset:1024 sc0 sc1
  v_mfma_f32_16x16x32_bf16 a[84:87], a[164:167], v[104:107], a[84:87]
  ds_read_b64_tr_b16 a[186:187], v22 offset:5312
  v_mfma_f32_16x16x32_bf16 a[124:127], a[164:167], v[108:111], a[124:127]
  s_waitcnt lgkmcnt(6)
  v_mfma_f32_16x16x32_bf16 a[8:11], a[168:171], v[96:99], a[8:11]
  ds_read_b64_tr_b16 a[188:189], v23 offset:192
  v_mfma_f32_16x16x32_bf16 a[48:51], a[168:171], v[100:103], a[48:51]
  s_add_u32 m0, s64, 106496
  s_nop 0
  buffer_load_dwordx4 v14, s[8:11], s62 offen lds
  v_mfma_f32_16x16x32_bf16 a[88:91], a[168:171], v[104:107], a[88:91]
  ds_read_b64_tr_b16 a[190:191], v23 offset:5312
  v_mfma_f32_16x16x32_bf16 a[128:131], a[168:171], v[108:111], a[128:131]
  v_mfma_f32_16x16x32_bf16 a[12:15], a[172:175], v[96:99], a[12:15]
  ds_read_b64_tr_b16 a[192:193], v22 offset:256
  v_mfma_f32_16x16x32_bf16 a[52:55], a[172:175], v[100:103], a[52:55]
  buffer_load_dwordx4 v[84:87], v8, s[16:19], s63 offen offset:1024 sc0 sc1
  v_mfma_f32_16x16x32_bf16 a[92:95], a[172:175], v[104:107], a[92:95]
  ds_read_b64_tr_b16 a[194:195], v22 offset:5376
  v_mfma_f32_16x16x32_bf16 a[132:135], a[172:175], v[108:111], a[132:135]
  s_waitcnt lgkmcnt(6)
  v_mfma_f32_16x16x32_bf16 a[16:19], a[176:179], v[96:99], a[16:19]
  ds_read_b64_tr_b16 a[196:197], v23 offset:256
  v_mfma_f32_16x16x32_bf16 a[56:59], a[176:179], v[100:103], a[56:59]
  s_add_u32 s62, s62, 81920
  v_mfma_f32_16x16x32_bf16 a[96:99], a[176:179], v[104:107], a[96:99]
  ds_read_b64_tr_b16 a[198:199], v23 offset:5376
  v_mfma_f32_16x16x32_bf16 a[136:139], a[176:179], v[108:111], a[136:139]
  v_mfma_f32_16x16x32_bf16 a[20:23], a[180:183], v[96:99], a[20:23]
  ds_read_b64_tr_b16 a[160:161], v22 offset:10240
  v_mfma_f32_16x16x32_bf16 a[60:63], a[180:183], v[100:103], a[60:63]
  buffer_load_dwordx4 v[88:91], v8, s[72:75], s63 offen offset:1024 sc0 sc1
  v_mfma_f32_16x16x32_bf16 a[100:103], a[180:183], v[104:107], a[100:103]
  ds_read_b64_tr_b16 a[162:163], v22 offset:15360
  v_mfma_f32_16x16x32_bf16 a[140:143], a[180:183], v[108:111], a[140:143]
  s_waitcnt lgkmcnt(6)
  v_mfma_f32_16x16x32_bf16 a[24:27], a[184:187], v[96:99], a[24:27]
  ds_read_b64_tr_b16 a[164:165], v23 offset:10240
  v_mfma_f32_16x16x32_bf16 a[64:67], a[184:187], v[100:103], a[64:67]
  v_mfma_f32_16x16x32_bf16 a[104:107], a[184:187], v[104:107], a[104:107]
  ds_read_b64_tr_b16 a[166:167], v23 offset:15360
  v_mfma_f32_16x16x32_bf16 a[144:147], a[184:187], v[108:111], a[144:147]
  v_mfma_f32_16x16x32_bf16 a[28:31], a[188:191], v[96:99], a[28:31]
  ds_read_b64_tr_b16 a[168:169], v22 offset:10304
  v_mfma_f32_16x16x32_bf16 a[68:71], a[188:191], v[100:103], a[68:71]
  buffer_load_dwordx4 v[92:95], v8, s[96:99], s63 offen offset:1024 sc0 sc1
  v_mfma_f32_16x16x32_bf16 a[108:111], a[188:191], v[104:107], a[108:111]
  ds_read_b64_tr_b16 a[170:171], v22 offset:15424
  v_mfma_f32_16x16x32_bf16 a[148:151], a[188:191], v[108:111], a[148:151]
  s_waitcnt lgkmcnt(6)
  v_mfma_f32_16x16x32_bf16 a[32:35], a[192:195], v[96:99], a[32:35]
  ds_read_b64_tr_b16 a[172:173], v23 offset:10304
  v_mfma_f32_16x16x32_bf16 a[72:75], a[192:195], v[100:103], a[72:75]
  v_mfma_f32_16x16x32_bf16 a[112:115], a[192:195], v[104:107], a[112:115]
  ds_read_b64_tr_b16 a[174:175], v23 offset:15424
  v_mfma_f32_16x16x32_bf16 a[152:155], a[192:195], v[108:111], a[152:155]
  v_mfma_f32_16x16x32_bf16 a[36:39], a[196:199], v[96:99], a[36:39]
  ds_read_b64_tr_b16 a[176:177], v22 offset:10368
  v_mfma_f32_16x16x32_bf16 a[76:79], a[196:199], v[100:103], a[76:79]
  v_mfma_f32_16x16x32_bf16 a[116:119], a[196:199], v[104:107], a[116:119]
  ds_read_b64_tr_b16 a[178:179], v22 offset:15488
  v_mfma_f32_16x16x32_bf16 a[156:159], a[196:199], v[108:111], a[156:159]
  s_waitcnt vmcnt(13)
  s_waitcnt lgkmcnt(6)
  v_mfma_f32_16x16x32_bf16 a[0:3], a[160:163], v[112:115], a[0:3]
  ds_read_b64_tr_b16 a[180:181], v23 offset:10368
  v_mfma_f32_16x16x32_bf16 a[40:43], a[160:163], v[116:119], a[40:43]
  v_mfma_f32_16x16x32_bf16 a[80:83], a[160:163], v[120:123], a[80:83]
  ds_read_b64_tr_b16 a[182:183], v23 offset:15488
  v_mfma_f32_16x16x32_bf16 a[120:123], a[160:163], v[124:127], a[120:123]
  v_mfma_f32_16x16x32_bf16 a[4:7], a[164:167], v[112:115], a[4:7]
  ds_read_b64_tr_b16 a[184:185], v22 offset:10432
  v_mfma_f32_16x16x32_bf16 a[44:47], a[164:167], v[116:119], a[44:47]
  buffer_load_dwordx4 v[96:99], v8, s[12:15], s63 offen offset:2048 sc0 sc1
  v_mfma_f32_16x16x32_bf16 a[84:87], a[164:167], v[120:123], a[84:87]
  ds_read_b64_tr_b16 a[186:187], v22 offset:15552
  v_mfma_f32_16x16x32_bf16 a[124:127], a[164:167], v[124:127], a[124:127]
  s_waitcnt lgkmcnt(6)
  v_mfma_f32_16x16x32_bf16 a[8:11], a[168:171], v[112:115], a[8:11]
  ds_read_b64_tr_b16 a[188:189], v23 offset:10432
  v_mfma_f32_16x16x32_bf16 a[48:51], a[168:171], v[116:119], a[48:51]
  v_mfma_f32_16x16x32_bf16 a[88:91], a[168:171], v[120:123], a[88:91]
  ds_read_b64_tr_b16 a[190:191], v23 offset:15552
  v_mfma_f32_16x16x32_bf16 a[128:131], a[168:171], v[124:127], a[128:131]
  v_mfma_f32_16x16x32_bf16 a[12:15], a[172:175], v[112:115], a[12:15]
  ds_read_b64_tr_b16 a[192:193], v22 offset:10496
  v_mfma_f32_16x16x32_bf16 a[52:55], a[172:175], v[116:119], a[52:55]
  buffer_load_dwordx4 v[100:103], v8, s[16:19], s63 offen offset:2048 sc0 sc1
  v_mfma_f32_16x16x32_bf16 a[92:95], a[172:175], v[120:123], a[92:95]
  ds_read_b64_tr_b16 a[194:195], v22 offset:15616
  v_mfma_f32_16x16x32_bf16 a[132:135], a[172:175], v[124:127], a[132:135]
  s_waitcnt lgkmcnt(6)
  v_mfma_f32_16x16x32_bf16 a[16:19], a[176:179], v[112:115], a[16:19]
  ds_read_b64_tr_b16 a[196:197], v23 offset:10496
  v_mfma_f32_16x16x32_bf16 a[56:59], a[176:179], v[116:119], a[56:59]
  v_mfma_f32_16x16x32_bf16 a[96:99], a[176:179], v[120:123], a[96:99]
  ds_read_b64_tr_b16 a[198:199], v23 offset:15616
  v_mfma_f32_16x16x32_bf16 a[136:139], a[176:179], v[124:127], a[136:139]
  s_barrier
  v_mfma_f32_16x16x32_bf16 a[20:23], a[180:183], v[112:115], a[20:23]
  ds_read_b64_tr_b16 a[160:161], v16 offset:0
  v_mfma_f32_16x16x32_bf16 a[60:63], a[180:183], v[116:119], a[60:63]
  buffer_load_dwordx4 v[104:107], v8, s[72:75], s63 offen offset:2048 sc0 sc1
  v_mfma_f32_16x16x32_bf16 a[100:103], a[180:183], v[120:123], a[100:103]
  ds_read_b64_tr_b16 a[162:163], v16 offset:5120
  v_mfma_f32_16x16x32_bf16 a[140:143], a[180:183], v[124:127], a[140:143]
  s_waitcnt lgkmcnt(6)
  v_mfma_f32_16x16x32_bf16 a[24:27], a[184:187], v[112:115], a[24:27]
  ds_read_b64_tr_b16 a[164:165], v17 offset:0
  v_mfma_f32_16x16x32_bf16 a[64:67], a[184:187], v[116:119], a[64:67]
  s_add_u32 m0, s64, 122880
  s_nop 0
  buffer_load_dwordx4 v10, s[8:11], s62 offen offset:0 lds
  v_mfma_f32_16x16x32_bf16 a[104:107], a[184:187], v[120:123], a[104:107]
  ds_read_b64_tr_b16 a[166:167], v17 offset:5120
  v_mfma_f32_16x16x32_bf16 a[144:147], a[184:187], v[124:127], a[144:147]
  v_mfma_f32_16x16x32_bf16 a[28:31], a[188:191], v[112:115], a[28:31]
  ds_read_b64_tr_b16 a[168:169], v16 offset:64
  v_mfma_f32_16x16x32_bf16 a[68:71], a[188:191], v[116:119], a[68:71]
  buffer_load_dwordx4 v[108:111], v8, s[96:99], s63 offen offset:2048 sc0 sc1
  v_mfma_f32_16x16x32_bf16 a[108:111], a[188:191], v[120:123], a[108:111]
  ds_read_b64_tr_b16 a[170:171], v16 offset:5184
  v_mfma_f32_16x16x32_bf16 a[148:151], a[188:191], v[124:127], a[148:151]
  s_waitcnt lgkmcnt(6)
  v_mfma_f32_16x16x32_bf16 a[32:35], a[192:195], v[112:115], a[32:35]
  ds_read_b64_tr_b16 a[172:173], v17 offset:64
  v_mfma_f32_16x16x32_bf16 a[72:75], a[192:195], v[116:119], a[72:75]
  buffer_load_dwordx4 v11, s[8:11], s62 offen offset:1024 lds
  v_mfma_f32_16x16x32_bf16 a[112:115], a[192:195], v[120:123], a[112:115]
  ds_read_b64_tr_b16 a[174:175], v17 offset:5184
  v_mfma_f32_16x16x32_bf16 a[152:155], a[192:195], v[124:127], a[152:155]
  v_mfma_f32_16x16x32_bf16 a[36:39], a[196:199], v[112:115], a[36:39]
  ds_read_b64_tr_b16 a[176:177], v16 offset:128
  v_mfma_f32_16x16x32_bf16 a[76:79], a[196:199], v[116:119], a[76:79]
  buffer_load_dwordx4 v12, s[8:11], s62 offen offset:2048 lds
  v_mfma_f32_16x16x32_bf16 a[116:119], a[196:199], v[120:123], a[116:119]
  ds_read_b64_tr_b16 a[178:179], v16 offset:5248
  v_mfma_f32_16x16x32_bf16 a[156:159], a[196:199], v[124:127], a[156:159]
  s_sub_u32 s66, s66, 1
  s_cmp_lg_u32 s66, 0
  s_cbranch_scc1 K2_LOOP
  s_waitcnt vmcnt(0) lgkmcnt(0)
  s_nop 15
  v_mov_b32 v1, 0
  v_mov_b32 v2, 1
  s_cmp_lg_u32 s56, 0
  s_cbranch_scc1 K2_X1
  v_accvgpr_read_b32 v4, a40
  v_accvgpr_read_b32 v5, a41
  v_accvgpr_read_b32 v6, a42
  v_accvgpr_read_b32 v7, a43
  v_cvt_pk_bf16_f32 v144, v4, v5
  v_cvt_pk_bf16_f32 v145, v6, v7
  v_accvgpr_read_b32 v4, a44
  v_accvgpr_read_b32 v5, a45
  v_accvgpr_read_b32 v6, a46
  v_accvgpr_read_b32 v7, a47
  v_cvt_pk_bf16_f32 v146, v4, v5
  v_cvt_pk_bf16_f32 v147, v6, v7
  s_add_u32 s59, s67, 81920
  buffer_store_dwordx4 v[144:147], v8, s[20:23], s59 offen offset:0 sc0 sc1
  v_accvgpr_read_b32 v4, a48
  v_accvgpr_read_b32 v5, a49
  v_accvgpr_read_b32 v6, a50
  v_accvgpr_read_b32 v7, a51
  v_cvt_pk_bf16_f32 v148, v4, v5
  v_cvt_pk_bf16_f32 v149, v6, v7
  v_accvgpr_read_b32 v4, a52
  v_accvgpr_read_b32 v5, a53
  v_accvgpr_read_b32 v6, a54
  v_accvgpr_read_b32 v7, a55
  v_cvt_pk_bf16_f32 v150, v4, v5
  v_cvt_pk_bf16_f32 v151, v6, v7
  buffer_store_dwordx4 v[148:151], v8, s[20:23], s59 offen offset:1024 sc0 sc1
  v_accvgpr_read_b32 v4, a56
  v_accvgpr_read_b32 v5, a57
  v_accvgpr_read_b32 v6, a58
  v_accvgpr_read_b32 v7, a59
  v_cvt_pk_bf16_f32 v152, v4, v5
  v_cvt_pk_bf16_f32 v153, v6, v7
  v_accvgpr_read_b32 v4, a60
  v_accvgpr_read_b32 v5, a61
  v_accvgpr_read_b32 v6, a62
  v_accvgpr_read_b32 v7, a63
  v_cvt_pk_bf16_f32 v154, v4, v5
  v_cvt_pk_bf16_f32 v155, v6, v7
  buffer_store_dwordx4 v[152:155], v8, s[20:23], s59 offen offset:2048 sc0 sc1
  v_accvgpr_read_b32 v4, a64
  v_accvgpr_read_b32 v5, a65
  v_accvgpr_read_b32 v6, a66
  v_accvgpr_read_b32 v7, a67
  v_cvt_pk_bf16_f32 v156, v4, v5
  v_cvt_pk_bf16_f32 v157, v6, v7
  v_accvgpr_read_b32 v4, a68
  v_accvgpr_read_b32 v5, a69
  v_accvgpr_read_b32 v6, a70
  v_accvgpr_read_b32 v7, a71
  v_cvt_pk_bf16_f32 v158, v4, v5
  v_cvt_pk_bf16_f32 v159, v6, v7
  buffer_store_dwordx4 v[156:159], v8, s[20:23], s59 offen offset:3072 sc0 sc1
  v_accvgpr_read_b32 v4, a72
  v_accvgpr_read_b32 v5, a73
  v_accvgpr_read_b32 v6, a74
  v_accvgpr_read_b32 v7, a75
  v_cvt_pk_bf16_f32 v160, v4, v5
  v_cvt_pk_bf16_f32 v161, v6, v7
  v_accvgpr_read_b32 v4, a76
  v_accvgpr_read_b32 v5, a77
  v_accvgpr_read_b32 v6, a78
  v_accvgpr_read_b32 v7, a79
  v_cvt_pk_bf16_f32 v162, v4, v5
  v_cvt_pk_bf16_f32 v163, v6, v7
  s_add_u32 s59, s67, 86016
  buffer_store_dwordx4 v[160:163], v8, s[20:23], s59 offen offset:0 sc0 sc1
  v_accvgpr_read_b32 v4, a80
  v_accvgpr_read_b32 v5, a81
  v_accvgpr_read_b32 v6, a82
  v_accvgpr_read_b32 v7, a83
  v_cvt_pk_bf16_f32 v164, v4, v5
  v_cvt_pk_bf16_f32 v165, v6, v7
  v_accvgpr_read_b32 v4, a84
  v_accvgpr_read_b32 v5, a85
  v_accvgpr_read_b32 v6, a86
  v_accvgpr_read_b32 v7, a87
  v_cvt_pk_bf16_f32 v166, v4, v5
  v_cvt_pk_bf16_f32 v167, v6, v7
  s_add_u32 s59, s67, 163840
  buffer_store_dwordx4 v[164:167], v8, s[20:23], s59 offen offset:0 sc0 sc1
  v_accvgpr_read_b32 v4, a88
  v_accvgpr_read_b32 v5, a89
  v_accvgpr_read_b32 v6, a90
  v_accvgpr_read_b32 v7, a91
  v_cvt_pk_bf16_f32 v168, v4, v5
  v_cvt_pk_bf16_f32 v169, v6, v7
  v_accvgpr_read_b32 v4, a92
  v_accvgpr_read_b32 v5, a93
  v_accvgpr_read_b32 v6, a94
  v_accvgpr_read_b32 v7, a95
  v_cvt_pk_bf16_f32 v170, v4, v5
  v_cvt_pk_bf16_f32 v171, v6, v7
  buffer_store_dwordx4 v[168:171], v8, s[20:23], s59 offen offset:1024 sc0 sc1
  v_accvgpr_read_b32 v4, a96
  v_accvgpr_read_b32 v5, a97
  v_accvgpr_read_b32 v6, a98
  v_accvgpr_read_b32 v7, a99
  v_cvt_pk_bf16_f32 v172, v4, v5
  v_cvt_pk_bf16_f32 v173, v6, v7
  v_accvgpr_read_b32 v4, a100
  v_accvgpr_read_b32 v5, a101
  v_accvgpr_read_b32 v6, a102
  v_accvgpr_read_b32 v7, a103
  v_cvt_pk_bf16_f32 v174, v4, v5
  v_cvt_pk_bf16_f32 v175, v6, v7
  buffer_store_dwordx4 v[172:175], v8, s[20:23], s59 offen offset:2048 sc0 sc1
  v_accvgpr_read_b32 v4, a104
  v_accvgpr_read_b32 v5, a105
  v_accvgpr_read_b32 v6, a106
  v_accvgpr_read_b32 v7, a107
  v_cvt_pk_bf16_f32 v176, v4, v5
  v_cvt_pk_bf16_f32 v177, v6, v7
  v_accvgpr_read_b32 v4, a108
  v_accvgpr_read_b32 v5, a109
  v_accvgpr_read_b32 v6, a110
  v_accvgpr_read_b32 v7, a111
  v_cvt_pk_bf16_f32 v178, v4, v5
  v_cvt_pk_bf16_f32 v179, v6, v7
  buffer_store_dwordx4 v[176:179], v8, s[20:23], s59 offen offset:3072 sc0 sc1
  v_accvgpr_read_b32 v4, a112
  v_accvgpr_read_b32 v5, a113
  v_accvgpr_read_b32 v6, a114
  v_accvgpr_read_b32 v7, a115
  v_cvt_pk_bf16_f32 v180, v4, v5
  v_cvt_pk_bf16_f32 v181, v6, v7
  v_accvgpr_read_b32 v4, a116
  v_accvgpr_read_b32 v5, a117
  v_accvgpr_read_b32 v6, a118
  v_accvgpr_read_b32 v7, a119
  v_cvt_pk_bf16_f32 v182, v4, v5
  v_cvt_pk_bf16_f32 v183, v6, v7
  s_add_u32 s59, s67, 167936
  buffer_store_dwordx4 v[180:183], v8, s[20:23], s59 offen offset:0 sc0 sc1
  v_accvgpr_read_b32 v4, a120
  v_accvgpr_read_b32 v5, a121
  v_accvgpr_read_b32 v6, a122
  v_accvgpr_read_b32 v7, a123
  v_cvt_pk_bf16_f32 v184, v4, v5
  v_cvt_pk_bf16_f32 v185, v6, v7
  v_accvgpr_read_b32 v4, a124
  v_accvgpr_read_b32 v5, a125
  v_accvgpr_read_b32 v6, a126
  v_accvgpr_read_b32 v7, a127
  v_cvt_pk_bf16_f32 v186, v4, v5
  v_cvt_pk_bf16_f32 v187, v6, v7
  s_add_u32 s59, s67, 245760
  buffer_store_dwordx4 v[184:187], v8, s[20:23], s59 offen offset:0 sc0 sc1
  v_accvgpr_read_b32 v4, a128
  v_accvgpr_read_b32 v5, a129
  v_accvgpr_read_b32 v6, a130
  v_accvgpr_read_b32 v7, a131
  v_cvt_pk_bf16_f32 v188, v4, v5
  v_cvt_pk_bf16_f32 v189, v6, v7
  v_accvgpr_read_b32 v4, a132
  v_accvgpr_read_b32 v5, a133
  v_accvgpr_read_b32 v6, a134
  v_accvgpr_read_b32 v7, a135
  v_cvt_pk_bf16_f32 v190, v4, v5
  v_cvt_pk_bf16_f32 v191, v6, v7
  buffer_store_dwordx4 v[188:191], v8, s[20:23], s59 offen offset:1024 sc0 sc1
  v_accvgpr_read_b32 v4, a136
  v_accvgpr_read_b32 v5, a137
  v_accvgpr_read_b32 v6, a138
  v_accvgpr_read_b32 v7, a139
  v_cvt_pk_bf16_f32 v192, v4, v5
  v_cvt_pk_bf16_f32 v193, v6, v7
  v_accvgpr_read_b32 v4, a140
  v_accvgpr_read_b32 v5, a141
  v_accvgpr_read_b32 v6, a142
  v_accvgpr_read_b32 v7, a143
  v_cvt_pk_bf16_f32 v194, v4, v5
  v_cvt_pk_bf16_f32 v195, v6, v7
  buffer_store_dwordx4 v[192:195], v8, s[20:23], s59 offen offset:2048 sc0 sc1
  v_accvgpr_read_b32 v4, a144
  v_accvgpr_read_b32 v5, a145
  v_accvgpr_read_b32 v6, a146
  v_accvgpr_read_b32 v7, a147
  v_cvt_pk_bf16_f32 v196, v4, v5
  v_cvt_pk_bf16_f32 v197, v6, v7
  v_accvgpr_read_b32 v4, a148
  v_accvgpr_read_b32 v5, a149
  v_accvgpr_read_b32 v6, a150
  v_accvgpr_read_b32 v7, a151
  v_cvt_pk_bf16_f32 v198, v4, v5
  v_cvt_pk_bf16_f32 v199, v6, v7
  buffer_store_dwordx4 v[196:199], v8, s[20:23], s59 offen offset:3072 sc0 sc1
  v_accvgpr_read_b32 v4, a152
  v_accvgpr_read_b32 v5, a153
  v_accvgpr_read_b32 v6, a154
  v_accvgpr_read_b32 v7, a155
  v_cvt_pk_bf16_f32 v200, v4, v5
  v_cvt_pk_bf16_f32 v201, v6, v7
  v_accvgpr_read_b32 v4, a156
  v_accvgpr_read_b32 v5, a157
  v_accvgpr_read_b32 v6, a158
  v_accvgpr_read_b32 v7, a159
  v_cvt_pk_bf16_f32 v202, v4, v5
  v_cvt_pk_bf16_f32 v203, v6, v7
  s_add_u32 s59, s67, 249856
  buffer_store_dwordx4 v[200:203], v8, s[20:23], s59 offen offset:0 sc0 sc1
  v_accvgpr_read_b32 v104, a0
  v_accvgpr_read_b32 v105, a1
  v_accvgpr_read_b32 v106, a2
  v_accvgpr_read_b32 v107, a3
  v_accvgpr_read_b32 v108, a4
  v_accvgpr_read_b32 v109, a5
  v_accvgpr_read_b32 v110, a6
  v_accvgpr_read_b32 v111, a7
  v_accvgpr_read_b32 v112, a8
  v_accvgpr_read_b32 v113, a9
  v_accvgpr_read_b32 v114, a10
  v_accvgpr_read_b32 v115, a11
  v_accvgpr_read_b32 v116, a12
  v_accvgpr_read_b32 v117, a13
  v_accvgpr_read_b32 v118, a14
  v_accvgpr_read_b32 v119, a15
  v_accvgpr_read_b32 v120, a16
  v_accvgpr_read_b32 v121, a17
  v_accvgpr_read_b32 v122, a18
  v_accvgpr_read_b32 v123, a19
  v_accvgpr_read_b32 v124, a20
  v_accvgpr_read_b32 v125, a21
  v_accvgpr_read_b32 v126, a22
  v_accvgpr_read_b32 v127, a23
  v_accvgpr_read_b32 v128, a24
  v_accvgpr_read_b32 v129, a25
  v_accvgpr_read_b32 v130, a26
  v_accvgpr_read_b32 v131, a27
  v_accvgpr_read_b32 v132, a28
  v_accvgpr_read_b32 v133, a29
  v_accvgpr_read_b32 v134, a30
  v_accvgpr_read_b32 v135, a31
  v_accvgpr_read_b32 v136, a32
  v_accvgpr_read_b32 v137, a33
  v_accvgpr_read_b32 v138, a34
  v_accvgpr_read_b32 v139, a35
  v_accvgpr_read_b32 v140, a36
  v_accvgpr_read_b32 v141, a37
  v_accvgpr_read_b32 v142, a38
  v_accvgpr_read_b32 v143, a39
  s_mov_b64 exec, 1
  s_waitcnt vmcnt(10)
  buffer_store_dword v2, v1, s[20:23], s70 offen offset:64 sc0 sc1
  s_waitcnt vmcnt(6)
  buffer_store_dword v2, v1, s[20:23], s70 offen offset:128 sc0 sc1
  s_waitcnt vmcnt(2)
  buffer_store_dword v2, v1, s[20:23], s70 offen offset:192 sc0 sc1
  s_mov_b64 exec, -1
  s_mov_b32 s71, 0
  s_mov_b64 exec, 14
K2_POLL0:
  buffer_load_dword v3, v8, s[20:23], s70 offen offset:0 sc0 sc1
  s_waitcnt vmcnt(0)
  v_cmp_ne_u32 vcc, 1, v3
  s_add_u32 s71, s71, 1
  s_cbranch_vccz K2_GOT0
  s_sleep 2
  s_cmp_lt_u32 s71, 100000
  s_cbranch_scc1 K2_POLL0
K2_GOT0:
  s_mov_b64 exec, -1
  s_add_u32 s59, s67, 61440
  buffer_load_dwordx4 v[64:67], v8, s[20:23], s59 offen offset:0 sc0 sc1
  buffer_load_dwordx4 v[68:71], v8, s[20:23], s59 offen offset:1024 sc0 sc1
  buffer_load_dwordx4 v[72:75], v8, s[20:23], s59 offen offset:2048 sc0 sc1
  buffer_load_dwordx4 v[76:79], v8, s[20:23], s59 offen offset:3072 sc0 sc1
  s_add_u32 s59, s67, 65536
  buffer_load_dwordx4 v[80:83], v8, s[20:23], s59 offen offset:0 sc0 sc1
  s_add_u32 s59, s67, 40960
  buffer_load_dwordx4 v[84:87], v8, s[20:23], s59 offen offset:0 sc0 sc1
  buffer_load_dwordx4 v[88:91], v8, s[20:23], s59 offen offset:1024 sc0 sc1
  buffer_load_dwordx4 v[92:95], v8, s[20:23], s59 offen offset:2048 sc0 sc1
  buffer_load_dwordx4 v[96:99], v8, s[20:23], s59 offen offset:3072 sc0 sc1
  s_add_u32 s59, s67, 45056
  buffer_load_dwordx4 v[100:103], v8, s[20:23], s59 offen offset:0 sc0 sc1
  s_add_u32 s59, s67, 20480
  buffer_load_dwordx4 v[204:207], v8, s[20:23], s59 offen offset:0 sc0 sc1
  buffer_load_dwordx4 v[208:211], v8, s[20:23], s59 offen offset:1024 sc0 sc1
  buffer_load_dwordx4 v[212:215], v8, s[20:23], s59 offen offset:2048 sc0 sc1
  buffer_load_dwordx4 v[216:219], v8, s[20:23], s59 offen offset:3072 sc0 sc1
  s_add_u32 s59, s67, 24576
  buffer_load_dwordx4 v[220:223], v8, s[20:23], s59 offen offset:0 sc0 sc1
  s_branch K2_SUM
K2_X1:
  s_cmp_lg_u32 s56, 1
  s_cbranch_scc1 K2_X2
  v_accvgpr_read_b32 v4, a80
  v_accvgpr_read_b32 v5, a81
  v_accvgpr_read_b32 v6, a82
  v_accvgpr_read_b32 v7, a83
  v_cvt_pk_bf16_f32 v144, v4, v5
  v_cvt_pk_bf16_f32 v145, v6, v7
  v_accvgpr_read_b32 v4, a84
  v_accvgpr_read_b32 v5, a85
  v_accvgpr_read_b32 v6, a86
  v_accvgpr_read_b32 v7, a87
  v_cvt_pk_bf16_f32 v146, v4, v5
  v_cvt_pk_bf16_f32 v147, v6, v7
  s_add_u32 s59, s67, 184320
  buffer_store_dwordx4 v[144:147], v8, s[20:23], s59 offen offset:0 sc0 sc1
  v_accvgpr_read_b32 v4, a88
  v_accvgpr_read_b32 v5, a89
  v_accvgpr_read_b32 v6, a90
  v_accvgpr_read_b32 v7, a91
  v_cvt_pk_bf16_f32 v148, v4, v5
  v_cvt_pk_bf16_f32 v149, v6, v7
  v_accvgpr_read_b32 v4, a92
  v_accvgpr_read_b32 v5, a93
  v_accvgpr_read_b32 v6, a94
  v_accvgpr_read_b32 v7, a95
  v_cvt_pk_bf16_f32 v150, v4, v5
  v_cvt_pk_bf16_f32 v151, v6, v7
  buffer_store_dwordx4 v[148:151], v8, s[20:23], s59 offen offset:1024 sc0 sc1
  v_accvgpr_read_b32 v4, a96
  v_accvgpr_read_b32 v5, a97
  v_accvgpr_read_b32 v6, a98
  v_accvgpr_read_b32 v7, a99
  v_cvt_pk_bf16_f32 v152, v4, v5
  v_cvt_pk_bf16_f32 v153, v6, v7
  v_accvgpr_read_b32 v4, a100
  v_accvgpr_read_b32 v5, a101
  v_accvgpr_read_b32 v6, a102
  v_accvgpr_read_b32 v7, a103
  v_cvt_pk_bf16_f32 v154, v4, v5
  v_cvt_pk_bf16_f32 v155, v6, v7
  buffer_store_dwordx4 v[152:155], v8, s[20:23], s59 offen offset:2048 sc0 sc1
  v_accvgpr_read_b32 v4, a104
  v_accvgpr_read_b32 v5, a105
  v_accvgpr_read_b32 v6, a106
  v_accvgpr_read_b32 v7, a107
  v_cvt_pk_bf16_f32 v156, v4, v5
  v_cvt_pk_bf16_f32 v157, v6, v7
  v_accvgpr_read_b32 v4, a108
  v_accvgpr_read_b32 v5, a109
  v_accvgpr_read_b32 v6, a110
  v_accvgpr_read_b32 v7, a111
  v_cvt_pk_bf16_f32 v158, v4, v5
  v_cvt_pk_bf16_f32 v159, v6, v7
  buffer_store_dwordx4 v[156:159], v8, s[20:23], s59 offen offset:3072 sc0 sc1
  v_accvgpr_read_b32 v4, a112
  v_accvgpr_read_b32 v5, a113
  v_accvgpr_read_b32 v6, a114
  v_accvgpr_read_b32 v7, a115
  v_cvt_pk_bf16_f32 v160, v4, v5
  v_cvt_pk_bf16_f32 v161, v6, v7
  v_accvgpr_read_b32 v4, a116
  v_accvgpr_read_b32 v5, a117
  v_accvgpr_read_b32 v6, a118
  v_accvgpr_read_b32 v7, a119
  v_cvt_pk_bf16_f32 v162, v4, v5
  v_cvt_pk_bf16_f32 v163, v6, v7
  s_add_u32 s59, s67, 188416
  buffer_store_dwordx4 v[160:163], v8, s[20:23], s59 offen offset:0 sc0 sc1
  v_accvgpr_read_b32 v4, a120
  v_accvgpr_read_b32 v5, a121
  v_accvgpr_read_b32 v6, a122
  v_accvgpr_read_b32 v7, a123
  v_cvt_pk_bf16_f32 v164, v4, v5
  v_cvt_pk_bf16_f32 v165, v6, v7
  v_accvgpr_read_b32 v4, a124
  v_accvgpr_read_b32 v5, a125
  v_accvgpr_read_b32 v6, a126
  v_accvgpr_read_b32 v7, a127
  v_cvt_pk_bf16_f32 v166, v4, v5
  v_cvt_pk_bf16_f32 v167, v6, v7
  s_add_u32 s59, s67, 266240
  buffer_store_dwordx4 v[164:167], v8, s[20:23], s59 offen offset:0 sc0 sc1
  v_accvgpr_read_b32 v4, a128
  v_accvgpr_read_b32 v5, a129
  v_accvgpr_read_b32 v6, a130
  v_accvgpr_read_b32 v7, a131
  v_cvt_pk_bf16_f32 v168, v4, v5
  v_cvt_pk_bf16_f32 v169, v6, v7
  v_accvgpr_read_b32 v4, a132
  v_accvgpr_read_b32 v5, a133
  v_accvgpr_read_b32 v6, a134
  v_accvgpr_read_b32 v7, a135
  v_cvt_pk_bf16_f32 v170, v4, v5
  v_cvt_pk_bf16_f32 v171, v6, v7
  buffer_store_dwordx4 v[168:171], v8, s[20:23], s59 offen offset:1024 sc0 sc1
  v_accvgpr_read_b32 v4, a136
  v_accvgpr_read_b32 v5, a137
  v_accvgpr_read_b32 v6, a138
  v_accvgpr_read_b32 v7, a139
  v_cvt_pk_bf16_f32 v172, v4, v5
  v_cvt_pk_bf16_f32 v173, v6, v7
  v_accvgpr_read_b32 v4, a140
  v_accvgpr_read_b32 v5, a141
  v_accvgpr_read_b32 v6, a142
  v_accvgpr_read_b32 v7, a143
  v_cvt_pk_bf16_f32 v174, v4, v5
  v_cvt_pk_bf16_f32 v175, v6, v7
  buffer_store_dwordx4 v[172:175], v8, s[20:23], s59 offen offset:2048 sc0 sc1
  v_accvgpr_read_b32 v4, a144
  v_accvgpr_read_b32 v5, a145
  v_accvgpr_read_b32 v6, a146
  v_accvgpr_read_b32 v7, a147
  v_cvt_pk_bf16_f32 v176, v4, v5
  v_cvt_pk_bf16_f32 v177, v6, v7
  v_accvgpr_read_b32 v4, a148
  v_accvgpr_read_b32 v5, a149
  v_accvgpr_read_b32 v6, a150
  v_accvgpr_read_b32 v7, a151
  v_cvt_pk_bf16_f32 v178, v4, v5
  v_cvt_pk_bf16_f32 v179, v6, v7
  buffer_store_dwordx4 v[176:179], v8, s[20:23], s59 offen offset:3072 sc0 sc1
  v_accvgpr_read_b32 v4, a152
  v_accvgpr_read_b32 v5, a153
  v_accvgpr_read_b32 v6, a154
  v_accvgpr_read_b32 v7, a155
  v_cvt_pk_bf16_f32 v180, v4, v5
  v_cvt_pk_bf16_f32 v181, v6, v7
  v_accvgpr_read_b32 v4, a156
  v_accvgpr_read_b32 v5, a157
  v_accvgpr_read_b32 v6, a158
  v_accvgpr_read_b32 v7, a159
  v_cvt_pk_bf16_f32 v182, v4, v5
  v_cvt_pk_bf16_f32 v183, v6, v7
  s_add_u32 s59, s67, 270336
  buffer_store_dwordx4 v[180:183], v8, s[20:23], s59 offen offset:0 sc0 sc1
  v_accvgpr_read_b32 v4, a0
  v_accvgpr_read_b32 v5, a1
  v_accvgpr_read_b32 v6, a2
  v_accvgpr_read_b32 v7, a3
  v_cvt_pk_bf16_f32 v184, v4, v5
  v_cvt_pk_bf16_f32 v185, v6, v7
  v_accvgpr_read_b32 v4, a4
  v_accvgpr_read_b32 v5, a5
  v_accvgpr_read_b32 v6, a6
  v_accvgpr_read_b32 v7, a7
  v_cvt_pk_bf16_f32 v186, v4, v5
  v_cvt_pk_bf16_f32 v187, v6, v7
  s_add_u32 s59, s67, 20480
  buffer_store_dwordx4 v[184:187], v8, s[20:23], s59 offen offset:0 sc0 sc1
  v_accvgpr_read_b32 v4, a8
  v_accvgpr_read_b32 v5, a9
  v_accvgpr_read_b32 v6, a10
  v_accvgpr_read_b32 v7, a11
  v_cvt_pk_bf16_f32 v188, v4, v5
  v_cvt_pk_bf16_f32 v189, v6, v7
  v_accvgpr_read_b32 v4, a12
  v_accvgpr_read_b32 v5, a13
  v_accvgpr_read_b32 v6, a14
  v_accvgpr_read_b32 v7, a15
  v_cvt_pk_bf16_f32 v190, v4, v5
  v_cvt_pk_bf16_f32 v191, v6, v7
  buffer_store_dwordx4 v[188:191], v8, s[20:23], s59 offen offset:1024 sc0 sc1
  v_accvgpr_read_b32 v4, a16
  v_accvgpr_read_b32 v5, a17
  v_accvgpr_read_b32 v6, a18
  v_accvgpr_read_b32 v7, a19
  v_cvt_pk_bf16_f32 v192, v4, v5
  v_cvt_pk_bf16_f32 v193, v6, v7
  v_accvgpr_read_b32 v4, a20
  v_accvgpr_read_b32 v5, a21
  v_accvgpr_read_b32 v6, a22
  v_accvgpr_read_b32 v7, a23
  v_cvt_pk_bf16_f32 v194, v4, v5
  v_cvt_pk_bf16_f32 v195, v6, v7
  buffer_store_dwordx4 v[192:195], v8, s[20:23], s59 offen offset:2048 sc0 sc1
  v_accvgpr_read_b32 v4, a24
  v_accvgpr_read_b32 v5, a25
  v_accvgpr_read_b32 v6, a26
  v_accvgpr_read_b32 v7, a27
  v_cvt_pk_bf16_f32 v196, v4, v5
  v_cvt_pk_bf16_f32 v197, v6, v7
  v_accvgpr_read_b32 v4, a28
  v_accvgpr_read_b32 v5, a29
  v_accvgpr_read_b32 v6, a30
  v_accvgpr_read_b32 v7, a31
  v_cvt_pk_bf16_f32 v198, v4, v5
  v_cvt_pk_bf16_f32 v199, v6, v7
  buffer_store_dwordx4 v[196:199], v8, s[20:23], s59 offen offset:3072 sc0 sc1
  v_accvgpr_read_b32 v4, a32
  v_accvgpr_read_b32 v5, a33
  v_accvgpr_read_b32 v6, a34
  v_accvgpr_read_b32 v7, a35
  v_cvt_pk_bf16_f32 v200, v4, v5
  v_cvt_pk_bf16_f32 v201, v6, v7
  v_accvgpr_read_b32 v4, a36
  v_accvgpr_read_b32 v5, a37
  v_accvgpr_read_b32 v6, a38
  v_accvgpr_read_b32 v7, a39
  v_cvt_pk_bf16_f32 v202, v4, v5
  v_cvt_pk_bf16_f32 v203, v6, v7
  s_add_u32 s59, s67, 24576
  buffer_store_dwordx4 v[200:203], v8, s[20:23], s59 offen offset:0 sc0 sc1
  v_accvgpr_read_b32 v104, a40
  v_accvgpr_read_b32 v105, a41
  v_accvgpr_read_b32 v106, a42
  v_accvgpr_read_b32 v107, a43
  v_accvgpr_read_b32 v108, a44
  v_accvgpr_read_b32 v109, a45
  v_accvgpr_read_b32 v110, a46
  v_accvgpr_read_b32 v111, a47
  v_accvgpr_read_b32 v112, a48
  v_accvgpr_read_b32 v113, a49
  v_accvgpr_read_b32 v114, a50
  v_accvgpr_read_b32 v115, a51
  v_accvgpr_read_b32 v116, a52
  v_accvgpr_read_b32 v117, a53
  v_accvgpr_read_b32 v118, a54
  v_accvgpr_read_b32 v119, a55
  v_accvgpr_read_b32 v120, a56
  v_accvgpr_read_b32 v121, a57
  v_accvgpr_read_b32 v122, a58
  v_accvgpr_read_b32 v123, a59
  v_accvgpr_read_b32 v124, a60
  v_accvgpr_read_b32 v125, a61
  v_accvgpr_read_b32 v126, a62
  v_accvgpr_read_b32 v127, a63
  v_accvgpr_read_b32 v128, a64
  v_accvgpr_read_b32 v129, a65
  v_accvgpr_read_b32 v130, a66
  v_accvgpr_read_b32 v131, a67
  v_accvgpr_read_b32 v132, a68
  v_accvgpr_read_b32 v133, a69
  v_accvgpr_read_b32 v134, a70
  v_accvgpr_read_b32 v135, a71
  v_accvgpr_read_b32 v136, a72
  v_accvgpr_read_b32 v137, a73
  v_accvgpr_read_b32 v138, a74
  v_accvgpr_read_b32 v139, a75
  v_accvgpr_read_b32 v140, a76
  v_accvgpr_read_b32 v141, a77
  v_accvgpr_read_b32 v142, a78
  v_accvgpr_read_b32 v143, a79
  s_mov_b64 exec, 1
  s_waitcnt vmcnt(10)
  buffer_store_dword v2, v1, s[20:23], s70 offen offset:144 sc0 sc1
  s_waitcnt vmcnt(6)
  buffer_store_dword v2, v1, s[20:23], s70 offen offset:208 sc0 sc1
  s_waitcnt vmcnt(2)
  buffer_store_dword v2, v1, s[20:23], s70 offen offset:16 sc0 sc1
  s_mov_b64 exec, -1
  s_mov_b32 s71, 0
  s_mov_b64 exec, 13
K2_POLL1:
  buffer_load_dword v3, v8, s[20:23], s70 offen offset:64 sc0 sc1
  s_waitcnt vmcnt(0)
  v_cmp_ne_u32 vcc, 1, v3
  s_add_u32 s71, s71, 1
  s_cbranch_vccz K2_GOT1
  s_sleep 2
  s_cmp_lt_u32 s71, 100000
  s_cbranch_scc1 K2_POLL1
K2_GOT1:
  s_mov_b64 exec, -1
  s_add_u32 s59, s67, 81920
  buffer_load_dwordx4 v[64:67], v8, s[20:23], s59 offen offset:0 sc0 sc1
  buffer_load_dwordx4 v[68:71], v8, s[20:23], s59 offen offset:1024 sc0 sc1
  buffer_load_dwordx4 v[72:75], v8, s[20:23], s59 offen offset:2048 sc0 sc1
  buffer_load_dwordx4 v[76:79], v8, s[20:23], s59 offen offset:3072 sc0 sc1
  s_add_u32 s59, s67, 86016
  buffer_load_dwordx4 v[80:83], v8, s[20:23], s59 offen offset:0 sc0 sc1
  s_add_u32 s59, s67, 143360
  buffer_load_dwordx4 v[84:87], v8, s[20:23], s59 offen offset:0 sc0 sc1
  buffer_load_dwordx4 v[88:91], v8, s[20:23], s59 offen offset:1024 sc0 sc1
  buffer_load_dwordx4 v[92:95], v8, s[20:23], s59 offen offset:2048 sc0 sc1
  buffer_load_dwordx4 v[96:99], v8, s[20:23], s59 offen offset:3072 sc0 sc1
  s_add_u32 s59, s67, 147456
  buffer_load_dwordx4 v[100:103], v8, s[20:23], s59 offen offset:0 sc0 sc1
  s_add_u32 s59, s67, 122880
  buffer_load_dwordx4 v[204:207], v8, s[20:23], s59 offen offset:0 sc0 sc1
  buffer_load_dwordx4 v[208:211], v8, s[20:23], s59 offen offset:1024 sc0 sc1
  buffer_load_dwordx4 v[212:215], v8, s[20:23], s59 offen offset:2048 sc0 sc1
  buffer_load_dwordx4 v[216:219], v8, s[20:23], s59 offen offset:3072 sc0 sc1
  s_add_u32 s59, s67, 126976
  buffer_load_dwordx4 v[220:223], v8, s[20:23], s59 offen offset:0 sc0 sc1
  s_branch K2_SUM
K2_X2:
  s_cmp_lg_u32 s56, 2
  s_cbranch_scc1 K2_X3
  v_accvgpr_read_b32 v4, a120
  v_accvgpr_read_b32 v5, a121
  v_accvgpr_read_b32 v6, a122
  v_accvgpr_read_b32 v7, a123
  v_cvt_pk_bf16_f32 v144, v4, v5
  v_cvt_pk_bf16_f32 v145, v6, v7
  v_accvgpr_read_b32 v4, a124
  v_accvgpr_read_b32 v5, a125
  v_accvgpr_read_b32 v6, a126
  v_accvgpr_read_b32 v7, a127
  v_cvt_pk_bf16_f32 v146, v4, v5
  v_cvt_pk_bf16_f32 v147, v6, v7
  s_add_u32 s59, s67, 286720
  buffer_store_dwordx4 v[144:147], v8, s[20:23], s59 offen offset:0 sc0 sc1
  v_accvgpr_read_b32 v4, a128
  v_accvgpr_read_b32 v5, a129
  v_accvgpr_read_b32 v6, a130
  v_accvgpr_read_b32 v7, a131
  v_cvt_pk_bf16_f32 v148, v4, v5
  v_cvt_pk_bf16_f32 v149, v6, v7
  v_accvgpr_read_b32 v4, a132
  v_accvgpr_read_b32 v5, a133
  v_accvgpr_read_b32 v6, a134
  v_accvgpr_read_b32 v7, a135
  v_cvt_pk_bf16_f32 v150, v4, v5
  v_cvt_pk_bf16_f32 v151, v6, v7
  buffer_store_dwordx4 v[148:151], v8, s[20:23], s59 offen offset:1024 sc0 sc1
  v_accvgpr_read_b32 v4, a136
  v_accvgpr_read_b32 v5, a137
  v_accvgpr_read_b32 v6, a138
  v_accvgpr_read_b32 v7, a139
  v_cvt_pk_bf16_f32 v152, v4, v5
  v_cvt_pk_bf16_f32 v153, v6, v7
  v_accvgpr_read_b32 v4, a140
  v_accvgpr_read_b32 v5, a141
  v_accvgpr_read_b32 v6, a142
  v_accvgpr_read_b32 v7, a143
  v_cvt_pk_bf16_f32 v154, v4, v5
  v_cvt_pk_bf16_f32 v155, v6, v7
  buffer_store_dwordx4 v[152:155], v8, s[20:23], s59 offen offset:2048 sc0 sc1
  v_accvgpr_read_b32 v4, a144
  v_accvgpr_read_b32 v5, a145
  v_accvgpr_read_b32 v6, a146
  v_accvgpr_read_b32 v7, a147
  v_cvt_pk_bf16_f32 v156, v4, v5
  v_cvt_pk_bf16_f32 v157, v6, v7
  v_accvgpr_read_b32 v4, a148
  v_accvgpr_read_b32 v5, a149
  v_accvgpr_read_b32 v6, a150
  v_accvgpr_read_b32 v7, a151
  v_cvt_pk_bf16_f32 v158, v4, v5
  v_cvt_pk_bf16_f32 v159, v6, v7
  buffer_store_dwordx4 v[156:159], v8, s[20:23], s59 offen offset:3072 sc0 sc1
  v_accvgpr_read_b32 v4, a152
  v_accvgpr_read_b32 v5, a153
  v_accvgpr_read_b32 v6, a154
  v_accvgpr_read_b32 v7, a155
  v_cvt_pk_bf16_f32 v160, v4, v5
  v_cvt_pk_bf16_f32 v161, v6, v7
  v_accvgpr_read_b32 v4, a156
  v_accvgpr_read_b32 v5, a157
  v_accvgpr_read_b32 v6, a158
  v_accvgpr_read_b32 v7, a159
  v_cvt_pk_bf16_f32 v162, v4, v5
  v_cvt_pk_bf16_f32 v163, v6, v7
  s_add_u32 s59, s67, 290816
  buffer_store_dwordx4 v[160:163], v8, s[20:23], s59 offen offset:0 sc0 sc1
  v_accvgpr_read_b32 v4, a0
  v_accvgpr_read_b32 v5, a1
  v_accvgpr_read_b32 v6, a2
  v_accvgpr_read_b32 v7, a3
  v_cvt_pk_bf16_f32 v164, v4, v5
  v_cvt_pk_bf16_f32 v165, v6, v7
  v_accvgpr_read_b32 v4, a4
  v_accvgpr_read_b32 v5, a5
  v_accvgpr_read_b32 v6, a6
  v_accvgpr_read_b32 v7, a7
  v_cvt_pk_bf16_f32 v166, v4, v5
  v_cvt_pk_bf16_f32 v167, v6, v7
  s_add_u32 s59, s67, 40960
  buffer_store_dwordx4 v[164:167], v8, s[20:23], s59 offen offset:0 sc0 sc1
  v_accvgpr_read_b32 v4, a8
  v_accvgpr_read_b32 v5, a9
  v_accvgpr_read_b32 v6, a10
  v_accvgpr_read_b32 v7, a11
  v_cvt_pk_bf16_f32 v168, v4, v5
  v_cvt_pk_bf16_f32 v169, v6, v7
  v_accvgpr_read_b32 v4, a12
  v_accvgpr_read_b32 v5, a13
  v_accvgpr_read_b32 v6, a14
  v_accvgpr_read_b32 v7, a15
  v_cvt_pk_bf16_f32 v170, v4, v5
  v_cvt_pk_bf16_f32 v171, v6, v7
  buffer_store_dwordx4 v[168:171], v8, s[20:23], s59 offen offset:1024 sc0 sc1
  v_accvgpr_read_b32 v4, a16
  v_accvgpr_read_b32 v5, a17
  v_accvgpr_read_b32 v6, a18
  v_accvgpr_read_b32 v7, a19
  v_cvt_pk_bf16_f32 v172, v4, v5
  v_cvt_pk_bf16_f32 v173, v6, v7
  v_accvgpr_read_b32 v4, a20
  v_accvgpr_read_b32 v5, a21
  v_accvgpr_read_b32 v6, a22
  v_accvgpr_read_b32 v7, a23
  v_cvt_pk_bf16_f32 v174, v4, v5
  v_cvt_pk_bf16_f32 v175, v6, v7
  buffer_store_dwordx4 v[172:175], v8, s[20:23], s59 offen offset:2048 sc0 sc1
  v_accvgpr_read_b32 v4, a24
  v_accvgpr_read_b32 v5, a25
  v_accvgpr_read_b32 v6, a26
  v_accvgpr_read_b32 v7, a27
  v_cvt_pk_bf16_f32 v176, v4, v5
  v_cvt_pk_bf16_f32 v177, v6, v7
  v_accvgpr_read_b32 v4, a28
  v_accvgpr_read_b32 v5, a29
  v_accvgpr_read_b32 v6, a30
  v_accvgpr_read_b32 v7, a31
  v_cvt_pk_bf16_f32 v178, v4, v5
  v_cvt_pk_bf16_f32 v179, v6, v7
  buffer_store_dwordx4 v[176:179], v8, s[20:23], s59 offen offset:3072 sc0 sc1
  v_accvgpr_read_b32 v4, a32
  v_accvgpr_read_b32 v5, a33
  v_accvgpr_read_b32 v6, a34
  v_accvgpr_read_b32 v7, a35
  v_cvt_pk_bf16_f32 v180, v4, v5
  v_cvt_pk_bf16_f32 v181, v6, v7
  v_accvgpr_read_b32 v4, a36
  v_accvgpr_read_b32 v5, a37
  v_accvgpr_read_b32 v6, a38
  v_accvgpr_read_b32 v7, a39
  v_cvt_pk_bf16_f32 v182, v4, v5
  v_cvt_pk_bf16_f32 v183, v6, v7
  s_add_u32 s59, s67, 45056
  buffer_store_dwordx4 v[180:183], v8, s[20:23], s59 offen offset:0 sc0 sc1
  v_accvgpr_read_b32 v4, a40
  v_accvgpr_read_b32 v5, a41
  v_accvgpr_read_b32 v6, a42
  v_accvgpr_read_b32 v7, a43
  v_cvt_pk_bf16_f32 v184, v4, v5
  v_cvt_pk_bf16_f32 v185, v6, v7
  v_accvgpr_read_b32 v4, a44
  v_accvgpr_read_b32 v5, a45
  v_accvgpr_read_b32 v6, a46
  v_accvgpr_read_b32 v7, a47
  v_cvt_pk_bf16_f32 v186, v4, v5
  v_cvt_pk_bf16_f32 v187, v6, v7
  s_add_u32 s59, s67, 122880
  buffer_store_dwordx4 v[184:187], v8, s[20:23], s59 offen offset:0 sc0 sc1
  v_accvgpr_read_b32 v4, a48
  v_accvgpr_read_b32 v5, a49
  v_accvgpr_read_b32 v6, a50
  v_accvgpr_read_b32 v7, a51
  v_cvt_pk_bf16_f32 v188, v4, v5
  v_cvt_pk_bf16_f32 v189, v6, v7
  v_accvgpr_read_b32 v4, a52
  v_accvgpr_read_b32 v5, a53
  v_accvgpr_read_b32 v6, a54
  v_accvgpr_read_b32 v7, a55
  v_cvt_pk_bf16_f32 v190, v4, v5
  v_cvt_pk_bf16_f32 v191, v6, v7
  buffer_store_dwordx4 v[188:191], v8, s[20:23], s59 offen offset:1024 sc0 sc1
  v_accvgpr_read_b32 v4, a56
  v_accvgpr_read_b32 v5, a57
  v_accvgpr_read_b32 v6, a58
  v_accvgpr_read_b32 v7, a59
  v_cvt_pk_bf16_f32 v192, v4, v5
  v_cvt_pk_bf16_f32 v193, v6, v7
  v_accvgpr_read_b32 v4, a60
  v_accvgpr_read_b32 v5, a61
  v_accvgpr_read_b32 v6, a62
  v_accvgpr_read_b32 v7, a63
  v_cvt_pk_bf16_f32 v194, v4, v5
  v_cvt_pk_bf16_f32 v195, v6, v7
  buffer_store_dwordx4 v[192:195], v8, s[20:23], s59 offen offset:2048 sc0 sc1
  v_accvgpr_read_b32 v4, a64
  v_accvgpr_read_b32 v5, a65
  v_accvgpr_read_b32 v6, a66
  v_accvgpr_read_b32 v7, a67
  v_cvt_pk_bf16_f32 v196, v4, v5
  v_cvt_pk_bf16_f32 v197, v6, v7
  v_accvgpr_read_b32 v4, a68
  v_accvgpr_read_b32 v5, a69
  v_accvgpr_read_b32 v6, a70
  v_accvgpr_read_b32 v7, a71
  v_cvt_pk_bf16_f32 v198, v4, v5
  v_cvt_pk_bf16_f32 v199, v6, v7
  buffer_store_dwordx4 v[196:199], v8, s[20:23], s59 offen offset:3072 sc0 sc1
  v_accvgpr_read_b32 v4, a72
  v_accvgpr_read_b32 v5, a73
  v_accvgpr_read_b32 v6, a74
  v_accvgpr_read_b32 v7, a75
  v_cvt_pk_bf16_f32 v200, v4, v5
  v_cvt_pk_bf16_f32 v201, v6, v7
  v_accvgpr_read_b32 v4, a76
  v_accvgpr_read_b32 v5, a77
  v_accvgpr_read_b32 v6, a78
  v_accvgpr_read_b32 v7, a79
  v_cvt_pk_bf16_f32 v202, v4, v5
  v_cvt_pk_bf16_f32 v203, v6, v7
  s_add_u32 s59, s67, 126976
  buffer_store_dwordx4 v[200:203], v8, s[20:23], s59 offen offset:0 sc0 sc1
  v_accvgpr_read_b32 v104, a80
  v_accvgpr_read_b32 v105, a81
  v_accvgpr_read_b32 v106, a82
  v_accvgpr_read_b32 v107, a83
  v_accvgpr_read_b32 v108, a84
  v_accvgpr_read_b32 v109, a85
  v_accvgpr_read_b32 v110, a86
  v_accvgpr_read_b32 v111, a87
  v_accvgpr_read_b32 v112, a88
  v_accvgpr_read_b32 v113, a89
  v_accvgpr_read_b32 v114, a90
  v_accvgpr_read_b32 v115, a91
  v_accvgpr_read_b32 v116, a92
  v_accvgpr_read_b32 v117, a93
  v_accvgpr_read_b32 v118, a94
  v_accvgpr_read_b32 v119, a95
  v_accvgpr_read_b32 v120, a96
  v_accvgpr_read_b32 v121, a97
  v_accvgpr_read_b32 v122, a98
  v_accvgpr_read_b32 v123, a99
  v_accvgpr_read_b32 v124, a100
  v_accvgpr_read_b32 v125, a101
  v_accvgpr_read_b32 v126, a102
  v_accvgpr_read_b32 v127, a103
  v_accvgpr_read_b32 v128, a104
  v_accvgpr_read_b32 v129, a105
  v_accvgpr_read_b32 v130, a106
  v_accvgpr_read_b32 v131, a107
  v_accvgpr_read_b32 v132, a108
  v_accvgpr_read_b32 v133, a109
  v_accvgpr_read_b32 v134, a110
  v_accvgpr_read_b32 v135, a111
  v_accvgpr_read_b32 v136, a112
  v_accvgpr_read_b32 v137, a113
  v_accvgpr_read_b32 v138, a114
  v_accvgpr_read_b32 v139, a115
  v_accvgpr_read_b32 v140, a116
  v_accvgpr_read_b32 v141, a117
  v_accvgpr_read_b32 v142, a118
  v_accvgpr_read_b32 v143, a119
  s_mov_b64 exec, 1
  s_waitcnt vmcnt(10)
  buffer_store_dword v2, v1, s[20:23], s70 offen offset:224 sc0 sc1
  s_waitcnt vmcnt(6)
  buffer_store_dword v2, v1, s[20:23], s70 offen offset:32 sc0 sc1
  s_waitcnt vmcnt(2)
  buffer_store_dword v2, v1, s[20:23], s70 offen offset:96 sc0 sc1
  s_mov_b64 exec, -1
  s_mov_b32 s71, 0
  s_mov_b64 exec, 11
K2_POLL2:
  buffer_load_dword v3, v8, s[20:23], s70 offen offset:128 sc0 sc1
  s_waitcnt vmcnt(0)
  v_cmp_ne_u32 vcc, 1, v3
  s_add_u32 s71, s71, 1
  s_cbranch_vccz K2_GOT2
  s_sleep 2
  s_cmp_lt_u32 s71, 100000
  s_cbranch_scc1 K2_POLL2
K2_GOT2:
  s_mov_b64 exec, -1
  s_add_u32 s59, s67, 184320
  buffer_load_dwordx4 v[64:67], v8, s[20:23], s59 offen offset:0 sc0 sc1
  buffer_load_dwordx4 v[68:71], v8, s[20:23], s59 offen offset:1024 sc0 sc1
  buffer_load_dwordx4 v[72:75], v8, s[20:23], s59 offen offset:2048 sc0 sc1
  buffer_load_dwordx4 v[76:79], v8, s[20:23], s59 offen offset:3072 sc0 sc1
  s_add_u32 s59, s67, 188416
  buffer_load_dwordx4 v[80:83], v8, s[20:23], s59 offen offset:0 sc0 sc1
  s_add_u32 s59, s67, 163840
  buffer_load_dwordx4 v[84:87], v8, s[20:23], s59 offen offset:0 sc0 sc1
  buffer_load_dwordx4 v[88:91], v8, s[20:23], s59 offen offset:1024 sc0 sc1
  buffer_load_dwordx4 v[92:95], v8, s[20:23], s59 offen offset:2048 sc0 sc1
  buffer_load_dwordx4 v[96:99], v8, s[20:23], s59 offen offset:3072 sc0 sc1
  s_add_u32 s59, s67, 167936
  buffer_load_dwordx4 v[100:103], v8, s[20:23], s59 offen offset:0 sc0 sc1
  s_add_u32 s59, s67, 225280
  buffer_load_dwordx4 v[204:207], v8, s[20:23], s59 offen offset:0 sc0 sc1
  buffer_load_dwordx4 v[208:211], v8, s[20:23], s59 offen offset:1024 sc0 sc1
  buffer_load_dwordx4 v[212:215], v8, s[20:23], s59 offen offset:2048 sc0 sc1
  buffer_load_dwordx4 v[216:219], v8, s[20:23], s59 offen offset:3072 sc0 sc1
  s_add_u32 s59, s67, 229376
  buffer_load_dwordx4 v[220:223], v8, s[20:23], s59 offen offset:0 sc0 sc1
  s_branch K2_SUM
K2_X3:
  v_accvgpr_read_b32 v4, a0
  v_accvgpr_read_b32 v5, a1
  v_accvgpr_read_b32 v6, a2
  v_accvgpr_read_b32 v7, a3
  v_cvt_pk_bf16_f32 v144, v4, v5
  v_cvt_pk_bf16_f32 v145, v6, v7
  v_accvgpr_read_b32 v4, a4
  v_accvgpr_read_b32 v5, a5
  v_accvgpr_read_b32 v6, a6
  v_accvgpr_read_b32 v7, a7
  v_cvt_pk_bf16_f32 v146, v4, v5
  v_cvt_pk_bf16_f32 v147, v6, v7
  s_add_u32 s59, s67, 61440
  buffer_store_dwordx4 v[144:147], v8, s[20:23], s59 offen offset:0 sc0 sc1
  v_accvgpr_read_b32 v4, a8
  v_accvgpr_read_b32 v5, a9
  v_accvgpr_read_b32 v6, a10
  v_accvgpr_read_b32 v7, a11
  v_cvt_pk_bf16_f32 v148, v4, v5
  v_cvt_pk_bf16_f32 v149, v6, v7
  v_accvgpr_read_b32 v4, a12
  v_accvgpr_read_b32 v5, a13
  v_accvgpr_read_b32 v6, a14
  v_accvgpr_read_b32 v7, a15
  v_cvt_pk_bf16_f32 v150, v4, v5
  v_cvt_pk_bf16_f32 v151, v6, v7
  buffer_store_dwordx4 v[148:151], v8, s[20:23], s59 offen offset:1024 sc0 sc1
  v_accvgpr_read_b32 v4, a16
  v_accvgpr_read_b32 v5, a17
  v_accvgpr_read_b32 v6, a18
  v_accvgpr_read_b32 v7, a19
  v_cvt_pk_bf16_f32 v152, v4, v5
  v_cvt_pk_bf16_f32 v153, v6, v7
  v_accvgpr_read_b32 v4, a20
  v_accvgpr_read_b32 v5, a21
  v_accvgpr_read_b32 v6, a22
  v_accvgpr_read_b32 v7, a23
  v_cvt_pk_bf16_f32 v154, v4, v5
  v_cvt_pk_bf16_f32 v155, v6, v7
  buffer_store_dwordx4 v[152:155], v8, s[20:23], s59 offen offset:2048 sc0 sc1
  v_accvgpr_read_b32 v4, a24
  v_accvgpr_read_b32 v5, a25
  v_accvgpr_read_b32 v6, a26
  v_accvgpr_read_b32 v7, a27
  v_cvt_pk_bf16_f32 v156, v4, v5
  v_cvt_pk_bf16_f32 v157, v6, v7
  v_accvgpr_read_b32 v4, a28
  v_accvgpr_read_b32 v5, a29
  v_accvgpr_read_b32 v6, a30
  v_accvgpr_read_b32 v7, a31
  v_cvt_pk_bf16_f32 v158, v4, v5
  v_cvt_pk_bf16_f32 v159, v6, v7
  buffer_store_dwordx4 v[156:159], v8, s[20:23], s59 offen offset:3072 sc0 sc1
  v_accvgpr_read_b32 v4, a32
  v_accvgpr_read_b32 v5, a33
  v_accvgpr_read_b32 v6, a34
  v_accvgpr_read_b32 v7, a35
  v_cvt_pk_bf16_f32 v160, v4, v5
  v_cvt_pk_bf16_f32 v161, v6, v7
  v_accvgpr_read_b32 v4, a36
  v_accvgpr_read_b32 v5, a37
  v_accvgpr_read_b32 v6, a38
  v_accvgpr_read_b32 v7, a39
  v_cvt_pk_bf16_f32 v162, v4, v5
  v_cvt_pk_bf16_f32 v163, v6, v7
  s_add_u32 s59, s67, 65536
  buffer_store_dwordx4 v[160:163], v8, s[20:23], s59 offen offset:0 sc0 sc1
  v_accvgpr_read_b32 v4, a40
  v_accvgpr_read_b32 v5, a41
  v_accvgpr_read_b32 v6, a42
  v_accvgpr_read_b32 v7, a43
  v_cvt_pk_bf16_f32 v164, v4, v5
  v_cvt_pk_bf16_f32 v165, v6, v7
  v_accvgpr_read_b32 v4, a44
  v_accvgpr_read_b32 v5, a45
  v_accvgpr_read_b32 v6, a46
  v_accvgpr_read_b32 v7, a47
  v_cvt_pk_bf16_f32 v166, v4, v5
  v_cvt_pk_bf16_f32 v167, v6, v7
  s_add_u32 s59, s67, 143360
  buffer_store_dwordx4 v[164:167], v8, s[20:23], s59 offen offset:0 sc0 sc1
  v_accvgpr_read_b32 v4, a48
  v_accvgpr_read_b32 v5, a49
  v_accvgpr_read_b32 v6, a50
  v_accvgpr_read_b32 v7, a51
  v_cvt_pk_bf16_f32 v168, v4, v5
  v_cvt_pk_bf16_f32 v169, v6, v7
  v_accvgpr_read_b32 v4, a52
  v_accvgpr_read_b32 v5, a53
  v_accvgpr_read_b32 v6, a54
  v_accvgpr_read_b32 v7, a55
  v_cvt_pk_bf16_f32 v170, v4, v5
  v_cvt_pk_bf16_f32 v171, v6, v7
  buffer_store_dwordx4 v[168:171], v8, s[20:23], s59 offen offset:1024 sc0 sc1
  v_accvgpr_read_b32 v4, a56
  v_accvgpr_read_b32 v5, a57
  v_accvgpr_read_b32 v6, a58
  v_accvgpr_read_b32 v7, a59
  v_cvt_pk_bf16_f32 v172, v4, v5
  v_cvt_pk_bf16_f32 v173, v6, v7
  v_accvgpr_read_b32 v4, a60
  v_accvgpr_read_b32 v5, a61
  v_accvgpr_read_b32 v6, a62
  v_accvgpr_read_b32 v7, a63
  v_cvt_pk_bf16_f32 v174, v4, v5
  v_cvt_pk_bf16_f32 v175, v6, v7
  buffer_store_dwordx4 v[172:175], v8, s[20:23], s59 offen offset:2048 sc0 sc1
  v_accvgpr_read_b32 v4, a64
  v_accvgpr_read_b32 v5, a65
  v_accvgpr_read_b32 v6, a66
  v_accvgpr_read_b32 v7, a67
  v_cvt_pk_bf16_f32 v176, v4, v5
  v_cvt_pk_bf16_f32 v177, v6, v7
  v_accvgpr_read_b32 v4, a68
  v_accvgpr_read_b32 v5, a69
  v_accvgpr_read_b32 v6, a70
  v_accvgpr_read_b32 v7, a71
  v_cvt_pk_bf16_f32 v178, v4, v5
  v_cvt_pk_bf16_f32 v179, v6, v7
  buffer_store_dwordx4 v[176:179], v8, s[20:23], s59 offen offset:3072 sc0 sc1
  v_accvgpr_read_b32 v4, a72
  v_accvgpr_read_b32 v5, a73
  v_accvgpr_read_b32 v6, a74
  v_accvgpr_read_b32 v7, a75
  v_cvt_pk_bf16_f32 v180, v4, v5
  v_cvt_pk_bf16_f32 v181, v6, v7
  v_accvgpr_read_b32 v4, a76
  v_accvgpr_read_b32 v5, a77
  v_accvgpr_read_b32 v6, a78
  v_accvgpr_read_b32 v7, a79
  v_cvt_pk_bf16_f32 v182, v4, v5
  v_cvt_pk_bf16_f32 v183, v6, v7
  s_add_u32 s59, s67, 147456
  buffer_store_dwordx4 v[180:183], v8, s[20:23], s59 offen offset:0 sc0 sc1
  v_accvgpr_read_b32 v4, a80
  v_accvgpr_read_b32 v5, a81
  v_accvgpr_read_b32 v6, a82
  v_accvgpr_read_b32 v7, a83
  v_cvt_pk_bf16_f32 v184, v4, v5
  v_cvt_pk_bf16_f32 v185, v6, v7
  v_accvgpr_read_b32 v4, a84
  v_accvgpr_read_b32 v5, a85
  v_accvgpr_read_b32 v6, a86
  v_accvgpr_read_b32 v7, a87
  v_cvt_pk_bf16_f32 v186, v4, v5
  v_cvt_pk_bf16_f32 v187, v6, v7
  s_add_u32 s59, s67, 225280
  buffer_store_dwordx4 v[184:187], v8, s[20:23], s59 offen offset:0 sc0 sc1
  v_accvgpr_read_b32 v4, a88
  v_accvgpr_read_b32 v5, a89
  v_accvgpr_read_b32 v6, a90
  v_accvgpr_read_b32 v7, a91
  v_cvt_pk_bf16_f32 v188, v4, v5
  v_cvt_pk_bf16_f32 v189, v6, v7
  v_accvgpr_read_b32 v4, a92
  v_accvgpr_read_b32 v5, a93
  v_accvgpr_read_b32 v6, a94
  v_accvgpr_read_b32 v7, a95
  v_cvt_pk_bf16_f32 v190, v4, v5
  v_cvt_pk_bf16_f32 v191, v6, v7
  buffer_store_dwordx4 v[188:191], v8, s[20:23], s59 offen offset:1024 sc0 sc1
  v_accvgpr_read_b32 v4, a96
  v_accvgpr_read_b32 v5, a97
  v_accvgpr_read_b32 v6, a98
  v_accvgpr_read_b32 v7, a99
  v_cvt_pk_bf16_f32 v192, v4, v5
  v_cvt_pk_bf16_f32 v193, v6, v7
  v_accvgpr_read_b32 v4, a100
  v_accvgpr_read_b32 v5, a101
  v_accvgpr_read_b32 v6, a102
  v_accvgpr_read_b32 v7, a103
  v_cvt_pk_bf16_f32 v194, v4, v5
  v_cvt_pk_bf16_f32 v195, v6, v7
  buffer_store_dwordx4 v[192:195], v8, s[20:23], s59 offen offset:2048 sc0 sc1
  v_accvgpr_read_b32 v4, a104
  v_accvgpr_read_b32 v5, a105
  v_accvgpr_read_b32 v6, a106
  v_accvgpr_read_b32 v7, a107
  v_cvt_pk_bf16_f32 v196, v4, v5
  v_cvt_pk_bf16_f32 v197, v6, v7
  v_accvgpr_read_b32 v4, a108
  v_accvgpr_read_b32 v5, a109
  v_accvgpr_read_b32 v6, a110
  v_accvgpr_read_b32 v7, a111
  v_cvt_pk_bf16_f32 v198, v4, v5
  v_cvt_pk_bf16_f32 v199, v6, v7
  buffer_store_dwordx4 v[196:199], v8, s[20:23], s59 offen offset:3072 sc0 sc1
  v_accvgpr_read_b32 v4, a112
  v_accvgpr_read_b32 v5, a113
  v_accvgpr_read_b32 v6, a114
  v_accvgpr_read_b32 v7, a115
  v_cvt_pk_bf16_f32 v200, v4, v5
  v_cvt_pk_bf16_f32 v201, v6, v7
  v_accvgpr_read_b32 v4, a116
  v_accvgpr_read_b32 v5, a117
  v_accvgpr_read_b32 v6, a118
  v_accvgpr_read_b32 v7, a119
  v_cvt_pk_bf16_f32 v202, v4, v5
  v_cvt_pk_bf16_f32 v203, v6, v7
  s_add_u32 s59, s67, 229376
  buffer_store_dwordx4 v[200:203], v8, s[20:23], s59 offen offset:0 sc0 sc1
  v_accvgpr_read_b32 v104, a120
  v_accvgpr_read_b32 v105, a121
  v_accvgpr_read_b32 v106, a122
  v_accvgpr_read_b32 v107, a123
  v_accvgpr_read_b32 v108, a124
  v_accvgpr_read_b32 v109, a125
  v_accvgpr_read_b32 v110, a126
  v_accvgpr_read_b32 v111, a127
  v_accvgpr_read_b32 v112, a128
  v_accvgpr_read_b32 v113, a129
  v_accvgpr_read_b32 v114, a130
  v_accvgpr_read_b32 v115, a131
  v_accvgpr_read_b32 v116, a132
  v_accvgpr_read_b32 v117, a133
  v_accvgpr_read_b32 v118, a134
  v_accvgpr_read_b32 v119, a135
  v_accvgpr_read_b32 v120, a136
  v_accvgpr_read_b32 v121, a137
  v_accvgpr_read_b32 v122, a138
  v_accvgpr_read_b32 v123, a139
  v_accvgpr_read_b32 v124, a140
  v_accvgpr_read_b32 v125, a141
  v_accvgpr_read_b32 v126, a142
  v_accvgpr_read_b32 v127, a143
  v_accvgpr_read_b32 v128, a144
  v_accvgpr_read_b32 v129, a145
  v_accvgpr_read_b32 v130, a146
  v_accvgpr_read_b32 v131, a147
  v_accvgpr_read_b32 v132, a148
  v_accvgpr_read_b32 v133, a149
  v_accvgpr_read_b32 v134, a150
  v_accvgpr_read_b32 v135, a151
  v_accvgpr_read_b32 v136, a152
  v_accvgpr_read_b32 v137, a153
  v_accvgpr_read_b32 v138, a154
  v_accvgpr_read_b32 v139, a155
  v_accvgpr_read_b32 v140, a156
  v_accvgpr_read_b32 v141, a157
  v_accvgpr_read_b32 v142, a158
  v_accvgpr_read_b32 v143, a159
  s_mov_b64 exec, 1
  s_waitcnt vmcnt(10)
  buffer_store_dword v2, v1, s[20:23], s70 offen offset:48 sc0 sc1
  s_waitcnt vmcnt(6)
  buffer_store_dword v2, v1, s[20:23], s70 offen offset:112 sc0 sc1
  s_waitcnt vmcnt(2)
  buffer_store_dword v2, v1, s[20:23], s70 offen offset:176 sc0 sc1
  s_mov_b64 exec, -1
  s_mov_b32 s71, 0
  s_mov_b64 exec, 7
K2_POLL3:
  buffer_load_dword v3, v8, s[20:23], s70 offen offset:192 sc0 sc1
  s_waitcnt vmcnt(0)
  v_cmp_ne_u32 vcc, 1, v3
  s_add_u32 s71, s71, 1
  s_cbranch_vccz K2_GOT3
  s_sleep 2
  s_cmp_lt_u32 s71, 100000
  s_cbranch_scc1 K2_POLL3
K2_GOT3:
  s_mov_b64 exec, -1
  s_add_u32 s59, s67, 286720
  buffer_load_dwordx4 v[64:67], v8, s[20:23], s59 offen offset:0 sc0 sc1
  buffer_load_dwordx4 v[68:71], v8, s[20:23], s59 offen offset:1024 sc0 sc1
  buffer_load_dwordx4 v[72:75], v8, s[20:23], s59 offen offset:2048 sc0 sc1
  buffer_load_dwordx4 v[76:79], v8, s[20:23], s59 offen offset:3072 sc0 sc1
  s_add_u32 s59, s67, 290816
  buffer_load_dwordx4 v[80:83], v8, s[20:23], s59 offen offset:0 sc0 sc1
  s_add_u32 s59, s67, 266240
  buffer_load_dwordx4 v[84:87], v8, s[20:23], s59 offen offset:0 sc0 sc1
  buffer_load_dwordx4 v[88:91], v8, s[20:23], s59 offen offset:1024 sc0 sc1
  buffer_load_dwordx4 v[92:95], v8, s[20:23], s59 offen offset:2048 sc0 sc1
  buffer_load_dwordx4 v[96:99], v8, s[20:23], s59 offen offset:3072 sc0 sc1
  s_add_u32 s59, s67, 270336
  buffer_load_dwordx4 v[100:103], v8, s[20:23], s59 offen offset:0 sc0 sc1
  s_add_u32 s59, s67, 245760
  buffer_load_dwordx4 v[204:207], v8, s[20:23], s59 offen offset:0 sc0 sc1
  buffer_load_dwordx4 v[208:211], v8, s[20:23], s59 offen offset:1024 sc0 sc1
  buffer_load_dwordx4 v[212:215], v8, s[20:23], s59 offen offset:2048 sc0 sc1
  buffer_load_dwordx4 v[216:219], v8, s[20:23], s59 offen offset:3072 sc0 sc1
  s_add_u32 s59, s67, 249856
  buffer_load_dwordx4 v[220:223], v8, s[20:23], s59 offen offset:0 sc0 sc1
K2_SUM:
  s_mov_b32 s46, 0xffff0000
  s_waitcnt vmcnt(10)
  v_lshlrev_b32 v4, 16, v64
  v_and_b32 v5, s46, v64
  v_add_f32 v104, v104, v4
  v_add_f32 v105, v105, v5
  v_lshlrev_b32 v4, 16, v65
  v_and_b32 v5, s46, v65
  v_add_f32 v106, v106, v4
  v_add_f32 v107, v107, v5
  v_lshlrev_b32 v4, 16, v66
  v_and_b32 v5, s46, v66
  v_add_f32 v108, v108, v4
  v_add_f32 v109, v109, v5
  v_lshlrev_b32 v4, 16, v67
  v_and_b32 v5, s46, v67
  v_add_f32 v110, v110, v4
  v_add_f32 v111, v111, v5
  v_lshlrev_b32 v4, 16, v68
  v_and_b32 v5, s46, v68
  v_add_f32 v112, v112, v4
  v_add_f32 v113, v113, v5
  v_lshlrev_b32 v4, 16, v69
  v_and_b32 v5, s46, v69
  v_add_f32 v114, v114, v4
  v_add_f32 v115, v115, v5
  v_lshlrev_b32 v4, 16, v70
  v_and_b32 v5, s46, v70
  v_add_f32 v116, v116, v4
  v_add_f32 v117, v117, v5
  v_lshlrev_b32 v4, 16, v71
  v_and_b32 v5, s46, v71
  v_add_f32 v118, v118, v4
  v_add_f32 v119, v119, v5
  v_lshlrev_b32 v4, 16, v72
  v_and_b32 v5, s46, v72
  v_add_f32 v120, v120, v4
  v_add_f32 v121, v121, v5
  v_lshlrev_b32 v4, 16, v73
  v_and_b32 v5, s46, v73
  v_add_f32 v122, v122, v4
  v_add_f32 v123, v123, v5
  v_lshlrev_b32 v4, 16, v74
  v_and_b32 v5, s46, v74
  v_add_f32 v124, v124, v4
  v_add_f32 v125, v125, v5
  v_lshlrev_b32 v4, 16, v75
  v_and_b32 v5, s46, v75
  v_add_f32 v126, v126, v4
  v_add_f32 v127, v127, v5
  v_lshlrev_b32 v4, 16, v76
  v_and_b32 v5, s46, v76
  v_add_f32 v128, v128, v4
  v_add_f32 v129, v129, v5
  v_lshlrev_b32 v4, 16, v77
  v_and_b32 v5, s46, v77
  v_add_f32 v130, v130, v4
  v_add_f32 v131, v131, v5
  v_lshlrev_b32 v4, 16, v78
  v_and_b32 v5, s46, v78
  v_add_f32 v132, v132, v4
  v_add_f32 v133, v133, v5
  v_lshlrev_b32 v4, 16, v79
  v_and_b32 v5, s46, v79
  v_add_f32 v134, v134, v4
  v_add_f32 v135, v135, v5
  v_lshlrev_b32 v4, 16, v80
  v_and_b32 v5, s46, v80
  v_add_f32 v136, v136, v4
  v_add_f32 v137, v137, v5
  v_lshlrev_b32 v4, 16, v81
  v_and_b32 v5, s46, v81
  v_add_f32 v138, v138, v4
  v_add_f32 v139, v139, v5
  v_lshlrev_b32 v4, 16, v82
  v_and_b32 v5, s46, v82
  v_add_f32 v140, v140, v4
  v_add_f32 v141, v141, v5
  v_lshlrev_b32 v4, 16, v83
  v_and_b32 v5, s46, v83
  v_add_f32 v142, v142, v4
  v_add_f32 v143, v143, v5
  s_waitcnt vmcnt(5)
  v_lshlrev_b32 v4, 16, v84
  v_and_b32 v5, s46, v84
  v_add_f32 v104, v104, v4
  v_add_f32 v105, v105, v5
  v_lshlrev_b32 v4, 16, v85
  v_and_b32 v5, s46, v85
  v_add_f32 v106, v106, v4
  v_add_f32 v107, v107, v5
  v_lshlrev_b32 v4, 16, v86
  v_and_b32 v5, s46, v86
  v_add_f32 v108, v108, v4
  v_add_f32 v109, v109, v5
  v_lshlrev_b32 v4, 16, v87
  v_and_b32 v5, s46, v87
  v_add_f32 v110, v110, v4
  v_add_f32 v111, v111, v5
  v_lshlrev_b32 v4, 16, v88
  v_and_b32 v5, s46, v88
  v_add_f32 v112, v112, v4
  v_add_f32 v113, v113, v5
  v_lshlrev_b32 v4, 16, v89
  v_and_b32 v5, s46, v89
  v_add_f32 v114, v114, v4
  v_add_f32 v115, v115, v5
  v_lshlrev_b32 v4, 16, v90
  v_and_b32 v5, s46, v90
  v_add_f32 v116, v116, v4
  v_add_f32 v117, v117, v5
  v_lshlrev_b32 v4, 16, v91
  v_and_b32 v5, s46, v91
  v_add_f32 v118, v118, v4
  v_add_f32 v119, v119, v5
  v_lshlrev_b32 v4, 16, v92
  v_and_b32 v5, s46, v92
  v_add_f32 v120, v120, v4
  v_add_f32 v121, v121, v5
  v_lshlrev_b32 v4, 16, v93
  v_and_b32 v5, s46, v93
  v_add_f32 v122, v122, v4
  v_add_f32 v123, v123, v5
  v_lshlrev_b32 v4, 16, v94
  v_and_b32 v5, s46, v94
  v_add_f32 v124, v124, v4
  v_add_f32 v125, v125, v5
  v_lshlrev_b32 v4, 16, v95
  v_and_b32 v5, s46, v95
  v_add_f32 v126, v126, v4
  v_add_f32 v127, v127, v5
  v_lshlrev_b32 v4, 16, v96
  v_and_b32 v5, s46, v96
  v_add_f32 v128, v128, v4
  v_add_f32 v129, v129, v5
  v_lshlrev_b32 v4, 16, v97
  v_and_b32 v5, s46, v97
  v_add_f32 v130, v130, v4
  v_add_f32 v131, v131, v5
  v_lshlrev_b32 v4, 16, v98
  v_and_b32 v5, s46, v98
  v_add_f32 v132, v132, v4
  v_add_f32 v133, v133, v5
  v_lshlrev_b32 v4, 16, v99
  v_and_b32 v5, s46, v99
  v_add_f32 v134, v134, v4
  v_add_f32 v135, v135, v5
  v_lshlrev_b32 v4, 16, v100
  v_and_b32 v5, s46, v100
  v_add_f32 v136, v136, v4
  v_add_f32 v137, v137, v5
  v_lshlrev_b32 v4, 16, v101
  v_and_b32 v5, s46, v101
  v_add_f32 v138, v138, v4
  v_add_f32 v139, v139, v5
  v_lshlrev_b32 v4, 16, v102
  v_and_b32 v5, s46, v102
  v_add_f32 v140, v140, v4
  v_add_f32 v141, v141, v5
  v_lshlrev_b32 v4, 16, v103
  v_and_b32 v5, s46, v103
  v_add_f32 v142, v142, v4
  v_add_f32 v143, v143, v5
  s_waitcnt vmcnt(0)
  v_lshlrev_b32 v4, 16, v204
  v_and_b32 v5, s46, v204
  v_add_f32 v104, v104, v4
  v_add_f32 v105, v105, v5
  v_lshlrev_b32 v4, 16, v205
  v_and_b32 v5, s46, v205
  v_add_f32 v106, v106, v4
  v_add_f32 v107, v107, v5
  v_lshlrev_b32 v4, 16, v206
  v_and_b32 v5, s46, v206
  v_add_f32 v108, v108, v4
  v_add_f32 v109, v109, v5
  v_lshlrev_b32 v4, 16, v207
  v_and_b32 v5, s46, v207
  v_add_f32 v110, v110, v4
  v_add_f32 v111, v111, v5
  v_lshlrev_b32 v4, 16, v208
  v_and_b32 v5, s46, v208
  v_add_f32 v112, v112, v4
  v_add_f32 v113, v113, v5
  v_lshlrev_b32 v4, 16, v209
  v_and_b32 v5, s46, v209
  v_add_f32 v114, v114, v4
  v_add_f32 v115, v115, v5
  v_lshlrev_b32 v4, 16, v210
  v_and_b32 v5, s46, v210
  v_add_f32 v116, v116, v4
  v_add_f32 v117, v117, v5
  v_lshlrev_b32 v4, 16, v211
  v_and_b32 v5, s46, v211
  v_add_f32 v118, v118, v4
  v_add_f32 v119, v119, v5
  v_lshlrev_b32 v4, 16, v212
  v_and_b32 v5, s46, v212
  v_add_f32 v120, v120, v4
  v_add_f32 v121, v121, v5
  v_lshlrev_b32 v4, 16, v213
  v_and_b32 v5, s46, v213
  v_add_f32 v122, v122, v4
  v_add_f32 v123, v123, v5
  v_lshlrev_b32 v4, 16, v214
  v_and_b32 v5, s46, v214
  v_add_f32 v124, v124, v4
  v_add_f32 v125, v125, v5
  v_lshlrev_b32 v4, 16, v215
  v_and_b32 v5, s46, v215
  v_add_f32 v126, v126, v4
  v_add_f32 v127, v127, v5
  v_lshlrev_b32 v4, 16, v216
  v_and_b32 v5, s46, v216
  v_add_f32 v128, v128, v4
  v_add_f32 v129, v129, v5
  v_lshlrev_b32 v4, 16, v217
  v_and_b32 v5, s46, v217
  v_add_f32 v130, v130, v4
  v_add_f32 v131, v131, v5
  v_lshlrev_b32 v4, 16, v218
  v_and_b32 v5, s46, v218
  v_add_f32 v132, v132, v4
  v_add_f32 v133, v133, v5
  v_lshlrev_b32 v4, 16, v219
  v_and_b32 v5, s46, v219
  v_add_f32 v134, v134, v4
  v_add_f32 v135, v135, v5
  v_lshlrev_b32 v4, 16, v220
  v_and_b32 v5, s46, v220
  v_add_f32 v136, v136, v4
  v_add_f32 v137, v137, v5
  v_lshlrev_b32 v4, 16, v221
  v_and_b32 v5, s46, v221
  v_add_f32 v138, v138, v4
  v_add_f32 v139, v139, v5
  v_lshlrev_b32 v4, 16, v222
  v_and_b32 v5, s46, v222
  v_add_f32 v140, v140, v4
  v_add_f32 v141, v141, v5
  v_lshlrev_b32 v4, 16, v223
  v_and_b32 v5, s46, v223
  v_add_f32 v142, v142, v4
  v_add_f32 v143, v143, v5
  v_cvt_pk_bf16_f32 v104, v104, v105
  v_cvt_pk_bf16_f32 v105, v106, v107
  buffer_store_dwordx2 v[104:105], v24, s[24:27], s69 offen offset:0
  v_cvt_pk_bf16_f32 v108, v108, v109
  v_cvt_pk_bf16_f32 v109, v110, v111
  buffer_store_dwordx2 v[108:109], v24, s[24:27], s69 offen offset:32
  v_cvt_pk_bf16_f32 v112, v112, v113
  v_cvt_pk_bf16_f32 v113, v114, v115
  buffer_store_dwordx2 v[112:113], v24, s[24:27], s69 offen offset:64
  v_cvt_pk_bf16_f32 v116, v116, v117
  v_cvt_pk_bf16_f32 v117, v118, v119
  buffer_store_dwordx2 v[116:117], v24, s[24:27], s69 offen offset:96
  v_cvt_pk_bf16_f32 v120, v120, v121
  v_cvt_pk_bf16_f32 v121, v122, v123
  buffer_store_dwordx2 v[120:121], v24, s[24:27], s69 offen offset:128
  v_cvt_pk_bf16_f32 v124, v124, v125
  v_cvt_pk_bf16_f32 v125, v126, v127
  buffer_store_dwordx2 v[124:125], v24, s[24:27], s69 offen offset:160
  v_cvt_pk_bf16_f32 v128, v128, v129
  v_cvt_pk_bf16_f32 v129, v130, v131
  buffer_store_dwordx2 v[128:129], v24, s[24:27], s69 offen offset:192
  v_cvt_pk_bf16_f32 v132, v132, v133
  v_cvt_pk_bf16_f32 v133, v134, v135
  buffer_store_dwordx2 v[132:133], v24, s[24:27], s69 offen offset:224
  v_cvt_pk_bf16_f32 v136, v136, v137
  v_cvt_pk_bf16_f32 v137, v138, v139
  buffer_store_dwordx2 v[136:137], v24, s[24:27], s69 offen offset:256
  v_cvt_pk_bf16_f32 v140, v140, v141
  v_cvt_pk_bf16_f32 v141, v142, v143
  buffer_store_dwordx2 v[140:141], v24, s[24:27], s69 offen offset:288
K2_END:
  s_endpgm
K1_SAFE:
  s_waitcnt vmcnt(0) lgkmcnt(0)
  s_barrier
  v_subrev_u32 v17, 49152, v17
  v_subrev_u32 v18, 49152, v18
  s_cmp_eq_u32 s56, 0
  s_cselect_b32 s16, s30, s40
  s_cselect_b32 s17, s31, s41
  s_mov_b32 s18, 393216
  s_add_u32 s16, s16, s78
  s_addc_u32 s17, s17, 0
  s_cmp_eq_u32 s56, 0
  s_cselect_b32 s20, s32, s42
  s_cselect_b32 s21, s33, s43
  s_mov_b32 s22, 393216
  s_add_u32 s20, s20, s78
  s_addc_u32 s21, s21, 0
  s_add_u32 s62, s55, 98304
  s_mov_b32 s63, s55
  s_add_u32 s64, s55, 49152
  s_mov_b32 s66, 0
  s_mov_b32 s60, 61440
  s_mov_b32 s61, 36864
  s_add_u32 m0, s55, 0
  s_mov_b32 s73, 0
  buffer_load_dwordx4 v25, s[16:19], s73 offen offset:0 nt lds
  buffer_load_dwordx4 v26, s[16:19], s73 offen offset:1024 nt lds
  buffer_load_dwordx4 v27, s[16:19], s73 offen offset:2048 nt lds
  s_add_u32 m0, s55, 24576
  s_mov_b32 s73, 12288
  buffer_load_dwordx4 v25, s[16:19], s73 offen offset:0 nt lds
  buffer_load_dwordx4 v26, s[16:19], s73 offen offset:1024 nt lds
  buffer_load_dwordx4 v27, s[16:19], s73 offen offset:2048 nt lds
  s_add_u32 m0, s55, 49152
  s_mov_b32 s73, 24576
  buffer_load_dwordx4 v25, s[16:19], s73 offen offset:0 nt lds
  buffer_load_dwordx4 v26, s[16:19], s73 offen offset:1024 nt lds
  buffer_load_dwordx4 v27, s[16:19], s73 offen offset:2048 nt lds
  s_add_u32 m0, s55, 12288
  s_mov_b32 s73, 0
  buffer_load_dwordx4 v25, s[20:23], s73 offen offset:0 nt lds
  buffer_load_dwordx4 v26, s[20:23], s73 offen offset:1024 nt lds
  buffer_load_dwordx4 v27, s[20:23], s73 offen offset:2048 nt lds
  s_add_u32 m0, s55, 73728
  s_mov_b32 s73, 36864
  buffer_load_dwordx4 v25, s[16:19], s73 offen offset:0 nt lds
  buffer_load_dwordx4 v26, s[16:19], s73 offen offset:1024 nt lds
  buffer_load_dwordx4 v27, s[16:19], s73 offen offset:2048 nt lds
  s_add_u32 m0, s55, 36864
  s_mov_b32 s73, 12288
  buffer_load_dwordx4 v25, s[20:23], s73 offen offset:0 nt lds
  buffer_load_dwordx4 v26, s[20:23], s73 offen offset:1024 nt lds
  buffer_load_dwordx4 v27, s[20:23], s73 offen offset:2048 nt lds
  s_add_u32 m0, s55, 98304
  s_mov_b32 s73, 49152
  buffer_load_dwordx4 v25, s[16:19], s73 offen offset:0 nt lds
  buffer_load_dwordx4 v26, s[16:19], s73 offen offset:1024 nt lds
  buffer_load_dwordx4 v27, s[16:19], s73 offen offset:2048 nt lds
  s_add_u32 m0, s55, 61440
  s_mov_b32 s73, 24576
  buffer_load_dwordx4 v25, s[20:23], s73 offen offset:0 nt lds
  buffer_load_dwordx4 v26, s[20:23], s73 offen offset:1024 nt lds
  buffer_load_dwordx4 v27, s[20:23], s73 offen offset:2048 nt lds
  s_waitcnt vmcnt(21)
  s_barrier
  ds_read_b128 a[192:195], v17 offset:0
  ds_read_b128 a[196:199], v18 offset:0
  ds_read_b128 a[200:203], v17 offset:128
  ds_read_b128 a[204:207], v18 offset:128
  ds_read_b128 a[208:211], v17 offset:256
  s_waitcnt lgkmcnt(3)
  v_mfma_f32_16x16x32_bf16 v[96:99], a[192:195], v[160:163], 0
  ds_read_b128 a[212:215], v18 offset:256
  s_add_u32 m0, s62, 24576
  v_mfma_f32_16x16x32_bf16 v[100:103], a[192:195], v[184:187], 0
  buffer_load_dwordx4 v25, s[16:19], s60 offen offset:0 nt lds
  v_mfma_f32_16x16x32_bf16 v[104:107], a[192:195], v[208:211], 0
  v_mfma_f32_16x16x32_bf16 v[108:111], a[192:195], v[232:235], 0
  v_mfma_f32_16x16x32_bf16 v[96:99], a[196:199], v[164:167], v[96:99]
  ds_read_b128 a[216:219], v17 offset:6144
  v_mfma_f32_16x16x32_bf16 v[100:103], a[196:199], v[188:191], v[100:103]
  v_mfma_f32_16x16x32_bf16 v[104:107], a[196:199], v[212:215], v[104:107]
  v_mfma_f32_16x16x32_bf16 v[108:111], a[196:199], v[236:239], v[108:111]
  buffer_load_dwordx4 v26, s[16:19], s60 offen offset:1024 nt lds
  s_waitcnt lgkmcnt(3)
  v_mfma_f32_16x16x32_bf16 v[96:99], a[200:203], v[168:171], v[96:99]
  ds_read_b128 a[220:223], v18 offset:6144
  v_mfma_f32_16x16x32_bf16 v[100:103], a[200:203], v[192:195], v[100:103]
  v_mfma_f32_16x16x32_bf16 v[104:107], a[200:203], v[216:219], v[104:107]
  v_mfma_f32_16x16x32_bf16 v[108:111], a[200:203], v[240:243], v[108:111]
  v_mfma_f32_16x16x32_bf16 v[96:99], a[204:207], v[172:175], v[96:99]
  ds_read_b128 a[224:227], v17 offset:6272
  v_mfma_f32_16x16x32_bf16 v[100:103], a[204:207], v[196:199], v[100:103]
  buffer_load_dwordx4 v27, s[16:19], s60 offen offset:2048 nt lds
  v_mfma_f32_16x16x32_bf16 v[104:107], a[204:207], v[220:223], v[104:107]
  s_add_u32 s60, s60, 12288
  s_add_u32 m0, s64, 36864
  v_mfma_f32_16x16x32_bf16 v[108:111], a[204:207], v[244:247], v[108:111]
  s_waitcnt lgkmcnt(3)
  v_mfma_f32_16x16x32_bf16 v[96:99], a[208:211], v[176:179], v[96:99]
  ds_read_b128 a[228:231], v18 offset:6272
  v_mfma_f32_16x16x32_bf16 v[100:103], a[208:211], v[200:203], v[100:103]
  v_mfma_f32_16x16x32_bf16 v[104:107], a[208:211], v[224:227], v[104:107]
  v_mfma_f32_16x16x32_bf16 v[108:111], a[208:211], v[248:251], v[108:111]
  buffer_load_dwordx4 v25, s[20:23], s61 offen offset:0 nt lds
  v_mfma_f32_16x16x32_bf16 v[96:99], a[212:215], v[180:183], v[96:99]
  ds_read_b128 a[232:235], v17 offset:6400
  v_mfma_f32_16x16x32_bf16 v[100:103], a[212:215], v[204:207], v[100:103]
  v_mfma_f32_16x16x32_bf16 v[104:107], a[212:215], v[228:231], v[104:107]
  v_mfma_f32_16x16x32_bf16 v[108:111], a[212:215], v[252:255], v[108:111]
  s_waitcnt lgkmcnt(3)
  v_mfma_f32_16x16x32_bf16 v[112:115], a[216:219], v[160:163], 0
  ds_read_b128 a[236:239], v18 offset:6400
  v_mfma_f32_16x16x32_bf16 v[116:119], a[216:219], v[184:187], 0
  buffer_load_dwordx4 v26, s[20:23], s61 offen offset:1024 nt lds
  v_mfma_f32_16x16x32_bf16 v[120:123], a[216:219], v[208:211], 0
  v_mfma_f32_16x16x32_bf16 v[124:127], a[216:219], v[232:235], 0
  v_mfma_f32_16x16x32_bf16 v[112:115], a[220:223], v[164:167], v[112:115]
  v_mfma_f32_16x16x32_bf16 v[116:119], a[220:223], v[188:191], v[116:119]
  v_mfma_f32_16x16x32_bf16 v[120:123], a[220:223], v[212:215], v[120:123]
  v_mfma_f32_16x16x32_bf16 v[124:127], a[220:223], v[236:239], v[124:127]
  buffer_load_dwordx4 v27, s[20:23], s61 offen offset:2048 nt lds
  s_waitcnt lgkmcnt(2)
  v_mfma_f32_16x16x32_bf16 v[112:115], a[224:227], v[168:171], v[112:115]
  s_add_u32 s61, s61, 12288
  v_mfma_f32_16x16x32_bf16 v[116:119], a[224:227], v[192:195], v[116:119]
  v_mfma_f32_16x16x32_bf16 v[120:123], a[224:227], v[216:219], v[120:123]
  v_mfma_f32_16x16x32_bf16 v[124:127], a[224:227], v[240:243], v[124:127]
  v_mfma_f32_16x16x32_bf16 v[112:115], a[228:231], v[172:175], v[112:115]
  v_mfma_f32_16x16x32_bf16 v[116:119], a[228:231], v[196:199], v[116:119]
  v_mfma_f32_16x16x32_bf16 v[120:123], a[228:231], v[220:223], v[120:123]
  v_mfma_f32_16x16x32_bf16 v[124:127], a[228:231], v[244:247], v[124:127]
  s_waitcnt lgkmcnt(0)
  v_mfma_f32_16x16x32_bf16 v[112:115], a[232:235], v[176:179], v[112:115]
  v_mfma_f32_16x16x32_bf16 v[116:119], a[232:235], v[200:203], v[116:119]
  v_mfma_f32_16x16x32_bf16 v[120:123], a[232:235], v[224:227], v[120:123]
  v_mfma_f32_16x16x32_bf16 v[124:127], a[232:235], v[248:251], v[124:127]
  v_mfma_f32_16x16x32_bf16 v[112:115], a[236:239], v[180:183], v[112:115]
  v_mfma_f32_16x16x32_bf16 v[116:119], a[236:239], v[204:207], v[116:119]
  v_mfma_f32_16x16x32_bf16 v[120:123], a[236:239], v[228:231], v[120:123]
  v_mfma_f32_16x16x32_bf16 v[124:127], a[236:239], v[252:255], v[124:127]
  s_nop 7
  s_nop 3
  s_waitcnt vmcnt(18)
  s_barrier
  ds_read_b128 a[192:195], v17 offset:24576
  ds_read_b128 a[196:199], v18 offset:24576
  ds_read_b128 a[200:203], v17 offset:24704
  ds_read_b128 a[204:207], v18 offset:24704
  ds_read_b128 a[208:211], v17 offset:24832
  v_max3_f32 v92, v96, v97, v98
  v_max3_f32 v92, v92, v99, v112
  v_max3_f32 v92, v92, v113, v114
  v_max_f32 v92, v92, v115
  v_mov_b32 v1, v92
  s_nop 1
  v_permlane32_swap_b32 v92, v1
  v_max_f32 v92, v92, v1
  v_mov_b32 v1, v92
  s_nop 1
  v_permlane16_swap_b32 v92, v1
  v_max_f32 v92, v92, v1
  v_mov_b32 v84, v92
  v_sub_f32 v88, 0, v92
  v_mov_b32 v80, 0
  v_add_f32 v33, 0x41000000, v92
  v_mov_b32 v29, 1.0
  v_max3_f32 v93, v100, v101, v102
  v_max3_f32 v93, v93, v103, v116
  v_max3_f32 v93, v93, v117, v118
  v_max_f32 v93, v93, v119
  v_mov_b32 v2, v93
  s_nop 1
  v_permlane32_swap_b32 v93, v2
  v_max_f32 v93, v93, v2
  v_mov_b32 v2, v93
  s_nop 1
  v_permlane16_swap_b32 v93, v2
  v_max_f32 v93, v93, v2
  v_mov_b32 v85, v93
  v_sub_f32 v89, 0, v93
  v_mov_b32 v81, 0
  v_add_f32 v34, 0x41000000, v93
  v_mov_b32 v30, 1.0
  v_max3_f32 v94, v104, v105, v106
  v_max3_f32 v94, v94, v107, v120
  v_max3_f32 v94, v94, v121, v122
  v_max_f32 v94, v94, v123
  v_mov_b32 v3, v94
  s_nop 1
  v_permlane32_swap_b32 v94, v3
  v_max_f32 v94, v94, v3
  v_mov_b32 v3, v94
  s_nop 1
  v_permlane16_swap_b32 v94, v3
  v_max_f32 v94, v94, v3
  v_mov_b32 v86, v94
  v_sub_f32 v90, 0, v94
  v_mov_b32 v82, 0
  v_add_f32 v35, 0x41000000, v94
  v_mov_b32 v31, 1.0
  v_max3_f32 v95, v108, v109, v110
  v_max3_f32 v95, v95, v111, v124
  v_max3_f32 v95, v95, v125, v126
  v_max_f32 v95, v95, v127
  v_mov_b32 v4, v95
  s_nop 1
  v_permlane32_swap_b32 v95, v4
  v_max_f32 v95, v95, v4
  v_mov_b32 v4, v95
  s_nop 1
  v_permlane16_swap_b32 v95, v4
  v_max_f32 v95, v95, v4
  v_mov_b32 v87, v95
  v_sub_f32 v91, 0, v95
  v_mov_b32 v83, 0
  v_add_f32 v36, 0x41000000, v95
  v_mov_b32 v32, 1.0
  v_add_f32 v96, v96, v88
  v_add_f32 v97, v97, v88
  v_add_f32 v98, v98, v88
  v_add_f32 v99, v99, v88
  v_add_f32 v100, v100, v89
  v_add_f32 v101, v101, v89
  v_add_f32 v102, v102, v89
  v_add_f32 v103, v103, v89
  v_add_f32 v104, v104, v90
  v_add_f32 v105, v105, v90
  v_add_f32 v106, v106, v90
  v_add_f32 v107, v107, v90
  v_add_f32 v108, v108, v91
  v_add_f32 v109, v109, v91
  v_add_f32 v110, v110, v91
  v_add_f32 v111, v111, v91
  v_add_f32 v112, v112, v88
  v_add_f32 v113, v113, v88
  v_add_f32 v114, v114, v88
  v_add_f32 v115, v115, v88
  v_add_f32 v116, v116, v89
  v_add_f32 v117, v117, v89
  v_add_f32 v118, v118, v89
  v_add_f32 v119, v119, v89
  v_add_f32 v120, v120, v90
  v_add_f32 v121, v121, v90
  v_add_f32 v122, v122, v90
  v_add_f32 v123, v123, v90
  v_add_f32 v124, v124, v91
  v_add_f32 v125, v125, v91
  v_add_f32 v126, v126, v91
  v_add_f32 v127, v127, v91
  v_exp_f32 v96, v96
  v_exp_f32 v97, v97
  v_exp_f32 v98, v98
  v_exp_f32 v99, v99
  v_exp_f32 v100, v100
  v_exp_f32 v101, v101
  v_exp_f32 v102, v102
  v_exp_f32 v103, v103
  s_waitcnt lgkmcnt(3)
  v_mfma_f32_16x16x32_bf16 v[128:131], a[192:195], v[160:163], 0
  ds_read_b128 a[212:215], v18 offset:24832
  s_mov_b32 m0, s63
  v_mfma_f32_16x16x32_bf16 v[132:135], a[192:195], v[184:187], 0
  buffer_load_dwordx4 v25, s[16:19], s60 offen offset:0 nt lds
  v_mfma_f32_16x16x32_bf16 v[136:139], a[192:195], v[208:211], 0
  v_exp_f32 v104, v104
  v_mfma_f32_16x16x32_bf16 v[140:143], a[192:195], v[232:235], 0
  v_exp_f32 v105, v105
  v_mfma_f32_16x16x32_bf16 v[128:131], a[196:199], v[164:167], v[128:131]
  ds_read_b128 a[216:219], v17 offset:30720
  v_add_f32 v80, v80, v96
  v_mfma_f32_16x16x32_bf16 v[132:135], a[196:199], v[188:191], v[132:135]
  v_exp_f32 v106, v106
  v_mfma_f32_16x16x32_bf16 v[136:139], a[196:199], v[212:215], v[136:139]
  v_add_f32 v80, v80, v97
  v_mfma_f32_16x16x32_bf16 v[140:143], a[196:199], v[236:239], v[140:143]
  buffer_load_dwordx4 v26, s[16:19], s60 offen offset:1024 nt lds
  s_waitcnt lgkmcnt(3)
  v_mfma_f32_16x16x32_bf16 v[128:131], a[200:203], v[168:171], v[128:131]
  ds_read_b128 a[220:223], v18 offset:30720
  v_mfma_f32_16x16x32_bf16 v[132:135], a[200:203], v[192:195], v[132:135]
  v_exp_f32 v107, v107
  v_mfma_f32_16x16x32_bf16 v[136:139], a[200:203], v[216:219], v[136:139]
  v_add_f32 v80, v80, v98
  v_mfma_f32_16x16x32_bf16 v[140:143], a[200:203], v[240:243], v[140:143]
  v_exp_f32 v108, v108
  v_mfma_f32_16x16x32_bf16 v[128:131], a[204:207], v[172:175], v[128:131]
  ds_read_b128 a[224:227], v17 offset:30848
  v_add_f32 v80, v80, v99
  v_mfma_f32_16x16x32_bf16 v[132:135], a[204:207], v[196:199], v[132:135]
  buffer_load_dwordx4 v27, s[16:19], s60 offen offset:2048 nt lds
  v_mfma_f32_16x16x32_bf16 v[136:139], a[204:207], v[220:223], v[136:139]
  s_add_u32 s60, s60, 12288
  s_add_u32 m0, s62, 12288
  v_exp_f32 v109, v109
  v_mfma_f32_16x16x32_bf16 v[140:143], a[204:207], v[244:247], v[140:143]
  v_add_f32 v81, v81, v100
  s_waitcnt lgkmcnt(3)
  v_mfma_f32_16x16x32_bf16 v[128:131], a[208:211], v[176:179], v[128:131]
  ds_read_b128 a[228:231], v18 offset:30848
  v_mfma_f32_16x16x32_bf16 v[132:135], a[208:211], v[200:203], v[132:135]
  v_exp_f32 v110, v110
  v_mfma_f32_16x16x32_bf16 v[136:139], a[208:211], v[224:227], v[136:139]
  v_add_f32 v81, v81, v101
  v_mfma_f32_16x16x32_bf16 v[140:143], a[208:211], v[248:251], v[140:143]
  buffer_load_dwordx4 v25, s[20:23], s61 offen offset:0 nt lds
  v_mfma_f32_16x16x32_bf16 v[128:131], a[212:215], v[180:183], v[128:131]
  ds_read_b128 a[232:235], v17 offset:30976
  v_mfma_f32_16x16x32_bf16 v[132:135], a[212:215], v[204:207], v[132:135]
  v_exp_f32 v111, v111
  v_mfma_f32_16x16x32_bf16 v[136:139], a[212:215], v[228:231], v[136:139]
  v_add_f32 v81, v81, v102
  v_mfma_f32_16x16x32_bf16 v[140:143], a[212:215], v[252:255], v[140:143]
  v_exp_f32 v112, v112
  s_waitcnt lgkmcnt(3)
  v_mfma_f32_16x16x32_bf16 v[144:147], a[216:219], v[160:163], 0
  ds_read_b128 a[236:239], v18 offset:30976
  v_add_f32 v81, v81, v103
  v_mfma_f32_16x16x32_bf16 v[148:151], a[216:219], v[184:187], 0
  buffer_load_dwordx4 v26, s[20:23], s61 offen offset:1024 nt lds
  v_mfma_f32_16x16x32_bf16 v[152:155], a[216:219], v[208:211], 0
  v_exp_f32 v113, v113
  v_mfma_f32_16x16x32_bf16 v[156:159], a[216:219], v[232:235], 0
  v_add_f32 v82, v82, v104
  v_mfma_f32_16x16x32_bf16 v[144:147], a[220:223], v[164:167], v[144:147]
  ds_read_b64_tr_b16 a[192:193], v21 offset:12288
  v_mfma_f32_16x16x32_bf16 v[148:151], a[220:223], v[188:191], v[148:151]
  v_exp_f32 v114, v114
  v_mfma_f32_16x16x32_bf16 v[152:155], a[220:223], v[212:215], v[152:155]
  ds_read_b64_tr_b16 a[194:195], v21 offset:18432
  v_add_f32 v82, v82, v105
  v_mfma_f32_16x16x32_bf16 v[156:159], a[220:223], v[236:239], v[156:159]
  buffer_load_dwordx4 v27, s[20:23], s61 offen offset:2048 nt lds
  s_waitcnt lgkmcnt(4)
  v_mfma_f32_16x16x32_bf16 v[144:147], a[224:227], v[168:171], v[144:147]
  ds_read_b64_tr_b16 a[196:197], v22 offset:12288
  s_add_u32 s61, s61, 12288
  v_mfma_f32_16x16x32_bf16 v[148:151], a[224:227], v[192:195], v[148:151]
  v_exp_f32 v115, v115
  v_mfma_f32_16x16x32_bf16 v[152:155], a[224:227], v[216:219], v[152:155]
  ds_read_b64_tr_b16 a[198:199], v22 offset:18432
  v_add_f32 v82, v82, v106
  v_mfma_f32_16x16x32_bf16 v[156:159], a[224:227], v[240:243], v[156:159]
  v_exp_f32 v116, v116
  v_mfma_f32_16x16x32_bf16 v[144:147], a[228:231], v[172:175], v[144:147]
  ds_read_b64_tr_b16 a[200:201], v23 offset:12288
  v_add_f32 v82, v82, v107
  v_mfma_f32_16x16x32_bf16 v[148:151], a[228:231], v[196:199], v[148:151]
  v_exp_f32 v117, v117
  v_mfma_f32_16x16x32_bf16 v[152:155], a[228:231], v[220:223], v[152:155]
  ds_read_b64_tr_b16 a[202:203], v23 offset:18432
  v_add_f32 v83, v83, v108
  v_mfma_f32_16x16x32_bf16 v[156:159], a[228:231], v[244:247], v[156:159]
  v_exp_f32 v118, v118
  s_waitcnt lgkmcnt(6)
  v_mfma_f32_16x16x32_bf16 v[144:147], a[232:235], v[176:179], v[144:147]
  ds_read_b64_tr_b16 a[204:205], v24 offset:12288
  v_add_f32 v83, v83, v109
  v_mfma_f32_16x16x32_bf16 v[148:151], a[232:235], v[200:203], v[148:151]
  v_exp_f32 v119, v119
  v_mfma_f32_16x16x32_bf16 v[152:155], a[232:235], v[224:227], v[152:155]
  ds_read_b64_tr_b16 a[206:207], v24 offset:18432
  v_add_f32 v83, v83, v110
  v_mfma_f32_16x16x32_bf16 v[156:159], a[232:235], v[248:251], v[156:159]
  v_exp_f32 v120, v120
  v_mfma_f32_16x16x32_bf16 v[144:147], a[236:239], v[180:183], v[144:147]
  ds_read_b64_tr_b16 a[208:209], v21 offset:12416
  v_add_f32 v83, v83, v111
  v_mfma_f32_16x16x32_bf16 v[148:151], a[236:239], v[204:207], v[148:151]
  v_exp_f32 v121, v121
  v_mfma_f32_16x16x32_bf16 v[152:155], a[236:239], v[228:231], v[152:155]
  ds_read_b64_tr_b16 a[210:211], v21 offset:18560
  v_add_f32 v80, v80, v112
  v_mfma_f32_16x16x32_bf16 v[156:159], a[236:239], v[252:255], v[156:159]
  v_exp_f32 v122, v122
  v_add_f32 v80, v80, v113
  v_exp_f32 v123, v123
  v_add_f32 v80, v80, v114
  v_exp_f32 v124, v124
  v_add_f32 v80, v80, v115
  v_exp_f32 v125, v125
  v_add_f32 v81, v81, v116
  v_exp_f32 v126, v126
  v_add_f32 v81, v81, v117
  v_exp_f32 v127, v127
  v_add_f32 v81, v81, v118
  v_add_f32 v81, v81, v119
  v_add_f32 v82, v82, v120
  v_add_f32 v82, v82, v121
  v_add_f32 v82, v82, v122
  v_add_f32 v82, v82, v123
  v_add_f32 v83, v83, v124
  v_add_f32 v83, v83, v125
  v_add_f32 v83, v83, v126
  v_add_f32 v83, v83, v127
  v_cvt_pk_bf16_f32 v48, v96, v97
  v_cvt_pk_bf16_f32 v49, v98, v99
  v_cvt_pk_bf16_f32 v52, v100, v101
  v_cvt_pk_bf16_f32 v53, v102, v103
  v_cvt_pk_bf16_f32 v56, v104, v105
  v_cvt_pk_bf16_f32 v57, v106, v107
  v_cvt_pk_bf16_f32 v60, v108, v109
  v_cvt_pk_bf16_f32 v61, v110, v111
  v_cvt_pk_bf16_f32 v50, v112, v113
  v_cvt_pk_bf16_f32 v51, v114, v115
  v_cvt_pk_bf16_f32 v54, v116, v117
  v_cvt_pk_bf16_f32 v55, v118, v119
  v_cvt_pk_bf16_f32 v58, v120, v121
  v_cvt_pk_bf16_f32 v59, v122, v123
  v_cvt_pk_bf16_f32 v62, v124, v125
  v_cvt_pk_bf16_f32 v63, v126, v127
  s_waitcnt lgkmcnt(6)
  v_mfma_f32_16x16x32_bf16 a[0:3], a[192:195], v[48:51], 0
  ds_read_b64_tr_b16 a[212:213], v22 offset:12416
  s_sub_u32 s79, s64, s63
  v_add_u32 v17, s79, v17
  v_mfma_f32_16x16x32_bf16 a[4:7], a[192:195], v[52:55], 0
  v_add_u32 v18, s79, v18
  v_mfma_f32_16x16x32_bf16 a[8:11], a[192:195], v[56:59], 0
  ds_read_b64_tr_b16 a[214:215], v22 offset:18560
  v_mfma_f32_16x16x32_bf16 a[12:15], a[192:195], v[60:63], 0
  v_mfma_f32_16x16x32_bf16 a[16:19], a[196:199], v[48:51], 0
  ds_read_b64_tr_b16 a[216:217], v23 offset:12416
  v_mfma_f32_16x16x32_bf16 a[20:23], a[196:199], v[52:55], 0
  v_mfma_f32_16x16x32_bf16 a[24:27], a[196:199], v[56:59], 0
  ds_read_b64_tr_b16 a[218:219], v23 offset:18560
  v_mfma_f32_16x16x32_bf16 a[28:31], a[196:199], v[60:63], 0
  s_waitcnt lgkmcnt(6)
  v_mfma_f32_16x16x32_bf16 a[32:35], a[200:203], v[48:51], 0
  ds_read_b64_tr_b16 a[220:221], v24 offset:12416
  v_max3_f32 v92, v128, v129, v130
  v_mfma_f32_16x16x32_bf16 a[36:39], a[200:203], v[52:55], 0
  v_max3_f32 v92, v92, v131, v144
  v_max3_f32 v92, v92, v145, v146
  v_mfma_f32_16x16x32_bf16 a[40:43], a[200:203], v[56:59], 0
  ds_read_b64_tr_b16 a[222:223], v24 offset:18560
  v_max_f32 v92, v92, v147
  v_mfma_f32_16x16x32_bf16 a[44:47], a[200:203], v[60:63], 0
  v_cmp_gt_f32 vcc, v92, v33
  s_cbranch_vccnz RARE_20_0
RET_20_0:
  v_max3_f32 v93, v132, v133, v134
  v_mfma_f32_16x16x32_bf16 a[48:51], a[204:207], v[48:51], 0
  ds_read_b64_tr_b16 a[224:225], v21 offset:12544
  v_max3_f32 v93, v93, v135, v148
  v_mfma_f32_16x16x32_bf16 a[52:55], a[204:207], v[52:55], 0
  v_max3_f32 v93, v93, v149, v150
  v_max_f32 v93, v93, v151
  v_mfma_f32_16x16x32_bf16 a[56:59], a[204:207], v[56:59], 0
  ds_read_b64_tr_b16 a[226:227], v21 offset:18688
  v_cmp_gt_f32 vcc, v93, v34
  v_mfma_f32_16x16x32_bf16 a[60:63], a[204:207], v[60:63], 0
  s_cbranch_vccnz RARE_20_1
RET_20_1:
  v_max3_f32 v94, v136, v137, v138
  v_max3_f32 v94, v94, v139, v152
  s_waitcnt lgkmcnt(6)
  v_mfma_f32_16x16x32_bf16 a[64:67], a[208:211], v[48:51], 0
  ds_read_b64_tr_b16 a[228:229], v22 offset:12544
  v_max3_f32 v94, v94, v153, v154
  v_mfma_f32_16x16x32_bf16 a[68:71], a[208:211], v[52:55], 0
  v_max_f32 v94, v94, v155
  v_cmp_gt_f32 vcc, v94, v35
  v_mfma_f32_16x16x32_bf16 a[72:75], a[208:211], v[56:59], 0
  ds_read_b64_tr_b16 a[230:231], v22 offset:18688
  s_cbranch_vccnz RARE_20_2
RET_20_2:
  v_max3_f32 v95, v140, v141, v142
  v_mfma_f32_16x16x32_bf16 a[76:79], a[208:211], v[60:63], 0
  v_max3_f32 v95, v95, v143, v156
  v_max3_f32 v95, v95, v157, v158
  v_mfma_f32_16x16x32_bf16 a[80:83], a[212:215], v[48:51], 0
  ds_read_b64_tr_b16 a[232:233], v23 offset:12544
  s_waitcnt vmcnt(18)
  s_barrier
  v_max_f32 v95, v95, v159
  v_mfma_f32_16x16x32_bf16 a[84:87], a[212:215], v[52:55], 0
  v_cmp_gt_f32 vcc, v95, v36
  s_cbranch_vccnz RARE_20_3
RET_20_3:
  v_add_f32 v128, v128, v88
  v_mfma_f32_16x16x32_bf16 a[88:91], a[212:215], v[56:59], 0
  ds_read_b64_tr_b16 a[234:235], v23 offset:18688
  v_add_f32 v129, v129, v88
  v_mfma_f32_16x16x32_bf16 a[92:95], a[212:215], v[60:63], 0
  v_add_f32 v130, v130, v88
  v_add_f32 v131, v131, v88
  s_waitcnt lgkmcnt(6)
  v_mfma_f32_16x16x32_bf16 a[96:99], a[216:219], v[48:51], 0
  ds_read_b64_tr_b16 a[236:237], v24 offset:12544
  v_add_f32 v132, v132, v89
  v_mfma_f32_16x16x32_bf16 a[100:103], a[216:219], v[52:55], 0
  v_add_f32 v133, v133, v89
  v_add_f32 v134, v134, v89
  v_mfma_f32_16x16x32_bf16 a[104:107], a[216:219], v[56:59], 0
  ds_read_b64_tr_b16 a[238:239], v24 offset:18688
  v_add_f32 v135, v135, v89
  v_mfma_f32_16x16x32_bf16 a[108:111], a[216:219], v[60:63], 0
  v_add_f32 v136, v136, v90
  v_add_f32 v137, v137, v90
  v_mfma_f32_16x16x32_bf16 a[112:115], a[220:223], v[48:51], 0
  ds_read_b128 a[192:195], v17 offset:0
  v_add_f32 v138, v138, v90
  v_mfma_f32_16x16x32_bf16 a[116:119], a[220:223], v[52:55], 0
  v_add_f32 v139, v139, v90
  v_add_f32 v140, v140, v91
  v_mfma_f32_16x16x32_bf16 a[120:123], a[220:223], v[56:59], 0
  v_add_f32 v141, v141, v91
  v_add_f32 v142, v142, v91
  v_mfma_f32_16x16x32_bf16 a[124:127], a[220:223], v[60:63], 0
  v_add_f32 v143, v143, v91
  v_add_f32 v144, v144, v88
  s_waitcnt lgkmcnt(5)
  v_mfma_f32_16x16x32_bf16 a[128:131], a[224:227], v[48:51], 0
  ds_read_b128 a[196:199], v18 offset:0
  v_add_f32 v145, v145, v88
  v_mfma_f32_16x16x32_bf16 a[132:135], a[224:227], v[52:55], 0
  v_add_f32 v146, v146, v88
  v_add_f32 v147, v147, v88
  v_mfma_f32_16x16x32_bf16 a[136:139], a[224:227], v[56:59], 0
  v_add_f32 v148, v148, v89
  v_add_f32 v149, v149, v89
  v_mfma_f32_16x16x32_bf16 a[140:143], a[224:227], v[60:63], 0
  v_add_f32 v150, v150, v89
  v_add_f32 v151, v151, v89
  v_mfma_f32_16x16x32_bf16 a[144:147], a[228:231], v[48:51], 0
  ds_read_b128 a[200:203], v17 offset:128
  v_add_f32 v152, v152, v90
  v_mfma_f32_16x16x32_bf16 a[148:151], a[228:231], v[52:55], 0
  v_add_f32 v153, v153, v90
  v_add_f32 v154, v154, v90
  v_mfma_f32_16x16x32_bf16 a[152:155], a[228:231], v[56:59], 0
  v_add_f32 v155, v155, v90
  v_add_f32 v156, v156, v91
  v_mfma_f32_16x16x32_bf16 a[156:159], a[228:231], v[60:63], 0
  v_add_f32 v157, v157, v91
  v_add_f32 v158, v158, v91
  s_waitcnt lgkmcnt(3)
  v_mfma_f32_16x16x32_bf16 a[160:163], a[232:235], v[48:51], 0
  ds_read_b128 a[204:207], v18 offset:128
  v_add_f32 v159, v159, v91
  v_mfma_f32_16x16x32_bf16 a[164:167], a[232:235], v[52:55], 0
  v_exp_f32 v128, v128
  v_mfma_f32_16x16x32_bf16 a[168:171], a[232:235], v[56:59], 0
  v_exp_f32 v129, v129
  v_mfma_f32_16x16x32_bf16 a[172:175], a[232:235], v[60:63], 0
  v_exp_f32 v130, v130
  v_mfma_f32_16x16x32_bf16 a[176:179], a[236:239], v[48:51], 0
  ds_read_b128 a[208:211], v17 offset:256
  v_mfma_f32_16x16x32_bf16 a[180:183], a[236:239], v[52:55], 0
  v_exp_f32 v131, v131
  v_mfma_f32_16x16x32_bf16 a[184:187], a[236:239], v[56:59], 0
  v_exp_f32 v132, v132
  v_mfma_f32_16x16x32_bf16 a[188:191], a[236:239], v[60:63], 0
  v_exp_f32 v133, v133
  v_exp_f32 v134, v134
  v_exp_f32 v135, v135
  s_cmp_lg_u32 s66, 0
  s_mov_b32 s67, 20
  s_cbranch_scc1 RESCALE
RESC_RET_20:
  s_mov_b32 s68, s62
  s_mov_b32 s62, s63
  s_mov_b32 s63, s64
  s_mov_b32 s64, s68
  s_mov_b32 s65, 15
K1_SLOOP:
  s_waitcnt lgkmcnt(3)
  v_mfma_f32_16x16x32_bf16 v[96:99], a[192:195], v[160:163], 0
  ds_read_b128 a[212:215], v18 offset:256
  s_add_u32 m0, s62, 24576
  v_mfma_f32_16x16x32_bf16 v[100:103], a[192:195], v[184:187], 0
  buffer_load_dwordx4 v25, s[16:19], s60 offen offset:0 nt lds
  v_mfma_f32_16x16x32_bf16 v[104:107], a[192:195], v[208:211], 0
  v_exp_f32 v136, v136
  v_mfma_f32_16x16x32_bf16 v[108:111], a[192:195], v[232:235], 0
  v_exp_f32 v137, v137
  v_mfma_f32_16x16x32_bf16 v[96:99], a[196:199], v[164:167], v[96:99]
  ds_read_b128 a[216:219], v17 offset:6144
  v_add_f32 v80, v80, v128
  v_mfma_f32_16x16x32_bf16 v[100:103], a[196:199], v[188:191], v[100:103]
  v_exp_f32 v138, v138
  v_mfma_f32_16x16x32_bf16 v[104:107], a[196:199], v[212:215], v[104:107]
  v_add_f32 v80, v80, v129
  v_mfma_f32_16x16x32_bf16 v[108:111], a[196:199], v[236:239], v[108:111]
  buffer_load_dwordx4 v26, s[16:19], s60 offen offset:1024 nt lds
  s_waitcnt lgkmcnt(3)
  v_mfma_f32_16x16x32_bf16 v[96:99], a[200:203], v[168:171], v[96:99]
  ds_read_b128 a[220:223], v18 offset:6144
  v_mfma_f32_16x16x32_bf16 v[100:103], a[200:203], v[192:195], v[100:103]
  v_exp_f32 v139, v139
  v_mfma_f32_16x16x32_bf16 v[104:107], a[200:203], v[216:219], v[104:107]
  v_add_f32 v80, v80, v130
  v_mfma_f32_16x16x32_bf16 v[108:111], a[200:203], v[240:243], v[108:111]
  v_exp_f32 v140, v140
  v_mfma_f32_16x16x32_bf16 v[96:99], a[204:207], v[172:175], v[96:99]
  ds_read_b128 a[224:227], v17 offset:6272
  v_add_f32 v80, v80, v131
  v_mfma_f32_16x16x32_bf16 v[100:103], a[204:207], v[196:199], v[100:103]
  buffer_load_dwordx4 v27, s[16:19], s60 offen offset:2048 nt lds
  v_mfma_f32_16x16x32_bf16 v[104:107], a[204:207], v[220:223], v[104:107]
  s_add_u32 s60, s60, 12288
  s_add_u32 m0, s64, 36864
  v_exp_f32 v141, v141
  v_mfma_f32_16x16x32_bf16 v[108:111], a[204:207], v[244:247], v[108:111]
  v_add_f32 v81, v81, v132
  s_waitcnt lgkmcnt(3)
  v_mfma_f32_16x16x32_bf16 v[96:99], a[208:211], v[176:179], v[96:99]
  ds_read_b128 a[228:231], v18 offset:6272
  v_mfma_f32_16x16x32_bf16 v[100:103], a[208:211], v[200:203], v[100:103]
  v_exp_f32 v142, v142
  v_mfma_f32_16x16x32_bf16 v[104:107], a[208:211], v[224:227], v[104:107]
  v_add_f32 v81, v81, v133
  v_mfma_f32_16x16x32_bf16 v[108:111], a[208:211], v[248:251], v[108:111]
  buffer_load_dwordx4 v25, s[20:23], s61 offen offset:0 nt lds
  v_mfma_f32_16x16x32_bf16 v[96:99], a[212:215], v[180:183], v[96:99]
  ds_read_b128 a[232:235], v17 offset:6400
  v_mfma_f32_16x16x32_bf16 v[100:103], a[212:215], v[204:207], v[100:103]
  v_exp_f32 v143, v143
  v_mfma_f32_16x16x32_bf16 v[104:107], a[212:215], v[228:231], v[104:107]
  v_add_f32 v81, v81, v134
  v_mfma_f32_16x16x32_bf16 v[108:111], a[212:215], v[252:255], v[108:111]
  v_exp_f32 v144, v144
  s_waitcnt lgkmcnt(3)
  v_mfma_f32_16x16x32_bf16 v[112:115], a[216:219], v[160:163], 0
  ds_read_b128 a[236:239], v18 offset:6400
  v_add_f32 v81, v81, v135
  v_mfma_f32_16x16x32_bf16 v[116:119], a[216:219], v[184:187], 0
  buffer_load_dwordx4 v26, s[20:23], s61 offen offset:1024 nt lds
  v_mfma_f32_16x16x32_bf16 v[120:123], a[216:219], v[208:211], 0
  v_exp_f32 v145, v145
  v_mfma_f32_16x16x32_bf16 v[124:127], a[216:219], v[232:235], 0
  v_add_f32 v82, v82, v136
  v_mfma_f32_16x16x32_bf16 v[112:115], a[220:223], v[164:167], v[112:115]
  ds_read_b64_tr_b16 a[192:193], v21 offset:36864
  v_mfma_f32_16x16x32_bf16 v[116:119], a[220:223], v[188:191], v[116:119]
  v_exp_f32 v146, v146
  v_mfma_f32_16x16x32_bf16 v[120:123], a[220:223], v[212:215], v[120:123]
  ds_read_b64_tr_b16 a[194:195], v21 offset:43008
  v_add_f32 v82, v82, v137
  v_mfma_f32_16x16x32_bf16 v[124:127], a[220:223], v[236:239], v[124:127]
  buffer_load_dwordx4 v27, s[20:23], s61 offen offset:2048 nt lds
  s_waitcnt lgkmcnt(4)
  v_mfma_f32_16x16x32_bf16 v[112:115], a[224:227], v[168:171], v[112:115]
  ds_read_b64_tr_b16 a[196:197], v22 offset:36864
  s_add_u32 s61, s61, 12288
  v_mfma_f32_16x16x32_bf16 v[116:119], a[224:227], v[192:195], v[116:119]
  v_exp_f32 v147, v147
  v_mfma_f32_16x16x32_bf16 v[120:123], a[224:227], v[216:219], v[120:123]
  ds_read_b64_tr_b16 a[198:199], v22 offset:43008
  v_add_f32 v82, v82, v138
  v_mfma_f32_16x16x32_bf16 v[124:127], a[224:227], v[240:243], v[124:127]
  v_exp_f32 v148, v148
  v_mfma_f32_16x16x32_bf16 v[112:115], a[228:231], v[172:175], v[112:115]
  ds_read_b64_tr_b16 a[200:201], v23 offset:36864
  v_add_f32 v82, v82, v139
  v_mfma_f32_16x16x32_bf16 v[116:119], a[228:231], v[196:199], v[116:119]
  v_exp_f32 v149, v149
  v_mfma_f32_16x16x32_bf16 v[120:123], a[228:231], v[220:223], v[120:123]
  ds_read_b64_tr_b16 a[202:203], v23 offset:43008
  v_add_f32 v83, v83, v140
  v_mfma_f32_16x16x32_bf16 v[124:127], a[228:231], v[244:247], v[124:127]
  v_exp_f32 v150, v150
  s_waitcnt lgkmcnt(6)
  v_mfma_f32_16x16x32_bf16 v[112:115], a[232:235], v[176:179], v[112:115]
  ds_read_b64_tr_b16 a[204:205], v24 offset:36864
  v_add_f32 v83, v83, v141
  v_mfma_f32_16x16x32_bf16 v[116:119], a[232:235], v[200:203], v[116:119]
  v_exp_f32 v151, v151
  v_mfma_f32_16x16x32_bf16 v[120:123], a[232:235], v[224:227], v[120:123]
  ds_read_b64_tr_b16 a[206:207], v24 offset:43008
  v_add_f32 v83, v83, v142
  v_mfma_f32_16x16x32_bf16 v[124:127], a[232:235], v[248:251], v[124:127]
  v_exp_f32 v152, v152
  v_mfma_f32_16x16x32_bf16 v[112:115], a[236:239], v[180:183], v[112:115]
  ds_read_b64_tr_b16 a[208:209], v21 offset:36992
  v_add_f32 v83, v83, v143
  v_mfma_f32_16x16x32_bf16 v[116:119], a[236:239], v[204:207], v[116:119]
  v_exp_f32 v153, v153
  v_mfma_f32_16x16x32_bf16 v[120:123], a[236:239], v[228:231], v[120:123]
  ds_read_b64_tr_b16 a[210:211], v21 offset:43136
  v_add_f32 v80, v80, v144
  v_mfma_f32_16x16x32_bf16 v[124:127], a[236:239], v[252:255], v[124:127]
  v_exp_f32 v154, v154
  v_add_f32 v80, v80, v145
  v_exp_f32 v155, v155
  v_add_f32 v80, v80, v146
  v_exp_f32 v156, v156
  v_add_f32 v80, v80, v147
  v_exp_f32 v157, v157
  v_add_f32 v81, v81, v148
  v_exp_f32 v158, v158
  v_add_f32 v81, v81, v149
  v_exp_f32 v159, v159
  v_add_f32 v81, v81, v150
  v_add_f32 v81, v81, v151
  v_add_f32 v82, v82, v152
  v_add_f32 v82, v82, v153
  v_add_f32 v82, v82, v154
  v_add_f32 v82, v82, v155
  v_add_f32 v83, v83, v156
  v_add_f32 v83, v83, v157
  v_add_f32 v83, v83, v158
  v_add_f32 v83, v83, v159
  v_cvt_pk_bf16_f32 v48, v128, v129
  v_cvt_pk_bf16_f32 v49, v130, v131
  v_cvt_pk_bf16_f32 v52, v132, v133
  v_cvt_pk_bf16_f32 v53, v134, v135
  v_cvt_pk_bf16_f32 v56, v136, v137
  v_cvt_pk_bf16_f32 v57, v138, v139
  v_cvt_pk_bf16_f32 v60, v140, v141
  v_cvt_pk_bf16_f32 v61, v142, v143
  v_cvt_pk_bf16_f32 v50, v144, v145
  v_cvt_pk_bf16_f32 v51, v146, v147
  v_cvt_pk_bf16_f32 v54, v148, v149
  v_cvt_pk_bf16_f32 v55, v150, v151
  v_cvt_pk_bf16_f32 v58, v152, v153
  v_cvt_pk_bf16_f32 v59, v154, v155
  v_cvt_pk_bf16_f32 v62, v156, v157
  v_cvt_pk_bf16_f32 v63, v158, v159
  s_waitcnt lgkmcnt(6)
  v_mfma_f32_16x16x32_bf16 a[0:3], a[192:195], v[48:51], a[0:3]
  ds_read_b64_tr_b16 a[212:213], v22 offset:36992
  v_mfma_f32_16x16x32_bf16 a[4:7], a[192:195], v[52:55], a[4:7]
  v_mfma_f32_16x16x32_bf16 a[8:11], a[192:195], v[56:59], a[8:11]
  ds_read_b64_tr_b16 a[214:215], v22 offset:43136
  v_mfma_f32_16x16x32_bf16 a[12:15], a[192:195], v[60:63], a[12:15]
  v_mfma_f32_16x16x32_bf16 a[16:19], a[196:199], v[48:51], a[16:19]
  ds_read_b64_tr_b16 a[216:217], v23 offset:36992
  v_mfma_f32_16x16x32_bf16 a[20:23], a[196:199], v[52:55], a[20:23]
  v_mfma_f32_16x16x32_bf16 a[24:27], a[196:199], v[56:59], a[24:27]
  ds_read_b64_tr_b16 a[218:219], v23 offset:43136
  v_mfma_f32_16x16x32_bf16 a[28:31], a[196:199], v[60:63], a[28:31]
  s_waitcnt lgkmcnt(6)
  v_mfma_f32_16x16x32_bf16 a[32:35], a[200:203], v[48:51], a[32:35]
  ds_read_b64_tr_b16 a[220:221], v24 offset:36992
  v_max3_f32 v92, v96, v97, v98
  v_mfma_f32_16x16x32_bf16 a[36:39], a[200:203], v[52:55], a[36:39]
  v_max3_f32 v92, v92, v99, v112
  v_max3_f32 v92, v92, v113, v114
  v_mfma_f32_16x16x32_bf16 a[40:43], a[200:203], v[56:59], a[40:43]
  ds_read_b64_tr_b16 a[222:223], v24 offset:43136
  v_max_f32 v92, v92, v115
  v_mfma_f32_16x16x32_bf16 a[44:47], a[200:203], v[60:63], a[44:47]
  v_cmp_gt_f32 vcc, v92, v33
  s_cbranch_vccnz RARE_21_0
RET_21_0:
  v_max3_f32 v93, v100, v101, v102
  v_mfma_f32_16x16x32_bf16 a[48:51], a[204:207], v[48:51], a[48:51]
  ds_read_b64_tr_b16 a[224:225], v21 offset:37120
  v_max3_f32 v93, v93, v103, v116
  v_mfma_f32_16x16x32_bf16 a[52:55], a[204:207], v[52:55], a[52:55]
  v_max3_f32 v93, v93, v117, v118
  v_max_f32 v93, v93, v119
  v_mfma_f32_16x16x32_bf16 a[56:59], a[204:207], v[56:59], a[56:59]
  ds_read_b64_tr_b16 a[226:227], v21 offset:43264
  v_cmp_gt_f32 vcc, v93, v34
  v_mfma_f32_16x16x32_bf16 a[60:63], a[204:207], v[60:63], a[60:63]
  s_cbranch_vccnz RARE_21_1
RET_21_1:
  v_max3_f32 v94, v104, v105, v106
  v_max3_f32 v94, v94, v107, v120
  s_waitcnt lgkmcnt(6)
  v_mfma_f32_16x16x32_bf16 a[64:67], a[208:211], v[48:51], a[64:67]
  ds_read_b64_tr_b16 a[228:229], v22 offset:37120
  v_max3_f32 v94, v94, v121, v122
  v_mfma_f32_16x16x32_bf16 a[68:71], a[208:211], v[52:55], a[68:71]
  v_max_f32 v94, v94, v123
  v_cmp_gt_f32 vcc, v94, v35
  v_mfma_f32_16x16x32_bf16 a[72:75], a[208:211], v[56:59], a[72:75]
  ds_read_b64_tr_b16 a[230:231], v22 offset:43264
  s_cbranch_vccnz RARE_21_2
RET_21_2:
  v_max3_f32 v95, v108, v109, v110
  v_mfma_f32_16x16x32_bf16 a[76:79], a[208:211], v[60:63], a[76:79]
  v_max3_f32 v95, v95, v111, v124
  v_max3_f32 v95, v95, v125, v126
  v_mfma_f32_16x16x32_bf16 a[80:83], a[212:215], v[48:51], a[80:83]
  ds_read_b64_tr_b16 a[232:233], v23 offset:37120
  s_waitcnt vmcnt(18)
  s_barrier
  v_max_f32 v95, v95, v127
  v_mfma_f32_16x16x32_bf16 a[84:87], a[212:215], v[52:55], a[84:87]
  v_cmp_gt_f32 vcc, v95, v36
  s_cbranch_vccnz RARE_21_3
RET_21_3:
  v_add_f32 v96, v96, v88
  v_mfma_f32_16x16x32_bf16 a[88:91], a[212:215], v[56:59], a[88:91]
  ds_read_b64_tr_b16 a[234:235], v23 offset:43264
  v_add_f32 v97, v97, v88
  v_mfma_f32_16x16x32_bf16 a[92:95], a[212:215], v[60:63], a[92:95]
  v_add_f32 v98, v98, v88
  v_add_f32 v99, v99, v88
  s_waitcnt lgkmcnt(6)
  v_mfma_f32_16x16x32_bf16 a[96:99], a[216:219], v[48:51], a[96:99]
  ds_read_b64_tr_b16 a[236:237], v24 offset:37120
  v_add_f32 v100, v100, v89
  v_mfma_f32_16x16x32_bf16 a[100:103], a[216:219], v[52:55], a[100:103]
  v_add_f32 v101, v101, v89
  v_add_f32 v102, v102, v89
  v_mfma_f32_16x16x32_bf16 a[104:107], a[216:219], v[56:59], a[104:107]
  ds_read_b64_tr_b16 a[238:239], v24 offset:43264
  v_add_f32 v103, v103, v89
  v_mfma_f32_16x16x32_bf16 a[108:111], a[216:219], v[60:63], a[108:111]
  v_add_f32 v104, v104, v90
  v_add_f32 v105, v105, v90
  v_mfma_f32_16x16x32_bf16 a[112:115], a[220:223], v[48:51], a[112:115]
  ds_read_b128 a[192:195], v17 offset:24576
  v_add_f32 v106, v106, v90
  v_mfma_f32_16x16x32_bf16 a[116:119], a[220:223], v[52:55], a[116:119]
  v_add_f32 v107, v107, v90
  v_add_f32 v108, v108, v91
  v_mfma_f32_16x16x32_bf16 a[120:123], a[220:223], v[56:59], a[120:123]
  v_add_f32 v109, v109, v91
  v_add_f32 v110, v110, v91
  v_mfma_f32_16x16x32_bf16 a[124:127], a[220:223], v[60:63], a[124:127]
  v_add_f32 v111, v111, v91
  v_add_f32 v112, v112, v88
  s_waitcnt lgkmcnt(5)
  v_mfma_f32_16x16x32_bf16 a[128:131], a[224:227], v[48:51], a[128:131]
  ds_read_b128 a[196:199], v18 offset:24576
  v_add_f32 v113, v113, v88
  v_mfma_f32_16x16x32_bf16 a[132:135], a[224:227], v[52:55], a[132:135]
  v_add_f32 v114, v114, v88
  v_add_f32 v115, v115, v88
  v_mfma_f32_16x16x32_bf16 a[136:139], a[224:227], v[56:59], a[136:139]
  v_add_f32 v116, v116, v89
  v_add_f32 v117, v117, v89
  v_mfma_f32_16x16x32_bf16 a[140:143], a[224:227], v[60:63], a[140:143]
  v_add_f32 v118, v118, v89
  v_add_f32 v119, v119, v89
  v_mfma_f32_16x16x32_bf16 a[144:147], a[228:231], v[48:51], a[144:147]
  ds_read_b128 a[200:203], v17 offset:24704
  v_add_f32 v120, v120, v90
  v_mfma_f32_16x16x32_bf16 a[148:151], a[228:231], v[52:55], a[148:151]
  v_add_f32 v121, v121, v90
  v_add_f32 v122, v122, v90
  v_mfma_f32_16x16x32_bf16 a[152:155], a[228:231], v[56:59], a[152:155]
  v_add_f32 v123, v123, v90
  v_add_f32 v124, v124, v91
  v_mfma_f32_16x16x32_bf16 a[156:159], a[228:231], v[60:63], a[156:159]
  v_add_f32 v125, v125, v91
  v_add_f32 v126, v126, v91
  s_waitcnt lgkmcnt(3)
  v_mfma_f32_16x16x32_bf16 a[160:163], a[232:235], v[48:51], a[160:163]
  ds_read_b128 a[204:207], v18 offset:24704
  v_add_f32 v127, v127, v91
  v_mfma_f32_16x16x32_bf16 a[164:167], a[232:235], v[52:55], a[164:167]
  v_exp_f32 v96, v96
  v_mfma_f32_16x16x32_bf16 a[168:171], a[232:235], v[56:59], a[168:171]
  v_exp_f32 v97, v97
  v_mfma_f32_16x16x32_bf16 a[172:175], a[232:235], v[60:63], a[172:175]
  v_exp_f32 v98, v98
  v_mfma_f32_16x16x32_bf16 a[176:179], a[236:239], v[48:51], a[176:179]
  ds_read_b128 a[208:211], v17 offset:24832
  v_mfma_f32_16x16x32_bf16 a[180:183], a[236:239], v[52:55], a[180:183]
  v_exp_f32 v99, v99
  v_mfma_f32_16x16x32_bf16 a[184:187], a[236:239], v[56:59], a[184:187]
  v_exp_f32 v100, v100
  v_mfma_f32_16x16x32_bf16 a[188:191], a[236:239], v[60:63], a[188:191]
  v_exp_f32 v101, v101
  v_exp_f32 v102, v102
  v_exp_f32 v103, v103
  s_cmp_lg_u32 s66, 0
  s_mov_b32 s67, 21
  s_cbranch_scc1 RESCALE
RESC_RET_21:
  s_waitcnt lgkmcnt(3)
  v_mfma_f32_16x16x32_bf16 v[128:131], a[192:195], v[160:163], 0
  ds_read_b128 a[212:215], v18 offset:24832
  s_sub_u32 s3, s63, s62
  v_add_u32 v21, s3, v21
  s_mov_b32 m0, s63
  v_mfma_f32_16x16x32_bf16 v[132:135], a[192:195], v[184:187], 0
  v_add_u32 v22, s3, v22
  v_add_u32 v23, s3, v23
  v_mfma_f32_16x16x32_bf16 v[136:139], a[192:195], v[208:211], 0
  v_add_u32 v24, s3, v24
  v_mfma_f32_16x16x32_bf16 v[140:143], a[192:195], v[232:235], 0
  buffer_load_dwordx4 v25, s[16:19], s60 offen offset:0 nt lds
  v_mfma_f32_16x16x32_bf16 v[128:131], a[196:199], v[164:167], v[128:131]
  ds_read_b128 a[216:219], v17 offset:30720
  v_mfma_f32_16x16x32_bf16 v[132:135], a[196:199], v[188:191], v[132:135]
  v_exp_f32 v104, v104
  v_mfma_f32_16x16x32_bf16 v[136:139], a[196:199], v[212:215], v[136:139]
  v_exp_f32 v105, v105
  v_mfma_f32_16x16x32_bf16 v[140:143], a[196:199], v[236:239], v[140:143]
  v_add_f32 v80, v80, v96
  s_waitcnt lgkmcnt(3)
  v_mfma_f32_16x16x32_bf16 v[128:131], a[200:203], v[168:171], v[128:131]
  ds_read_b128 a[220:223], v18 offset:30720
  v_mfma_f32_16x16x32_bf16 v[132:135], a[200:203], v[192:195], v[132:135]
  buffer_load_dwordx4 v26, s[16:19], s60 offen offset:1024 nt lds
  v_mfma_f32_16x16x32_bf16 v[136:139], a[200:203], v[216:219], v[136:139]
  v_exp_f32 v106, v106
  v_mfma_f32_16x16x32_bf16 v[140:143], a[200:203], v[240:243], v[140:143]
  v_add_f32 v80, v80, v97
  v_mfma_f32_16x16x32_bf16 v[128:131], a[204:207], v[172:175], v[128:131]
  ds_read_b128 a[224:227], v17 offset:30848
  v_mfma_f32_16x16x32_bf16 v[132:135], a[204:207], v[196:199], v[132:135]
  v_exp_f32 v107, v107
  v_mfma_f32_16x16x32_bf16 v[136:139], a[204:207], v[220:223], v[136:139]
  v_add_f32 v80, v80, v98
  v_mfma_f32_16x16x32_bf16 v[140:143], a[204:207], v[244:247], v[140:143]
  buffer_load_dwordx4 v27, s[16:19], s60 offen offset:2048 nt lds
  s_waitcnt lgkmcnt(3)
  v_mfma_f32_16x16x32_bf16 v[128:131], a[208:211], v[176:179], v[128:131]
  ds_read_b128 a[228:231], v18 offset:30848
  s_add_u32 s60, s60, 12288
  s_add_u32 m0, s62, 12288
  v_mfma_f32_16x16x32_bf16 v[132:135], a[208:211], v[200:203], v[132:135]
  v_exp_f32 v108, v108
  v_mfma_f32_16x16x32_bf16 v[136:139], a[208:211], v[224:227], v[136:139]
  v_add_f32 v80, v80, v99
  v_mfma_f32_16x16x32_bf16 v[140:143], a[208:211], v[248:251], v[140:143]
  v_exp_f32 v109, v109
  v_mfma_f32_16x16x32_bf16 v[128:131], a[212:215], v[180:183], v[128:131]
  ds_read_b128 a[232:235], v17 offset:30976
  v_add_f32 v81, v81, v100
  v_mfma_f32_16x16x32_bf16 v[132:135], a[212:215], v[204:207], v[132:135]
  buffer_load_dwordx4 v25, s[20:23], s61 offen offset:0 nt lds
  v_mfma_f32_16x16x32_bf16 v[136:139], a[212:215], v[228:231], v[136:139]
  v_exp_f32 v110, v110
  v_mfma_f32_16x16x32_bf16 v[140:143], a[212:215], v[252:255], v[140:143]
  v_add_f32 v81, v81, v101
  s_waitcnt lgkmcnt(3)
  v_mfma_f32_16x16x32_bf16 v[144:147], a[216:219], v[160:163], 0
  ds_read_b128 a[236:239], v18 offset:30976
  v_mfma_f32_16x16x32_bf16 v[148:151], a[216:219], v[184:187], 0
  v_exp_f32 v111, v111
  v_mfma_f32_16x16x32_bf16 v[152:155], a[216:219], v[208:211], 0
  v_add_f32 v81, v81, v102
  v_mfma_f32_16x16x32_bf16 v[156:159], a[216:219], v[232:235], 0
  buffer_load_dwordx4 v26, s[20:23], s61 offen offset:1024 nt lds
  v_mfma_f32_16x16x32_bf16 v[144:147], a[220:223], v[164:167], v[144:147]
  ds_read_b64_tr_b16 a[192:193], v21 offset:12288
  v_mfma_f32_16x16x32_bf16 v[148:151], a[220:223], v[188:191], v[148:151]
  v_exp_f32 v112, v112
  v_mfma_f32_16x16x32_bf16 v[152:155], a[220:223], v[212:215], v[152:155]
  ds_read_b64_tr_b16 a[194:195], v21 offset:18432
  v_add_f32 v81, v81, v103
  v_mfma_f32_16x16x32_bf16 v[156:159], a[220:223], v[236:239], v[156:159]
  v_exp_f32 v113, v113
  s_waitcnt lgkmcnt(4)
  v_mfma_f32_16x16x32_bf16 v[144:147], a[224:227], v[168:171], v[144:147]
  ds_read_b64_tr_b16 a[196:197], v22 offset:12288
  v_add_f32 v82, v82, v104
  v_mfma_f32_16x16x32_bf16 v[148:151], a[224:227], v[192:195], v[148:151]
  buffer_load_dwordx4 v27, s[20:23], s61 offen offset:2048 nt lds
  v_mfma_f32_16x16x32_bf16 v[152:155], a[224:227], v[216:219], v[152:155]
  ds_read_b64_tr_b16 a[198:199], v22 offset:18432
  s_add_u32 s61, s61, 12288
  v_mfma_f32_16x16x32_bf16 v[156:159], a[224:227], v[240:243], v[156:159]
  v_exp_f32 v114, v114
  v_mfma_f32_16x16x32_bf16 v[144:147], a[228:231], v[172:175], v[144:147]
  ds_read_b64_tr_b16 a[200:201], v23 offset:12288
  v_add_f32 v82, v82, v105
  v_mfma_f32_16x16x32_bf16 v[148:151], a[228:231], v[196:199], v[148:151]
  v_exp_f32 v115, v115
  v_mfma_f32_16x16x32_bf16 v[152:155], a[228:231], v[220:223], v[152:155]
  ds_read_b64_tr_b16 a[202:203], v23 offset:18432
  v_add_f32 v82, v82, v106
  v_mfma_f32_16x16x32_bf16 v[156:159], a[228:231], v[244:247], v[156:159]
  v_exp_f32 v116, v116
  s_waitcnt lgkmcnt(6)
  v_mfma_f32_16x16x32_bf16 v[144:147], a[232:235], v[176:179], v[144:147]
  ds_read_b64_tr_b16 a[204:205], v24 offset:12288
  v_add_f32 v82, v82, v107
  v_mfma_f32_16x16x32_bf16 v[148:151], a[232:235], v[200:203], v[148:151]
  v_exp_f32 v117, v117
  v_mfma_f32_16x16x32_bf16 v[152:155], a[232:235], v[224:227], v[152:155]
  ds_read_b64_tr_b16 a[206:207], v24 offset:18432
  v_add_f32 v83, v83, v108
  v_mfma_f32_16x16x32_bf16 v[156:159], a[232:235], v[248:251], v[156:159]
  v_exp_f32 v118, v118
  v_mfma_f32_16x16x32_bf16 v[144:147], a[236:239], v[180:183], v[144:147]
  ds_read_b64_tr_b16 a[208:209], v21 offset:12416
  v_add_f32 v83, v83, v109
  v_mfma_f32_16x16x32_bf16 v[148:151], a[236:239], v[204:207], v[148:151]
  v_exp_f32 v119, v119
  v_mfma_f32_16x16x32_bf16 v[152:155], a[236:239], v[228:231], v[152:155]
  ds_read_b64_tr_b16 a[210:211], v21 offset:18560
  v_add_f32 v83, v83, v110
  v_mfma_f32_16x16x32_bf16 v[156:159], a[236:239], v[252:255], v[156:159]
  v_exp_f32 v120, v120
  v_add_f32 v83, v83, v111
  v_exp_f32 v121, v121
  v_add_f32 v80, v80, v112
  v_exp_f32 v122, v122
  v_add_f32 v80, v80, v113
  v_exp_f32 v123, v123
  v_add_f32 v80, v80, v114
  v_exp_f32 v124, v124
  v_add_f32 v80, v80, v115
  v_exp_f32 v125, v125
  v_add_f32 v81, v81, v116
  v_exp_f32 v126, v126
  v_add_f32 v81, v81, v117
  v_exp_f32 v127, v127
  v_add_f32 v81, v81, v118
  v_add_f32 v81, v81, v119
  v_add_f32 v82, v82, v120
  v_add_f32 v82, v82, v121
  v_add_f32 v82, v82, v122
  v_add_f32 v82, v82, v123
  v_add_f32 v83, v83, v124
  v_add_f32 v83, v83, v125
  v_add_f32 v83, v83, v126
  v_add_f32 v83, v83, v127
  v_cvt_pk_bf16_f32 v48, v96, v97
  v_cvt_pk_bf16_f32 v49, v98, v99
  v_cvt_pk_bf16_f32 v52, v100, v101
  v_cvt_pk_bf16_f32 v53, v102, v103
  v_cvt_pk_bf16_f32 v56, v104, v105
  v_cvt_pk_bf16_f32 v57, v106, v107
  v_cvt_pk_bf16_f32 v60, v108, v109
  v_cvt_pk_bf16_f32 v61, v110, v111
  v_cvt_pk_bf16_f32 v50, v112, v113
  v_cvt_pk_bf16_f32 v51, v114, v115
  v_cvt_pk_bf16_f32 v54, v116, v117
  v_cvt_pk_bf16_f32 v55, v118, v119
  v_cvt_pk_bf16_f32 v58, v120, v121
  v_cvt_pk_bf16_f32 v59, v122, v123
  v_cvt_pk_bf16_f32 v62, v124, v125
  v_cvt_pk_bf16_f32 v63, v126, v127
  s_waitcnt lgkmcnt(6)
  v_mfma_f32_16x16x32_bf16 a[0:3], a[192:195], v[48:51], a[0:3]
  ds_read_b64_tr_b16 a[212:213], v22 offset:12416
  s_sub_u32 s79, s64, s63
  v_add_u32 v17, s79, v17
  v_mfma_f32_16x16x32_bf16 a[4:7], a[192:195], v[52:55], a[4:7]
  v_add_u32 v18, s79, v18
  v_mfma_f32_16x16x32_bf16 a[8:11], a[192:195], v[56:59], a[8:11]
  ds_read_b64_tr_b16 a[214:215], v22 offset:18560
  v_mfma_f32_16x16x32_bf16 a[12:15], a[192:195], v[60:63], a[12:15]
  v_mfma_f32_16x16x32_bf16 a[16:19], a[196:199], v[48:51], a[16:19]
  ds_read_b64_tr_b16 a[216:217], v23 offset:12416
  v_mfma_f32_16x16x32_bf16 a[20:23], a[196:199], v[52:55], a[20:23]
  v_mfma_f32_16x16x32_bf16 a[24:27], a[196:199], v[56:59], a[24:27]
  ds_read_b64_tr_b16 a[218:219], v23 offset:18560
  v_mfma_f32_16x16x32_bf16 a[28:31], a[196:199], v[60:63], a[28:31]
  s_waitcnt lgkmcnt(6)
  v_mfma_f32_16x16x32_bf16 a[32:35], a[200:203], v[48:51], a[32:35]
  ds_read_b64_tr_b16 a[220:221], v24 offset:12416
  v_max3_f32 v92, v128, v129, v130
  v_mfma_f32_16x16x32_bf16 a[36:39], a[200:203], v[52:55], a[36:39]
  v_max3_f32 v92, v92, v131, v144
  v_max3_f32 v92, v92, v145, v146
  v_mfma_f32_16x16x32_bf16 a[40:43], a[200:203], v[56:59], a[40:43]
  ds_read_b64_tr_b16 a[222:223], v24 offset:18560
  v_max_f32 v92, v92, v147
  v_mfma_f32_16x16x32_bf16 a[44:47], a[200:203], v[60:63], a[44:47]
  v_cmp_gt_f32 vcc, v92, v33
  s_cbranch_vccnz RARE_22_0
RET_22_0:
  v_max3_f32 v93, v132, v133, v134
  v_mfma_f32_16x16x32_bf16 a[48:51], a[204:207], v[48:51], a[48:51]
  ds_read_b64_tr_b16 a[224:225], v21 offset:12544
  v_max3_f32 v93, v93, v135, v148
  v_mfma_f32_16x16x32_bf16 a[52:55], a[204:207], v[52:55], a[52:55]
  v_max3_f32 v93, v93, v149, v150
  v_max_f32 v93, v93, v151
  v_mfma_f32_16x16x32_bf16 a[56:59], a[204:207], v[56:59], a[56:59]
  ds_read_b64_tr_b16 a[226:227], v21 offset:18688
  v_cmp_gt_f32 vcc, v93, v34
  v_mfma_f32_16x16x32_bf16 a[60:63], a[204:207], v[60:63], a[60:63]
  s_cbranch_vccnz RARE_22_1
RET_22_1:
  v_max3_f32 v94, v136, v137, v138
  v_max3_f32 v94, v94, v139, v152
  s_waitcnt lgkmcnt(6)
  v_mfma_f32_16x16x32_bf16 a[64:67], a[208:211], v[48:51], a[64:67]
  ds_read_b64_tr_b16 a[228:229], v22 offset:12544
  v_max3_f32 v94, v94, v153, v154
  v_mfma_f32_16x16x32_bf16 a[68:71], a[208:211], v[52:55], a[68:71]
  v_max_f32 v94, v94, v155
  v_cmp_gt_f32 vcc, v94, v35
  v_mfma_f32_16x16x32_bf16 a[72:75], a[208:211], v[56:59], a[72:75]
  ds_read_b64_tr_b16 a[230:231], v22 offset:18688
  s_cbranch_vccnz RARE_22_2
RET_22_2:
  v_max3_f32 v95, v140, v141, v142
  v_mfma_f32_16x16x32_bf16 a[76:79], a[208:211], v[60:63], a[76:79]
  v_max3_f32 v95, v95, v143, v156
  v_max3_f32 v95, v95, v157, v158
  v_mfma_f32_16x16x32_bf16 a[80:83], a[212:215], v[48:51], a[80:83]
  ds_read_b64_tr_b16 a[232:233], v23 offset:12544
  s_waitcnt vmcnt(18)
  s_barrier
  v_max_f32 v95, v95, v159
  v_mfma_f32_16x16x32_bf16 a[84:87], a[212:215], v[52:55], a[84:87]
  v_cmp_gt_f32 vcc, v95, v36
  s_cbranch_vccnz RARE_22_3
RET_22_3:
  v_add_f32 v128, v128, v88
  v_mfma_f32_16x16x32_bf16 a[88:91], a[212:215], v[56:59], a[88:91]
  ds_read_b64_tr_b16 a[234:235], v23 offset:18688
  v_add_f32 v129, v129, v88
  v_mfma_f32_16x16x32_bf16 a[92:95], a[212:215], v[60:63], a[92:95]
  v_add_f32 v130, v130, v88
  v_add_f32 v131, v131, v88
  s_waitcnt lgkmcnt(6)
  v_mfma_f32_16x16x32_bf16 a[96:99], a[216:219], v[48:51], a[96:99]
  ds_read_b64_tr_b16 a[236:237], v24 offset:12544
  v_add_f32 v132, v132, v89
  v_mfma_f32_16x16x32_bf16 a[100:103], a[216:219], v[52:55], a[100:103]
  v_add_f32 v133, v133, v89
  v_add_f32 v134, v134, v89
  v_mfma_f32_16x16x32_bf16 a[104:107], a[216:219], v[56:59], a[104:107]
  ds_read_b64_tr_b16 a[238:239], v24 offset:18688
  v_add_f32 v135, v135, v89
  v_mfma_f32_16x16x32_bf16 a[108:111], a[216:219], v[60:63], a[108:111]
  v_add_f32 v136, v136, v90
  v_add_f32 v137, v137, v90
  v_mfma_f32_16x16x32_bf16 a[112:115], a[220:223], v[48:51], a[112:115]
  ds_read_b128 a[192:195], v17 offset:0
  v_add_f32 v138, v138, v90
  v_mfma_f32_16x16x32_bf16 a[116:119], a[220:223], v[52:55], a[116:119]
  v_add_f32 v139, v139, v90
  v_add_f32 v140, v140, v91
  v_mfma_f32_16x16x32_bf16 a[120:123], a[220:223], v[56:59], a[120:123]
  v_add_f32 v141, v141, v91
  v_add_f32 v142, v142, v91
  v_mfma_f32_16x16x32_bf16 a[124:127], a[220:223], v[60:63], a[124:127]
  v_add_f32 v143, v143, v91
  v_add_f32 v144, v144, v88
  s_waitcnt lgkmcnt(5)
  v_mfma_f32_16x16x32_bf16 a[128:131], a[224:227], v[48:51], a[128:131]
  ds_read_b128 a[196:199], v18 offset:0
  v_add_f32 v145, v145, v88
  v_mfma_f32_16x16x32_bf16 a[132:135], a[224:227], v[52:55], a[132:135]
  v_add_f32 v146, v146, v88
  v_add_f32 v147, v147, v88
  v_mfma_f32_16x16x32_bf16 a[136:139], a[224:227], v[56:59], a[136:139]
  v_add_f32 v148, v148, v89
  v_add_f32 v149, v149, v89
  v_mfma_f32_16x16x32_bf16 a[140:143], a[224:227], v[60:63], a[140:143]
  v_add_f32 v150, v150, v89
  v_add_f32 v151, v151, v89
  v_mfma_f32_16x16x32_bf16 a[144:147], a[228:231], v[48:51], a[144:147]
  ds_read_b128 a[200:203], v17 offset:128
  v_add_f32 v152, v152, v90
  v_mfma_f32_16x16x32_bf16 a[148:151], a[228:231], v[52:55], a[148:151]
  v_add_f32 v153, v153, v90
  v_add_f32 v154, v154, v90
  v_mfma_f32_16x16x32_bf16 a[152:155], a[228:231], v[56:59], a[152:155]
  v_add_f32 v155, v155, v90
  v_add_f32 v156, v156, v91
  v_mfma_f32_16x16x32_bf16 a[156:159], a[228:231], v[60:63], a[156:159]
  v_add_f32 v157, v157, v91
  v_add_f32 v158, v158, v91
  s_waitcnt lgkmcnt(3)
  v_mfma_f32_16x16x32_bf16 a[160:163], a[232:235], v[48:51], a[160:163]
  ds_read_b128 a[204:207], v18 offset:128
  v_add_f32 v159, v159, v91
  v_mfma_f32_16x16x32_bf16 a[164:167], a[232:235], v[52:55], a[164:167]
  v_exp_f32 v128, v128
  v_mfma_f32_16x16x32_bf16 a[168:171], a[232:235], v[56:59], a[168:171]
  v_exp_f32 v129, v129
  v_mfma_f32_16x16x32_bf16 a[172:175], a[232:235], v[60:63], a[172:175]
  v_exp_f32 v130, v130
  v_mfma_f32_16x16x32_bf16 a[176:179], a[236:239], v[48:51], a[176:179]
  ds_read_b128 a[208:211], v17 offset:256
  v_mfma_f32_16x16x32_bf16 a[180:183], a[236:239], v[52:55], a[180:183]
  v_exp_f32 v131, v131
  v_mfma_f32_16x16x32_bf16 a[184:187], a[236:239], v[56:59], a[184:187]
  v_exp_f32 v132, v132
  v_mfma_f32_16x16x32_bf16 a[188:191], a[236:239], v[60:63], a[188:191]
  v_exp_f32 v133, v133
  v_exp_f32 v134, v134
  v_exp_f32 v135, v135
  s_cmp_lg_u32 s66, 0
  s_mov_b32 s67, 22
  s_cbranch_scc1 RESCALE
RESC_RET_22:
  s_mov_b32 s68, s62
  s_mov_b32 s62, s63
  s_mov_b32 s63, s64
  s_mov_b32 s64, s68
  s_sub_u32 s65, s65, 1
  s_cmp_lg_u32 s65, 0
  s_cbranch_scc1 K1_SLOOP
  ds_read_b64_tr_b16 a[192:193], v21 offset:36864
  ds_read_b64_tr_b16 a[194:195], v21 offset:43008
  ds_read_b64_tr_b16 a[196:197], v22 offset:36864
  ds_read_b64_tr_b16 a[198:199], v22 offset:43008
  ds_read_b64_tr_b16 a[200:201], v23 offset:36864
  ds_read_b64_tr_b16 a[202:203], v23 offset:43008
  ds_read_b64_tr_b16 a[204:205], v24 offset:36864
  ds_read_b64_tr_b16 a[206:207], v24 offset:43008
  ds_read_b64_tr_b16 a[208:209], v21 offset:36992
  ds_read_b64_tr_b16 a[210:211], v21 offset:43136
  v_exp_f32 v136, v136
  v_exp_f32 v137, v137
  v_add_f32 v80, v80, v128
  v_exp_f32 v138, v138
  v_add_f32 v80, v80, v129
  v_exp_f32 v139, v139
  v_add_f32 v80, v80, v130
  v_exp_f32 v140, v140
  v_add_f32 v80, v80, v131
  v_exp_f32 v141, v141
  v_add_f32 v81, v81, v132
  v_exp_f32 v142, v142
  v_add_f32 v81, v81, v133
  v_exp_f32 v143, v143
  v_add_f32 v81, v81, v134
  v_exp_f32 v144, v144
  v_add_f32 v81, v81, v135
  v_exp_f32 v145, v145
  v_add_f32 v82, v82, v136
  v_exp_f32 v146, v146
  v_add_f32 v82, v82, v137
  v_exp_f32 v147, v147
  v_add_f32 v82, v82, v138
  v_exp_f32 v148, v148
  v_add_f32 v82, v82, v139
  v_exp_f32 v149, v149
  v_add_f32 v83, v83, v140
  v_exp_f32 v150, v150
  v_add_f32 v83, v83, v141
  v_exp_f32 v151, v151
  v_add_f32 v83, v83, v142
  v_exp_f32 v152, v152
  v_add_f32 v83, v83, v143
  v_exp_f32 v153, v153
  v_add_f32 v80, v80, v144
  v_exp_f32 v154, v154
  v_add_f32 v80, v80, v145
  v_exp_f32 v155, v155
  v_add_f32 v80, v80, v146
  v_exp_f32 v156, v156
  v_add_f32 v80, v80, v147
  v_exp_f32 v157, v157
  v_add_f32 v81, v81, v148
  v_exp_f32 v158, v158
  v_add_f32 v81, v81, v149
  v_exp_f32 v159, v159
  v_add_f32 v81, v81, v150
  v_add_f32 v81, v81, v151
  v_add_f32 v82, v82, v152
  v_add_f32 v82, v82, v153
  v_add_f32 v82, v82, v154
  v_add_f32 v82, v82, v155
  v_add_f32 v83, v83, v156
  v_add_f32 v83, v83, v157
  v_add_f32 v83, v83, v158
  v_add_f32 v83, v83, v159
  v_cvt_pk_bf16_f32 v48, v128, v129
  v_cvt_pk_bf16_f32 v49, v130, v131
  v_cvt_pk_bf16_f32 v52, v132, v133
  v_cvt_pk_bf16_f32 v53, v134, v135
  v_cvt_pk_bf16_f32 v56, v136, v137
  v_cvt_pk_bf16_f32 v57, v138, v139
  v_cvt_pk_bf16_f32 v60, v140, v141
  v_cvt_pk_bf16_f32 v61, v142, v143
  v_cvt_pk_bf16_f32 v50, v144, v145
  v_cvt_pk_bf16_f32 v51, v146, v147
  v_cvt_pk_bf16_f32 v54, v148, v149
  v_cvt_pk_bf16_f32 v55, v150, v151
  v_cvt_pk_bf16_f32 v58, v152, v153
  v_cvt_pk_bf16_f32 v59, v154, v155
  v_cvt_pk_bf16_f32 v62, v156, v157
  v_cvt_pk_bf16_f32 v63, v158, v159
  s_nop 1
  s_waitcnt lgkmcnt(6)
  v_mfma_f32_16x16x32_bf16 a[0:3], a[192:195], v[48:51], a[0:3]
  ds_read_b64_tr_b16 a[212:213], v22 offset:36992
  v_mfma_f32_16x16x32_bf16 a[4:7], a[192:195], v[52:55], a[4:7]
  v_mfma_f32_16x16x32_bf16 a[8:11], a[192:195], v[56:59], a[8:11]
  ds_read_b64_tr_b16 a[214:215], v22 offset:43136
  v_mfma_f32_16x16x32_bf16 a[12:15], a[192:195], v[60:63], a[12:15]
  v_mfma_f32_16x16x32_bf16 a[16:19], a[196:199], v[48:51], a[16:19]
  ds_read_b64_tr_b16 a[216:217], v23 offset:36992
  v_mfma_f32_16x16x32_bf16 a[20:23], a[196:199], v[52:55], a[20:23]
  v_mfma_f32_16x16x32_bf16 a[24:27], a[196:199], v[56:59], a[24:27]
  ds_read_b64_tr_b16 a[218:219], v23 offset:43136
  v_mfma_f32_16x16x32_bf16 a[28:31], a[196:199], v[60:63], a[28:31]
  s_waitcnt lgkmcnt(6)
  v_mfma_f32_16x16x32_bf16 a[32:35], a[200:203], v[48:51], a[32:35]
  ds_read_b64_tr_b16 a[220:221], v24 offset:36992
  v_mfma_f32_16x16x32_bf16 a[36:39], a[200:203], v[52:55], a[36:39]
  v_mfma_f32_16x16x32_bf16 a[40:43], a[200:203], v[56:59], a[40:43]
  ds_read_b64_tr_b16 a[222:223], v24 offset:43136
  v_mfma_f32_16x16x32_bf16 a[44:47], a[200:203], v[60:63], a[44:47]
  v_mfma_f32_16x16x32_bf16 a[48:51], a[204:207], v[48:51], a[48:51]
  ds_read_b64_tr_b16 a[224:225], v21 offset:37120
  v_mfma_f32_16x16x32_bf16 a[52:55], a[204:207], v[52:55], a[52:55]
  v_mfma_f32_16x16x32_bf16 a[56:59], a[204:207], v[56:59], a[56:59]
  ds_read_b64_tr_b16 a[226:227], v21 offset:43264
  v_mfma_f32_16x16x32_bf16 a[60:63], a[204:207], v[60:63], a[60:63]
  s_waitcnt lgkmcnt(6)
  v_mfma_f32_16x16x32_bf16 a[64:67], a[208:211], v[48:51], a[64:67]
  ds_read_b64_tr_b16 a[228:229], v22 offset:37120
  v_mfma_f32_16x16x32_bf16 a[68:71], a[208:211], v[52:55], a[68:71]
  v_mfma_f32_16x16x32_bf16 a[72:75], a[208:211], v[56:59], a[72:75]
  ds_read_b64_tr_b16 a[230:231], v22 offset:43264
  v_mfma_f32_16x16x32_bf16 a[76:79], a[208:211], v[60:63], a[76:79]
  v_mfma_f32_16x16x32_bf16 a[80:83], a[212:215], v[48:51], a[80:83]
  ds_read_b64_tr_b16 a[232:233], v23 offset:37120
  v_mfma_f32_16x16x32_bf16 a[84:87], a[212:215], v[52:55], a[84:87]
  v_mfma_f32_16x16x32_bf16 a[88:91], a[212:215], v[56:59], a[88:91]
  ds_read_b64_tr_b16 a[234:235], v23 offset:43264
  v_mfma_f32_16x16x32_bf16 a[92:95], a[212:215], v[60:63], a[92:95]
  s_waitcnt lgkmcnt(6)
  v_mfma_f32_16x16x32_bf16 a[96:99], a[216:219], v[48:51], a[96:99]
  ds_read_b64_tr_b16 a[236:237], v24 offset:37120
  v_mfma_f32_16x16x32_bf16 a[100:103], a[216:219], v[52:55], a[100:103]
  v_mfma_f32_16x16x32_bf16 a[104:107], a[216:219], v[56:59], a[104:107]
  ds_read_b64_tr_b16 a[238:239], v24 offset:43264
  v_mfma_f32_16x16x32_bf16 a[108:111], a[216:219], v[60:63], a[108:111]
  v_mfma_f32_16x16x32_bf16 a[112:115], a[220:223], v[48:51], a[112:115]
  v_mfma_f32_16x16x32_bf16 a[116:119], a[220:223], v[52:55], a[116:119]
  v_mfma_f32_16x16x32_bf16 a[120:123], a[220:223], v[56:59], a[120:123]
  v_mfma_f32_16x16x32_bf16 a[124:127], a[220:223], v[60:63], a[124:127]
  s_waitcnt lgkmcnt(4)
  v_mfma_f32_16x16x32_bf16 a[128:131], a[224:227], v[48:51], a[128:131]
  v_mfma_f32_16x16x32_bf16 a[132:135], a[224:227], v[52:55], a[132:135]
  v_mfma_f32_16x16x32_bf16 a[136:139], a[224:227], v[56:59], a[136:139]
  v_mfma_f32_16x16x32_bf16 a[140:143], a[224:227], v[60:63], a[140:143]
  v_mfma_f32_16x16x32_bf16 a[144:147], a[228:231], v[48:51], a[144:147]
  v_mfma_f32_16x16x32_bf16 a[148:151], a[228:231], v[52:55], a[148:151]
  v_mfma_f32_16x16x32_bf16 a[152:155], a[228:231], v[56:59], a[152:155]
  v_mfma_f32_16x16x32_bf16 a[156:159], a[228:231], v[60:63], a[156:159]
  s_waitcnt lgkmcnt(0)
  v_mfma_f32_16x16x32_bf16 a[160:163], a[232:235], v[48:51], a[160:163]
  v_mfma_f32_16x16x32_bf16 a[164:167], a[232:235], v[52:55], a[164:167]
  v_mfma_f32_16x16x32_bf16 a[168:171], a[232:235], v[56:59], a[168:171]
  v_mfma_f32_16x16x32_bf16 a[172:175], a[232:235], v[60:63], a[172:175]
  v_mfma_f32_16x16x32_bf16 a[176:179], a[236:239], v[48:51], a[176:179]
  v_mfma_f32_16x16x32_bf16 a[180:183], a[236:239], v[52:55], a[180:183]
  v_mfma_f32_16x16x32_bf16 a[184:187], a[236:239], v[56:59], a[184:187]
  v_mfma_f32_16x16x32_bf16 a[188:191], a[236:239], v[60:63], a[188:191]
  s_nop 15
  v_subrev_u32 v17, 49152, v17
  v_subrev_u32 v18, 49152, v18
  v_mov_b32 v1, v80
  v_mov_b32 v2, v81
  v_mov_b32 v3, v82
  v_mov_b32 v4, v83
  s_nop 0
  v_permlane32_swap_b32 v80, v1
  v_permlane32_swap_b32 v81, v2
  v_permlane32_swap_b32 v82, v3
  v_permlane32_swap_b32 v83, v4
  v_add_f32 v80, v80, v1
  v_add_f32 v81, v81, v2
  v_add_f32 v82, v82, v3
  v_add_f32 v83, v83, v4
  v_mov_b32 v1, v80
  v_mov_b32 v2, v81
  v_mov_b32 v3, v82
  v_mov_b32 v4, v83
  s_nop 0
  v_permlane16_swap_b32 v80, v1
  v_permlane16_swap_b32 v81, v2
  v_permlane16_swap_b32 v82, v3
  v_permlane16_swap_b32 v83, v4
  v_add_f32 v80, v80, v1
  v_add_f32 v81, v81, v2
  v_add_f32 v82, v82, v3
  v_add_f32 v83, v83, v4
  v_rcp_f32 v37, v80
  v_rcp_f32 v38, v81
  v_rcp_f32 v39, v82
  v_rcp_f32 v40, v83
  s_nop 3
  s_mul_i32 s68, s56, 25165824
  s_add_u32 s72, s72, s68
  v_accvgpr_read_b32 v48, a0
  v_accvgpr_read_b32 v49, a1
  v_accvgpr_read_b32 v50, a2
  v_accvgpr_read_b32 v51, a3
  v_accvgpr_read_b32 v52, a16
  v_accvgpr_read_b32 v53, a17
  v_accvgpr_read_b32 v54, a18
  v_accvgpr_read_b32 v55, a19
  v_mul_f32 v48, v48, v37
  v_mul_f32 v49, v49, v37
  v_mul_f32 v50, v50, v37
  v_mul_f32 v51, v51, v37
  v_mul_f32 v52, v52, v37
  v_mul_f32 v53, v53, v37
  v_mul_f32 v54, v54, v37
  v_mul_f32 v55, v55, v37
  v_cvt_pk_bf16_f32 v56, v48, v49
  v_cvt_pk_bf16_f32 v57, v50, v51
  v_cvt_pk_bf16_f32 v58, v52, v53
  v_cvt_pk_bf16_f32 v59, v54, v55
  s_add_u32 s53, s72, 0
  buffer_store_dwordx4 v[56:59], v28, s[24:27], s53 offen sc0 sc1
  v_accvgpr_read_b32 v48, a4
  v_accvgpr_read_b32 v49, a5
  v_accvgpr_read_b32 v50, a6
  v_accvgpr_read_b32 v51, a7
  v_accvgpr_read_b32 v52, a20
  v_accvgpr_read_b32 v53, a21
  v_accvgpr_read_b32 v54, a22
  v_accvgpr_read_b32 v55, a23
  v_mul_f32 v48, v48, v38
  v_mul_f32 v49, v49, v38
  v_mul_f32 v50, v50, v38
  v_mul_f32 v51, v51, v38
  v_mul_f32 v52, v52, v38
  v_mul_f32 v53, v53, v38
  v_mul_f32 v54, v54, v38
  v_mul_f32 v55, v55, v38
  v_cvt_pk_bf16_f32 v60, v48, v49
  v_cvt_pk_bf16_f32 v61, v50, v51
  v_cvt_pk_bf16_f32 v62, v52, v53
  v_cvt_pk_bf16_f32 v63, v54, v55
  s_add_u32 s53, s72, 196608
  buffer_store_dwordx4 v[60:63], v28, s[24:27], s53 offen sc0 sc1
  v_accvgpr_read_b32 v48, a8
  v_accvgpr_read_b32 v49, a9
  v_accvgpr_read_b32 v50, a10
  v_accvgpr_read_b32 v51, a11
  v_accvgpr_read_b32 v52, a24
  v_accvgpr_read_b32 v53, a25
  v_accvgpr_read_b32 v54, a26
  v_accvgpr_read_b32 v55, a27
  v_mul_f32 v48, v48, v39
  v_mul_f32 v49, v49, v39
  v_mul_f32 v50, v50, v39
  v_mul_f32 v51, v51, v39
  v_mul_f32 v52, v52, v39
  v_mul_f32 v53, v53, v39
  v_mul_f32 v54, v54, v39
  v_mul_f32 v55, v55, v39
  v_cvt_pk_bf16_f32 v56, v48, v49
  v_cvt_pk_bf16_f32 v57, v50, v51
  v_cvt_pk_bf16_f32 v58, v52, v53
  v_cvt_pk_bf16_f32 v59, v54, v55
  s_add_u32 s53, s72, 393216
  buffer_store_dwordx4 v[56:59], v28, s[24:27], s53 offen sc0 sc1
  v_accvgpr_read_b32 v48, a12
  v_accvgpr_read_b32 v49, a13
  v_accvgpr_read_b32 v50, a14
  v_accvgpr_read_b32 v51, a15
  v_accvgpr_read_b32 v52, a28
  v_accvgpr_read_b32 v53, a29
  v_accvgpr_read_b32 v54, a30
  v_accvgpr_read_b32 v55, a31
  v_mul_f32 v48, v48, v40
  v_mul_f32 v49, v49, v40
  v_mul_f32 v50, v50, v40
  v_mul_f32 v51, v51, v40
  v_mul_f32 v52, v52, v40
  v_mul_f32 v53, v53, v40
  v_mul_f32 v54, v54, v40
  v_mul_f32 v55, v55, v40
  v_cvt_pk_bf16_f32 v60, v48, v49
  v_cvt_pk_bf16_f32 v61, v50, v51
  v_cvt_pk_bf16_f32 v62, v52, v53
  v_cvt_pk_bf16_f32 v63, v54, v55
  s_add_u32 s53, s72, 589824
  buffer_store_dwordx4 v[60:63], v28, s[24:27], s53 offen sc0 sc1
  v_accvgpr_read_b32 v48, a32
  v_accvgpr_read_b32 v49, a33
  v_accvgpr_read_b32 v50, a34
  v_accvgpr_read_b32 v51, a35
  v_accvgpr_read_b32 v52, a48
  v_accvgpr_read_b32 v53, a49
  v_accvgpr_read_b32 v54, a50
  v_accvgpr_read_b32 v55, a51
  v_mul_f32 v48, v48, v37
  v_mul_f32 v49, v49, v37
  v_mul_f32 v50, v50, v37
  v_mul_f32 v51, v51, v37
  v_mul_f32 v52, v52, v37
  v_mul_f32 v53, v53, v37
  v_mul_f32 v54, v54, v37
  v_mul_f32 v55, v55, v37
  v_cvt_pk_bf16_f32 v56, v48, v49
  v_cvt_pk_bf16_f32 v57, v50, v51
  v_cvt_pk_bf16_f32 v58, v52, v53
  v_cvt_pk_bf16_f32 v59, v54, v55
  s_add_u32 s53, s72, 1024
  buffer_store_dwordx4 v[56:59], v28, s[24:27], s53 offen sc0 sc1
  v_accvgpr_read_b32 v48, a36
  v_accvgpr_read_b32 v49, a37
  v_accvgpr_read_b32 v50, a38
  v_accvgpr_read_b32 v51, a39
  v_accvgpr_read_b32 v52, a52
  v_accvgpr_read_b32 v53, a53
  v_accvgpr_read_b32 v54, a54
  v_accvgpr_read_b32 v55, a55
  v_mul_f32 v48, v48, v38
  v_mul_f32 v49, v49, v38
  v_mul_f32 v50, v50, v38
  v_mul_f32 v51, v51, v38
  v_mul_f32 v52, v52, v38
  v_mul_f32 v53, v53, v38
  v_mul_f32 v54, v54, v38
  v_mul_f32 v55, v55, v38
  v_cvt_pk_bf16_f32 v60, v48, v49
  v_cvt_pk_bf16_f32 v61, v50, v51
  v_cvt_pk_bf16_f32 v62, v52, v53
  v_cvt_pk_bf16_f32 v63, v54, v55
  s_add_u32 s53, s72, 197632
  buffer_store_dwordx4 v[60:63], v28, s[24:27], s53 offen sc0 sc1
  v_accvgpr_read_b32 v48, a40
  v_accvgpr_read_b32 v49, a41
  v_accvgpr_read_b32 v50, a42
  v_accvgpr_read_b32 v51, a43
  v_accvgpr_read_b32 v52, a56
  v_accvgpr_read_b32 v53, a57
  v_accvgpr_read_b32 v54, a58
  v_accvgpr_read_b32 v55, a59
  v_mul_f32 v48, v48, v39
  v_mul_f32 v49, v49, v39
  v_mul_f32 v50, v50, v39
  v_mul_f32 v51, v51, v39
  v_mul_f32 v52, v52, v39
  v_mul_f32 v53, v53, v39
  v_mul_f32 v54, v54, v39
  v_mul_f32 v55, v55, v39
  v_cvt_pk_bf16_f32 v56, v48, v49
  v_cvt_pk_bf16_f32 v57, v50, v51
  v_cvt_pk_bf16_f32 v58, v52, v53
  v_cvt_pk_bf16_f32 v59, v54, v55
  s_add_u32 s53, s72, 394240
  buffer_store_dwordx4 v[56:59], v28, s[24:27], s53 offen sc0 sc1
  v_accvgpr_read_b32 v48, a44
  v_accvgpr_read_b32 v49, a45
  v_accvgpr_read_b32 v50, a46
  v_accvgpr_read_b32 v51, a47
  v_accvgpr_read_b32 v52, a60
  v_accvgpr_read_b32 v53, a61
  v_accvgpr_read_b32 v54, a62
  v_accvgpr_read_b32 v55, a63
  v_mul_f32 v48, v48, v40
  v_mul_f32 v49, v49, v40
  v_mul_f32 v50, v50, v40
  v_mul_f32 v51, v51, v40
  v_mul_f32 v52, v52, v40
  v_mul_f32 v53, v53, v40
  v_mul_f32 v54, v54, v40
  v_mul_f32 v55, v55, v40
  v_cvt_pk_bf16_f32 v60, v48, v49
  v_cvt_pk_bf16_f32 v61, v50, v51
  v_cvt_pk_bf16_f32 v62, v52, v53
  v_cvt_pk_bf16_f32 v63, v54, v55
  s_add_u32 s53, s72, 590848
  buffer_store_dwordx4 v[60:63], v28, s[24:27], s53 offen sc0 sc1
  v_accvgpr_read_b32 v48, a64
  v_accvgpr_read_b32 v49, a65
  v_accvgpr_read_b32 v50, a66
  v_accvgpr_read_b32 v51, a67
  v_accvgpr_read_b32 v52, a80
  v_accvgpr_read_b32 v53, a81
  v_accvgpr_read_b32 v54, a82
  v_accvgpr_read_b32 v55, a83
  v_mul_f32 v48, v48, v37
  v_mul_f32 v49, v49, v37
  v_mul_f32 v50, v50, v37
  v_mul_f32 v51, v51, v37
  v_mul_f32 v52, v52, v37
  v_mul_f32 v53, v53, v37
  v_mul_f32 v54, v54, v37
  v_mul_f32 v55, v55, v37
  v_cvt_pk_bf16_f32 v56, v48, v49
  v_cvt_pk_bf16_f32 v57, v50, v51
  v_cvt_pk_bf16_f32 v58, v52, v53
  v_cvt_pk_bf16_f32 v59, v54, v55
  s_add_u32 s53, s72, 2048
  buffer_store_dwordx4 v[56:59], v28, s[24:27], s53 offen sc0 sc1
  v_accvgpr_read_b32 v48, a68
  v_accvgpr_read_b32 v49, a69
  v_accvgpr_read_b32 v50, a70
  v_accvgpr_read_b32 v51, a71
  v_accvgpr_read_b32 v52, a84
  v_accvgpr_read_b32 v53, a85
  v_accvgpr_read_b32 v54, a86
  v_accvgpr_read_b32 v55, a87
  v_mul_f32 v48, v48, v38
  v_mul_f32 v49, v49, v38
  v_mul_f32 v50, v50, v38
  v_mul_f32 v51, v51, v38
  v_mul_f32 v52, v52, v38
  v_mul_f32 v53, v53, v38
  v_mul_f32 v54, v54, v38
  v_mul_f32 v55, v55, v38
  v_cvt_pk_bf16_f32 v60, v48, v49
  v_cvt_pk_bf16_f32 v61, v50, v51
  v_cvt_pk_bf16_f32 v62, v52, v53
  v_cvt_pk_bf16_f32 v63, v54, v55
  s_add_u32 s53, s72, 198656
  buffer_store_dwordx4 v[60:63], v28, s[24:27], s53 offen sc0 sc1
  v_accvgpr_read_b32 v48, a72
  v_accvgpr_read_b32 v49, a73
  v_accvgpr_read_b32 v50, a74
  v_accvgpr_read_b32 v51, a75
  v_accvgpr_read_b32 v52, a88
  v_accvgpr_read_b32 v53, a89
  v_accvgpr_read_b32 v54, a90
  v_accvgpr_read_b32 v55, a91
  v_mul_f32 v48, v48, v39
  v_mul_f32 v49, v49, v39
  v_mul_f32 v50, v50, v39
  v_mul_f32 v51, v51, v39
  v_mul_f32 v52, v52, v39
  v_mul_f32 v53, v53, v39
  v_mul_f32 v54, v54, v39
  v_mul_f32 v55, v55, v39
  v_cvt_pk_bf16_f32 v56, v48, v49
  v_cvt_pk_bf16_f32 v57, v50, v51
  v_cvt_pk_bf16_f32 v58, v52, v53
  v_cvt_pk_bf16_f32 v59, v54, v55
  s_add_u32 s53, s72, 395264
  buffer_store_dwordx4 v[56:59], v28, s[24:27], s53 offen sc0 sc1
  v_accvgpr_read_b32 v48, a76
  v_accvgpr_read_b32 v49, a77
  v_accvgpr_read_b32 v50, a78
  v_accvgpr_read_b32 v51, a79
  v_accvgpr_read_b32 v52, a92
  v_accvgpr_read_b32 v53, a93
  v_accvgpr_read_b32 v54, a94
  v_accvgpr_read_b32 v55, a95
  v_mul_f32 v48, v48, v40
  v_mul_f32 v49, v49, v40
  v_mul_f32 v50, v50, v40
  v_mul_f32 v51, v51, v40
  v_mul_f32 v52, v52, v40
  v_mul_f32 v53, v53, v40
  v_mul_f32 v54, v54, v40
  v_mul_f32 v55, v55, v40
  v_cvt_pk_bf16_f32 v60, v48, v49
  v_cvt_pk_bf16_f32 v61, v50, v51
  v_cvt_pk_bf16_f32 v62, v52, v53
  v_cvt_pk_bf16_f32 v63, v54, v55
  s_add_u32 s53, s72, 591872
  buffer_store_dwordx4 v[60:63], v28, s[24:27], s53 offen sc0 sc1
  v_accvgpr_read_b32 v48, a96
  v_accvgpr_read_b32 v49, a97
  v_accvgpr_read_b32 v50, a98
  v_accvgpr_read_b32 v51, a99
  v_accvgpr_read_b32 v52, a112
  v_accvgpr_read_b32 v53, a113
  v_accvgpr_read_b32 v54, a114
  v_accvgpr_read_b32 v55, a115
  v_mul_f32 v48, v48, v37
  v_mul_f32 v49, v49, v37
  v_mul_f32 v50, v50, v37
  v_mul_f32 v51, v51, v37
  v_mul_f32 v52, v52, v37
  v_mul_f32 v53, v53, v37
  v_mul_f32 v54, v54, v37
  v_mul_f32 v55, v55, v37
  v_cvt_pk_bf16_f32 v56, v48, v49
  v_cvt_pk_bf16_f32 v57, v50, v51
  v_cvt_pk_bf16_f32 v58, v52, v53
  v_cvt_pk_bf16_f32 v59, v54, v55
  s_add_u32 s53, s72, 3072
  buffer_store_dwordx4 v[56:59], v28, s[24:27], s53 offen sc0 sc1
  v_accvgpr_read_b32 v48, a100
  v_accvgpr_read_b32 v49, a101
  v_accvgpr_read_b32 v50, a102
  v_accvgpr_read_b32 v51, a103
  v_accvgpr_read_b32 v52, a116
  v_accvgpr_read_b32 v53, a117
  v_accvgpr_read_b32 v54, a118
  v_accvgpr_read_b32 v55, a119
  v_mul_f32 v48, v48, v38
  v_mul_f32 v49, v49, v38
  v_mul_f32 v50, v50, v38
  v_mul_f32 v51, v51, v38
  v_mul_f32 v52, v52, v38
  v_mul_f32 v53, v53, v38
  v_mul_f32 v54, v54, v38
  v_mul_f32 v55, v55, v38
  v_cvt_pk_bf16_f32 v60, v48, v49
  v_cvt_pk_bf16_f32 v61, v50, v51
  v_cvt_pk_bf16_f32 v62, v52, v53
  v_cvt_pk_bf16_f32 v63, v54, v55
  s_add_u32 s53, s72, 199680
  buffer_store_dwordx4 v[60:63], v28, s[24:27], s53 offen sc0 sc1
  v_accvgpr_read_b32 v48, a104
  v_accvgpr_read_b32 v49, a105
  v_accvgpr_read_b32 v50, a106
  v_accvgpr_read_b32 v51, a107
  v_accvgpr_read_b32 v52, a120
  v_accvgpr_read_b32 v53, a121
  v_accvgpr_read_b32 v54, a122
  v_accvgpr_read_b32 v55, a123
  v_mul_f32 v48, v48, v39
  v_mul_f32 v49, v49, v39
  v_mul_f32 v50, v50, v39
  v_mul_f32 v51, v51, v39
  v_mul_f32 v52, v52, v39
  v_mul_f32 v53, v53, v39
  v_mul_f32 v54, v54, v39
  v_mul_f32 v55, v55, v39
  v_cvt_pk_bf16_f32 v56, v48, v49
  v_cvt_pk_bf16_f32 v57, v50, v51
  v_cvt_pk_bf16_f32 v58, v52, v53
  v_cvt_pk_bf16_f32 v59, v54, v55
  s_add_u32 s53, s72, 396288
  buffer_store_dwordx4 v[56:59], v28, s[24:27], s53 offen sc0 sc1
  v_accvgpr_read_b32 v48, a108
  v_accvgpr_read_b32 v49, a109
  v_accvgpr_read_b32 v50, a110
  v_accvgpr_read_b32 v51, a111
  v_accvgpr_read_b32 v52, a124
  v_accvgpr_read_b32 v53, a125
  v_accvgpr_read_b32 v54, a126
  v_accvgpr_read_b32 v55, a127
  v_mul_f32 v48, v48, v40
  v_mul_f32 v49, v49, v40
  v_mul_f32 v50, v50, v40
  v_mul_f32 v51, v51, v40
  v_mul_f32 v52, v52, v40
  v_mul_f32 v53, v53, v40
  v_mul_f32 v54, v54, v40
  v_mul_f32 v55, v55, v40
  v_cvt_pk_bf16_f32 v60, v48, v49
  v_cvt_pk_bf16_f32 v61, v50, v51
  v_cvt_pk_bf16_f32 v62, v52, v53
  v_cvt_pk_bf16_f32 v63, v54, v55
  s_add_u32 s53, s72, 592896
  buffer_store_dwordx4 v[60:63], v28, s[24:27], s53 offen sc0 sc1
  v_accvgpr_read_b32 v48, a128
  v_accvgpr_read_b32 v49, a129
  v_accvgpr_read_b32 v50, a130
  v_accvgpr_read_b32 v51, a131
  v_accvgpr_read_b32 v52, a144
  v_accvgpr_read_b32 v53, a145
  v_accvgpr_read_b32 v54, a146
  v_accvgpr_read_b32 v55, a147
  v_mul_f32 v48, v48, v37
  v_mul_f32 v49, v49, v37
  v_mul_f32 v50, v50, v37
  v_mul_f32 v51, v51, v37
  v_mul_f32 v52, v52, v37
  v_mul_f32 v53, v53, v37
  v_mul_f32 v54, v54, v37
  v_mul_f32 v55, v55, v37
  v_cvt_pk_bf16_f32 v56, v48, v49
  v_cvt_pk_bf16_f32 v57, v50, v51
  v_cvt_pk_bf16_f32 v58, v52, v53
  v_cvt_pk_bf16_f32 v59, v54, v55
  s_add_u32 s53, s72, 4096
  buffer_store_dwordx4 v[56:59], v28, s[24:27], s53 offen sc0 sc1
  v_accvgpr_read_b32 v48, a132
  v_accvgpr_read_b32 v49, a133
  v_accvgpr_read_b32 v50, a134
  v_accvgpr_read_b32 v51, a135
  v_accvgpr_read_b32 v52, a148
  v_accvgpr_read_b32 v53, a149
  v_accvgpr_read_b32 v54, a150
  v_accvgpr_read_b32 v55, a151
  v_mul_f32 v48, v48, v38
  v_mul_f32 v49, v49, v38
  v_mul_f32 v50, v50, v38
  v_mul_f32 v51, v51, v38
  v_mul_f32 v52, v52, v38
  v_mul_f32 v53, v53, v38
  v_mul_f32 v54, v54, v38
  v_mul_f32 v55, v55, v38
  v_cvt_pk_bf16_f32 v60, v48, v49
  v_cvt_pk_bf16_f32 v61, v50, v51
  v_cvt_pk_bf16_f32 v62, v52, v53
  v_cvt_pk_bf16_f32 v63, v54, v55
  s_add_u32 s53, s72, 200704
  buffer_store_dwordx4 v[60:63], v28, s[24:27], s53 offen sc0 sc1
  v_accvgpr_read_b32 v48, a136
  v_accvgpr_read_b32 v49, a137
  v_accvgpr_read_b32 v50, a138
  v_accvgpr_read_b32 v51, a139
  v_accvgpr_read_b32 v52, a152
  v_accvgpr_read_b32 v53, a153
  v_accvgpr_read_b32 v54, a154
  v_accvgpr_read_b32 v55, a155
  v_mul_f32 v48, v48, v39
  v_mul_f32 v49, v49, v39
  v_mul_f32 v50, v50, v39
  v_mul_f32 v51, v51, v39
  v_mul_f32 v52, v52, v39
  v_mul_f32 v53, v53, v39
  v_mul_f32 v54, v54, v39
  v_mul_f32 v55, v55, v39
  v_cvt_pk_bf16_f32 v56, v48, v49
  v_cvt_pk_bf16_f32 v57, v50, v51
  v_cvt_pk_bf16_f32 v58, v52, v53
  v_cvt_pk_bf16_f32 v59, v54, v55
  s_add_u32 s53, s72, 397312
  buffer_store_dwordx4 v[56:59], v28, s[24:27], s53 offen sc0 sc1
  v_accvgpr_read_b32 v48, a140
  v_accvgpr_read_b32 v49, a141
  v_accvgpr_read_b32 v50, a142
  v_accvgpr_read_b32 v51, a143
  v_accvgpr_read_b32 v52, a156
  v_accvgpr_read_b32 v53, a157
  v_accvgpr_read_b32 v54, a158
  v_accvgpr_read_b32 v55, a159
  v_mul_f32 v48, v48, v40
  v_mul_f32 v49, v49, v40
  v_mul_f32 v50, v50, v40
  v_mul_f32 v51, v51, v40
  v_mul_f32 v52, v52, v40
  v_mul_f32 v53, v53, v40
  v_mul_f32 v54, v54, v40
  v_mul_f32 v55, v55, v40
  v_cvt_pk_bf16_f32 v60, v48, v49
  v_cvt_pk_bf16_f32 v61, v50, v51
  v_cvt_pk_bf16_f32 v62, v52, v53
  v_cvt_pk_bf16_f32 v63, v54, v55
  s_add_u32 s53, s72, 593920
  buffer_store_dwordx4 v[60:63], v28, s[24:27], s53 offen sc0 sc1
  v_accvgpr_read_b32 v48, a160
  v_accvgpr_read_b32 v49, a161
  v_accvgpr_read_b32 v50, a162
  v_accvgpr_read_b32 v51, a163
  v_accvgpr_read_b32 v52, a176
  v_accvgpr_read_b32 v53, a177
  v_accvgpr_read_b32 v54, a178
  v_accvgpr_read_b32 v55, a179
  v_mul_f32 v48, v48, v37
  v_mul_f32 v49, v49, v37
  v_mul_f32 v50, v50, v37
  v_mul_f32 v51, v51, v37
  v_mul_f32 v52, v52, v37
  v_mul_f32 v53, v53, v37
  v_mul_f32 v54, v54, v37
  v_mul_f32 v55, v55, v37
  v_cvt_pk_bf16_f32 v56, v48, v49
  v_cvt_pk_bf16_f32 v57, v50, v51
  v_cvt_pk_bf16_f32 v58, v52, v53
  v_cvt_pk_bf16_f32 v59, v54, v55
  s_add_u32 s53, s72, 5120
  buffer_store_dwordx4 v[56:59], v28, s[24:27], s53 offen sc0 sc1
  v_accvgpr_read_b32 v48, a164
  v_accvgpr_read_b32 v49, a165
  v_accvgpr_read_b32 v50, a166
  v_accvgpr_read_b32 v51, a167
  v_accvgpr_read_b32 v52, a180
  v_accvgpr_read_b32 v53, a181
  v_accvgpr_read_b32 v54, a182
  v_accvgpr_read_b32 v55, a183
  v_mul_f32 v48, v48, v38
  v_mul_f32 v49, v49, v38
  v_mul_f32 v50, v50, v38
  v_mul_f32 v51, v51, v38
  v_mul_f32 v52, v52, v38
  v_mul_f32 v53, v53, v38
  v_mul_f32 v54, v54, v38
  v_mul_f32 v55, v55, v38
  v_cvt_pk_bf16_f32 v60, v48, v49
  v_cvt_pk_bf16_f32 v61, v50, v51
  v_cvt_pk_bf16_f32 v62, v52, v53
  v_cvt_pk_bf16_f32 v63, v54, v55
  s_add_u32 s53, s72, 201728
  buffer_store_dwordx4 v[60:63], v28, s[24:27], s53 offen sc0 sc1
  v_accvgpr_read_b32 v48, a168
  v_accvgpr_read_b32 v49, a169
  v_accvgpr_read_b32 v50, a170
  v_accvgpr_read_b32 v51, a171
  v_accvgpr_read_b32 v52, a184
  v_accvgpr_read_b32 v53, a185
  v_accvgpr_read_b32 v54, a186
  v_accvgpr_read_b32 v55, a187
  v_mul_f32 v48, v48, v39
  v_mul_f32 v49, v49, v39
  v_mul_f32 v50, v50, v39
  v_mul_f32 v51, v51, v39
  v_mul_f32 v52, v52, v39
  v_mul_f32 v53, v53, v39
  v_mul_f32 v54, v54, v39
  v_mul_f32 v55, v55, v39
  v_cvt_pk_bf16_f32 v56, v48, v49
  v_cvt_pk_bf16_f32 v57, v50, v51
  v_cvt_pk_bf16_f32 v58, v52, v53
  v_cvt_pk_bf16_f32 v59, v54, v55
  s_add_u32 s53, s72, 398336
  buffer_store_dwordx4 v[56:59], v28, s[24:27], s53 offen sc0 sc1
  v_accvgpr_read_b32 v48, a172
  v_accvgpr_read_b32 v49, a173
  v_accvgpr_read_b32 v50, a174
  v_accvgpr_read_b32 v51, a175
  v_accvgpr_read_b32 v52, a188
  v_accvgpr_read_b32 v53, a189
  v_accvgpr_read_b32 v54, a190
  v_accvgpr_read_b32 v55, a191
  v_mul_f32 v48, v48, v40
  v_mul_f32 v49, v49, v40
  v_mul_f32 v50, v50, v40
  v_mul_f32 v51, v51, v40
  v_mul_f32 v52, v52, v40
  v_mul_f32 v53, v53, v40
  v_mul_f32 v54, v54, v40
  v_mul_f32 v55, v55, v40
  v_cvt_pk_bf16_f32 v60, v48, v49
  v_cvt_pk_bf16_f32 v61, v50, v51
  v_cvt_pk_bf16_f32 v62, v52, v53
  v_cvt_pk_bf16_f32 v63, v54, v55
  s_add_u32 s53, s72, 594944
  buffer_store_dwordx4 v[60:63], v28, s[24:27], s53 offen sc0 sc1
  s_sub_u32 s72, s72, s68
  s_waitcnt vmcnt(0) lgkmcnt(0)
  s_barrier
  s_add_u32 s56, s56, 1
  s_cmp_lt_u32 s56, 2
  s_cbranch_scc1 K1_COLD
  s_branch K1_FIN
RARE_20_0:
  v_mov_b32 v1, v92
  s_nop 1
  v_permlane32_swap_b32 v92, v1
  v_max_f32 v92, v92, v1
  v_mov_b32 v1, v92
  s_nop 1
  v_permlane16_swap_b32 v92, v1
  v_max_f32 v92, v92, v1
  v_max_f32 v92, v92, v84
  v_sub_f32 v1, v84, v92
  v_exp_f32 v29, v1
  v_mov_b32 v84, v92
  v_sub_f32 v88, 0, v92
  v_add_f32 v33, 0x41000000, v92
  s_mov_b32 s66, 1
  s_branch RET_20_0
RARE_20_1:
  v_mov_b32 v2, v93
  s_nop 1
  v_permlane32_swap_b32 v93, v2
  v_max_f32 v93, v93, v2
  v_mov_b32 v2, v93
  s_nop 1
  v_permlane16_swap_b32 v93, v2
  v_max_f32 v93, v93, v2
  v_max_f32 v93, v93, v85
  v_sub_f32 v2, v85, v93
  v_exp_f32 v30, v2
  v_mov_b32 v85, v93
  v_sub_f32 v89, 0, v93
  v_add_f32 v34, 0x41000000, v93
  s_mov_b32 s66, 1
  s_branch RET_20_1
RARE_20_2:
  v_mov_b32 v3, v94
  s_nop 1
  v_permlane32_swap_b32 v94, v3
  v_max_f32 v94, v94, v3
  v_mov_b32 v3, v94
  s_nop 1
  v_permlane16_swap_b32 v94, v3
  v_max_f32 v94, v94, v3
  v_max_f32 v94, v94, v86
  v_sub_f32 v3, v86, v94
  v_exp_f32 v31, v3
  v_mov_b32 v86, v94
  v_sub_f32 v90, 0, v94
  v_add_f32 v35, 0x41000000, v94
  s_mov_b32 s66, 1
  s_branch RET_20_2
RARE_20_3:
  v_mov_b32 v4, v95
  s_nop 1
  v_permlane32_swap_b32 v95, v4
  v_max_f32 v95, v95, v4
  v_mov_b32 v4, v95
  s_nop 1
  v_permlane16_swap_b32 v95, v4
  v_max_f32 v95, v95, v4
  v_max_f32 v95, v95, v87
  v_sub_f32 v4, v87, v95
  v_exp_f32 v32, v4
  v_mov_b32 v87, v95
  v_sub_f32 v91, 0, v95
  v_add_f32 v36, 0x41000000, v95
  s_mov_b32 s66, 1
  s_branch RET_20_3
RARE_21_0:
  v_mov_b32 v1, v92
  s_nop 1
  v_permlane32_swap_b32 v92, v1
  v_max_f32 v92, v92, v1
  v_mov_b32 v1, v92
  s_nop 1
  v_permlane16_swap_b32 v92, v1
  v_max_f32 v92, v92, v1
  v_max_f32 v92, v92, v84
  v_sub_f32 v1, v84, v92
  v_exp_f32 v29, v1
  v_mov_b32 v84, v92
  v_sub_f32 v88, 0, v92
  v_add_f32 v33, 0x41000000, v92
  s_mov_b32 s66, 1
  s_branch RET_21_0
RARE_21_1:
  v_mov_b32 v2, v93
  s_nop 1
  v_permlane32_swap_b32 v93, v2
  v_max_f32 v93, v93, v2
  v_mov_b32 v2, v93
  s_nop 1
  v_permlane16_swap_b32 v93, v2
  v_max_f32 v93, v93, v2
  v_max_f32 v93, v93, v85
  v_sub_f32 v2, v85, v93
  v_exp_f32 v30, v2
  v_mov_b32 v85, v93
  v_sub_f32 v89, 0, v93
  v_add_f32 v34, 0x41000000, v93
  s_mov_b32 s66, 1
  s_branch RET_21_1
RARE_21_2:
  v_mov_b32 v3, v94
  s_nop 1
  v_permlane32_swap_b32 v94, v3
  v_max_f32 v94, v94, v3
  v_mov_b32 v3, v94
  s_nop 1
  v_permlane16_swap_b32 v94, v3
  v_max_f32 v94, v94, v3
  v_max_f32 v94, v94, v86
  v_sub_f32 v3, v86, v94
  v_exp_f32 v31, v3
  v_mov_b32 v86, v94
  v_sub_f32 v90, 0, v94
  v_add_f32 v35, 0x41000000, v94
  s_mov_b32 s66, 1
  s_branch RET_21_2
RARE_21_3:
  v_mov_b32 v4, v95
  s_nop 1
  v_permlane32_swap_b32 v95, v4
  v_max_f32 v95, v95, v4
  v_mov_b32 v4, v95
  s_nop 1
  v_permlane16_swap_b32 v95, v4
  v_max_f32 v95, v95, v4
  v_max_f32 v95, v95, v87
  v_sub_f32 v4, v87, v95
  v_exp_f32 v32, v4
  v_mov_b32 v87, v95
  v_sub_f32 v91, 0, v95
  v_add_f32 v36, 0x41000000, v95
  s_mov_b32 s66, 1
  s_branch RET_21_3
RARE_22_0:
  v_mov_b32 v1, v92
  s_nop 1
  v_permlane32_swap_b32 v92, v1
  v_max_f32 v92, v92, v1
  v_mov_b32 v1, v92
  s_nop 1
  v_permlane16_swap_b32 v92, v1
  v_max_f32 v92, v92, v1
  v_max_f32 v92, v92, v84
  v_sub_f32 v1, v84, v92
  v_exp_f32 v29, v1
  v_mov_b32 v84, v92
  v_sub_f32 v88, 0, v92
  v_add_f32 v33, 0x41000000, v92
  s_mov_b32 s66, 1
  s_branch RET_22_0
RARE_22_1:
  v_mov_b32 v2, v93
  s_nop 1
  v_permlane32_swap_b32 v93, v2
  v_max_f32 v93, v93, v2
  v_mov_b32 v2, v93
  s_nop 1
  v_permlane16_swap_b32 v93, v2
  v_max_f32 v93, v93, v2
  v_max_f32 v93, v93, v85
  v_sub_f32 v2, v85, v93
  v_exp_f32 v30, v2
  v_mov_b32 v85, v93
  v_sub_f32 v89, 0, v93
  v_add_f32 v34, 0x41000000, v93
  s_mov_b32 s66, 1
  s_branch RET_22_1
RARE_22_2:
  v_mov_b32 v3, v94
  s_nop 1
  v_permlane32_swap_b32 v94, v3
  v_max_f32 v94, v94, v3
  v_mov_b32 v3, v94
  s_nop 1
  v_permlane16_swap_b32 v94, v3
  v_max_f32 v94, v94, v3
  v_max_f32 v94, v94, v86
  v_sub_f32 v3, v86, v94
  v_exp_f32 v31, v3
  v_mov_b32 v86, v94
  v_sub_f32 v90, 0, v94
  v_add_f32 v35, 0x41000000, v94
  s_mov_b32 s66, 1
  s_branch RET_22_2
RARE_22_3:
  v_mov_b32 v4, v95
  s_nop 1
  v_permlane32_swap_b32 v95, v4
  v_max_f32 v95, v95, v4
  v_mov_b32 v4, v95
  s_nop 1
  v_permlane16_swap_b32 v95, v4
  v_max_f32 v95, v95, v4
  v_max_f32 v95, v95, v87
  v_sub_f32 v4, v87, v95
  v_exp_f32 v32, v4
  v_mov_b32 v87, v95
  v_sub_f32 v91, 0, v95
  v_add_f32 v36, 0x41000000, v95
  s_mov_b32 s66, 1
  s_branch RET_22_3
RESCALE:
  s_nop 15
  v_mul_f32 v80, v80, v29
  v_accvgpr_read_b32 v1, a0
  v_accvgpr_read_b32 v2, a1
  v_accvgpr_read_b32 v3, a2
  v_accvgpr_read_b32 v4, a3
  v_accvgpr_read_b32 v5, a16
  v_accvgpr_read_b32 v6, a17
  v_accvgpr_read_b32 v7, a18
  v_accvgpr_read_b32 v8, a19
  v_mul_f32 v1, v1, v29
  v_mul_f32 v2, v2, v29
  v_mul_f32 v3, v3, v29
  v_mul_f32 v4, v4, v29
  v_mul_f32 v5, v5, v29
  v_mul_f32 v6, v6, v29
  v_mul_f32 v7, v7, v29
  v_mul_f32 v8, v8, v29
  v_accvgpr_write_b32 a0, v1
  v_accvgpr_write_b32 a1, v2
  v_accvgpr_write_b32 a2, v3
  v_accvgpr_write_b32 a3, v4
  v_accvgpr_write_b32 a16, v5
  v_accvgpr_write_b32 a17, v6
  v_accvgpr_write_b32 a18, v7
  v_accvgpr_write_b32 a19, v8
  v_accvgpr_read_b32 v1, a32
  v_accvgpr_read_b32 v2, a33
  v_accvgpr_read_b32 v3, a34
  v_accvgpr_read_b32 v4, a35
  v_accvgpr_read_b32 v5, a48
  v_accvgpr_read_b32 v6, a49
  v_accvgpr_read_b32 v7, a50
  v_accvgpr_read_b32 v8, a51
  v_mul_f32 v1, v1, v29
  v_mul_f32 v2, v2, v29
  v_mul_f32 v3, v3, v29
  v_mul_f32 v4, v4, v29
  v_mul_f32 v5, v5, v29
  v_mul_f32 v6, v6, v29
  v_mul_f32 v7, v7, v29
  v_mul_f32 v8, v8, v29
  v_accvgpr_write_b32 a32, v1
  v_accvgpr_write_b32 a33, v2
  v_accvgpr_write_b32 a34, v3
  v_accvgpr_write_b32 a35, v4
  v_accvgpr_write_b32 a48, v5
  v_accvgpr_write_b32 a49, v6
  v_accvgpr_write_b32 a50, v7
  v_accvgpr_write_b32 a51, v8
  v_accvgpr_read_b32 v1, a64
  v_accvgpr_read_b32 v2, a65
  v_accvgpr_read_b32 v3, a66
  v_accvgpr_read_b32 v4, a67
  v_accvgpr_read_b32 v5, a80
  v_accvgpr_read_b32 v6, a81
  v_accvgpr_read_b32 v7, a82
  v_accvgpr_read_b32 v8, a83
  v_mul_f32 v1, v1, v29
  v_mul_f32 v2, v2, v29
  v_mul_f32 v3, v3, v29
  v_mul_f32 v4, v4, v29
  v_mul_f32 v5, v5, v29
  v_mul_f32 v6, v6, v29
  v_mul_f32 v7, v7, v29
  v_mul_f32 v8, v8, v29
  v_accvgpr_write_b32 a64, v1
  v_accvgpr_write_b32 a65, v2
  v_accvgpr_write_b32 a66, v3
  v_accvgpr_write_b32 a67, v4
  v_accvgpr_write_b32 a80, v5
  v_accvgpr_write_b32 a81, v6
  v_accvgpr_write_b32 a82, v7
  v_accvgpr_write_b32 a83, v8
  v_accvgpr_read_b32 v1, a96
  v_accvgpr_read_b32 v2, a97
  v_accvgpr_read_b32 v3, a98
  v_accvgpr_read_b32 v4, a99
  v_accvgpr_read_b32 v5, a112
  v_accvgpr_read_b32 v6, a113
  v_accvgpr_read_b32 v7, a114
  v_accvgpr_read_b32 v8, a115
  v_mul_f32 v1, v1, v29
  v_mul_f32 v2, v2, v29
  v_mul_f32 v3, v3, v29
  v_mul_f32 v4, v4, v29
  v_mul_f32 v5, v5, v29
  v_mul_f32 v6, v6, v29
  v_mul_f32 v7, v7, v29
  v_mul_f32 v8, v8, v29
  v_accvgpr_write_b32 a96, v1
  v_accvgpr_write_b32 a97, v2
  v_accvgpr_write_b32 a98, v3
  v_accvgpr_write_b32 a99, v4
  v_accvgpr_write_b32 a112, v5
  v_accvgpr_write_b32 a113, v6
  v_accvgpr_write_b32 a114, v7
  v_accvgpr_write_b32 a115, v8
  v_accvgpr_read_b32 v1, a128
  v_accvgpr_read_b32 v2, a129
  v_accvgpr_read_b32 v3, a130
  v_accvgpr_read_b32 v4, a131
  v_accvgpr_read_b32 v5, a144
  v_accvgpr_read_b32 v6, a145
  v_accvgpr_read_b32 v7, a146
  v_accvgpr_read_b32 v8, a147
  v_mul_f32 v1, v1, v29
  v_mul_f32 v2, v2, v29
  v_mul_f32 v3, v3, v29
  v_mul_f32 v4, v4, v29
  v_mul_f32 v5, v5, v29
  v_mul_f32 v6, v6, v29
  v_mul_f32 v7, v7, v29
  v_mul_f32 v8, v8, v29
  v_accvgpr_write_b32 a128, v1
  v_accvgpr_write_b32 a129, v2
  v_accvgpr_write_b32 a130, v3
  v_accvgpr_write_b32 a131, v4
  v_accvgpr_write_b32 a144, v5
  v_accvgpr_write_b32 a145, v6
  v_accvgpr_write_b32 a146, v7
  v_accvgpr_write_b32 a147, v8
  v_accvgpr_read_b32 v1, a160
  v_accvgpr_read_b32 v2, a161
  v_accvgpr_read_b32 v3, a162
  v_accvgpr_read_b32 v4, a163
  v_accvgpr_read_b32 v5, a176
  v_accvgpr_read_b32 v6, a177
  v_accvgpr_read_b32 v7, a178
  v_accvgpr_read_b32 v8, a179
  v_mul_f32 v1, v1, v29
  v_mul_f32 v2, v2, v29
  v_mul_f32 v3, v3, v29
  v_mul_f32 v4, v4, v29
  v_mul_f32 v5, v5, v29
  v_mul_f32 v6, v6, v29
  v_mul_f32 v7, v7, v29
  v_mul_f32 v8, v8, v29
  v_accvgpr_write_b32 a160, v1
  v_accvgpr_write_b32 a161, v2
  v_accvgpr_write_b32 a162, v3
  v_accvgpr_write_b32 a163, v4
  v_accvgpr_write_b32 a176, v5
  v_accvgpr_write_b32 a177, v6
  v_accvgpr_write_b32 a178, v7
  v_accvgpr_write_b32 a179, v8
  v_mov_b32 v29, 1.0
  v_mul_f32 v81, v81, v30
  v_accvgpr_read_b32 v1, a4
  v_accvgpr_read_b32 v2, a5
  v_accvgpr_read_b32 v3, a6
  v_accvgpr_read_b32 v4, a7
  v_accvgpr_read_b32 v5, a20
  v_accvgpr_read_b32 v6, a21
  v_accvgpr_read_b32 v7, a22
  v_accvgpr_read_b32 v8, a23
  v_mul_f32 v1, v1, v30
  v_mul_f32 v2, v2, v30
  v_mul_f32 v3, v3, v30
  v_mul_f32 v4, v4, v30
  v_mul_f32 v5, v5, v30
  v_mul_f32 v6, v6, v30
  v_mul_f32 v7, v7, v30
  v_mul_f32 v8, v8, v30
  v_accvgpr_write_b32 a4, v1
  v_accvgpr_write_b32 a5, v2
  v_accvgpr_write_b32 a6, v3
  v_accvgpr_write_b32 a7, v4
  v_accvgpr_write_b32 a20, v5
  v_accvgpr_write_b32 a21, v6
  v_accvgpr_write_b32 a22, v7
  v_accvgpr_write_b32 a23, v8
  v_accvgpr_read_b32 v1, a36
  v_accvgpr_read_b32 v2, a37
  v_accvgpr_read_b32 v3, a38
  v_accvgpr_read_b32 v4, a39
  v_accvgpr_read_b32 v5, a52
  v_accvgpr_read_b32 v6, a53
  v_accvgpr_read_b32 v7, a54
  v_accvgpr_read_b32 v8, a55
  v_mul_f32 v1, v1, v30
  v_mul_f32 v2, v2, v30
  v_mul_f32 v3, v3, v30
  v_mul_f32 v4, v4, v30
  v_mul_f32 v5, v5, v30
  v_mul_f32 v6, v6, v30
  v_mul_f32 v7, v7, v30
  v_mul_f32 v8, v8, v30
  v_accvgpr_write_b32 a36, v1
  v_accvgpr_write_b32 a37, v2
  v_accvgpr_write_b32 a38, v3
  v_accvgpr_write_b32 a39, v4
  v_accvgpr_write_b32 a52, v5
  v_accvgpr_write_b32 a53, v6
  v_accvgpr_write_b32 a54, v7
  v_accvgpr_write_b32 a55, v8
  v_accvgpr_read_b32 v1, a68
  v_accvgpr_read_b32 v2, a69
  v_accvgpr_read_b32 v3, a70
  v_accvgpr_read_b32 v4, a71
  v_accvgpr_read_b32 v5, a84
  v_accvgpr_read_b32 v6, a85
  v_accvgpr_read_b32 v7, a86
  v_accvgpr_read_b32 v8, a87
  v_mul_f32 v1, v1, v30
  v_mul_f32 v2, v2, v30
  v_mul_f32 v3, v3, v30
  v_mul_f32 v4, v4, v30
  v_mul_f32 v5, v5, v30
  v_mul_f32 v6, v6, v30
  v_mul_f32 v7, v7, v30
  v_mul_f32 v8, v8, v30
  v_accvgpr_write_b32 a68, v1
  v_accvgpr_write_b32 a69, v2
  v_accvgpr_write_b32 a70, v3
  v_accvgpr_write_b32 a71, v4
  v_accvgpr_write_b32 a84, v5
  v_accvgpr_write_b32 a85, v6
  v_accvgpr_write_b32 a86, v7
  v_accvgpr_write_b32 a87, v8
  v_accvgpr_read_b32 v1, a100
  v_accvgpr_read_b32 v2, a101
  v_accvgpr_read_b32 v3, a102
  v_accvgpr_read_b32 v4, a103
  v_accvgpr_read_b32 v5, a116
  v_accvgpr_read_b32 v6, a117
  v_accvgpr_read_b32 v7, a118
  v_accvgpr_read_b32 v8, a119
  v_mul_f32 v1, v1, v30
  v_mul_f32 v2, v2, v30
  v_mul_f32 v3, v3, v30
  v_mul_f32 v4, v4, v30
  v_mul_f32 v5, v5, v30
  v_mul_f32 v6, v6, v30
  v_mul_f32 v7, v7, v30
  v_mul_f32 v8, v8, v30
  v_accvgpr_write_b32 a100, v1
  v_accvgpr_write_b32 a101, v2
  v_accvgpr_write_b32 a102, v3
  v_accvgpr_write_b32 a103, v4
  v_accvgpr_write_b32 a116, v5
  v_accvgpr_write_b32 a117, v6
  v_accvgpr_write_b32 a118, v7
  v_accvgpr_write_b32 a119, v8
  v_accvgpr_read_b32 v1, a132
  v_accvgpr_read_b32 v2, a133
  v_accvgpr_read_b32 v3, a134
  v_accvgpr_read_b32 v4, a135
  v_accvgpr_read_b32 v5, a148
  v_accvgpr_read_b32 v6, a149
  v_accvgpr_read_b32 v7, a150
  v_accvgpr_read_b32 v8, a151
  v_mul_f32 v1, v1, v30
  v_mul_f32 v2, v2, v30
  v_mul_f32 v3, v3, v30
  v_mul_f32 v4, v4, v30
  v_mul_f32 v5, v5, v30
  v_mul_f32 v6, v6, v30
  v_mul_f32 v7, v7, v30
  v_mul_f32 v8, v8, v30
  v_accvgpr_write_b32 a132, v1
  v_accvgpr_write_b32 a133, v2
  v_accvgpr_write_b32 a134, v3
  v_accvgpr_write_b32 a135, v4
  v_accvgpr_write_b32 a148, v5
  v_accvgpr_write_b32 a149, v6
  v_accvgpr_write_b32 a150, v7
  v_accvgpr_write_b32 a151, v8
  v_accvgpr_read_b32 v1, a164
  v_accvgpr_read_b32 v2, a165
  v_accvgpr_read_b32 v3, a166
  v_accvgpr_read_b32 v4, a167
  v_accvgpr_read_b32 v5, a180
  v_accvgpr_read_b32 v6, a181
  v_accvgpr_read_b32 v7, a182
  v_accvgpr_read_b32 v8, a183
  v_mul_f32 v1, v1, v30
  v_mul_f32 v2, v2, v30
  v_mul_f32 v3, v3, v30
  v_mul_f32 v4, v4, v30
  v_mul_f32 v5, v5, v30
  v_mul_f32 v6, v6, v30
  v_mul_f32 v7, v7, v30
  v_mul_f32 v8, v8, v30
  v_accvgpr_write_b32 a164, v1
  v_accvgpr_write_b32 a165, v2
  v_accvgpr_write_b32 a166, v3
  v_accvgpr_write_b32 a167, v4
  v_accvgpr_write_b32 a180, v5
  v_accvgpr_write_b32 a181, v6
  v_accvgpr_write_b32 a182, v7
  v_accvgpr_write_b32 a183, v8
  v_mov_b32 v30, 1.0
  v_mul_f32 v82, v82, v31
  v_accvgpr_read_b32 v1, a8
  v_accvgpr_read_b32 v2, a9
  v_accvgpr_read_b32 v3, a10
  v_accvgpr_read_b32 v4, a11
  v_accvgpr_read_b32 v5, a24
  v_accvgpr_read_b32 v6, a25
  v_accvgpr_read_b32 v7, a26
  v_accvgpr_read_b32 v8, a27
  v_mul_f32 v1, v1, v31
  v_mul_f32 v2, v2, v31
  v_mul_f32 v3, v3, v31
  v_mul_f32 v4, v4, v31
  v_mul_f32 v5, v5, v31
  v_mul_f32 v6, v6, v31
  v_mul_f32 v7, v7, v31
  v_mul_f32 v8, v8, v31
  v_accvgpr_write_b32 a8, v1
  v_accvgpr_write_b32 a9, v2
  v_accvgpr_write_b32 a10, v3
  v_accvgpr_write_b32 a11, v4
  v_accvgpr_write_b32 a24, v5
  v_accvgpr_write_b32 a25, v6
  v_accvgpr_write_b32 a26, v7
  v_accvgpr_write_b32 a27, v8
  v_accvgpr_read_b32 v1, a40
  v_accvgpr_read_b32 v2, a41
  v_accvgpr_read_b32 v3, a42
  v_accvgpr_read_b32 v4, a43
  v_accvgpr_read_b32 v5, a56
  v_accvgpr_read_b32 v6, a57
  v_accvgpr_read_b32 v7, a58
  v_accvgpr_read_b32 v8, a59
  v_mul_f32 v1, v1, v31
  v_mul_f32 v2, v2, v31
  v_mul_f32 v3, v3, v31
  v_mul_f32 v4, v4, v31
  v_mul_f32 v5, v5, v31
  v_mul_f32 v6, v6, v31
  v_mul_f32 v7, v7, v31
  v_mul_f32 v8, v8, v31
  v_accvgpr_write_b32 a40, v1
  v_accvgpr_write_b32 a41, v2
  v_accvgpr_write_b32 a42, v3
  v_accvgpr_write_b32 a43, v4
  v_accvgpr_write_b32 a56, v5
  v_accvgpr_write_b32 a57, v6
  v_accvgpr_write_b32 a58, v7
  v_accvgpr_write_b32 a59, v8
  v_accvgpr_read_b32 v1, a72
  v_accvgpr_read_b32 v2, a73
  v_accvgpr_read_b32 v3, a74
  v_accvgpr_read_b32 v4, a75
  v_accvgpr_read_b32 v5, a88
  v_accvgpr_read_b32 v6, a89
  v_accvgpr_read_b32 v7, a90
  v_accvgpr_read_b32 v8, a91
  v_mul_f32 v1, v1, v31
  v_mul_f32 v2, v2, v31
  v_mul_f32 v3, v3, v31
  v_mul_f32 v4, v4, v31
  v_mul_f32 v5, v5, v31
  v_mul_f32 v6, v6, v31
  v_mul_f32 v7, v7, v31
  v_mul_f32 v8, v8, v31
  v_accvgpr_write_b32 a72, v1
  v_accvgpr_write_b32 a73, v2
  v_accvgpr_write_b32 a74, v3
  v_accvgpr_write_b32 a75, v4
  v_accvgpr_write_b32 a88, v5
  v_accvgpr_write_b32 a89, v6
  v_accvgpr_write_b32 a90, v7
  v_accvgpr_write_b32 a91, v8
  v_accvgpr_read_b32 v1, a104
  v_accvgpr_read_b32 v2, a105
  v_accvgpr_read_b32 v3, a106
  v_accvgpr_read_b32 v4, a107
  v_accvgpr_read_b32 v5, a120
  v_accvgpr_read_b32 v6, a121
  v_accvgpr_read_b32 v7, a122
  v_accvgpr_read_b32 v8, a123
  v_mul_f32 v1, v1, v31
  v_mul_f32 v2, v2, v31
  v_mul_f32 v3, v3, v31
  v_mul_f32 v4, v4, v31
  v_mul_f32 v5, v5, v31
  v_mul_f32 v6, v6, v31
  v_mul_f32 v7, v7, v31
  v_mul_f32 v8, v8, v31
  v_accvgpr_write_b32 a104, v1
  v_accvgpr_write_b32 a105, v2
  v_accvgpr_write_b32 a106, v3
  v_accvgpr_write_b32 a107, v4
  v_accvgpr_write_b32 a120, v5
  v_accvgpr_write_b32 a121, v6
  v_accvgpr_write_b32 a122, v7
  v_accvgpr_write_b32 a123, v8
  v_accvgpr_read_b32 v1, a136
  v_accvgpr_read_b32 v2, a137
  v_accvgpr_read_b32 v3, a138
  v_accvgpr_read_b32 v4, a139
  v_accvgpr_read_b32 v5, a152
  v_accvgpr_read_b32 v6, a153
  v_accvgpr_read_b32 v7, a154
  v_accvgpr_read_b32 v8, a155
  v_mul_f32 v1, v1, v31
  v_mul_f32 v2, v2, v31
  v_mul_f32 v3, v3, v31
  v_mul_f32 v4, v4, v31
  v_mul_f32 v5, v5, v31
  v_mul_f32 v6, v6, v31
  v_mul_f32 v7, v7, v31
  v_mul_f32 v8, v8, v31
  v_accvgpr_write_b32 a136, v1
  v_accvgpr_write_b32 a137, v2
  v_accvgpr_write_b32 a138, v3
  v_accvgpr_write_b32 a139, v4
  v_accvgpr_write_b32 a152, v5
  v_accvgpr_write_b32 a153, v6
  v_accvgpr_write_b32 a154, v7
  v_accvgpr_write_b32 a155, v8
  v_accvgpr_read_b32 v1, a168
  v_accvgpr_read_b32 v2, a169
  v_accvgpr_read_b32 v3, a170
  v_accvgpr_read_b32 v4, a171
  v_accvgpr_read_b32 v5, a184
  v_accvgpr_read_b32 v6, a185
  v_accvgpr_read_b32 v7, a186
  v_accvgpr_read_b32 v8, a187
  v_mul_f32 v1, v1, v31
  v_mul_f32 v2, v2, v31
  v_mul_f32 v3, v3, v31
  v_mul_f32 v4, v4, v31
  v_mul_f32 v5, v5, v31
  v_mul_f32 v6, v6, v31
  v_mul_f32 v7, v7, v31
  v_mul_f32 v8, v8, v31
  v_accvgpr_write_b32 a168, v1
  v_accvgpr_write_b32 a169, v2
  v_accvgpr_write_b32 a170, v3
  v_accvgpr_write_b32 a171, v4
  v_accvgpr_write_b32 a184, v5
  v_accvgpr_write_b32 a185, v6
  v_accvgpr_write_b32 a186, v7
  v_accvgpr_write_b32 a187, v8
  v_mov_b32 v31, 1.0
  v_mul_f32 v83, v83, v32
  v_accvgpr_read_b32 v1, a12
  v_accvgpr_read_b32 v2, a13
  v_accvgpr_read_b32 v3, a14
  v_accvgpr_read_b32 v4, a15
  v_accvgpr_read_b32 v5, a28
  v_accvgpr_read_b32 v6, a29
  v_accvgpr_read_b32 v7, a30
  v_accvgpr_read_b32 v8, a31
  v_mul_f32 v1, v1, v32
  v_mul_f32 v2, v2, v32
  v_mul_f32 v3, v3, v32
  v_mul_f32 v4, v4, v32
  v_mul_f32 v5, v5, v32
  v_mul_f32 v6, v6, v32
  v_mul_f32 v7, v7, v32
  v_mul_f32 v8, v8, v32
  v_accvgpr_write_b32 a12, v1
  v_accvgpr_write_b32 a13, v2
  v_accvgpr_write_b32 a14, v3
  v_accvgpr_write_b32 a15, v4
  v_accvgpr_write_b32 a28, v5
  v_accvgpr_write_b32 a29, v6
  v_accvgpr_write_b32 a30, v7
  v_accvgpr_write_b32 a31, v8
  v_accvgpr_read_b32 v1, a44
  v_accvgpr_read_b32 v2, a45
  v_accvgpr_read_b32 v3, a46
  v_accvgpr_read_b32 v4, a47
  v_accvgpr_read_b32 v5, a60
  v_accvgpr_read_b32 v6, a61
  v_accvgpr_read_b32 v7, a62
  v_accvgpr_read_b32 v8, a63
  v_mul_f32 v1, v1, v32
  v_mul_f32 v2, v2, v32
  v_mul_f32 v3, v3, v32
  v_mul_f32 v4, v4, v32
  v_mul_f32 v5, v5, v32
  v_mul_f32 v6, v6, v32
  v_mul_f32 v7, v7, v32
  v_mul_f32 v8, v8, v32
  v_accvgpr_write_b32 a44, v1
  v_accvgpr_write_b32 a45, v2
  v_accvgpr_write_b32 a46, v3
  v_accvgpr_write_b32 a47, v4
  v_accvgpr_write_b32 a60, v5
  v_accvgpr_write_b32 a61, v6
  v_accvgpr_write_b32 a62, v7
  v_accvgpr_write_b32 a63, v8
  v_accvgpr_read_b32 v1, a76
  v_accvgpr_read_b32 v2, a77
  v_accvgpr_read_b32 v3, a78
  v_accvgpr_read_b32 v4, a79
  v_accvgpr_read_b32 v5, a92
  v_accvgpr_read_b32 v6, a93
  v_accvgpr_read_b32 v7, a94
  v_accvgpr_read_b32 v8, a95
  v_mul_f32 v1, v1, v32
  v_mul_f32 v2, v2, v32
  v_mul_f32 v3, v3, v32
  v_mul_f32 v4, v4, v32
  v_mul_f32 v5, v5, v32
  v_mul_f32 v6, v6, v32
  v_mul_f32 v7, v7, v32
  v_mul_f32 v8, v8, v32
  v_accvgpr_write_b32 a76, v1
  v_accvgpr_write_b32 a77, v2
  v_accvgpr_write_b32 a78, v3
  v_accvgpr_write_b32 a79, v4
  v_accvgpr_write_b32 a92, v5
  v_accvgpr_write_b32 a93, v6
  v_accvgpr_write_b32 a94, v7
  v_accvgpr_write_b32 a95, v8
  v_accvgpr_read_b32 v1, a108
  v_accvgpr_read_b32 v2, a109
  v_accvgpr_read_b32 v3, a110
  v_accvgpr_read_b32 v4, a111
  v_accvgpr_read_b32 v5, a124
  v_accvgpr_read_b32 v6, a125
  v_accvgpr_read_b32 v7, a126
  v_accvgpr_read_b32 v8, a127
  v_mul_f32 v1, v1, v32
  v_mul_f32 v2, v2, v32
  v_mul_f32 v3, v3, v32
  v_mul_f32 v4, v4, v32
  v_mul_f32 v5, v5, v32
  v_mul_f32 v6, v6, v32
  v_mul_f32 v7, v7, v32
  v_mul_f32 v8, v8, v32
  v_accvgpr_write_b32 a108, v1
  v_accvgpr_write_b32 a109, v2
  v_accvgpr_write_b32 a110, v3
  v_accvgpr_write_b32 a111, v4
  v_accvgpr_write_b32 a124, v5
  v_accvgpr_write_b32 a125, v6
  v_accvgpr_write_b32 a126, v7
  v_accvgpr_write_b32 a127, v8
  v_accvgpr_read_b32 v1, a140
  v_accvgpr_read_b32 v2, a141
  v_accvgpr_read_b32 v3, a142
  v_accvgpr_read_b32 v4, a143
  v_accvgpr_read_b32 v5, a156
  v_accvgpr_read_b32 v6, a157
  v_accvgpr_read_b32 v7, a158
  v_accvgpr_read_b32 v8, a159
  v_mul_f32 v1, v1, v32
  v_mul_f32 v2, v2, v32
  v_mul_f32 v3, v3, v32
  v_mul_f32 v4, v4, v32
  v_mul_f32 v5, v5, v32
  v_mul_f32 v6, v6, v32
  v_mul_f32 v7, v7, v32
  v_mul_f32 v8, v8, v32
  v_accvgpr_write_b32 a140, v1
  v_accvgpr_write_b32 a141, v2
  v_accvgpr_write_b32 a142, v3
  v_accvgpr_write_b32 a143, v4
  v_accvgpr_write_b32 a156, v5
  v_accvgpr_write_b32 a157, v6
  v_accvgpr_write_b32 a158, v7
  v_accvgpr_write_b32 a159, v8
  v_accvgpr_read_b32 v1, a172
  v_accvgpr_read_b32 v2, a173
  v_accvgpr_read_b32 v3, a174
  v_accvgpr_read_b32 v4, a175
  v_accvgpr_read_b32 v5, a188
  v_accvgpr_read_b32 v6, a189
  v_accvgpr_read_b32 v7, a190
  v_accvgpr_read_b32 v8, a191
  v_mul_f32 v1, v1, v32
  v_mul_f32 v2, v2, v32
  v_mul_f32 v3, v3, v32
  v_mul_f32 v4, v4, v32
  v_mul_f32 v5, v5, v32
  v_mul_f32 v6, v6, v32
  v_mul_f32 v7, v7, v32
  v_mul_f32 v8, v8, v32
  v_accvgpr_write_b32 a172, v1
  v_accvgpr_write_b32 a173, v2
  v_accvgpr_write_b32 a174, v3
  v_accvgpr_write_b32 a175, v4
  v_accvgpr_write_b32 a188, v5
  v_accvgpr_write_b32 a189, v6
  v_accvgpr_write_b32 a190, v7
  v_accvgpr_write_b32 a191, v8
  v_mov_b32 v32, 1.0
  s_mov_b32 s66, 0
  s_nop 1
  s_cmp_eq_u32 s67, 20
  s_cbranch_scc1 RESC_RET_20
  s_cmp_eq_u32 s67, 21
  s_cbranch_scc1 RESC_RET_21
  s_branch RESC_RET_22
.section .rodata,"a"
.p2align 6
.amdhsa_kernel concat_heads__gqa_block_cached__gqa_block_cached__near_ridge_kernel
  .amdhsa_next_free_vgpr 512
  .amdhsa_next_free_sgpr 102
  .amdhsa_accum_offset 256
  .amdhsa_group_segment_fixed_size 0
  .amdhsa_kernarg_size 104
  .amdhsa_user_sgpr_count 2
  .amdhsa_user_sgpr_kernarg_segment_ptr 1
  .amdhsa_system_sgpr_workgroup_id_x 1
.end_amdhsa_kernel
```
